```python
import torch

def _softmax(x, axis=-1):
    return torch.softmax(x, dim=axis)

def _gelu(x):
    return torch.nn.functional.gelu(x, approximate='tanh')

def _silu(x):
    return torch.nn.functional.silu(x)

def _sigmoid(x):
    return torch.sigmoid(x)

def _layernorm(x, axis=-1, eps=1e-05):
    m = x.mean(dim=axis, keepdim=True)
    v = x.var(dim=axis, keepdim=True, unbiased=False)
    return (x - m) / torch.sqrt(v + eps)

def _scatter_add(tgt, idx, src, axis=0):
    return tgt.clone().index_add_(axis, idx, src)

def _segment_sum(src, seg, n):
    out = torch.zeros((n,) + src.shape[1:], dtype=src.dtype)
    return out.index_add_(0, seg, src)

def _pad(x, pw):
    flat = tuple((v for pair in reversed(pw) for v in pair))
    return torch.nn.functional.pad(x, flat)
kernel_name = 'interleave_layers__sliding_block__memory_aug_recurrent_mem_tr__prompt'

def setup_inputs():

    _w = lambda a: (lambda t: t.to(torch.bfloat16) if t.is_floating_point() else t)(torch.as_tensor(a))

    def _A_setup():
        B, S, D = (1, 2048, 448)
        return {'x': _w((lambda *s: torch.randn(*s, dtype=torch.bfloat16) * 0.05)(B, S, D)), 'wqkv': _w((lambda *s: torch.randn(*s, dtype=torch.bfloat16) * 0.05)(D, 3 * D)), 'wo': _w((lambda *s: torch.randn(*s, dtype=torch.bfloat16) * 0.05)(D, D))}
    _A_in = _A_setup()

    def _B_setup():
        B, S, Dm = (1, 2048, 448)
        H, Dh = (16, 256)
        M, seg = (8, 32)
        seg = min(seg, S)
        S = S // seg * seg
        return {'x': _w((lambda *s: torch.randn(*s, dtype=torch.bfloat16) * 0.05)(B, S, Dm)), 'mem0': _w((lambda *s: torch.randn(*s, dtype=torch.bfloat16) * 0.8)(B, M, Dm)), 'Wq': _w((lambda *s: torch.randn(*s, dtype=torch.bfloat16) * 1.6)(Dm, H, Dh) * Dm ** (-0.5)), 'Wk': _w((lambda *s: torch.randn(*s, dtype=torch.bfloat16) * 1.6)(Dm, H, Dh) * Dm ** (-0.5)), 'Wv': _w((lambda *s: torch.randn(*s, dtype=torch.bfloat16) * 0.8)(Dm, H, Dh) * Dm ** (-0.5)), 'Wo': _w((lambda *s: torch.randn(*s, dtype=torch.bfloat16) * 0.8)(H, Dh, Dm) * (H * Dh) ** (-0.5)), 'seg_len': seg}
    _B_in = _B_setup()
    return {'A_x': _A_in['x'], 'A_wqkv': _A_in['wqkv'], 'A_wo': _A_in['wo'], 'B_x': _B_in['x'], 'B_mem0': _B_in['mem0'], 'B_Wq': _B_in['Wq'], 'B_Wk': _B_in['Wk'], 'B_Wv': _B_in['Wv'], 'B_Wo': _B_in['Wo'], 'B_seg_len': _B_in['seg_len']}

def reference(A_x, A_wqkv, A_wo, B_x, B_mem0, B_Wq, B_Wk, B_Wv, B_Wo, B_seg_len):

    def _A_ref(x, wqkv, wo):
        B, S, D = x.shape
        H = 16
        Dh = D // H
        W = 256
        qkv = (lambda x, *d: x.permute(*d))((x @ wqkv).reshape(B, S, 3, H, Dh), 2, 0, 3, 1, 4)
        q, k, v = (qkv[0], qkv[1], qkv[2])
        scores = torch.einsum('bhqd,bhkd->bhqk', q, k) * Dh ** (-0.5)
        idx = torch.arange(S)
        mask = (idx[:, None] - idx[None, :] >= 0) & (idx[:, None] - idx[None, :] < W)
        scores = torch.where(mask[None, None], scores, -1000000000.0)
        p = _softmax(scores, axis=-1)
        o = torch.einsum('bhqk,bhkd->bhqd', p, v)
        return (lambda x, *d: x.permute(*d))(o, 0, 2, 1, 3).reshape(B, S, D) @ wo

    def _B_ref(x, mem0, Wq, Wk, Wv, Wo, seg_len):
        B, S, Dm = x.shape
        H, Dh = (Wq.shape[1], Wq.shape[2])
        M = mem0.shape[1]
        scale = Dh ** (-0.5)
        n_seg = S // seg_len
        L = M + seg_len
        idx = torch.arange(L)
        mask = (idx[:, None] < M) | (idx[:, None] >= idx[None, :])
        mem = mem0
        outs = []
        for s in range(n_seg):
            xs = x[:, s * seg_len:(s + 1) * seg_len, :].clone()
            h = torch.concatenate([mem, xs], axis=1)
            q = torch.einsum('btd,dhe->bhte', h, Wq)
            k = torch.einsum('btd,dhe->bhte', h, Wk)
            v = torch.einsum('btd,dhe->bhte', h, Wv)
            scores = torch.einsum('bhqe,bhke->bhqk', q, k) * scale
            scores = torch.where(mask[None, None], scores, -1000000000.0)
            p = _softmax(scores, axis=-1)
            o = torch.einsum('bhqk,bhke->bhqe', p, v)
            o = torch.einsum('bhte,hed->btd', o, Wo)
            mem = o[:, :M, :].clone()
            outs.append(o[:, M:, :])
        return torch.concatenate(outs, axis=1)
    x = A_x
    x = x + _A_ref(_layernorm(x, axis=-1), A_wqkv, A_wo)
    x = x + _B_ref(_layernorm(x, axis=-1), B_mem0, B_Wq, B_Wk, B_Wv, B_Wo, B_seg_len)
    x = x + _A_ref(_layernorm(x, axis=-1), A_wqkv, A_wo)
    x = x + _B_ref(_layernorm(x, axis=-1), B_mem0, B_Wq, B_Wk, B_Wv, B_Wo, B_seg_len)
    return x
```

```asm
; @launch kernel=k1_kernel grid=(2767,1,1) block=(256,1,1) lds=73728
; @launch kernel=k2_kernel grid=(192,1,1) block=(256,1,1) lds=29184
; @launch kernel=k3_kernel grid=(736,1,1) block=(256,1,1) lds=73728
; @launch kernel=k4_kernel grid=(128,1,1) block=(256,1,1) lds=1024
; @launch kernel=mega_kernel grid=(256,1,1) block=(256,1,1) lds=155648
.amdgcn_target "amdgcn-amd-amdhsa--gfx950"
.text
.globl k1_kernel
.p2align 8
.type k1_kernel,@function
k1_kernel:
    s_cmp_ge_u32 s2, 224
    s_cbranch_scc1 k1_prep
g1g_start:
    s_load_dwordx4 s[4:7], s[0:1], 40
    s_load_dwordx2 s[12:13], s[0:1], 56
    s_load_dwordx2 s[14:15], s[0:1], 96
    v_and_b32 v1, 63, v0
    v_lshrrev_b32 v2, 6, v0
    s_nop 0
    v_readfirstlane_b32 s3, v2
    v_and_b32 v2, 15, v1
    v_lshrrev_b32 v3, 4, v1
    s_mul_hi_u32 s26, s2, 306783379
    s_mul_i32 s27, s26, 14
    s_sub_u32 s27, s2, s27
    s_and_b32 s28, s27, 1
    s_lshr_b32 s27, s27, 1
    s_waitcnt lgkmcnt(0)
    s_mov_b32 s20, s14
    s_and_b32 s21, s15, 0xffff
    s_mov_b32 s22, 268435456
    s_mov_b32 s23, 0x20000
    s_mov_b32 s8, s4
    s_and_b32 s9, s5, 0xffff
    s_mov_b32 s10, 3670016
    s_mov_b32 s11, 0x20000
    s_mov_b32 s16, s6
    s_and_b32 s17, s7, 0xffff
    s_mov_b32 s18, 3670016
    s_mov_b32 s19, 0x20000
    s_lshl_b32 s30, s26, 9
    s_mov_b32 s31, 0x3d800000
    v_lshrrev_b32 v4, 3, v1
    v_and_b32 v5, 7, v1
    v_xor_b32 v5, v5, v4
    v_lshlrev_b32 v5, 4, v5
    v_lshl_add_u32 v6, v4, 13, v5
    v_mul_u32_u24 v7, 8192, v4
    v_add_u32 v7, v7, v5
    s_lshl_b32 s32, s27, 6
    s_lshl_b32 s33, s3, 4
    s_add_u32 s32, s32, s33
    s_lshl_b32 s32, s32, 13
    s_lshl_b32 s33, s26, 9
    s_add_u32 s32, s32, s33
    s_mul_i32 s33, s28, 224
    s_mul_i32 s29, s3, 56
    s_add_u32 s33, s33, s29
    s_mul_i32 s33, s33, 8192
    s_add_u32 s33, s33, s30
    s_lshl_b32 s34, s3, 11
    s_mul_i32 s35, s3, 7168
    s_add_u32 s35, s35, 8192
    v_and_b32 v8, 7, v2
    v_xor_b32 v9, v3, v8
    v_lshlrev_b32 v9, 4, v9
    v_lshl_add_u32 v9, v2, 7, v9
    v_add_u32 v10, 4, v3
    v_xor_b32 v10, v10, v8
    v_lshlrev_b32 v10, 4, v10
    v_lshl_add_u32 v10, v2, 7, v10
    s_and_b32 s38, s3, 1
    s_mul_i32 s38, s38, 14336
    s_add_u32 s38, s38, 8192
    v_add_u32 v11, s38, v9
    v_add_u32 v12, s38, v10
    s_lshr_b32 s38, s3, 1
    s_lshl_b32 s38, s38, 12
    v_add_u32 v9, s38, v9
    v_add_u32 v10, s38, v10
    s_add_u32 s36, s34, 0
    s_mov_b32 m0, s36
    s_add_u32 s37, s32, 0
    buffer_load_dwordx4 v6, s[8:11], s37 offen lds
    s_add_u32 s36, s34, 1024
    s_mov_b32 m0, s36
    s_add_u32 s37, s32, 65536
    buffer_load_dwordx4 v6, s[8:11], s37 offen lds
    s_add_u32 s36, s35, 0
    s_mov_b32 m0, s36
    s_add_u32 s37, s33, 0
    buffer_load_dwordx4 v7, s[16:19], s37 offen lds
    s_add_u32 s36, s35, 1024
    s_mov_b32 m0, s36
    s_add_u32 s37, s33, 65536
    buffer_load_dwordx4 v7, s[16:19], s37 offen lds
    s_add_u32 s36, s35, 2048
    s_mov_b32 m0, s36
    s_add_u32 s37, s33, 131072
    buffer_load_dwordx4 v7, s[16:19], s37 offen lds
    s_add_u32 s36, s35, 3072
    s_mov_b32 m0, s36
    s_add_u32 s37, s33, 196608
    buffer_load_dwordx4 v7, s[16:19], s37 offen lds
    s_add_u32 s36, s35, 4096
    s_mov_b32 m0, s36
    s_add_u32 s37, s33, 262144
    buffer_load_dwordx4 v7, s[16:19], s37 offen lds
    s_add_u32 s36, s35, 5120
    s_mov_b32 m0, s36
    s_add_u32 s37, s33, 327680
    buffer_load_dwordx4 v7, s[16:19], s37 offen lds
    s_add_u32 s36, s35, 6144
    s_mov_b32 m0, s36
    s_add_u32 s37, s33, 393216
    buffer_load_dwordx4 v7, s[16:19], s37 offen lds
    s_add_u32 s36, s34, 36864
    s_mov_b32 m0, s36
    s_add_u32 s37, s32, 128
    buffer_load_dwordx4 v6, s[8:11], s37 offen lds
    s_add_u32 s36, s34, 37888
    s_mov_b32 m0, s36
    s_add_u32 s37, s32, 65664
    buffer_load_dwordx4 v6, s[8:11], s37 offen lds
    s_add_u32 s36, s35, 36864
    s_mov_b32 m0, s36
    s_add_u32 s37, s33, 128
    buffer_load_dwordx4 v7, s[16:19], s37 offen lds
    s_add_u32 s36, s35, 37888
    s_mov_b32 m0, s36
    s_add_u32 s37, s33, 65664
    buffer_load_dwordx4 v7, s[16:19], s37 offen lds
    s_add_u32 s36, s35, 38912
    s_mov_b32 m0, s36
    s_add_u32 s37, s33, 131200
    buffer_load_dwordx4 v7, s[16:19], s37 offen lds
    s_add_u32 s36, s35, 39936
    s_mov_b32 m0, s36
    s_add_u32 s37, s33, 196736
    buffer_load_dwordx4 v7, s[16:19], s37 offen lds
    s_add_u32 s36, s35, 40960
    s_mov_b32 m0, s36
    s_add_u32 s37, s33, 262272
    buffer_load_dwordx4 v7, s[16:19], s37 offen lds
    s_add_u32 s36, s35, 41984
    s_mov_b32 m0, s36
    s_add_u32 s37, s33, 327808
    buffer_load_dwordx4 v7, s[16:19], s37 offen lds
    s_add_u32 s36, s35, 43008
    s_mov_b32 m0, s36
    s_add_u32 s37, s33, 393344
    buffer_load_dwordx4 v7, s[16:19], s37 offen lds
    s_waitcnt vmcnt(9)
    s_barrier
    ds_read_b128 v[72:75], v9 offset:0
    ds_read_b128 v[76:79], v9 offset:2048
    ds_read_b128 v[88:91], v11 offset:0
    ds_read_b128 v[92:95], v11 offset:2048
    ds_read_b128 v[96:99], v11 offset:4096
    ds_read_b128 v[100:103], v11 offset:6144
    ds_read_b128 v[104:107], v11 offset:8192
    ds_read_b128 v[108:111], v11 offset:10240
    ds_read_b128 v[112:115], v11 offset:12288
    ds_read_b128 v[80:83], v10 offset:0
    ds_read_b128 v[84:87], v10 offset:2048
    ds_read_b128 v[116:119], v12 offset:0
    ds_read_b128 v[120:123], v12 offset:2048
    ds_read_b128 v[124:127], v12 offset:4096
    ds_read_b128 v[128:131], v12 offset:6144
    ds_read_b128 v[132:135], v12 offset:8192
    ds_read_b128 v[136:139], v12 offset:10240
    ds_read_b128 v[140:143], v12 offset:12288
    s_waitcnt lgkmcnt(0)
    s_barrier
    s_add_u32 s36, s34, 0
    s_mov_b32 m0, s36
    s_add_u32 s37, s32, 256
    buffer_load_dwordx4 v6, s[8:11], s37 offen lds
    s_add_u32 s36, s34, 1024
    s_mov_b32 m0, s36
    s_add_u32 s37, s32, 65792
    buffer_load_dwordx4 v6, s[8:11], s37 offen lds
    s_add_u32 s36, s35, 0
    s_mov_b32 m0, s36
    s_add_u32 s37, s33, 256
    buffer_load_dwordx4 v7, s[16:19], s37 offen lds
    s_add_u32 s36, s35, 1024
    s_mov_b32 m0, s36
    s_add_u32 s37, s33, 65792
    buffer_load_dwordx4 v7, s[16:19], s37 offen lds
    s_add_u32 s36, s35, 2048
    s_mov_b32 m0, s36
    s_add_u32 s37, s33, 131328
    buffer_load_dwordx4 v7, s[16:19], s37 offen lds
    s_add_u32 s36, s35, 3072
    s_mov_b32 m0, s36
    s_add_u32 s37, s33, 196864
    buffer_load_dwordx4 v7, s[16:19], s37 offen lds
    s_add_u32 s36, s35, 4096
    s_mov_b32 m0, s36
    s_add_u32 s37, s33, 262400
    buffer_load_dwordx4 v7, s[16:19], s37 offen lds
    s_add_u32 s36, s35, 5120
    s_mov_b32 m0, s36
    s_add_u32 s37, s33, 327936
    buffer_load_dwordx4 v7, s[16:19], s37 offen lds
    s_add_u32 s36, s35, 6144
    s_mov_b32 m0, s36
    s_add_u32 s37, s33, 393472
    buffer_load_dwordx4 v7, s[16:19], s37 offen lds
    v_mfma_f32_16x16x32_bf16 v[16:19], v[72:75], v[88:91], 0
    v_mfma_f32_16x16x32_bf16 v[20:23], v[72:75], v[92:95], 0
    v_mfma_f32_16x16x32_bf16 v[24:27], v[72:75], v[96:99], 0
    v_mfma_f32_16x16x32_bf16 v[28:31], v[72:75], v[100:103], 0
    v_mfma_f32_16x16x32_bf16 v[32:35], v[72:75], v[104:107], 0
    v_mfma_f32_16x16x32_bf16 v[36:39], v[72:75], v[108:111], 0
    v_mfma_f32_16x16x32_bf16 v[40:43], v[72:75], v[112:115], 0
    v_mfma_f32_16x16x32_bf16 v[44:47], v[76:79], v[88:91], 0
    v_mfma_f32_16x16x32_bf16 v[48:51], v[76:79], v[92:95], 0
    v_mfma_f32_16x16x32_bf16 v[52:55], v[76:79], v[96:99], 0
    v_mfma_f32_16x16x32_bf16 v[56:59], v[76:79], v[100:103], 0
    v_mfma_f32_16x16x32_bf16 v[60:63], v[76:79], v[104:107], 0
    v_mfma_f32_16x16x32_bf16 v[64:67], v[76:79], v[108:111], 0
    v_mfma_f32_16x16x32_bf16 v[68:71], v[76:79], v[112:115], 0
    v_mfma_f32_16x16x32_bf16 v[16:19], v[80:83], v[116:119], v[16:19]
    v_mfma_f32_16x16x32_bf16 v[20:23], v[80:83], v[120:123], v[20:23]
    v_mfma_f32_16x16x32_bf16 v[24:27], v[80:83], v[124:127], v[24:27]
    v_mfma_f32_16x16x32_bf16 v[28:31], v[80:83], v[128:131], v[28:31]
    v_mfma_f32_16x16x32_bf16 v[32:35], v[80:83], v[132:135], v[32:35]
    v_mfma_f32_16x16x32_bf16 v[36:39], v[80:83], v[136:139], v[36:39]
    v_mfma_f32_16x16x32_bf16 v[40:43], v[80:83], v[140:143], v[40:43]
    v_mfma_f32_16x16x32_bf16 v[44:47], v[84:87], v[116:119], v[44:47]
    v_mfma_f32_16x16x32_bf16 v[48:51], v[84:87], v[120:123], v[48:51]
    v_mfma_f32_16x16x32_bf16 v[52:55], v[84:87], v[124:127], v[52:55]
    v_mfma_f32_16x16x32_bf16 v[56:59], v[84:87], v[128:131], v[56:59]
    v_mfma_f32_16x16x32_bf16 v[60:63], v[84:87], v[132:135], v[60:63]
    v_mfma_f32_16x16x32_bf16 v[64:67], v[84:87], v[136:139], v[64:67]
    v_mfma_f32_16x16x32_bf16 v[68:71], v[84:87], v[140:143], v[68:71]
    s_waitcnt vmcnt(9)
    s_barrier
    ds_read_b128 v[72:75], v9 offset:36864
    ds_read_b128 v[76:79], v9 offset:38912
    ds_read_b128 v[88:91], v11 offset:36864
    ds_read_b128 v[92:95], v11 offset:38912
    ds_read_b128 v[96:99], v11 offset:40960
    ds_read_b128 v[100:103], v11 offset:43008
    ds_read_b128 v[104:107], v11 offset:45056
    ds_read_b128 v[108:111], v11 offset:47104
    ds_read_b128 v[112:115], v11 offset:49152
    ds_read_b128 v[80:83], v10 offset:36864
    ds_read_b128 v[84:87], v10 offset:38912
    ds_read_b128 v[116:119], v12 offset:36864
    ds_read_b128 v[120:123], v12 offset:38912
    ds_read_b128 v[124:127], v12 offset:40960
    ds_read_b128 v[128:131], v12 offset:43008
    ds_read_b128 v[132:135], v12 offset:45056
    ds_read_b128 v[136:139], v12 offset:47104
    ds_read_b128 v[140:143], v12 offset:49152
    s_waitcnt lgkmcnt(0)
    s_barrier
    s_add_u32 s36, s34, 36864
    s_mov_b32 m0, s36
    s_add_u32 s37, s32, 384
    buffer_load_dwordx4 v6, s[8:11], s37 offen lds
    s_add_u32 s36, s34, 37888
    s_mov_b32 m0, s36
    s_add_u32 s37, s32, 65920
    buffer_load_dwordx4 v6, s[8:11], s37 offen lds
    s_add_u32 s36, s35, 36864
    s_mov_b32 m0, s36
    s_add_u32 s37, s33, 384
    buffer_load_dwordx4 v7, s[16:19], s37 offen lds
    s_add_u32 s36, s35, 37888
    s_mov_b32 m0, s36
    s_add_u32 s37, s33, 65920
    buffer_load_dwordx4 v7, s[16:19], s37 offen lds
    s_add_u32 s36, s35, 38912
    s_mov_b32 m0, s36
    s_add_u32 s37, s33, 131456
    buffer_load_dwordx4 v7, s[16:19], s37 offen lds
    s_add_u32 s36, s35, 39936
    s_mov_b32 m0, s36
    s_add_u32 s37, s33, 196992
    buffer_load_dwordx4 v7, s[16:19], s37 offen lds
    s_add_u32 s36, s35, 40960
    s_mov_b32 m0, s36
    s_add_u32 s37, s33, 262528
    buffer_load_dwordx4 v7, s[16:19], s37 offen lds
    s_add_u32 s36, s35, 41984
    s_mov_b32 m0, s36
    s_add_u32 s37, s33, 328064
    buffer_load_dwordx4 v7, s[16:19], s37 offen lds
    s_add_u32 s36, s35, 43008
    s_mov_b32 m0, s36
    s_add_u32 s37, s33, 393600
    buffer_load_dwordx4 v7, s[16:19], s37 offen lds
    v_mfma_f32_16x16x32_bf16 v[16:19], v[72:75], v[88:91], v[16:19]
    v_mfma_f32_16x16x32_bf16 v[20:23], v[72:75], v[92:95], v[20:23]
    v_mfma_f32_16x16x32_bf16 v[24:27], v[72:75], v[96:99], v[24:27]
    v_mfma_f32_16x16x32_bf16 v[28:31], v[72:75], v[100:103], v[28:31]
    v_mfma_f32_16x16x32_bf16 v[32:35], v[72:75], v[104:107], v[32:35]
    v_mfma_f32_16x16x32_bf16 v[36:39], v[72:75], v[108:111], v[36:39]
    v_mfma_f32_16x16x32_bf16 v[40:43], v[72:75], v[112:115], v[40:43]
    v_mfma_f32_16x16x32_bf16 v[44:47], v[76:79], v[88:91], v[44:47]
    v_mfma_f32_16x16x32_bf16 v[48:51], v[76:79], v[92:95], v[48:51]
    v_mfma_f32_16x16x32_bf16 v[52:55], v[76:79], v[96:99], v[52:55]
    v_mfma_f32_16x16x32_bf16 v[56:59], v[76:79], v[100:103], v[56:59]
    v_mfma_f32_16x16x32_bf16 v[60:63], v[76:79], v[104:107], v[60:63]
    v_mfma_f32_16x16x32_bf16 v[64:67], v[76:79], v[108:111], v[64:67]
    v_mfma_f32_16x16x32_bf16 v[68:71], v[76:79], v[112:115], v[68:71]
    v_mfma_f32_16x16x32_bf16 v[16:19], v[80:83], v[116:119], v[16:19]
    v_mfma_f32_16x16x32_bf16 v[20:23], v[80:83], v[120:123], v[20:23]
    v_mfma_f32_16x16x32_bf16 v[24:27], v[80:83], v[124:127], v[24:27]
    v_mfma_f32_16x16x32_bf16 v[28:31], v[80:83], v[128:131], v[28:31]
    v_mfma_f32_16x16x32_bf16 v[32:35], v[80:83], v[132:135], v[32:35]
    v_mfma_f32_16x16x32_bf16 v[36:39], v[80:83], v[136:139], v[36:39]
    v_mfma_f32_16x16x32_bf16 v[40:43], v[80:83], v[140:143], v[40:43]
    v_mfma_f32_16x16x32_bf16 v[44:47], v[84:87], v[116:119], v[44:47]
    v_mfma_f32_16x16x32_bf16 v[48:51], v[84:87], v[120:123], v[48:51]
    v_mfma_f32_16x16x32_bf16 v[52:55], v[84:87], v[124:127], v[52:55]
    v_mfma_f32_16x16x32_bf16 v[56:59], v[84:87], v[128:131], v[56:59]
    v_mfma_f32_16x16x32_bf16 v[60:63], v[84:87], v[132:135], v[60:63]
    v_mfma_f32_16x16x32_bf16 v[64:67], v[84:87], v[136:139], v[64:67]
    v_mfma_f32_16x16x32_bf16 v[68:71], v[84:87], v[140:143], v[68:71]
    s_waitcnt vmcnt(9)
    s_barrier
    ds_read_b128 v[72:75], v9 offset:0
    ds_read_b128 v[76:79], v9 offset:2048
    ds_read_b128 v[88:91], v11 offset:0
    ds_read_b128 v[92:95], v11 offset:2048
    ds_read_b128 v[96:99], v11 offset:4096
    ds_read_b128 v[100:103], v11 offset:6144
    ds_read_b128 v[104:107], v11 offset:8192
    ds_read_b128 v[108:111], v11 offset:10240
    ds_read_b128 v[112:115], v11 offset:12288
    ds_read_b128 v[80:83], v10 offset:0
    ds_read_b128 v[84:87], v10 offset:2048
    ds_read_b128 v[116:119], v12 offset:0
    ds_read_b128 v[120:123], v12 offset:2048
    ds_read_b128 v[124:127], v12 offset:4096
    ds_read_b128 v[128:131], v12 offset:6144
    ds_read_b128 v[132:135], v12 offset:8192
    ds_read_b128 v[136:139], v12 offset:10240
    ds_read_b128 v[140:143], v12 offset:12288
    s_waitcnt lgkmcnt(0)
    s_barrier
    v_mfma_f32_16x16x32_bf16 v[16:19], v[72:75], v[88:91], v[16:19]
    v_mfma_f32_16x16x32_bf16 v[20:23], v[72:75], v[92:95], v[20:23]
    v_mfma_f32_16x16x32_bf16 v[24:27], v[72:75], v[96:99], v[24:27]
    v_mfma_f32_16x16x32_bf16 v[28:31], v[72:75], v[100:103], v[28:31]
    v_mfma_f32_16x16x32_bf16 v[32:35], v[72:75], v[104:107], v[32:35]
    v_mfma_f32_16x16x32_bf16 v[36:39], v[72:75], v[108:111], v[36:39]
    v_mfma_f32_16x16x32_bf16 v[40:43], v[72:75], v[112:115], v[40:43]
    v_mfma_f32_16x16x32_bf16 v[44:47], v[76:79], v[88:91], v[44:47]
    v_mfma_f32_16x16x32_bf16 v[48:51], v[76:79], v[92:95], v[48:51]
    v_mfma_f32_16x16x32_bf16 v[52:55], v[76:79], v[96:99], v[52:55]
    v_mfma_f32_16x16x32_bf16 v[56:59], v[76:79], v[100:103], v[56:59]
    v_mfma_f32_16x16x32_bf16 v[60:63], v[76:79], v[104:107], v[60:63]
    v_mfma_f32_16x16x32_bf16 v[64:67], v[76:79], v[108:111], v[64:67]
    v_mfma_f32_16x16x32_bf16 v[68:71], v[76:79], v[112:115], v[68:71]
    v_mfma_f32_16x16x32_bf16 v[16:19], v[80:83], v[116:119], v[16:19]
    v_mfma_f32_16x16x32_bf16 v[20:23], v[80:83], v[120:123], v[20:23]
    v_mfma_f32_16x16x32_bf16 v[24:27], v[80:83], v[124:127], v[24:27]
    v_mfma_f32_16x16x32_bf16 v[28:31], v[80:83], v[128:131], v[28:31]
    v_mfma_f32_16x16x32_bf16 v[32:35], v[80:83], v[132:135], v[32:35]
    v_mfma_f32_16x16x32_bf16 v[36:39], v[80:83], v[136:139], v[36:39]
    v_mfma_f32_16x16x32_bf16 v[40:43], v[80:83], v[140:143], v[40:43]
    v_mfma_f32_16x16x32_bf16 v[44:47], v[84:87], v[116:119], v[44:47]
    v_mfma_f32_16x16x32_bf16 v[48:51], v[84:87], v[120:123], v[48:51]
    v_mfma_f32_16x16x32_bf16 v[52:55], v[84:87], v[124:127], v[52:55]
    v_mfma_f32_16x16x32_bf16 v[56:59], v[84:87], v[128:131], v[56:59]
    v_mfma_f32_16x16x32_bf16 v[60:63], v[84:87], v[132:135], v[60:63]
    v_mfma_f32_16x16x32_bf16 v[64:67], v[84:87], v[136:139], v[64:67]
    v_mfma_f32_16x16x32_bf16 v[68:71], v[84:87], v[140:143], v[68:71]
    s_waitcnt vmcnt(0)
    s_barrier
    ds_read_b128 v[72:75], v9 offset:36864
    ds_read_b128 v[76:79], v9 offset:38912
    ds_read_b128 v[88:91], v11 offset:36864
    ds_read_b128 v[92:95], v11 offset:38912
    ds_read_b128 v[96:99], v11 offset:40960
    ds_read_b128 v[100:103], v11 offset:43008
    ds_read_b128 v[104:107], v11 offset:45056
    ds_read_b128 v[108:111], v11 offset:47104
    ds_read_b128 v[112:115], v11 offset:49152
    ds_read_b128 v[80:83], v10 offset:36864
    ds_read_b128 v[84:87], v10 offset:38912
    ds_read_b128 v[116:119], v12 offset:36864
    ds_read_b128 v[120:123], v12 offset:38912
    ds_read_b128 v[124:127], v12 offset:40960
    ds_read_b128 v[128:131], v12 offset:43008
    ds_read_b128 v[132:135], v12 offset:45056
    ds_read_b128 v[136:139], v12 offset:47104
    ds_read_b128 v[140:143], v12 offset:49152
    s_waitcnt lgkmcnt(0)
    s_barrier
    v_mfma_f32_16x16x32_bf16 v[16:19], v[72:75], v[88:91], v[16:19]
    v_mfma_f32_16x16x32_bf16 v[20:23], v[72:75], v[92:95], v[20:23]
    v_mfma_f32_16x16x32_bf16 v[24:27], v[72:75], v[96:99], v[24:27]
    v_mfma_f32_16x16x32_bf16 v[28:31], v[72:75], v[100:103], v[28:31]
    v_mfma_f32_16x16x32_bf16 v[32:35], v[72:75], v[104:107], v[32:35]
    v_mfma_f32_16x16x32_bf16 v[36:39], v[72:75], v[108:111], v[36:39]
    v_mfma_f32_16x16x32_bf16 v[40:43], v[72:75], v[112:115], v[40:43]
    v_mfma_f32_16x16x32_bf16 v[44:47], v[76:79], v[88:91], v[44:47]
    v_mfma_f32_16x16x32_bf16 v[48:51], v[76:79], v[92:95], v[48:51]
    v_mfma_f32_16x16x32_bf16 v[52:55], v[76:79], v[96:99], v[52:55]
    v_mfma_f32_16x16x32_bf16 v[56:59], v[76:79], v[100:103], v[56:59]
    v_mfma_f32_16x16x32_bf16 v[60:63], v[76:79], v[104:107], v[60:63]
    v_mfma_f32_16x16x32_bf16 v[64:67], v[76:79], v[108:111], v[64:67]
    v_mfma_f32_16x16x32_bf16 v[68:71], v[76:79], v[112:115], v[68:71]
    v_mfma_f32_16x16x32_bf16 v[16:19], v[80:83], v[116:119], v[16:19]
    v_mfma_f32_16x16x32_bf16 v[20:23], v[80:83], v[120:123], v[20:23]
    v_mfma_f32_16x16x32_bf16 v[24:27], v[80:83], v[124:127], v[24:27]
    v_mfma_f32_16x16x32_bf16 v[28:31], v[80:83], v[128:131], v[28:31]
    v_mfma_f32_16x16x32_bf16 v[32:35], v[80:83], v[132:135], v[32:35]
    v_mfma_f32_16x16x32_bf16 v[36:39], v[80:83], v[136:139], v[36:39]
    v_mfma_f32_16x16x32_bf16 v[40:43], v[80:83], v[140:143], v[40:43]
    v_mfma_f32_16x16x32_bf16 v[44:47], v[84:87], v[116:119], v[44:47]
    v_mfma_f32_16x16x32_bf16 v[48:51], v[84:87], v[120:123], v[48:51]
    v_mfma_f32_16x16x32_bf16 v[52:55], v[84:87], v[124:127], v[52:55]
    v_mfma_f32_16x16x32_bf16 v[56:59], v[84:87], v[128:131], v[56:59]
    v_mfma_f32_16x16x32_bf16 v[60:63], v[84:87], v[132:135], v[60:63]
    v_mfma_f32_16x16x32_bf16 v[64:67], v[84:87], v[136:139], v[64:67]
    v_mfma_f32_16x16x32_bf16 v[68:71], v[84:87], v[140:143], v[68:71]
    s_nop 7
    v_lshrrev_b32 v6, 1, v3
    v_lshlrev_b32 v6, 8, v6
    v_lshl_add_u32 v6, v2, 4, v6
    v_and_b32 v7, 1, v3
    v_lshl_add_u32 v6, v7, 3, v6
    s_add_u32 s40, s26, 0
    s_mul_i32 s40, s40, 28
    s_mul_i32 s41, s28, 14
    s_add_u32 s40, s40, s41
    s_and_b32 s41, s3, 1
    s_mul_i32 s41, s41, 7
    s_add_u32 s40, s40, s41
    s_mul_i32 s40, s40, 14336
    s_lshl_b32 s41, s27, 11
    s_add_u32 s40, s40, s41
    s_lshr_b32 s41, s3, 1
    s_lshl_b32 s41, s41, 10
    s_add_u32 s40, s40, s41
    s_add_u32 s40, s40, 5275648
    v_mul_f32 v16, s31, v16
    v_mul_f32 v17, s31, v17
    v_mul_f32 v18, s31, v18
    v_mul_f32 v19, s31, v19
    v_cvt_pk_bf16_f32 v16, v16, v17
    v_cvt_pk_bf16_f32 v17, v18, v19
    buffer_store_dwordx2 v[16:17], v6, s[20:23], s40 offen offset:0
    v_mul_f32 v44, s31, v44
    v_mul_f32 v45, s31, v45
    v_mul_f32 v46, s31, v46
    v_mul_f32 v47, s31, v47
    v_cvt_pk_bf16_f32 v44, v44, v45
    v_cvt_pk_bf16_f32 v45, v46, v47
    buffer_store_dwordx2 v[44:45], v6, s[20:23], s40 offen offset:512
    s_add_u32 s40, s40, 14336
    v_mul_f32 v20, s31, v20
    v_mul_f32 v21, s31, v21
    v_mul_f32 v22, s31, v22
    v_mul_f32 v23, s31, v23
    v_cvt_pk_bf16_f32 v20, v20, v21
    v_cvt_pk_bf16_f32 v21, v22, v23
    buffer_store_dwordx2 v[20:21], v6, s[20:23], s40 offen offset:0
    v_mul_f32 v48, s31, v48
    v_mul_f32 v49, s31, v49
    v_mul_f32 v50, s31, v50
    v_mul_f32 v51, s31, v51
    v_cvt_pk_bf16_f32 v48, v48, v49
    v_cvt_pk_bf16_f32 v49, v50, v51
    buffer_store_dwordx2 v[48:49], v6, s[20:23], s40 offen offset:512
    s_add_u32 s40, s40, 14336
    v_mul_f32 v24, s31, v24
    v_mul_f32 v25, s31, v25
    v_mul_f32 v26, s31, v26
    v_mul_f32 v27, s31, v27
    v_cvt_pk_bf16_f32 v24, v24, v25
    v_cvt_pk_bf16_f32 v25, v26, v27
    buffer_store_dwordx2 v[24:25], v6, s[20:23], s40 offen offset:0
    v_mul_f32 v52, s31, v52
    v_mul_f32 v53, s31, v53
    v_mul_f32 v54, s31, v54
    v_mul_f32 v55, s31, v55
    v_cvt_pk_bf16_f32 v52, v52, v53
    v_cvt_pk_bf16_f32 v53, v54, v55
    buffer_store_dwordx2 v[52:53], v6, s[20:23], s40 offen offset:512
    s_add_u32 s40, s40, 14336
    v_mul_f32 v28, s31, v28
    v_mul_f32 v29, s31, v29
    v_mul_f32 v30, s31, v30
    v_mul_f32 v31, s31, v31
    v_cvt_pk_bf16_f32 v28, v28, v29
    v_cvt_pk_bf16_f32 v29, v30, v31
    buffer_store_dwordx2 v[28:29], v6, s[20:23], s40 offen offset:0
    v_mul_f32 v56, s31, v56
    v_mul_f32 v57, s31, v57
    v_mul_f32 v58, s31, v58
    v_mul_f32 v59, s31, v59
    v_cvt_pk_bf16_f32 v56, v56, v57
    v_cvt_pk_bf16_f32 v57, v58, v59
    buffer_store_dwordx2 v[56:57], v6, s[20:23], s40 offen offset:512
    s_add_u32 s40, s40, 14336
    v_mul_f32 v32, s31, v32
    v_mul_f32 v33, s31, v33
    v_mul_f32 v34, s31, v34
    v_mul_f32 v35, s31, v35
    v_cvt_pk_bf16_f32 v32, v32, v33
    v_cvt_pk_bf16_f32 v33, v34, v35
    buffer_store_dwordx2 v[32:33], v6, s[20:23], s40 offen offset:0
    v_mul_f32 v60, s31, v60
    v_mul_f32 v61, s31, v61
    v_mul_f32 v62, s31, v62
    v_mul_f32 v63, s31, v63
    v_cvt_pk_bf16_f32 v60, v60, v61
    v_cvt_pk_bf16_f32 v61, v62, v63
    buffer_store_dwordx2 v[60:61], v6, s[20:23], s40 offen offset:512
    s_add_u32 s40, s40, 14336
    v_mul_f32 v36, s31, v36
    v_mul_f32 v37, s31, v37
    v_mul_f32 v38, s31, v38
    v_mul_f32 v39, s31, v39
    v_cvt_pk_bf16_f32 v36, v36, v37
    v_cvt_pk_bf16_f32 v37, v38, v39
    buffer_store_dwordx2 v[36:37], v6, s[20:23], s40 offen offset:0
    v_mul_f32 v64, s31, v64
    v_mul_f32 v65, s31, v65
    v_mul_f32 v66, s31, v66
    v_mul_f32 v67, s31, v67
    v_cvt_pk_bf16_f32 v64, v64, v65
    v_cvt_pk_bf16_f32 v65, v66, v67
    buffer_store_dwordx2 v[64:65], v6, s[20:23], s40 offen offset:512
    s_add_u32 s40, s40, 14336
    v_mul_f32 v40, s31, v40
    v_mul_f32 v41, s31, v41
    v_mul_f32 v42, s31, v42
    v_mul_f32 v43, s31, v43
    v_cvt_pk_bf16_f32 v40, v40, v41
    v_cvt_pk_bf16_f32 v41, v42, v43
    buffer_store_dwordx2 v[40:41], v6, s[20:23], s40 offen offset:0
    v_mul_f32 v68, s31, v68
    v_mul_f32 v69, s31, v69
    v_mul_f32 v70, s31, v70
    v_mul_f32 v71, s31, v71
    v_cvt_pk_bf16_f32 v68, v68, v69
    v_cvt_pk_bf16_f32 v69, v70, v71
    buffer_store_dwordx2 v[68:69], v6, s[20:23], s40 offen offset:512
    s_endpgm
k1_prep:
    s_sub_u32 s2, s2, 224
    s_load_dwordx4 s[4:7], s[0:1], 8
    s_load_dwordx2 s[12:13], s[0:1], 64
    s_load_dwordx2 s[14:15], s[0:1], 96
    s_load_dwordx2 s[16:17], s[0:1], 32
    v_and_b32 v1, 63, v0
    v_lshrrev_b32 v2, 6, v0
    s_nop 0
    v_readfirstlane_b32 s3, v2
    s_waitcnt lgkmcnt(0)
    s_mov_b32 s20, s14
    s_and_b32 s21, s15, 0xffff
    s_mov_b32 s22, 268435456
    s_mov_b32 s23, 0x20000
    s_cmp_ge_u32 s2, 1288
    s_cbranch_scc1 prep_fill
    s_lshl_b32 s24, s2, 2
    s_add_u32 s24, s24, s3
    s_cmp_ge_u32 s24, 1176
    s_cbranch_scc1 prep_jb
    s_mul_hi_u32 s25, s24, 204522253
    s_mul_i32 s26, s25, 21
    s_sub_u32 s26, s24, s26
    s_mov_b32 s27, 2688
    s_mov_b32 s28, 896
    s_mov_b32 s29, 0
    s_mov_b32 s30, 0
    s_mov_b32 s8, s4
    s_and_b32 s9, s5, 0xffff
    s_mov_b32 s10, 1204224
    s_mov_b32 s11, 0x20000
    s_branch prep_common
prep_jb:
    s_cmp_ge_u32 s24, 1568
    s_cbranch_scc1 prep_jc
    s_sub_u32 s24, s24, 1176
    s_mul_hi_u32 s25, s24, 613566757
    s_mul_i32 s26, s25, 7
    s_sub_u32 s26, s24, s26
    s_mov_b32 s27, 896
    s_mov_b32 s28, 896
    s_mov_b32 s29, 1204224
    s_mov_b32 s30, 0
    s_mov_b32 s8, s6
    s_and_b32 s9, s7, 0xffff
    s_mov_b32 s10, 401408
    s_mov_b32 s11, 0x20000
    s_branch prep_common
prep_jc:
    s_sub_u32 s24, s24, 1568
    s_mul_hi_u32 s31, s24, 19173962
    s_mul_i32 s26, s31, 224
    s_sub_u32 s24, s24, s26
    s_mul_hi_u32 s25, s24, 613566757
    s_mul_i32 s26, s25, 7
    s_sub_u32 s26, s24, s26
    s_mov_b32 s27, 896
    s_mov_b32 s28, 512
    s_mul_i32 s30, s31, 229376
    s_add_u32 s29, s30, 1605632
    s_mov_b32 s8, s12
    s_and_b32 s9, s13, 0xffff
    s_mov_b32 s10, 3670016
    s_mov_b32 s11, 0x20000
prep_common:
    s_mul_i32 s32, s25, s27
    s_lshl_b32 s32, s32, 3
    s_add_u32 s32, s32, s30
    s_lshl_b32 s33, s26, 7
    s_add_u32 s32, s32, s33
    v_lshlrev_b32 v3, 1, v1
    buffer_load_ushort v8, v3, s[8:11], s32 offen
    s_add_u32 s32, s32, s27
    buffer_load_ushort v9, v3, s[8:11], s32 offen
    s_add_u32 s32, s32, s27
    buffer_load_ushort v10, v3, s[8:11], s32 offen
    s_add_u32 s32, s32, s27
    buffer_load_ushort v11, v3, s[8:11], s32 offen
    s_add_u32 s32, s32, s27
    buffer_load_ushort v12, v3, s[8:11], s32 offen
    s_add_u32 s32, s32, s27
    buffer_load_ushort v13, v3, s[8:11], s32 offen
    s_add_u32 s32, s32, s27
    buffer_load_ushort v14, v3, s[8:11], s32 offen
    s_add_u32 s32, s32, s27
    buffer_load_ushort v15, v3, s[8:11], s32 offen
    s_lshl_b32 s33, s26, 6
    v_add_u32 v4, s33, v1
    s_cmp_eq_u32 s28, 896
    s_cbranch_scc0 prep_np
    v_lshrrev_b32 v5, 4, v4
    v_mul_u32_u24 v5, 14336, v5
    v_and_b32 v4, 15, v4
    v_lshl_add_u32 v4, v4, 4, v5
    s_lshr_b32 s33, s25, 2
    s_lshl_b32 s33, s33, 10
    s_and_b32 s34, s25, 3
    s_lshl_b32 s34, s34, 8
    s_add_u32 s33, s33, s34
    s_add_u32 s33, s33, s29
    s_branch prep_st
prep_np:
    v_mul_lo_u32 v4, v4, s28
    s_lshl_b32 s33, s25, 4
    s_add_u32 s33, s33, s29
prep_st:
    s_waitcnt vmcnt(0)
    v_lshl_or_b32 v16, v9, 16, v8
    v_lshl_or_b32 v17, v11, 16, v10
    v_lshl_or_b32 v18, v13, 16, v12
    v_lshl_or_b32 v19, v15, 16, v14
    buffer_store_dwordx4 v[16:19], v4, s[20:23], s33 offen
    s_endpgm
prep_fill:
    s_cmp_ge_u32 s2, 1576
    s_cbranch_scc1 prep_sent
    s_sub_u32 s24, s2, 1288
    v_mov_b32 v4, 0
    v_mov_b32 v5, 0
    v_mov_b32 v6, 0
    v_mov_b32 v7, 0
    s_cmp_ge_u32 s24, 256
    s_cbranch_scc0 prep_zpad
    s_sub_u32 s24, s24, 256
    s_lshl_b32 s24, s24, 8
    v_add_u32 v3, s24, v0
    v_lshlrev_b32 v3, 4, v3
    s_mov_b32 s25, 167542784
    buffer_store_dwordx4 v[4:7], v3, s[20:23], s25 offen
    s_endpgm
prep_zpad:
    s_lshl_b32 s24, s24, 8
    v_add_u32 v3, s24, v0
    v_lshlrev_b32 v3, 6, v3
    s_mov_b32 s25, 18120760
    buffer_store_dwordx2 v[4:5], v3, s[20:23], s25 offen
    s_endpgm
prep_sent:
    s_cmp_ge_u32 s2, 2543
    s_cbranch_scc1 prep_end
    s_sub_u32 s24, s2, 1576
    s_lshl_b32 s24, s24, 8
    v_add_u32 v3, s24, v0
    v_lshlrev_b32 v3, 4, v3
    s_mov_b32 s8, s16
    s_and_b32 s9, s17, 0xffff
    s_mov_b32 s10, 7168
    s_mov_b32 s11, 0x20000
    s_mov_b32 s25, 465920
    v_subrev_u32 v4, s25, v3
    v_cmp_le_u32 vcc, s25, v3
    s_nop 1
    v_cndmask_b32 v4, v3, v4, vcc
    v_subrev_u32 v5, s25, v4
    v_cmp_le_u32 vcc, s25, v4
    s_nop 1
    v_cndmask_b32 v4, v4, v5, vcc
    v_subrev_u32 v5, s25, v4
    v_cmp_le_u32 vcc, s25, v4
    s_nop 1
    v_cndmask_b32 v4, v4, v5, vcc
    v_mov_b32 v13, v4
    s_mov_b32 s25, 153391690
    v_lshrrev_b32 v5, 8, v4
    v_mul_hi_u32 v5, v5, s25
    v_mul_u32_u24 v5, 7168, v5
    v_sub_u32 v4, v4, v5
    v_lshrrev_b32 v5, 8, v4
    v_bfe_u32 v6, v4, 5, 3
    v_and_b32 v7, 16, v4
    v_mul_u32_u24 v6, 896, v6
    v_lshl_add_u32 v6, v5, 5, v6
    v_add_u32 v6, v6, v7
    s_mov_b32 s25, 7168
    v_cmp_gt_u32 vcc, s25, v13
    v_mov_b32 v7, 0x7fffffff
    s_nop 0
    v_cndmask_b32 v6, v7, v6, vcc
    buffer_load_dwordx4 v[8:11], v6, s[8:11], 0 offen
    s_mov_b32 s25, 7168
    v_cmp_gt_u32 vcc, s25, v13
    s_mov_b32 s26, 1863680
    v_cmp_gt_u32 s[28:29], s26, v3
    s_and_b64 vcc, vcc, s[28:29]
    v_mov_b32 v12, -1
    s_waitcnt vmcnt(0)
    v_cndmask_b32 v8, v12, v8, vcc
    v_cndmask_b32 v9, v12, v9, vcc
    v_cndmask_b32 v10, v12, v10, vcc
    v_cndmask_b32 v11, v12, v11, vcc
    s_mov_b32 s26, 3960832
    v_cmp_gt_u32 vcc, s26, v3
    s_and_saveexec_b64 s[28:29], vcc
    s_cbranch_execz prep_end
    s_mov_b32 s25, 173965312
    buffer_store_dwordx4 v[8:11], v3, s[20:23], s25 offen
prep_end:
    s_endpgm
.globl k2_kernel
.p2align 8
.type k2_kernel,@function
k2_kernel:
    s_cmp_ge_u32 s2, 192
    s_cbranch_scc0 k2a_go
    s_endpgm
k2a_go:
    s_load_dwordx2 s[12:13], s[0:1], 0
    s_load_dwordx2 s[14:15], s[0:1], 96
    v_and_b32 v1, 63, v0
    v_lshrrev_b32 v2, 6, v0
    s_nop 0
    v_readfirstlane_b32 s3, v2
    v_and_b32 v2, 15, v1
    v_lshrrev_b32 v3, 4, v1
    s_lshr_b32 s24, s2, 6
    s_and_b32 s25, s2, 63
    s_waitcnt lgkmcnt(0)
    s_mov_b32 s20, s14
    s_and_b32 s21, s15, 0xffff
    s_mov_b32 s22, 268435456
    s_mov_b32 s23, 0x20000
    s_mov_b32 s8, s12
    s_and_b32 s9, s13, 0xffff
    s_mov_b32 s10, 1835008
    s_mov_b32 s11, 0x20000
    v_lshrrev_b32 v4, 3, v1
    v_and_b32 v5, 7, v1
    v_mul_u32_u24 v6, 896, v4
    v_lshl_add_u32 v6, v5, 4, v6
    s_lshl_b32 s26, s25, 5
    s_lshl_b32 s27, s3, 3
    s_add_u32 s26, s26, s27
    s_mul_i32 s26, s26, 896
    buffer_load_dwordx4 v[8:11], v6, s[8:11], s26 offen offset:0
    buffer_load_dwordx4 v[12:15], v6, s[8:11], s26 offen offset:128
    buffer_load_dwordx4 v[16:19], v6, s[8:11], s26 offen offset:256
    buffer_load_dwordx4 v[20:23], v6, s[8:11], s26 offen offset:384
    buffer_load_dwordx4 v[24:27], v6, s[8:11], s26 offen offset:512
    buffer_load_dwordx4 v[28:31], v6, s[8:11], s26 offen offset:640
    buffer_load_dwordx4 v[32:35], v6, s[8:11], s26 offen offset:768
    v_lshlrev_b32 v7, 4, v1
    v_add_u32 v96, 4096, v7
    v_add_u32 v97, 8192, v7
    v_add_u32 v98, 12288, v7
    s_mul_i32 s28, s24, 448
    s_mul_i32 s29, s3, 112
    s_add_u32 s28, s28, s29
    s_mul_i32 s28, s28, 896
    s_add_u32 s28, s28, 0
    s_add_u32 s29, s28, 14336
    s_add_u32 s30, s29, 14336
    s_add_u32 s31, s30, 14336
    s_add_u32 s32, s31, 14336
    s_add_u32 s33, s32, 14336
    s_add_u32 s34, s33, 14336
    buffer_load_dwordx4 v[100:103], v7, s[20:23], s28 offen offset:0
    buffer_load_dwordx4 v[104:107], v7, s[20:23], s29 offen offset:0
    buffer_load_dwordx4 v[108:111], v7, s[20:23], s30 offen offset:0
    buffer_load_dwordx4 v[112:115], v7, s[20:23], s31 offen offset:0
    buffer_load_dwordx4 v[116:119], v7, s[20:23], s32 offen offset:0
    buffer_load_dwordx4 v[120:123], v7, s[20:23], s33 offen offset:0
    buffer_load_dwordx4 v[124:127], v7, s[20:23], s34 offen offset:0
    buffer_load_dwordx4 v[128:131], v7, s[20:23], s28 offen offset:1024
    buffer_load_dwordx4 v[132:135], v7, s[20:23], s29 offen offset:1024
    buffer_load_dwordx4 v[136:139], v7, s[20:23], s30 offen offset:1024
    buffer_load_dwordx4 v[140:143], v7, s[20:23], s31 offen offset:1024
    buffer_load_dwordx4 v[144:147], v7, s[20:23], s32 offen offset:1024
    buffer_load_dwordx4 v[148:151], v7, s[20:23], s33 offen offset:1024
    buffer_load_dwordx4 v[152:155], v7, s[20:23], s34 offen offset:1024
    buffer_load_dwordx4 v[156:159], v7, s[20:23], s28 offen offset:2048
    buffer_load_dwordx4 v[160:163], v7, s[20:23], s29 offen offset:2048
    buffer_load_dwordx4 v[164:167], v7, s[20:23], s30 offen offset:2048
    buffer_load_dwordx4 v[168:171], v7, s[20:23], s31 offen offset:2048
    buffer_load_dwordx4 v[172:175], v7, s[20:23], s32 offen offset:2048
    buffer_load_dwordx4 v[176:179], v7, s[20:23], s33 offen offset:2048
    buffer_load_dwordx4 v[180:183], v7, s[20:23], s34 offen offset:2048
    buffer_load_dwordx4 v[184:187], v7, s[20:23], s28 offen offset:3072
    buffer_load_dwordx4 v[188:191], v7, s[20:23], s29 offen offset:3072
    buffer_load_dwordx4 v[192:195], v7, s[20:23], s30 offen offset:3072
    buffer_load_dwordx4 v[196:199], v7, s[20:23], s31 offen offset:3072
    buffer_load_dwordx4 v[200:203], v7, s[20:23], s32 offen offset:3072
    buffer_load_dwordx4 v[204:207], v7, s[20:23], s33 offen offset:3072
    buffer_load_dwordx4 v[208:211], v7, s[20:23], s34 offen offset:3072
    s_waitcnt vmcnt(28)
    v_lshlrev_b32 v40, 16, v8
    v_and_b32 v41, 0xffff0000, v8
    v_lshlrev_b32 v42, 16, v9
    v_and_b32 v43, 0xffff0000, v9
    v_lshlrev_b32 v44, 16, v10
    v_and_b32 v45, 0xffff0000, v10
    v_lshlrev_b32 v46, 16, v11
    v_and_b32 v47, 0xffff0000, v11
    v_lshlrev_b32 v48, 16, v12
    v_and_b32 v49, 0xffff0000, v12
    v_lshlrev_b32 v50, 16, v13
    v_and_b32 v51, 0xffff0000, v13
    v_lshlrev_b32 v52, 16, v14
    v_and_b32 v53, 0xffff0000, v14
    v_lshlrev_b32 v54, 16, v15
    v_and_b32 v55, 0xffff0000, v15
    v_lshlrev_b32 v56, 16, v16
    v_and_b32 v57, 0xffff0000, v16
    v_lshlrev_b32 v58, 16, v17
    v_and_b32 v59, 0xffff0000, v17
    v_lshlrev_b32 v60, 16, v18
    v_and_b32 v61, 0xffff0000, v18
    v_lshlrev_b32 v62, 16, v19
    v_and_b32 v63, 0xffff0000, v19
    v_lshlrev_b32 v64, 16, v20
    v_and_b32 v65, 0xffff0000, v20
    v_lshlrev_b32 v66, 16, v21
    v_and_b32 v67, 0xffff0000, v21
    v_lshlrev_b32 v68, 16, v22
    v_and_b32 v69, 0xffff0000, v22
    v_lshlrev_b32 v70, 16, v23
    v_and_b32 v71, 0xffff0000, v23
    v_lshlrev_b32 v72, 16, v24
    v_and_b32 v73, 0xffff0000, v24
    v_lshlrev_b32 v74, 16, v25
    v_and_b32 v75, 0xffff0000, v25
    v_lshlrev_b32 v76, 16, v26
    v_and_b32 v77, 0xffff0000, v26
    v_lshlrev_b32 v78, 16, v27
    v_and_b32 v79, 0xffff0000, v27
    v_lshlrev_b32 v80, 16, v28
    v_and_b32 v81, 0xffff0000, v28
    v_lshlrev_b32 v82, 16, v29
    v_and_b32 v83, 0xffff0000, v29
    v_lshlrev_b32 v84, 16, v30
    v_and_b32 v85, 0xffff0000, v30
    v_lshlrev_b32 v86, 16, v31
    v_and_b32 v87, 0xffff0000, v31
    v_lshlrev_b32 v88, 16, v32
    v_and_b32 v89, 0xffff0000, v32
    v_lshlrev_b32 v90, 16, v33
    v_and_b32 v91, 0xffff0000, v33
    v_lshlrev_b32 v92, 16, v34
    v_and_b32 v93, 0xffff0000, v34
    v_lshlrev_b32 v94, 16, v35
    v_and_b32 v95, 0xffff0000, v35
    v_add_f32 v36, v40, v41
    v_add_f32 v36, v36, v42
    v_add_f32 v36, v36, v43
    v_add_f32 v36, v36, v44
    v_add_f32 v36, v36, v45
    v_add_f32 v36, v36, v46
    v_add_f32 v36, v36, v47
    v_add_f32 v36, v36, v48
    v_add_f32 v36, v36, v49
    v_add_f32 v36, v36, v50
    v_add_f32 v36, v36, v51
    v_add_f32 v36, v36, v52
    v_add_f32 v36, v36, v53
    v_add_f32 v36, v36, v54
    v_add_f32 v36, v36, v55
    v_add_f32 v36, v36, v56
    v_add_f32 v36, v36, v57
    v_add_f32 v36, v36, v58
    v_add_f32 v36, v36, v59
    v_add_f32 v36, v36, v60
    v_add_f32 v36, v36, v61
    v_add_f32 v36, v36, v62
    v_add_f32 v36, v36, v63
    v_add_f32 v36, v36, v64
    v_add_f32 v36, v36, v65
    v_add_f32 v36, v36, v66
    v_add_f32 v36, v36, v67
    v_add_f32 v36, v36, v68
    v_add_f32 v36, v36, v69
    v_add_f32 v36, v36, v70
    v_add_f32 v36, v36, v71
    v_add_f32 v36, v36, v72
    v_add_f32 v36, v36, v73
    v_add_f32 v36, v36, v74
    v_add_f32 v36, v36, v75
    v_add_f32 v36, v36, v76
    v_add_f32 v36, v36, v77
    v_add_f32 v36, v36, v78
    v_add_f32 v36, v36, v79
    v_add_f32 v36, v36, v80
    v_add_f32 v36, v36, v81
    v_add_f32 v36, v36, v82
    v_add_f32 v36, v36, v83
    v_add_f32 v36, v36, v84
    v_add_f32 v36, v36, v85
    v_add_f32 v36, v36, v86
    v_add_f32 v36, v36, v87
    v_add_f32 v36, v36, v88
    v_add_f32 v36, v36, v89
    v_add_f32 v36, v36, v90
    v_add_f32 v36, v36, v91
    v_add_f32 v36, v36, v92
    v_add_f32 v36, v36, v93
    v_add_f32 v36, v36, v94
    v_add_f32 v36, v36, v95
    s_nop 1
    v_add_f32_dpp v36, v36, v36 quad_perm:[1,0,3,2] row_mask:0xf bank_mask:0xf
    s_nop 1
    v_add_f32_dpp v36, v36, v36 quad_perm:[2,3,0,1] row_mask:0xf bank_mask:0xf
    s_nop 1
    v_add_f32_dpp v36, v36, v36 row_half_mirror row_mask:0xf bank_mask:0xf
    v_mul_f32 v36, 0x3b124925, v36
    v_mov_b32 v37, 0
    v_sub_f32 v38, v40, v36
    v_fmac_f32 v37, v38, v38
    v_sub_f32 v38, v41, v36
    v_fmac_f32 v37, v38, v38
    v_sub_f32 v38, v42, v36
    v_fmac_f32 v37, v38, v38
    v_sub_f32 v38, v43, v36
    v_fmac_f32 v37, v38, v38
    v_sub_f32 v38, v44, v36
    v_fmac_f32 v37, v38, v38
    v_sub_f32 v38, v45, v36
    v_fmac_f32 v37, v38, v38
    v_sub_f32 v38, v46, v36
    v_fmac_f32 v37, v38, v38
    v_sub_f32 v38, v47, v36
    v_fmac_f32 v37, v38, v38
    v_sub_f32 v38, v48, v36
    v_fmac_f32 v37, v38, v38
    v_sub_f32 v38, v49, v36
    v_fmac_f32 v37, v38, v38
    v_sub_f32 v38, v50, v36
    v_fmac_f32 v37, v38, v38
    v_sub_f32 v38, v51, v36
    v_fmac_f32 v37, v38, v38
    v_sub_f32 v38, v52, v36
    v_fmac_f32 v37, v38, v38
    v_sub_f32 v38, v53, v36
    v_fmac_f32 v37, v38, v38
    v_sub_f32 v38, v54, v36
    v_fmac_f32 v37, v38, v38
    v_sub_f32 v38, v55, v36
    v_fmac_f32 v37, v38, v38
    v_sub_f32 v38, v56, v36
    v_fmac_f32 v37, v38, v38
    v_sub_f32 v38, v57, v36
    v_fmac_f32 v37, v38, v38
    v_sub_f32 v38, v58, v36
    v_fmac_f32 v37, v38, v38
    v_sub_f32 v38, v59, v36
    v_fmac_f32 v37, v38, v38
    v_sub_f32 v38, v60, v36
    v_fmac_f32 v37, v38, v38
    v_sub_f32 v38, v61, v36
    v_fmac_f32 v37, v38, v38
    v_sub_f32 v38, v62, v36
    v_fmac_f32 v37, v38, v38
    v_sub_f32 v38, v63, v36
    v_fmac_f32 v37, v38, v38
    v_sub_f32 v38, v64, v36
    v_fmac_f32 v37, v38, v38
    v_sub_f32 v38, v65, v36
    v_fmac_f32 v37, v38, v38
    v_sub_f32 v38, v66, v36
    v_fmac_f32 v37, v38, v38
    v_sub_f32 v38, v67, v36
    v_fmac_f32 v37, v38, v38
    v_sub_f32 v38, v68, v36
    v_fmac_f32 v37, v38, v38
    v_sub_f32 v38, v69, v36
    v_fmac_f32 v37, v38, v38
    v_sub_f32 v38, v70, v36
    v_fmac_f32 v37, v38, v38
    v_sub_f32 v38, v71, v36
    v_fmac_f32 v37, v38, v38
    v_sub_f32 v38, v72, v36
    v_fmac_f32 v37, v38, v38
    v_sub_f32 v38, v73, v36
    v_fmac_f32 v37, v38, v38
    v_sub_f32 v38, v74, v36
    v_fmac_f32 v37, v38, v38
    v_sub_f32 v38, v75, v36
    v_fmac_f32 v37, v38, v38
    v_sub_f32 v38, v76, v36
    v_fmac_f32 v37, v38, v38
    v_sub_f32 v38, v77, v36
    v_fmac_f32 v37, v38, v38
    v_sub_f32 v38, v78, v36
    v_fmac_f32 v37, v38, v38
    v_sub_f32 v38, v79, v36
    v_fmac_f32 v37, v38, v38
    v_sub_f32 v38, v80, v36
    v_fmac_f32 v37, v38, v38
    v_sub_f32 v38, v81, v36
    v_fmac_f32 v37, v38, v38
    v_sub_f32 v38, v82, v36
    v_fmac_f32 v37, v38, v38
    v_sub_f32 v38, v83, v36
    v_fmac_f32 v37, v38, v38
    v_sub_f32 v38, v84, v36
    v_fmac_f32 v37, v38, v38
    v_sub_f32 v38, v85, v36
    v_fmac_f32 v37, v38, v38
    v_sub_f32 v38, v86, v36
    v_fmac_f32 v37, v38, v38
    v_sub_f32 v38, v87, v36
    v_fmac_f32 v37, v38, v38
    v_sub_f32 v38, v88, v36
    v_fmac_f32 v37, v38, v38
    v_sub_f32 v38, v89, v36
    v_fmac_f32 v37, v38, v38
    v_sub_f32 v38, v90, v36
    v_fmac_f32 v37, v38, v38
    v_sub_f32 v38, v91, v36
    v_fmac_f32 v37, v38, v38
    v_sub_f32 v38, v92, v36
    v_fmac_f32 v37, v38, v38
    v_sub_f32 v38, v93, v36
    v_fmac_f32 v37, v38, v38
    v_sub_f32 v38, v94, v36
    v_fmac_f32 v37, v38, v38
    v_sub_f32 v38, v95, v36
    v_fmac_f32 v37, v38, v38
    s_nop 1
    v_add_f32_dpp v37, v37, v37 quad_perm:[1,0,3,2] row_mask:0xf bank_mask:0xf
    s_nop 1
    v_add_f32_dpp v37, v37, v37 quad_perm:[2,3,0,1] row_mask:0xf bank_mask:0xf
    s_nop 1
    v_add_f32_dpp v37, v37, v37 row_half_mirror row_mask:0xf bank_mask:0xf
    v_mul_f32 v37, 0x3b124925, v37
    v_cvt_pk_bf16_f32 v36, v36, v36
    v_and_b32 v36, 0xffff0000, v36
    v_cvt_pk_bf16_f32 v37, v37, v37
    v_and_b32 v37, 0xffff0000, v37
    v_add_f32 v37, 0x3727c5ac, v37
    v_cvt_pk_bf16_f32 v37, v37, v37
    v_and_b32 v37, 0xffff0000, v37
    v_sqrt_f32 v37, v37
    s_nop 0
    v_cvt_pk_bf16_f32 v37, v37, v37
    v_and_b32 v37, 0xffff0000, v37
    v_rcp_f32 v37, v37
    s_nop 0
    v_sub_f32 v40, v40, v36
    v_sub_f32 v41, v41, v36
    v_sub_f32 v42, v42, v36
    v_sub_f32 v43, v43, v36
    v_sub_f32 v44, v44, v36
    v_sub_f32 v45, v45, v36
    v_sub_f32 v46, v46, v36
    v_sub_f32 v47, v47, v36
    v_sub_f32 v48, v48, v36
    v_sub_f32 v49, v49, v36
    v_sub_f32 v50, v50, v36
    v_sub_f32 v51, v51, v36
    v_sub_f32 v52, v52, v36
    v_sub_f32 v53, v53, v36
    v_sub_f32 v54, v54, v36
    v_sub_f32 v55, v55, v36
    v_sub_f32 v56, v56, v36
    v_sub_f32 v57, v57, v36
    v_sub_f32 v58, v58, v36
    v_sub_f32 v59, v59, v36
    v_sub_f32 v60, v60, v36
    v_sub_f32 v61, v61, v36
    v_sub_f32 v62, v62, v36
    v_sub_f32 v63, v63, v36
    v_sub_f32 v64, v64, v36
    v_sub_f32 v65, v65, v36
    v_sub_f32 v66, v66, v36
    v_sub_f32 v67, v67, v36
    v_sub_f32 v68, v68, v36
    v_sub_f32 v69, v69, v36
    v_sub_f32 v70, v70, v36
    v_sub_f32 v71, v71, v36
    v_sub_f32 v72, v72, v36
    v_sub_f32 v73, v73, v36
    v_sub_f32 v74, v74, v36
    v_sub_f32 v75, v75, v36
    v_sub_f32 v76, v76, v36
    v_sub_f32 v77, v77, v36
    v_sub_f32 v78, v78, v36
    v_sub_f32 v79, v79, v36
    v_sub_f32 v80, v80, v36
    v_sub_f32 v81, v81, v36
    v_sub_f32 v82, v82, v36
    v_sub_f32 v83, v83, v36
    v_sub_f32 v84, v84, v36
    v_sub_f32 v85, v85, v36
    v_sub_f32 v86, v86, v36
    v_sub_f32 v87, v87, v36
    v_sub_f32 v88, v88, v36
    v_sub_f32 v89, v89, v36
    v_sub_f32 v90, v90, v36
    v_sub_f32 v91, v91, v36
    v_sub_f32 v92, v92, v36
    v_sub_f32 v93, v93, v36
    v_sub_f32 v94, v94, v36
    v_sub_f32 v95, v95, v36
    v_cvt_pk_bf16_f32 v8, v40, v41
    v_cvt_pk_bf16_f32 v9, v42, v43
    v_cvt_pk_bf16_f32 v10, v44, v45
    v_cvt_pk_bf16_f32 v11, v46, v47
    v_cvt_pk_bf16_f32 v12, v48, v49
    v_cvt_pk_bf16_f32 v13, v50, v51
    v_cvt_pk_bf16_f32 v14, v52, v53
    v_cvt_pk_bf16_f32 v15, v54, v55
    v_cvt_pk_bf16_f32 v16, v56, v57
    v_cvt_pk_bf16_f32 v17, v58, v59
    v_cvt_pk_bf16_f32 v18, v60, v61
    v_cvt_pk_bf16_f32 v19, v62, v63
    v_cvt_pk_bf16_f32 v20, v64, v65
    v_cvt_pk_bf16_f32 v21, v66, v67
    v_cvt_pk_bf16_f32 v22, v68, v69
    v_cvt_pk_bf16_f32 v23, v70, v71
    v_cvt_pk_bf16_f32 v24, v72, v73
    v_cvt_pk_bf16_f32 v25, v74, v75
    v_cvt_pk_bf16_f32 v26, v76, v77
    v_cvt_pk_bf16_f32 v27, v78, v79
    v_cvt_pk_bf16_f32 v28, v80, v81
    v_cvt_pk_bf16_f32 v29, v82, v83
    v_cvt_pk_bf16_f32 v30, v84, v85
    v_cvt_pk_bf16_f32 v31, v86, v87
    v_cvt_pk_bf16_f32 v32, v88, v89
    v_cvt_pk_bf16_f32 v33, v90, v91
    v_cvt_pk_bf16_f32 v34, v92, v93
    v_cvt_pk_bf16_f32 v35, v94, v95
    v_lshlrev_b32 v40, 16, v8
    v_and_b32 v41, 0xffff0000, v8
    v_lshlrev_b32 v42, 16, v9
    v_and_b32 v43, 0xffff0000, v9
    v_lshlrev_b32 v44, 16, v10
    v_and_b32 v45, 0xffff0000, v10
    v_lshlrev_b32 v46, 16, v11
    v_and_b32 v47, 0xffff0000, v11
    v_lshlrev_b32 v48, 16, v12
    v_and_b32 v49, 0xffff0000, v12
    v_lshlrev_b32 v50, 16, v13
    v_and_b32 v51, 0xffff0000, v13
    v_lshlrev_b32 v52, 16, v14
    v_and_b32 v53, 0xffff0000, v14
    v_lshlrev_b32 v54, 16, v15
    v_and_b32 v55, 0xffff0000, v15
    v_lshlrev_b32 v56, 16, v16
    v_and_b32 v57, 0xffff0000, v16
    v_lshlrev_b32 v58, 16, v17
    v_and_b32 v59, 0xffff0000, v17
    v_lshlrev_b32 v60, 16, v18
    v_and_b32 v61, 0xffff0000, v18
    v_lshlrev_b32 v62, 16, v19
    v_and_b32 v63, 0xffff0000, v19
    v_lshlrev_b32 v64, 16, v20
    v_and_b32 v65, 0xffff0000, v20
    v_lshlrev_b32 v66, 16, v21
    v_and_b32 v67, 0xffff0000, v21
    v_lshlrev_b32 v68, 16, v22
    v_and_b32 v69, 0xffff0000, v22
    v_lshlrev_b32 v70, 16, v23
    v_and_b32 v71, 0xffff0000, v23
    v_lshlrev_b32 v72, 16, v24
    v_and_b32 v73, 0xffff0000, v24
    v_lshlrev_b32 v74, 16, v25
    v_and_b32 v75, 0xffff0000, v25
    v_lshlrev_b32 v76, 16, v26
    v_and_b32 v77, 0xffff0000, v26
    v_lshlrev_b32 v78, 16, v27
    v_and_b32 v79, 0xffff0000, v27
    v_lshlrev_b32 v80, 16, v28
    v_and_b32 v81, 0xffff0000, v28
    v_lshlrev_b32 v82, 16, v29
    v_and_b32 v83, 0xffff0000, v29
    v_lshlrev_b32 v84, 16, v30
    v_and_b32 v85, 0xffff0000, v30
    v_lshlrev_b32 v86, 16, v31
    v_and_b32 v87, 0xffff0000, v31
    v_lshlrev_b32 v88, 16, v32
    v_and_b32 v89, 0xffff0000, v32
    v_lshlrev_b32 v90, 16, v33
    v_and_b32 v91, 0xffff0000, v33
    v_lshlrev_b32 v92, 16, v34
    v_and_b32 v93, 0xffff0000, v34
    v_lshlrev_b32 v94, 16, v35
    v_and_b32 v95, 0xffff0000, v35
    v_mul_f32 v40, v40, v37
    v_mul_f32 v41, v41, v37
    v_mul_f32 v42, v42, v37
    v_mul_f32 v43, v43, v37
    v_mul_f32 v44, v44, v37
    v_mul_f32 v45, v45, v37
    v_mul_f32 v46, v46, v37
    v_mul_f32 v47, v47, v37
    v_mul_f32 v48, v48, v37
    v_mul_f32 v49, v49, v37
    v_mul_f32 v50, v50, v37
    v_mul_f32 v51, v51, v37
    v_mul_f32 v52, v52, v37
    v_mul_f32 v53, v53, v37
    v_mul_f32 v54, v54, v37
    v_mul_f32 v55, v55, v37
    v_mul_f32 v56, v56, v37
    v_mul_f32 v57, v57, v37
    v_mul_f32 v58, v58, v37
    v_mul_f32 v59, v59, v37
    v_mul_f32 v60, v60, v37
    v_mul_f32 v61, v61, v37
    v_mul_f32 v62, v62, v37
    v_mul_f32 v63, v63, v37
    v_mul_f32 v64, v64, v37
    v_mul_f32 v65, v65, v37
    v_mul_f32 v66, v66, v37
    v_mul_f32 v67, v67, v37
    v_mul_f32 v68, v68, v37
    v_mul_f32 v69, v69, v37
    v_mul_f32 v70, v70, v37
    v_mul_f32 v71, v71, v37
    v_mul_f32 v72, v72, v37
    v_mul_f32 v73, v73, v37
    v_mul_f32 v74, v74, v37
    v_mul_f32 v75, v75, v37
    v_mul_f32 v76, v76, v37
    v_mul_f32 v77, v77, v37
    v_mul_f32 v78, v78, v37
    v_mul_f32 v79, v79, v37
    v_mul_f32 v80, v80, v37
    v_mul_f32 v81, v81, v37
    v_mul_f32 v82, v82, v37
    v_mul_f32 v83, v83, v37
    v_mul_f32 v84, v84, v37
    v_mul_f32 v85, v85, v37
    v_mul_f32 v86, v86, v37
    v_mul_f32 v87, v87, v37
    v_mul_f32 v88, v88, v37
    v_mul_f32 v89, v89, v37
    v_mul_f32 v90, v90, v37
    v_mul_f32 v91, v91, v37
    v_mul_f32 v92, v92, v37
    v_mul_f32 v93, v93, v37
    v_mul_f32 v94, v94, v37
    v_mul_f32 v95, v95, v37
    v_cvt_pk_bf16_f32 v8, v40, v41
    v_cvt_pk_bf16_f32 v9, v42, v43
    v_cvt_pk_bf16_f32 v10, v44, v45
    v_cvt_pk_bf16_f32 v11, v46, v47
    v_cvt_pk_bf16_f32 v12, v48, v49
    v_cvt_pk_bf16_f32 v13, v50, v51
    v_cvt_pk_bf16_f32 v14, v52, v53
    v_cvt_pk_bf16_f32 v15, v54, v55
    v_cvt_pk_bf16_f32 v16, v56, v57
    v_cvt_pk_bf16_f32 v17, v58, v59
    v_cvt_pk_bf16_f32 v18, v60, v61
    v_cvt_pk_bf16_f32 v19, v62, v63
    v_cvt_pk_bf16_f32 v20, v64, v65
    v_cvt_pk_bf16_f32 v21, v66, v67
    v_cvt_pk_bf16_f32 v22, v68, v69
    v_cvt_pk_bf16_f32 v23, v70, v71
    v_cvt_pk_bf16_f32 v24, v72, v73
    v_cvt_pk_bf16_f32 v25, v74, v75
    v_cvt_pk_bf16_f32 v26, v76, v77
    v_cvt_pk_bf16_f32 v27, v78, v79
    v_cvt_pk_bf16_f32 v28, v80, v81
    v_cvt_pk_bf16_f32 v29, v82, v83
    v_cvt_pk_bf16_f32 v30, v84, v85
    v_cvt_pk_bf16_f32 v31, v86, v87
    v_cvt_pk_bf16_f32 v32, v88, v89
    v_cvt_pk_bf16_f32 v33, v90, v91
    v_cvt_pk_bf16_f32 v34, v92, v93
    v_cvt_pk_bf16_f32 v35, v94, v95
    s_mul_i32 s27, s3, 7296
    v_mul_u32_u24 v6, 912, v4
    v_lshl_add_u32 v6, v5, 4, v6
    v_add_u32 v6, s27, v6
    ds_write_b128 v6, v[8:11] offset:0
    ds_write_b128 v6, v[12:15] offset:128
    ds_write_b128 v6, v[16:19] offset:256
    ds_write_b128 v6, v[20:23] offset:384
    ds_write_b128 v6, v[24:27] offset:512
    ds_write_b128 v6, v[28:31] offset:640
    ds_write_b128 v6, v[32:35] offset:768
    v_mul_u32_u24 v6, 912, v2
    v_lshl_add_u32 v6, v3, 4, v6
    v_add_u32 v5, 14592, v6
    s_waitcnt lgkmcnt(0)
    s_barrier
    s_cmp_eq_u32 s24, 2
    s_cbranch_scc1 k2a_v
    ds_read_b128 v[64:67], v6 offset:0
    ds_read_b128 v[68:71], v5 offset:0
    buffer_load_dwordx4 v[212:215], v96, s[20:23], s28 offen offset:0
    buffer_load_dwordx4 v[216:219], v96, s[20:23], s29 offen offset:0
    buffer_load_dwordx4 v[220:223], v96, s[20:23], s30 offen offset:0
    buffer_load_dwordx4 v[224:227], v96, s[20:23], s31 offen offset:0
    buffer_load_dwordx4 v[228:231], v96, s[20:23], s32 offen offset:0
    buffer_load_dwordx4 v[232:235], v96, s[20:23], s33 offen offset:0
    buffer_load_dwordx4 v[236:239], v96, s[20:23], s34 offen offset:0
    ds_read_b128 v[72:75], v6 offset:64
    ds_read_b128 v[76:79], v5 offset:64
    s_waitcnt vmcnt(28) lgkmcnt(2)
    v_mfma_f32_16x16x32_bf16 v[8:11], v[100:103], v[64:67], 0
    v_mfma_f32_16x16x32_bf16 v[12:15], v[100:103], v[68:71], 0
    v_mfma_f32_16x16x32_bf16 v[16:19], v[104:107], v[64:67], 0
    v_mfma_f32_16x16x32_bf16 v[20:23], v[104:107], v[68:71], 0
    v_mfma_f32_16x16x32_bf16 v[24:27], v[108:111], v[64:67], 0
    v_mfma_f32_16x16x32_bf16 v[28:31], v[108:111], v[68:71], 0
    v_mfma_f32_16x16x32_bf16 v[32:35], v[112:115], v[64:67], 0
    v_mfma_f32_16x16x32_bf16 v[36:39], v[112:115], v[68:71], 0
    v_mfma_f32_16x16x32_bf16 v[40:43], v[116:119], v[64:67], 0
    v_mfma_f32_16x16x32_bf16 v[44:47], v[116:119], v[68:71], 0
    v_mfma_f32_16x16x32_bf16 v[48:51], v[120:123], v[64:67], 0
    v_mfma_f32_16x16x32_bf16 v[52:55], v[120:123], v[68:71], 0
    v_mfma_f32_16x16x32_bf16 v[56:59], v[124:127], v[64:67], 0
    v_mfma_f32_16x16x32_bf16 v[60:63], v[124:127], v[68:71], 0
    buffer_load_dwordx4 v[100:103], v96, s[20:23], s28 offen offset:1024
    buffer_load_dwordx4 v[104:107], v96, s[20:23], s29 offen offset:1024
    buffer_load_dwordx4 v[108:111], v96, s[20:23], s30 offen offset:1024
    buffer_load_dwordx4 v[112:115], v96, s[20:23], s31 offen offset:1024
    buffer_load_dwordx4 v[116:119], v96, s[20:23], s32 offen offset:1024
    buffer_load_dwordx4 v[120:123], v96, s[20:23], s33 offen offset:1024
    buffer_load_dwordx4 v[124:127], v96, s[20:23], s34 offen offset:1024
    ds_read_b128 v[64:67], v6 offset:128
    ds_read_b128 v[68:71], v5 offset:128
    s_waitcnt vmcnt(28) lgkmcnt(2)
    v_mfma_f32_16x16x32_bf16 v[8:11], v[128:131], v[72:75], v[8:11]
    v_mfma_f32_16x16x32_bf16 v[12:15], v[128:131], v[76:79], v[12:15]
    v_mfma_f32_16x16x32_bf16 v[16:19], v[132:135], v[72:75], v[16:19]
    v_mfma_f32_16x16x32_bf16 v[20:23], v[132:135], v[76:79], v[20:23]
    v_mfma_f32_16x16x32_bf16 v[24:27], v[136:139], v[72:75], v[24:27]
    v_mfma_f32_16x16x32_bf16 v[28:31], v[136:139], v[76:79], v[28:31]
    v_mfma_f32_16x16x32_bf16 v[32:35], v[140:143], v[72:75], v[32:35]
    v_mfma_f32_16x16x32_bf16 v[36:39], v[140:143], v[76:79], v[36:39]
    v_mfma_f32_16x16x32_bf16 v[40:43], v[144:147], v[72:75], v[40:43]
    v_mfma_f32_16x16x32_bf16 v[44:47], v[144:147], v[76:79], v[44:47]
    v_mfma_f32_16x16x32_bf16 v[48:51], v[148:151], v[72:75], v[48:51]
    v_mfma_f32_16x16x32_bf16 v[52:55], v[148:151], v[76:79], v[52:55]
    v_mfma_f32_16x16x32_bf16 v[56:59], v[152:155], v[72:75], v[56:59]
    v_mfma_f32_16x16x32_bf16 v[60:63], v[152:155], v[76:79], v[60:63]
    buffer_load_dwordx4 v[128:131], v96, s[20:23], s28 offen offset:2048
    buffer_load_dwordx4 v[132:135], v96, s[20:23], s29 offen offset:2048
    buffer_load_dwordx4 v[136:139], v96, s[20:23], s30 offen offset:2048
    buffer_load_dwordx4 v[140:143], v96, s[20:23], s31 offen offset:2048
    buffer_load_dwordx4 v[144:147], v96, s[20:23], s32 offen offset:2048
    buffer_load_dwordx4 v[148:151], v96, s[20:23], s33 offen offset:2048
    buffer_load_dwordx4 v[152:155], v96, s[20:23], s34 offen offset:2048
    ds_read_b128 v[72:75], v6 offset:192
    ds_read_b128 v[76:79], v5 offset:192
    s_waitcnt vmcnt(28) lgkmcnt(2)
    v_mfma_f32_16x16x32_bf16 v[8:11], v[156:159], v[64:67], v[8:11]
    v_mfma_f32_16x16x32_bf16 v[12:15], v[156:159], v[68:71], v[12:15]
    v_mfma_f32_16x16x32_bf16 v[16:19], v[160:163], v[64:67], v[16:19]
    v_mfma_f32_16x16x32_bf16 v[20:23], v[160:163], v[68:71], v[20:23]
    v_mfma_f32_16x16x32_bf16 v[24:27], v[164:167], v[64:67], v[24:27]
    v_mfma_f32_16x16x32_bf16 v[28:31], v[164:167], v[68:71], v[28:31]
    v_mfma_f32_16x16x32_bf16 v[32:35], v[168:171], v[64:67], v[32:35]
    v_mfma_f32_16x16x32_bf16 v[36:39], v[168:171], v[68:71], v[36:39]
    v_mfma_f32_16x16x32_bf16 v[40:43], v[172:175], v[64:67], v[40:43]
    v_mfma_f32_16x16x32_bf16 v[44:47], v[172:175], v[68:71], v[44:47]
    v_mfma_f32_16x16x32_bf16 v[48:51], v[176:179], v[64:67], v[48:51]
    v_mfma_f32_16x16x32_bf16 v[52:55], v[176:179], v[68:71], v[52:55]
    v_mfma_f32_16x16x32_bf16 v[56:59], v[180:183], v[64:67], v[56:59]
    v_mfma_f32_16x16x32_bf16 v[60:63], v[180:183], v[68:71], v[60:63]
    buffer_load_dwordx4 v[156:159], v96, s[20:23], s28 offen offset:3072
    buffer_load_dwordx4 v[160:163], v96, s[20:23], s29 offen offset:3072
    buffer_load_dwordx4 v[164:167], v96, s[20:23], s30 offen offset:3072
    buffer_load_dwordx4 v[168:171], v96, s[20:23], s31 offen offset:3072
    buffer_load_dwordx4 v[172:175], v96, s[20:23], s32 offen offset:3072
    buffer_load_dwordx4 v[176:179], v96, s[20:23], s33 offen offset:3072
    buffer_load_dwordx4 v[180:183], v96, s[20:23], s34 offen offset:3072
    ds_read_b128 v[64:67], v6 offset:256
    ds_read_b128 v[68:71], v5 offset:256
    s_waitcnt vmcnt(28) lgkmcnt(2)
    v_mfma_f32_16x16x32_bf16 v[8:11], v[184:187], v[72:75], v[8:11]
    v_mfma_f32_16x16x32_bf16 v[12:15], v[184:187], v[76:79], v[12:15]
    v_mfma_f32_16x16x32_bf16 v[16:19], v[188:191], v[72:75], v[16:19]
    v_mfma_f32_16x16x32_bf16 v[20:23], v[188:191], v[76:79], v[20:23]
    v_mfma_f32_16x16x32_bf16 v[24:27], v[192:195], v[72:75], v[24:27]
    v_mfma_f32_16x16x32_bf16 v[28:31], v[192:195], v[76:79], v[28:31]
    v_mfma_f32_16x16x32_bf16 v[32:35], v[196:199], v[72:75], v[32:35]
    v_mfma_f32_16x16x32_bf16 v[36:39], v[196:199], v[76:79], v[36:39]
    v_mfma_f32_16x16x32_bf16 v[40:43], v[200:203], v[72:75], v[40:43]
    v_mfma_f32_16x16x32_bf16 v[44:47], v[200:203], v[76:79], v[44:47]
    v_mfma_f32_16x16x32_bf16 v[48:51], v[204:207], v[72:75], v[48:51]
    v_mfma_f32_16x16x32_bf16 v[52:55], v[204:207], v[76:79], v[52:55]
    v_mfma_f32_16x16x32_bf16 v[56:59], v[208:211], v[72:75], v[56:59]
    v_mfma_f32_16x16x32_bf16 v[60:63], v[208:211], v[76:79], v[60:63]
    buffer_load_dwordx4 v[184:187], v97, s[20:23], s28 offen offset:0
    buffer_load_dwordx4 v[188:191], v97, s[20:23], s29 offen offset:0
    buffer_load_dwordx4 v[192:195], v97, s[20:23], s30 offen offset:0
    buffer_load_dwordx4 v[196:199], v97, s[20:23], s31 offen offset:0
    buffer_load_dwordx4 v[200:203], v97, s[20:23], s32 offen offset:0
    buffer_load_dwordx4 v[204:207], v97, s[20:23], s33 offen offset:0
    buffer_load_dwordx4 v[208:211], v97, s[20:23], s34 offen offset:0
    ds_read_b128 v[72:75], v6 offset:320
    ds_read_b128 v[76:79], v5 offset:320
    s_waitcnt vmcnt(28) lgkmcnt(2)
    v_mfma_f32_16x16x32_bf16 v[8:11], v[212:215], v[64:67], v[8:11]
    v_mfma_f32_16x16x32_bf16 v[12:15], v[212:215], v[68:71], v[12:15]
    v_mfma_f32_16x16x32_bf16 v[16:19], v[216:219], v[64:67], v[16:19]
    v_mfma_f32_16x16x32_bf16 v[20:23], v[216:219], v[68:71], v[20:23]
    v_mfma_f32_16x16x32_bf16 v[24:27], v[220:223], v[64:67], v[24:27]
    v_mfma_f32_16x16x32_bf16 v[28:31], v[220:223], v[68:71], v[28:31]
    v_mfma_f32_16x16x32_bf16 v[32:35], v[224:227], v[64:67], v[32:35]
    v_mfma_f32_16x16x32_bf16 v[36:39], v[224:227], v[68:71], v[36:39]
    v_mfma_f32_16x16x32_bf16 v[40:43], v[228:231], v[64:67], v[40:43]
    v_mfma_f32_16x16x32_bf16 v[44:47], v[228:231], v[68:71], v[44:47]
    v_mfma_f32_16x16x32_bf16 v[48:51], v[232:235], v[64:67], v[48:51]
    v_mfma_f32_16x16x32_bf16 v[52:55], v[232:235], v[68:71], v[52:55]
    v_mfma_f32_16x16x32_bf16 v[56:59], v[236:239], v[64:67], v[56:59]
    v_mfma_f32_16x16x32_bf16 v[60:63], v[236:239], v[68:71], v[60:63]
    buffer_load_dwordx4 v[212:215], v97, s[20:23], s28 offen offset:1024
    buffer_load_dwordx4 v[216:219], v97, s[20:23], s29 offen offset:1024
    buffer_load_dwordx4 v[220:223], v97, s[20:23], s30 offen offset:1024
    buffer_load_dwordx4 v[224:227], v97, s[20:23], s31 offen offset:1024
    buffer_load_dwordx4 v[228:231], v97, s[20:23], s32 offen offset:1024
    buffer_load_dwordx4 v[232:235], v97, s[20:23], s33 offen offset:1024
    buffer_load_dwordx4 v[236:239], v97, s[20:23], s34 offen offset:1024
    ds_read_b128 v[64:67], v6 offset:384
    ds_read_b128 v[68:71], v5 offset:384
    s_waitcnt vmcnt(28) lgkmcnt(2)
    v_mfma_f32_16x16x32_bf16 v[8:11], v[100:103], v[72:75], v[8:11]
    v_mfma_f32_16x16x32_bf16 v[12:15], v[100:103], v[76:79], v[12:15]
    v_mfma_f32_16x16x32_bf16 v[16:19], v[104:107], v[72:75], v[16:19]
    v_mfma_f32_16x16x32_bf16 v[20:23], v[104:107], v[76:79], v[20:23]
    v_mfma_f32_16x16x32_bf16 v[24:27], v[108:111], v[72:75], v[24:27]
    v_mfma_f32_16x16x32_bf16 v[28:31], v[108:111], v[76:79], v[28:31]
    v_mfma_f32_16x16x32_bf16 v[32:35], v[112:115], v[72:75], v[32:35]
    v_mfma_f32_16x16x32_bf16 v[36:39], v[112:115], v[76:79], v[36:39]
    v_mfma_f32_16x16x32_bf16 v[40:43], v[116:119], v[72:75], v[40:43]
    v_mfma_f32_16x16x32_bf16 v[44:47], v[116:119], v[76:79], v[44:47]
    v_mfma_f32_16x16x32_bf16 v[48:51], v[120:123], v[72:75], v[48:51]
    v_mfma_f32_16x16x32_bf16 v[52:55], v[120:123], v[76:79], v[52:55]
    v_mfma_f32_16x16x32_bf16 v[56:59], v[124:127], v[72:75], v[56:59]
    v_mfma_f32_16x16x32_bf16 v[60:63], v[124:127], v[76:79], v[60:63]
    buffer_load_dwordx4 v[100:103], v97, s[20:23], s28 offen offset:2048
    buffer_load_dwordx4 v[104:107], v97, s[20:23], s29 offen offset:2048
    buffer_load_dwordx4 v[108:111], v97, s[20:23], s30 offen offset:2048
    buffer_load_dwordx4 v[112:115], v97, s[20:23], s31 offen offset:2048
    buffer_load_dwordx4 v[116:119], v97, s[20:23], s32 offen offset:2048
    buffer_load_dwordx4 v[120:123], v97, s[20:23], s33 offen offset:2048
    buffer_load_dwordx4 v[124:127], v97, s[20:23], s34 offen offset:2048
    ds_read_b128 v[72:75], v6 offset:448
    ds_read_b128 v[76:79], v5 offset:448
    s_waitcnt vmcnt(28) lgkmcnt(2)
    v_mfma_f32_16x16x32_bf16 v[8:11], v[128:131], v[64:67], v[8:11]
    v_mfma_f32_16x16x32_bf16 v[12:15], v[128:131], v[68:71], v[12:15]
    v_mfma_f32_16x16x32_bf16 v[16:19], v[132:135], v[64:67], v[16:19]
    v_mfma_f32_16x16x32_bf16 v[20:23], v[132:135], v[68:71], v[20:23]
    v_mfma_f32_16x16x32_bf16 v[24:27], v[136:139], v[64:67], v[24:27]
    v_mfma_f32_16x16x32_bf16 v[28:31], v[136:139], v[68:71], v[28:31]
    v_mfma_f32_16x16x32_bf16 v[32:35], v[140:143], v[64:67], v[32:35]
    v_mfma_f32_16x16x32_bf16 v[36:39], v[140:143], v[68:71], v[36:39]
    v_mfma_f32_16x16x32_bf16 v[40:43], v[144:147], v[64:67], v[40:43]
    v_mfma_f32_16x16x32_bf16 v[44:47], v[144:147], v[68:71], v[44:47]
    v_mfma_f32_16x16x32_bf16 v[48:51], v[148:151], v[64:67], v[48:51]
    v_mfma_f32_16x16x32_bf16 v[52:55], v[148:151], v[68:71], v[52:55]
    v_mfma_f32_16x16x32_bf16 v[56:59], v[152:155], v[64:67], v[56:59]
    v_mfma_f32_16x16x32_bf16 v[60:63], v[152:155], v[68:71], v[60:63]
    buffer_load_dwordx4 v[128:131], v97, s[20:23], s28 offen offset:3072
    buffer_load_dwordx4 v[132:135], v97, s[20:23], s29 offen offset:3072
    buffer_load_dwordx4 v[136:139], v97, s[20:23], s30 offen offset:3072
    buffer_load_dwordx4 v[140:143], v97, s[20:23], s31 offen offset:3072
    buffer_load_dwordx4 v[144:147], v97, s[20:23], s32 offen offset:3072
    buffer_load_dwordx4 v[148:151], v97, s[20:23], s33 offen offset:3072
    buffer_load_dwordx4 v[152:155], v97, s[20:23], s34 offen offset:3072
    ds_read_b128 v[64:67], v6 offset:512
    ds_read_b128 v[68:71], v5 offset:512
    s_waitcnt vmcnt(28) lgkmcnt(2)
    v_mfma_f32_16x16x32_bf16 v[8:11], v[156:159], v[72:75], v[8:11]
    v_mfma_f32_16x16x32_bf16 v[12:15], v[156:159], v[76:79], v[12:15]
    v_mfma_f32_16x16x32_bf16 v[16:19], v[160:163], v[72:75], v[16:19]
    v_mfma_f32_16x16x32_bf16 v[20:23], v[160:163], v[76:79], v[20:23]
    v_mfma_f32_16x16x32_bf16 v[24:27], v[164:167], v[72:75], v[24:27]
    v_mfma_f32_16x16x32_bf16 v[28:31], v[164:167], v[76:79], v[28:31]
    v_mfma_f32_16x16x32_bf16 v[32:35], v[168:171], v[72:75], v[32:35]
    v_mfma_f32_16x16x32_bf16 v[36:39], v[168:171], v[76:79], v[36:39]
    v_mfma_f32_16x16x32_bf16 v[40:43], v[172:175], v[72:75], v[40:43]
    v_mfma_f32_16x16x32_bf16 v[44:47], v[172:175], v[76:79], v[44:47]
    v_mfma_f32_16x16x32_bf16 v[48:51], v[176:179], v[72:75], v[48:51]
    v_mfma_f32_16x16x32_bf16 v[52:55], v[176:179], v[76:79], v[52:55]
    v_mfma_f32_16x16x32_bf16 v[56:59], v[180:183], v[72:75], v[56:59]
    v_mfma_f32_16x16x32_bf16 v[60:63], v[180:183], v[76:79], v[60:63]
    buffer_load_dwordx4 v[156:159], v98, s[20:23], s28 offen offset:0
    buffer_load_dwordx4 v[160:163], v98, s[20:23], s29 offen offset:0
    buffer_load_dwordx4 v[164:167], v98, s[20:23], s30 offen offset:0
    buffer_load_dwordx4 v[168:171], v98, s[20:23], s31 offen offset:0
    buffer_load_dwordx4 v[172:175], v98, s[20:23], s32 offen offset:0
    buffer_load_dwordx4 v[176:179], v98, s[20:23], s33 offen offset:0
    buffer_load_dwordx4 v[180:183], v98, s[20:23], s34 offen offset:0
    ds_read_b128 v[72:75], v6 offset:576
    ds_read_b128 v[76:79], v5 offset:576
    s_waitcnt vmcnt(28) lgkmcnt(2)
    v_mfma_f32_16x16x32_bf16 v[8:11], v[184:187], v[64:67], v[8:11]
    v_mfma_f32_16x16x32_bf16 v[12:15], v[184:187], v[68:71], v[12:15]
    v_mfma_f32_16x16x32_bf16 v[16:19], v[188:191], v[64:67], v[16:19]
    v_mfma_f32_16x16x32_bf16 v[20:23], v[188:191], v[68:71], v[20:23]
    v_mfma_f32_16x16x32_bf16 v[24:27], v[192:195], v[64:67], v[24:27]
    v_mfma_f32_16x16x32_bf16 v[28:31], v[192:195], v[68:71], v[28:31]
    v_mfma_f32_16x16x32_bf16 v[32:35], v[196:199], v[64:67], v[32:35]
    v_mfma_f32_16x16x32_bf16 v[36:39], v[196:199], v[68:71], v[36:39]
    v_mfma_f32_16x16x32_bf16 v[40:43], v[200:203], v[64:67], v[40:43]
    v_mfma_f32_16x16x32_bf16 v[44:47], v[200:203], v[68:71], v[44:47]
    v_mfma_f32_16x16x32_bf16 v[48:51], v[204:207], v[64:67], v[48:51]
    v_mfma_f32_16x16x32_bf16 v[52:55], v[204:207], v[68:71], v[52:55]
    v_mfma_f32_16x16x32_bf16 v[56:59], v[208:211], v[64:67], v[56:59]
    v_mfma_f32_16x16x32_bf16 v[60:63], v[208:211], v[68:71], v[60:63]
    buffer_load_dwordx4 v[184:187], v98, s[20:23], s28 offen offset:1024
    buffer_load_dwordx4 v[188:191], v98, s[20:23], s29 offen offset:1024
    buffer_load_dwordx4 v[192:195], v98, s[20:23], s30 offen offset:1024
    buffer_load_dwordx4 v[196:199], v98, s[20:23], s31 offen offset:1024
    buffer_load_dwordx4 v[200:203], v98, s[20:23], s32 offen offset:1024
    buffer_load_dwordx4 v[204:207], v98, s[20:23], s33 offen offset:1024
    buffer_load_dwordx4 v[208:211], v98, s[20:23], s34 offen offset:1024
    ds_read_b128 v[64:67], v6 offset:640
    ds_read_b128 v[68:71], v5 offset:640
    s_waitcnt vmcnt(28) lgkmcnt(2)
    v_mfma_f32_16x16x32_bf16 v[8:11], v[212:215], v[72:75], v[8:11]
    v_mfma_f32_16x16x32_bf16 v[12:15], v[212:215], v[76:79], v[12:15]
    v_mfma_f32_16x16x32_bf16 v[16:19], v[216:219], v[72:75], v[16:19]
    v_mfma_f32_16x16x32_bf16 v[20:23], v[216:219], v[76:79], v[20:23]
    v_mfma_f32_16x16x32_bf16 v[24:27], v[220:223], v[72:75], v[24:27]
    v_mfma_f32_16x16x32_bf16 v[28:31], v[220:223], v[76:79], v[28:31]
    v_mfma_f32_16x16x32_bf16 v[32:35], v[224:227], v[72:75], v[32:35]
    v_mfma_f32_16x16x32_bf16 v[36:39], v[224:227], v[76:79], v[36:39]
    v_mfma_f32_16x16x32_bf16 v[40:43], v[228:231], v[72:75], v[40:43]
    v_mfma_f32_16x16x32_bf16 v[44:47], v[228:231], v[76:79], v[44:47]
    v_mfma_f32_16x16x32_bf16 v[48:51], v[232:235], v[72:75], v[48:51]
    v_mfma_f32_16x16x32_bf16 v[52:55], v[232:235], v[76:79], v[52:55]
    v_mfma_f32_16x16x32_bf16 v[56:59], v[236:239], v[72:75], v[56:59]
    v_mfma_f32_16x16x32_bf16 v[60:63], v[236:239], v[76:79], v[60:63]
    ds_read_b128 v[72:75], v6 offset:704
    ds_read_b128 v[76:79], v5 offset:704
    s_waitcnt vmcnt(21) lgkmcnt(2)
    v_mfma_f32_16x16x32_bf16 v[8:11], v[100:103], v[64:67], v[8:11]
    v_mfma_f32_16x16x32_bf16 v[12:15], v[100:103], v[68:71], v[12:15]
    v_mfma_f32_16x16x32_bf16 v[16:19], v[104:107], v[64:67], v[16:19]
    v_mfma_f32_16x16x32_bf16 v[20:23], v[104:107], v[68:71], v[20:23]
    v_mfma_f32_16x16x32_bf16 v[24:27], v[108:111], v[64:67], v[24:27]
    v_mfma_f32_16x16x32_bf16 v[28:31], v[108:111], v[68:71], v[28:31]
    v_mfma_f32_16x16x32_bf16 v[32:35], v[112:115], v[64:67], v[32:35]
    v_mfma_f32_16x16x32_bf16 v[36:39], v[112:115], v[68:71], v[36:39]
    v_mfma_f32_16x16x32_bf16 v[40:43], v[116:119], v[64:67], v[40:43]
    v_mfma_f32_16x16x32_bf16 v[44:47], v[116:119], v[68:71], v[44:47]
    v_mfma_f32_16x16x32_bf16 v[48:51], v[120:123], v[64:67], v[48:51]
    v_mfma_f32_16x16x32_bf16 v[52:55], v[120:123], v[68:71], v[52:55]
    v_mfma_f32_16x16x32_bf16 v[56:59], v[124:127], v[64:67], v[56:59]
    v_mfma_f32_16x16x32_bf16 v[60:63], v[124:127], v[68:71], v[60:63]
    ds_read_b128 v[64:67], v6 offset:768
    ds_read_b128 v[68:71], v5 offset:768
    s_waitcnt vmcnt(14) lgkmcnt(2)
    v_mfma_f32_16x16x32_bf16 v[8:11], v[128:131], v[72:75], v[8:11]
    v_mfma_f32_16x16x32_bf16 v[12:15], v[128:131], v[76:79], v[12:15]
    v_mfma_f32_16x16x32_bf16 v[16:19], v[132:135], v[72:75], v[16:19]
    v_mfma_f32_16x16x32_bf16 v[20:23], v[132:135], v[76:79], v[20:23]
    v_mfma_f32_16x16x32_bf16 v[24:27], v[136:139], v[72:75], v[24:27]
    v_mfma_f32_16x16x32_bf16 v[28:31], v[136:139], v[76:79], v[28:31]
    v_mfma_f32_16x16x32_bf16 v[32:35], v[140:143], v[72:75], v[32:35]
    v_mfma_f32_16x16x32_bf16 v[36:39], v[140:143], v[76:79], v[36:39]
    v_mfma_f32_16x16x32_bf16 v[40:43], v[144:147], v[72:75], v[40:43]
    v_mfma_f32_16x16x32_bf16 v[44:47], v[144:147], v[76:79], v[44:47]
    v_mfma_f32_16x16x32_bf16 v[48:51], v[148:151], v[72:75], v[48:51]
    v_mfma_f32_16x16x32_bf16 v[52:55], v[148:151], v[76:79], v[52:55]
    v_mfma_f32_16x16x32_bf16 v[56:59], v[152:155], v[72:75], v[56:59]
    v_mfma_f32_16x16x32_bf16 v[60:63], v[152:155], v[76:79], v[60:63]
    ds_read_b128 v[72:75], v6 offset:832
    ds_read_b128 v[76:79], v5 offset:832
    s_waitcnt vmcnt(7) lgkmcnt(2)
    v_mfma_f32_16x16x32_bf16 v[8:11], v[156:159], v[64:67], v[8:11]
    v_mfma_f32_16x16x32_bf16 v[12:15], v[156:159], v[68:71], v[12:15]
    v_mfma_f32_16x16x32_bf16 v[16:19], v[160:163], v[64:67], v[16:19]
    v_mfma_f32_16x16x32_bf16 v[20:23], v[160:163], v[68:71], v[20:23]
    v_mfma_f32_16x16x32_bf16 v[24:27], v[164:167], v[64:67], v[24:27]
    v_mfma_f32_16x16x32_bf16 v[28:31], v[164:167], v[68:71], v[28:31]
    v_mfma_f32_16x16x32_bf16 v[32:35], v[168:171], v[64:67], v[32:35]
    v_mfma_f32_16x16x32_bf16 v[36:39], v[168:171], v[68:71], v[36:39]
    v_mfma_f32_16x16x32_bf16 v[40:43], v[172:175], v[64:67], v[40:43]
    v_mfma_f32_16x16x32_bf16 v[44:47], v[172:175], v[68:71], v[44:47]
    v_mfma_f32_16x16x32_bf16 v[48:51], v[176:179], v[64:67], v[48:51]
    v_mfma_f32_16x16x32_bf16 v[52:55], v[176:179], v[68:71], v[52:55]
    v_mfma_f32_16x16x32_bf16 v[56:59], v[180:183], v[64:67], v[56:59]
    v_mfma_f32_16x16x32_bf16 v[60:63], v[180:183], v[68:71], v[60:63]
    s_waitcnt vmcnt(0) lgkmcnt(0)
    v_mfma_f32_16x16x32_bf16 v[8:11], v[184:187], v[72:75], v[8:11]
    v_mfma_f32_16x16x32_bf16 v[12:15], v[184:187], v[76:79], v[12:15]
    v_mfma_f32_16x16x32_bf16 v[16:19], v[188:191], v[72:75], v[16:19]
    v_mfma_f32_16x16x32_bf16 v[20:23], v[188:191], v[76:79], v[20:23]
    v_mfma_f32_16x16x32_bf16 v[24:27], v[192:195], v[72:75], v[24:27]
    v_mfma_f32_16x16x32_bf16 v[28:31], v[192:195], v[76:79], v[28:31]
    v_mfma_f32_16x16x32_bf16 v[32:35], v[196:199], v[72:75], v[32:35]
    v_mfma_f32_16x16x32_bf16 v[36:39], v[196:199], v[76:79], v[36:39]
    v_mfma_f32_16x16x32_bf16 v[40:43], v[200:203], v[72:75], v[40:43]
    v_mfma_f32_16x16x32_bf16 v[44:47], v[200:203], v[76:79], v[44:47]
    v_mfma_f32_16x16x32_bf16 v[48:51], v[204:207], v[72:75], v[48:51]
    v_mfma_f32_16x16x32_bf16 v[52:55], v[204:207], v[76:79], v[52:55]
    v_mfma_f32_16x16x32_bf16 v[56:59], v[208:211], v[72:75], v[56:59]
    v_mfma_f32_16x16x32_bf16 v[60:63], v[208:211], v[76:79], v[60:63]
    s_nop 7
    s_lshl_b32 s26, s24, 21
    s_add_u32 s26, s26, 18120704
    s_lshl_b32 s27, s3, 19
    s_add_u32 s26, s26, s27
    s_lshl_b32 s27, s25, 11
    s_add_u32 s26, s26, s27
    v_lshlrev_b32 v64, 6, v2
    v_lshlrev_b32 v65, 2, v3
    v_add_u32 v65, 0, v65
    v_mul_u32_u24 v66, 37, v65
    v_lshrrev_b32 v66, 10, v66
    v_mul_u32_u24 v67, 28, v66
    v_sub_u32 v65, v65, v67
    v_lshl_add_u32 v65, v65, 1, v64
    v_lshl_add_u32 v65, v66, 17, v65
    v_cvt_pk_bf16_f32 v8, v8, v9
    v_cvt_pk_bf16_f32 v9, v10, v11
    buffer_store_dwordx2 v[8:9], v65, s[20:23], s26 offen offset:0
    v_cvt_pk_bf16_f32 v12, v12, v13
    v_cvt_pk_bf16_f32 v13, v14, v15
    buffer_store_dwordx2 v[12:13], v65, s[20:23], s26 offen offset:1024
    v_lshlrev_b32 v65, 2, v3
    v_add_u32 v65, 16, v65
    v_mul_u32_u24 v66, 37, v65
    v_lshrrev_b32 v66, 10, v66
    v_mul_u32_u24 v67, 28, v66
    v_sub_u32 v65, v65, v67
    v_lshl_add_u32 v65, v65, 1, v64
    v_lshl_add_u32 v65, v66, 17, v65
    v_cvt_pk_bf16_f32 v16, v16, v17
    v_cvt_pk_bf16_f32 v17, v18, v19
    buffer_store_dwordx2 v[16:17], v65, s[20:23], s26 offen offset:0
    v_cvt_pk_bf16_f32 v20, v20, v21
    v_cvt_pk_bf16_f32 v21, v22, v23
    buffer_store_dwordx2 v[20:21], v65, s[20:23], s26 offen offset:1024
    v_lshlrev_b32 v65, 2, v3
    v_add_u32 v65, 32, v65
    v_mul_u32_u24 v66, 37, v65
    v_lshrrev_b32 v66, 10, v66
    v_mul_u32_u24 v67, 28, v66
    v_sub_u32 v65, v65, v67
    v_lshl_add_u32 v65, v65, 1, v64
    v_lshl_add_u32 v65, v66, 17, v65
    v_cvt_pk_bf16_f32 v24, v24, v25
    v_cvt_pk_bf16_f32 v25, v26, v27
    buffer_store_dwordx2 v[24:25], v65, s[20:23], s26 offen offset:0
    v_cvt_pk_bf16_f32 v28, v28, v29
    v_cvt_pk_bf16_f32 v29, v30, v31
    buffer_store_dwordx2 v[28:29], v65, s[20:23], s26 offen offset:1024
    v_lshlrev_b32 v65, 2, v3
    v_add_u32 v65, 48, v65
    v_mul_u32_u24 v66, 37, v65
    v_lshrrev_b32 v66, 10, v66
    v_mul_u32_u24 v67, 28, v66
    v_sub_u32 v65, v65, v67
    v_lshl_add_u32 v65, v65, 1, v64
    v_lshl_add_u32 v65, v66, 17, v65
    v_cvt_pk_bf16_f32 v32, v32, v33
    v_cvt_pk_bf16_f32 v33, v34, v35
    buffer_store_dwordx2 v[32:33], v65, s[20:23], s26 offen offset:0
    v_cvt_pk_bf16_f32 v36, v36, v37
    v_cvt_pk_bf16_f32 v37, v38, v39
    buffer_store_dwordx2 v[36:37], v65, s[20:23], s26 offen offset:1024
    v_lshlrev_b32 v65, 2, v3
    v_add_u32 v65, 64, v65
    v_mul_u32_u24 v66, 37, v65
    v_lshrrev_b32 v66, 10, v66
    v_mul_u32_u24 v67, 28, v66
    v_sub_u32 v65, v65, v67
    v_lshl_add_u32 v65, v65, 1, v64
    v_lshl_add_u32 v65, v66, 17, v65
    v_cvt_pk_bf16_f32 v40, v40, v41
    v_cvt_pk_bf16_f32 v41, v42, v43
    buffer_store_dwordx2 v[40:41], v65, s[20:23], s26 offen offset:0
    v_cvt_pk_bf16_f32 v44, v44, v45
    v_cvt_pk_bf16_f32 v45, v46, v47
    buffer_store_dwordx2 v[44:45], v65, s[20:23], s26 offen offset:1024
    v_lshlrev_b32 v65, 2, v3
    v_add_u32 v65, 80, v65
    v_mul_u32_u24 v66, 37, v65
    v_lshrrev_b32 v66, 10, v66
    v_mul_u32_u24 v67, 28, v66
    v_sub_u32 v65, v65, v67
    v_lshl_add_u32 v65, v65, 1, v64
    v_lshl_add_u32 v65, v66, 17, v65
    v_cvt_pk_bf16_f32 v48, v48, v49
    v_cvt_pk_bf16_f32 v49, v50, v51
    buffer_store_dwordx2 v[48:49], v65, s[20:23], s26 offen offset:0
    v_cvt_pk_bf16_f32 v52, v52, v53
    v_cvt_pk_bf16_f32 v53, v54, v55
    buffer_store_dwordx2 v[52:53], v65, s[20:23], s26 offen offset:1024
    v_lshlrev_b32 v65, 2, v3
    v_add_u32 v65, 96, v65
    v_mul_u32_u24 v66, 37, v65
    v_lshrrev_b32 v66, 10, v66
    v_mul_u32_u24 v67, 28, v66
    v_sub_u32 v65, v65, v67
    v_lshl_add_u32 v65, v65, 1, v64
    v_lshl_add_u32 v65, v66, 17, v65
    v_cvt_pk_bf16_f32 v56, v56, v57
    v_cvt_pk_bf16_f32 v57, v58, v59
    buffer_store_dwordx2 v[56:57], v65, s[20:23], s26 offen offset:0
    v_cvt_pk_bf16_f32 v60, v60, v61
    v_cvt_pk_bf16_f32 v61, v62, v63
    buffer_store_dwordx2 v[60:61], v65, s[20:23], s26 offen offset:1024
    s_endpgm
k2a_v:
    ds_read_b128 v[64:67], v6 offset:0
    ds_read_b128 v[68:71], v5 offset:0
    buffer_load_dwordx4 v[212:215], v96, s[20:23], s28 offen offset:0
    buffer_load_dwordx4 v[216:219], v96, s[20:23], s29 offen offset:0
    buffer_load_dwordx4 v[220:223], v96, s[20:23], s30 offen offset:0
    buffer_load_dwordx4 v[224:227], v96, s[20:23], s31 offen offset:0
    buffer_load_dwordx4 v[228:231], v96, s[20:23], s32 offen offset:0
    buffer_load_dwordx4 v[232:235], v96, s[20:23], s33 offen offset:0
    buffer_load_dwordx4 v[236:239], v96, s[20:23], s34 offen offset:0
    ds_read_b128 v[72:75], v6 offset:64
    ds_read_b128 v[76:79], v5 offset:64
    s_waitcnt vmcnt(28) lgkmcnt(2)
    v_mfma_f32_16x16x32_bf16 v[8:11], v[64:67], v[100:103], 0
    v_mfma_f32_16x16x32_bf16 v[12:15], v[68:71], v[100:103], 0
    v_mfma_f32_16x16x32_bf16 v[16:19], v[64:67], v[104:107], 0
    v_mfma_f32_16x16x32_bf16 v[20:23], v[68:71], v[104:107], 0
    v_mfma_f32_16x16x32_bf16 v[24:27], v[64:67], v[108:111], 0
    v_mfma_f32_16x16x32_bf16 v[28:31], v[68:71], v[108:111], 0
    v_mfma_f32_16x16x32_bf16 v[32:35], v[64:67], v[112:115], 0
    v_mfma_f32_16x16x32_bf16 v[36:39], v[68:71], v[112:115], 0
    v_mfma_f32_16x16x32_bf16 v[40:43], v[64:67], v[116:119], 0
    v_mfma_f32_16x16x32_bf16 v[44:47], v[68:71], v[116:119], 0
    v_mfma_f32_16x16x32_bf16 v[48:51], v[64:67], v[120:123], 0
    v_mfma_f32_16x16x32_bf16 v[52:55], v[68:71], v[120:123], 0
    v_mfma_f32_16x16x32_bf16 v[56:59], v[64:67], v[124:127], 0
    v_mfma_f32_16x16x32_bf16 v[60:63], v[68:71], v[124:127], 0
    buffer_load_dwordx4 v[100:103], v96, s[20:23], s28 offen offset:1024
    buffer_load_dwordx4 v[104:107], v96, s[20:23], s29 offen offset:1024
    buffer_load_dwordx4 v[108:111], v96, s[20:23], s30 offen offset:1024
    buffer_load_dwordx4 v[112:115], v96, s[20:23], s31 offen offset:1024
    buffer_load_dwordx4 v[116:119], v96, s[20:23], s32 offen offset:1024
    buffer_load_dwordx4 v[120:123], v96, s[20:23], s33 offen offset:1024
    buffer_load_dwordx4 v[124:127], v96, s[20:23], s34 offen offset:1024
    ds_read_b128 v[64:67], v6 offset:128
    ds_read_b128 v[68:71], v5 offset:128
    s_waitcnt vmcnt(28) lgkmcnt(2)
    v_mfma_f32_16x16x32_bf16 v[8:11], v[72:75], v[128:131], v[8:11]
    v_mfma_f32_16x16x32_bf16 v[12:15], v[76:79], v[128:131], v[12:15]
    v_mfma_f32_16x16x32_bf16 v[16:19], v[72:75], v[132:135], v[16:19]
    v_mfma_f32_16x16x32_bf16 v[20:23], v[76:79], v[132:135], v[20:23]
    v_mfma_f32_16x16x32_bf16 v[24:27], v[72:75], v[136:139], v[24:27]
    v_mfma_f32_16x16x32_bf16 v[28:31], v[76:79], v[136:139], v[28:31]
    v_mfma_f32_16x16x32_bf16 v[32:35], v[72:75], v[140:143], v[32:35]
    v_mfma_f32_16x16x32_bf16 v[36:39], v[76:79], v[140:143], v[36:39]
    v_mfma_f32_16x16x32_bf16 v[40:43], v[72:75], v[144:147], v[40:43]
    v_mfma_f32_16x16x32_bf16 v[44:47], v[76:79], v[144:147], v[44:47]
    v_mfma_f32_16x16x32_bf16 v[48:51], v[72:75], v[148:151], v[48:51]
    v_mfma_f32_16x16x32_bf16 v[52:55], v[76:79], v[148:151], v[52:55]
    v_mfma_f32_16x16x32_bf16 v[56:59], v[72:75], v[152:155], v[56:59]
    v_mfma_f32_16x16x32_bf16 v[60:63], v[76:79], v[152:155], v[60:63]
    buffer_load_dwordx4 v[128:131], v96, s[20:23], s28 offen offset:2048
    buffer_load_dwordx4 v[132:135], v96, s[20:23], s29 offen offset:2048
    buffer_load_dwordx4 v[136:139], v96, s[20:23], s30 offen offset:2048
    buffer_load_dwordx4 v[140:143], v96, s[20:23], s31 offen offset:2048
    buffer_load_dwordx4 v[144:147], v96, s[20:23], s32 offen offset:2048
    buffer_load_dwordx4 v[148:151], v96, s[20:23], s33 offen offset:2048
    buffer_load_dwordx4 v[152:155], v96, s[20:23], s34 offen offset:2048
    ds_read_b128 v[72:75], v6 offset:192
    ds_read_b128 v[76:79], v5 offset:192
    s_waitcnt vmcnt(28) lgkmcnt(2)
    v_mfma_f32_16x16x32_bf16 v[8:11], v[64:67], v[156:159], v[8:11]
    v_mfma_f32_16x16x32_bf16 v[12:15], v[68:71], v[156:159], v[12:15]
    v_mfma_f32_16x16x32_bf16 v[16:19], v[64:67], v[160:163], v[16:19]
    v_mfma_f32_16x16x32_bf16 v[20:23], v[68:71], v[160:163], v[20:23]
    v_mfma_f32_16x16x32_bf16 v[24:27], v[64:67], v[164:167], v[24:27]
    v_mfma_f32_16x16x32_bf16 v[28:31], v[68:71], v[164:167], v[28:31]
    v_mfma_f32_16x16x32_bf16 v[32:35], v[64:67], v[168:171], v[32:35]
    v_mfma_f32_16x16x32_bf16 v[36:39], v[68:71], v[168:171], v[36:39]
    v_mfma_f32_16x16x32_bf16 v[40:43], v[64:67], v[172:175], v[40:43]
    v_mfma_f32_16x16x32_bf16 v[44:47], v[68:71], v[172:175], v[44:47]
    v_mfma_f32_16x16x32_bf16 v[48:51], v[64:67], v[176:179], v[48:51]
    v_mfma_f32_16x16x32_bf16 v[52:55], v[68:71], v[176:179], v[52:55]
    v_mfma_f32_16x16x32_bf16 v[56:59], v[64:67], v[180:183], v[56:59]
    v_mfma_f32_16x16x32_bf16 v[60:63], v[68:71], v[180:183], v[60:63]
    buffer_load_dwordx4 v[156:159], v96, s[20:23], s28 offen offset:3072
    buffer_load_dwordx4 v[160:163], v96, s[20:23], s29 offen offset:3072
    buffer_load_dwordx4 v[164:167], v96, s[20:23], s30 offen offset:3072
    buffer_load_dwordx4 v[168:171], v96, s[20:23], s31 offen offset:3072
    buffer_load_dwordx4 v[172:175], v96, s[20:23], s32 offen offset:3072
    buffer_load_dwordx4 v[176:179], v96, s[20:23], s33 offen offset:3072
    buffer_load_dwordx4 v[180:183], v96, s[20:23], s34 offen offset:3072
    ds_read_b128 v[64:67], v6 offset:256
    ds_read_b128 v[68:71], v5 offset:256
    s_waitcnt vmcnt(28) lgkmcnt(2)
    v_mfma_f32_16x16x32_bf16 v[8:11], v[72:75], v[184:187], v[8:11]
    v_mfma_f32_16x16x32_bf16 v[12:15], v[76:79], v[184:187], v[12:15]
    v_mfma_f32_16x16x32_bf16 v[16:19], v[72:75], v[188:191], v[16:19]
    v_mfma_f32_16x16x32_bf16 v[20:23], v[76:79], v[188:191], v[20:23]
    v_mfma_f32_16x16x32_bf16 v[24:27], v[72:75], v[192:195], v[24:27]
    v_mfma_f32_16x16x32_bf16 v[28:31], v[76:79], v[192:195], v[28:31]
    v_mfma_f32_16x16x32_bf16 v[32:35], v[72:75], v[196:199], v[32:35]
    v_mfma_f32_16x16x32_bf16 v[36:39], v[76:79], v[196:199], v[36:39]
    v_mfma_f32_16x16x32_bf16 v[40:43], v[72:75], v[200:203], v[40:43]
    v_mfma_f32_16x16x32_bf16 v[44:47], v[76:79], v[200:203], v[44:47]
    v_mfma_f32_16x16x32_bf16 v[48:51], v[72:75], v[204:207], v[48:51]
    v_mfma_f32_16x16x32_bf16 v[52:55], v[76:79], v[204:207], v[52:55]
    v_mfma_f32_16x16x32_bf16 v[56:59], v[72:75], v[208:211], v[56:59]
    v_mfma_f32_16x16x32_bf16 v[60:63], v[76:79], v[208:211], v[60:63]
    buffer_load_dwordx4 v[184:187], v97, s[20:23], s28 offen offset:0
    buffer_load_dwordx4 v[188:191], v97, s[20:23], s29 offen offset:0
    buffer_load_dwordx4 v[192:195], v97, s[20:23], s30 offen offset:0
    buffer_load_dwordx4 v[196:199], v97, s[20:23], s31 offen offset:0
    buffer_load_dwordx4 v[200:203], v97, s[20:23], s32 offen offset:0
    buffer_load_dwordx4 v[204:207], v97, s[20:23], s33 offen offset:0
    buffer_load_dwordx4 v[208:211], v97, s[20:23], s34 offen offset:0
    ds_read_b128 v[72:75], v6 offset:320
    ds_read_b128 v[76:79], v5 offset:320
    s_waitcnt vmcnt(28) lgkmcnt(2)
    v_mfma_f32_16x16x32_bf16 v[8:11], v[64:67], v[212:215], v[8:11]
    v_mfma_f32_16x16x32_bf16 v[12:15], v[68:71], v[212:215], v[12:15]
    v_mfma_f32_16x16x32_bf16 v[16:19], v[64:67], v[216:219], v[16:19]
    v_mfma_f32_16x16x32_bf16 v[20:23], v[68:71], v[216:219], v[20:23]
    v_mfma_f32_16x16x32_bf16 v[24:27], v[64:67], v[220:223], v[24:27]
    v_mfma_f32_16x16x32_bf16 v[28:31], v[68:71], v[220:223], v[28:31]
    v_mfma_f32_16x16x32_bf16 v[32:35], v[64:67], v[224:227], v[32:35]
    v_mfma_f32_16x16x32_bf16 v[36:39], v[68:71], v[224:227], v[36:39]
    v_mfma_f32_16x16x32_bf16 v[40:43], v[64:67], v[228:231], v[40:43]
    v_mfma_f32_16x16x32_bf16 v[44:47], v[68:71], v[228:231], v[44:47]
    v_mfma_f32_16x16x32_bf16 v[48:51], v[64:67], v[232:235], v[48:51]
    v_mfma_f32_16x16x32_bf16 v[52:55], v[68:71], v[232:235], v[52:55]
    v_mfma_f32_16x16x32_bf16 v[56:59], v[64:67], v[236:239], v[56:59]
    v_mfma_f32_16x16x32_bf16 v[60:63], v[68:71], v[236:239], v[60:63]
    buffer_load_dwordx4 v[212:215], v97, s[20:23], s28 offen offset:1024
    buffer_load_dwordx4 v[216:219], v97, s[20:23], s29 offen offset:1024
    buffer_load_dwordx4 v[220:223], v97, s[20:23], s30 offen offset:1024
    buffer_load_dwordx4 v[224:227], v97, s[20:23], s31 offen offset:1024
    buffer_load_dwordx4 v[228:231], v97, s[20:23], s32 offen offset:1024
    buffer_load_dwordx4 v[232:235], v97, s[20:23], s33 offen offset:1024
    buffer_load_dwordx4 v[236:239], v97, s[20:23], s34 offen offset:1024
    ds_read_b128 v[64:67], v6 offset:384
    ds_read_b128 v[68:71], v5 offset:384
    s_waitcnt vmcnt(28) lgkmcnt(2)
    v_mfma_f32_16x16x32_bf16 v[8:11], v[72:75], v[100:103], v[8:11]
    v_mfma_f32_16x16x32_bf16 v[12:15], v[76:79], v[100:103], v[12:15]
    v_mfma_f32_16x16x32_bf16 v[16:19], v[72:75], v[104:107], v[16:19]
    v_mfma_f32_16x16x32_bf16 v[20:23], v[76:79], v[104:107], v[20:23]
    v_mfma_f32_16x16x32_bf16 v[24:27], v[72:75], v[108:111], v[24:27]
    v_mfma_f32_16x16x32_bf16 v[28:31], v[76:79], v[108:111], v[28:31]
    v_mfma_f32_16x16x32_bf16 v[32:35], v[72:75], v[112:115], v[32:35]
    v_mfma_f32_16x16x32_bf16 v[36:39], v[76:79], v[112:115], v[36:39]
    v_mfma_f32_16x16x32_bf16 v[40:43], v[72:75], v[116:119], v[40:43]
    v_mfma_f32_16x16x32_bf16 v[44:47], v[76:79], v[116:119], v[44:47]
    v_mfma_f32_16x16x32_bf16 v[48:51], v[72:75], v[120:123], v[48:51]
    v_mfma_f32_16x16x32_bf16 v[52:55], v[76:79], v[120:123], v[52:55]
    v_mfma_f32_16x16x32_bf16 v[56:59], v[72:75], v[124:127], v[56:59]
    v_mfma_f32_16x16x32_bf16 v[60:63], v[76:79], v[124:127], v[60:63]
    buffer_load_dwordx4 v[100:103], v97, s[20:23], s28 offen offset:2048
    buffer_load_dwordx4 v[104:107], v97, s[20:23], s29 offen offset:2048
    buffer_load_dwordx4 v[108:111], v97, s[20:23], s30 offen offset:2048
    buffer_load_dwordx4 v[112:115], v97, s[20:23], s31 offen offset:2048
    buffer_load_dwordx4 v[116:119], v97, s[20:23], s32 offen offset:2048
    buffer_load_dwordx4 v[120:123], v97, s[20:23], s33 offen offset:2048
    buffer_load_dwordx4 v[124:127], v97, s[20:23], s34 offen offset:2048
    ds_read_b128 v[72:75], v6 offset:448
    ds_read_b128 v[76:79], v5 offset:448
    s_waitcnt vmcnt(28) lgkmcnt(2)
    v_mfma_f32_16x16x32_bf16 v[8:11], v[64:67], v[128:131], v[8:11]
    v_mfma_f32_16x16x32_bf16 v[12:15], v[68:71], v[128:131], v[12:15]
    v_mfma_f32_16x16x32_bf16 v[16:19], v[64:67], v[132:135], v[16:19]
    v_mfma_f32_16x16x32_bf16 v[20:23], v[68:71], v[132:135], v[20:23]
    v_mfma_f32_16x16x32_bf16 v[24:27], v[64:67], v[136:139], v[24:27]
    v_mfma_f32_16x16x32_bf16 v[28:31], v[68:71], v[136:139], v[28:31]
    v_mfma_f32_16x16x32_bf16 v[32:35], v[64:67], v[140:143], v[32:35]
    v_mfma_f32_16x16x32_bf16 v[36:39], v[68:71], v[140:143], v[36:39]
    v_mfma_f32_16x16x32_bf16 v[40:43], v[64:67], v[144:147], v[40:43]
    v_mfma_f32_16x16x32_bf16 v[44:47], v[68:71], v[144:147], v[44:47]
    v_mfma_f32_16x16x32_bf16 v[48:51], v[64:67], v[148:151], v[48:51]
    v_mfma_f32_16x16x32_bf16 v[52:55], v[68:71], v[148:151], v[52:55]
    v_mfma_f32_16x16x32_bf16 v[56:59], v[64:67], v[152:155], v[56:59]
    v_mfma_f32_16x16x32_bf16 v[60:63], v[68:71], v[152:155], v[60:63]
    buffer_load_dwordx4 v[128:131], v97, s[20:23], s28 offen offset:3072
    buffer_load_dwordx4 v[132:135], v97, s[20:23], s29 offen offset:3072
    buffer_load_dwordx4 v[136:139], v97, s[20:23], s30 offen offset:3072
    buffer_load_dwordx4 v[140:143], v97, s[20:23], s31 offen offset:3072
    buffer_load_dwordx4 v[144:147], v97, s[20:23], s32 offen offset:3072
    buffer_load_dwordx4 v[148:151], v97, s[20:23], s33 offen offset:3072
    buffer_load_dwordx4 v[152:155], v97, s[20:23], s34 offen offset:3072
    ds_read_b128 v[64:67], v6 offset:512
    ds_read_b128 v[68:71], v5 offset:512
    s_waitcnt vmcnt(28) lgkmcnt(2)
    v_mfma_f32_16x16x32_bf16 v[8:11], v[72:75], v[156:159], v[8:11]
    v_mfma_f32_16x16x32_bf16 v[12:15], v[76:79], v[156:159], v[12:15]
    v_mfma_f32_16x16x32_bf16 v[16:19], v[72:75], v[160:163], v[16:19]
    v_mfma_f32_16x16x32_bf16 v[20:23], v[76:79], v[160:163], v[20:23]
    v_mfma_f32_16x16x32_bf16 v[24:27], v[72:75], v[164:167], v[24:27]
    v_mfma_f32_16x16x32_bf16 v[28:31], v[76:79], v[164:167], v[28:31]
    v_mfma_f32_16x16x32_bf16 v[32:35], v[72:75], v[168:171], v[32:35]
    v_mfma_f32_16x16x32_bf16 v[36:39], v[76:79], v[168:171], v[36:39]
    v_mfma_f32_16x16x32_bf16 v[40:43], v[72:75], v[172:175], v[40:43]
    v_mfma_f32_16x16x32_bf16 v[44:47], v[76:79], v[172:175], v[44:47]
    v_mfma_f32_16x16x32_bf16 v[48:51], v[72:75], v[176:179], v[48:51]
    v_mfma_f32_16x16x32_bf16 v[52:55], v[76:79], v[176:179], v[52:55]
    v_mfma_f32_16x16x32_bf16 v[56:59], v[72:75], v[180:183], v[56:59]
    v_mfma_f32_16x16x32_bf16 v[60:63], v[76:79], v[180:183], v[60:63]
    buffer_load_dwordx4 v[156:159], v98, s[20:23], s28 offen offset:0
    buffer_load_dwordx4 v[160:163], v98, s[20:23], s29 offen offset:0
    buffer_load_dwordx4 v[164:167], v98, s[20:23], s30 offen offset:0
    buffer_load_dwordx4 v[168:171], v98, s[20:23], s31 offen offset:0
    buffer_load_dwordx4 v[172:175], v98, s[20:23], s32 offen offset:0
    buffer_load_dwordx4 v[176:179], v98, s[20:23], s33 offen offset:0
    buffer_load_dwordx4 v[180:183], v98, s[20:23], s34 offen offset:0
    ds_read_b128 v[72:75], v6 offset:576
    ds_read_b128 v[76:79], v5 offset:576
    s_waitcnt vmcnt(28) lgkmcnt(2)
    v_mfma_f32_16x16x32_bf16 v[8:11], v[64:67], v[184:187], v[8:11]
    v_mfma_f32_16x16x32_bf16 v[12:15], v[68:71], v[184:187], v[12:15]
    v_mfma_f32_16x16x32_bf16 v[16:19], v[64:67], v[188:191], v[16:19]
    v_mfma_f32_16x16x32_bf16 v[20:23], v[68:71], v[188:191], v[20:23]
    v_mfma_f32_16x16x32_bf16 v[24:27], v[64:67], v[192:195], v[24:27]
    v_mfma_f32_16x16x32_bf16 v[28:31], v[68:71], v[192:195], v[28:31]
    v_mfma_f32_16x16x32_bf16 v[32:35], v[64:67], v[196:199], v[32:35]
    v_mfma_f32_16x16x32_bf16 v[36:39], v[68:71], v[196:199], v[36:39]
    v_mfma_f32_16x16x32_bf16 v[40:43], v[64:67], v[200:203], v[40:43]
    v_mfma_f32_16x16x32_bf16 v[44:47], v[68:71], v[200:203], v[44:47]
    v_mfma_f32_16x16x32_bf16 v[48:51], v[64:67], v[204:207], v[48:51]
    v_mfma_f32_16x16x32_bf16 v[52:55], v[68:71], v[204:207], v[52:55]
    v_mfma_f32_16x16x32_bf16 v[56:59], v[64:67], v[208:211], v[56:59]
    v_mfma_f32_16x16x32_bf16 v[60:63], v[68:71], v[208:211], v[60:63]
    buffer_load_dwordx4 v[184:187], v98, s[20:23], s28 offen offset:1024
    buffer_load_dwordx4 v[188:191], v98, s[20:23], s29 offen offset:1024
    buffer_load_dwordx4 v[192:195], v98, s[20:23], s30 offen offset:1024
    buffer_load_dwordx4 v[196:199], v98, s[20:23], s31 offen offset:1024
    buffer_load_dwordx4 v[200:203], v98, s[20:23], s32 offen offset:1024
    buffer_load_dwordx4 v[204:207], v98, s[20:23], s33 offen offset:1024
    buffer_load_dwordx4 v[208:211], v98, s[20:23], s34 offen offset:1024
    ds_read_b128 v[64:67], v6 offset:640
    ds_read_b128 v[68:71], v5 offset:640
    s_waitcnt vmcnt(28) lgkmcnt(2)
    v_mfma_f32_16x16x32_bf16 v[8:11], v[72:75], v[212:215], v[8:11]
    v_mfma_f32_16x16x32_bf16 v[12:15], v[76:79], v[212:215], v[12:15]
    v_mfma_f32_16x16x32_bf16 v[16:19], v[72:75], v[216:219], v[16:19]
    v_mfma_f32_16x16x32_bf16 v[20:23], v[76:79], v[216:219], v[20:23]
    v_mfma_f32_16x16x32_bf16 v[24:27], v[72:75], v[220:223], v[24:27]
    v_mfma_f32_16x16x32_bf16 v[28:31], v[76:79], v[220:223], v[28:31]
    v_mfma_f32_16x16x32_bf16 v[32:35], v[72:75], v[224:227], v[32:35]
    v_mfma_f32_16x16x32_bf16 v[36:39], v[76:79], v[224:227], v[36:39]
    v_mfma_f32_16x16x32_bf16 v[40:43], v[72:75], v[228:231], v[40:43]
    v_mfma_f32_16x16x32_bf16 v[44:47], v[76:79], v[228:231], v[44:47]
    v_mfma_f32_16x16x32_bf16 v[48:51], v[72:75], v[232:235], v[48:51]
    v_mfma_f32_16x16x32_bf16 v[52:55], v[76:79], v[232:235], v[52:55]
    v_mfma_f32_16x16x32_bf16 v[56:59], v[72:75], v[236:239], v[56:59]
    v_mfma_f32_16x16x32_bf16 v[60:63], v[76:79], v[236:239], v[60:63]
    ds_read_b128 v[72:75], v6 offset:704
    ds_read_b128 v[76:79], v5 offset:704
    s_waitcnt vmcnt(21) lgkmcnt(2)
    v_mfma_f32_16x16x32_bf16 v[8:11], v[64:67], v[100:103], v[8:11]
    v_mfma_f32_16x16x32_bf16 v[12:15], v[68:71], v[100:103], v[12:15]
    v_mfma_f32_16x16x32_bf16 v[16:19], v[64:67], v[104:107], v[16:19]
    v_mfma_f32_16x16x32_bf16 v[20:23], v[68:71], v[104:107], v[20:23]
    v_mfma_f32_16x16x32_bf16 v[24:27], v[64:67], v[108:111], v[24:27]
    v_mfma_f32_16x16x32_bf16 v[28:31], v[68:71], v[108:111], v[28:31]
    v_mfma_f32_16x16x32_bf16 v[32:35], v[64:67], v[112:115], v[32:35]
    v_mfma_f32_16x16x32_bf16 v[36:39], v[68:71], v[112:115], v[36:39]
    v_mfma_f32_16x16x32_bf16 v[40:43], v[64:67], v[116:119], v[40:43]
    v_mfma_f32_16x16x32_bf16 v[44:47], v[68:71], v[116:119], v[44:47]
    v_mfma_f32_16x16x32_bf16 v[48:51], v[64:67], v[120:123], v[48:51]
    v_mfma_f32_16x16x32_bf16 v[52:55], v[68:71], v[120:123], v[52:55]
    v_mfma_f32_16x16x32_bf16 v[56:59], v[64:67], v[124:127], v[56:59]
    v_mfma_f32_16x16x32_bf16 v[60:63], v[68:71], v[124:127], v[60:63]
    ds_read_b128 v[64:67], v6 offset:768
    ds_read_b128 v[68:71], v5 offset:768
    s_waitcnt vmcnt(14) lgkmcnt(2)
    v_mfma_f32_16x16x32_bf16 v[8:11], v[72:75], v[128:131], v[8:11]
    v_mfma_f32_16x16x32_bf16 v[12:15], v[76:79], v[128:131], v[12:15]
    v_mfma_f32_16x16x32_bf16 v[16:19], v[72:75], v[132:135], v[16:19]
    v_mfma_f32_16x16x32_bf16 v[20:23], v[76:79], v[132:135], v[20:23]
    v_mfma_f32_16x16x32_bf16 v[24:27], v[72:75], v[136:139], v[24:27]
    v_mfma_f32_16x16x32_bf16 v[28:31], v[76:79], v[136:139], v[28:31]
    v_mfma_f32_16x16x32_bf16 v[32:35], v[72:75], v[140:143], v[32:35]
    v_mfma_f32_16x16x32_bf16 v[36:39], v[76:79], v[140:143], v[36:39]
    v_mfma_f32_16x16x32_bf16 v[40:43], v[72:75], v[144:147], v[40:43]
    v_mfma_f32_16x16x32_bf16 v[44:47], v[76:79], v[144:147], v[44:47]
    v_mfma_f32_16x16x32_bf16 v[48:51], v[72:75], v[148:151], v[48:51]
    v_mfma_f32_16x16x32_bf16 v[52:55], v[76:79], v[148:151], v[52:55]
    v_mfma_f32_16x16x32_bf16 v[56:59], v[72:75], v[152:155], v[56:59]
    v_mfma_f32_16x16x32_bf16 v[60:63], v[76:79], v[152:155], v[60:63]
    ds_read_b128 v[72:75], v6 offset:832
    ds_read_b128 v[76:79], v5 offset:832
    s_waitcnt vmcnt(7) lgkmcnt(2)
    v_mfma_f32_16x16x32_bf16 v[8:11], v[64:67], v[156:159], v[8:11]
    v_mfma_f32_16x16x32_bf16 v[12:15], v[68:71], v[156:159], v[12:15]
    v_mfma_f32_16x16x32_bf16 v[16:19], v[64:67], v[160:163], v[16:19]
    v_mfma_f32_16x16x32_bf16 v[20:23], v[68:71], v[160:163], v[20:23]
    v_mfma_f32_16x16x32_bf16 v[24:27], v[64:67], v[164:167], v[24:27]
    v_mfma_f32_16x16x32_bf16 v[28:31], v[68:71], v[164:167], v[28:31]
    v_mfma_f32_16x16x32_bf16 v[32:35], v[64:67], v[168:171], v[32:35]
    v_mfma_f32_16x16x32_bf16 v[36:39], v[68:71], v[168:171], v[36:39]
    v_mfma_f32_16x16x32_bf16 v[40:43], v[64:67], v[172:175], v[40:43]
    v_mfma_f32_16x16x32_bf16 v[44:47], v[68:71], v[172:175], v[44:47]
    v_mfma_f32_16x16x32_bf16 v[48:51], v[64:67], v[176:179], v[48:51]
    v_mfma_f32_16x16x32_bf16 v[52:55], v[68:71], v[176:179], v[52:55]
    v_mfma_f32_16x16x32_bf16 v[56:59], v[64:67], v[180:183], v[56:59]
    v_mfma_f32_16x16x32_bf16 v[60:63], v[68:71], v[180:183], v[60:63]
    s_waitcnt vmcnt(0) lgkmcnt(0)
    v_mfma_f32_16x16x32_bf16 v[8:11], v[72:75], v[184:187], v[8:11]
    v_mfma_f32_16x16x32_bf16 v[12:15], v[76:79], v[184:187], v[12:15]
    v_mfma_f32_16x16x32_bf16 v[16:19], v[72:75], v[188:191], v[16:19]
    v_mfma_f32_16x16x32_bf16 v[20:23], v[76:79], v[188:191], v[20:23]
    v_mfma_f32_16x16x32_bf16 v[24:27], v[72:75], v[192:195], v[24:27]
    v_mfma_f32_16x16x32_bf16 v[28:31], v[76:79], v[192:195], v[28:31]
    v_mfma_f32_16x16x32_bf16 v[32:35], v[72:75], v[196:199], v[32:35]
    v_mfma_f32_16x16x32_bf16 v[36:39], v[76:79], v[196:199], v[36:39]
    v_mfma_f32_16x16x32_bf16 v[40:43], v[72:75], v[200:203], v[40:43]
    v_mfma_f32_16x16x32_bf16 v[44:47], v[76:79], v[200:203], v[44:47]
    v_mfma_f32_16x16x32_bf16 v[48:51], v[72:75], v[204:207], v[48:51]
    v_mfma_f32_16x16x32_bf16 v[52:55], v[76:79], v[204:207], v[52:55]
    v_mfma_f32_16x16x32_bf16 v[56:59], v[72:75], v[208:211], v[56:59]
    v_mfma_f32_16x16x32_bf16 v[60:63], v[76:79], v[208:211], v[60:63]
    s_nop 7
    s_lshl_b32 s27, s3, 19
    s_add_u32 s26, s27, 22315008
    s_lshl_b32 s27, s25, 11
    s_add_u32 s26, s26, s27
    v_lshlrev_b32 v64, 8, v3
    v_add_u32 v65, 0, v2
    v_mul_u32_u24 v66, 2341, v65
    v_lshrrev_b32 v66, 16, v66
    v_mul_u32_u24 v67, 28, v66
    v_sub_u32 v65, v65, v67
    v_lshrrev_b32 v67, 4, v65
    v_and_b32 v65, 15, v65
    v_lshl_add_u32 v65, v65, 4, v64
    v_lshl_add_u32 v65, v67, 10, v65
    v_lshl_add_u32 v65, v66, 17, v65
    v_cvt_pk_bf16_f32 v8, v8, v9
    v_cvt_pk_bf16_f32 v9, v10, v11
    v_cvt_pk_bf16_f32 v10, v12, v13
    v_cvt_pk_bf16_f32 v11, v14, v15
    buffer_store_dwordx4 v[8:11], v65, s[20:23], s26 offen
    v_add_u32 v65, 16, v2
    v_mul_u32_u24 v66, 2341, v65
    v_lshrrev_b32 v66, 16, v66
    v_mul_u32_u24 v67, 28, v66
    v_sub_u32 v65, v65, v67
    v_lshrrev_b32 v67, 4, v65
    v_and_b32 v65, 15, v65
    v_lshl_add_u32 v65, v65, 4, v64
    v_lshl_add_u32 v65, v67, 10, v65
    v_lshl_add_u32 v65, v66, 17, v65
    v_cvt_pk_bf16_f32 v16, v16, v17
    v_cvt_pk_bf16_f32 v17, v18, v19
    v_cvt_pk_bf16_f32 v18, v20, v21
    v_cvt_pk_bf16_f32 v19, v22, v23
    buffer_store_dwordx4 v[16:19], v65, s[20:23], s26 offen
    v_add_u32 v65, 32, v2
    v_mul_u32_u24 v66, 2341, v65
    v_lshrrev_b32 v66, 16, v66
    v_mul_u32_u24 v67, 28, v66
    v_sub_u32 v65, v65, v67
    v_lshrrev_b32 v67, 4, v65
    v_and_b32 v65, 15, v65
    v_lshl_add_u32 v65, v65, 4, v64
    v_lshl_add_u32 v65, v67, 10, v65
    v_lshl_add_u32 v65, v66, 17, v65
    v_cvt_pk_bf16_f32 v24, v24, v25
    v_cvt_pk_bf16_f32 v25, v26, v27
    v_cvt_pk_bf16_f32 v26, v28, v29
    v_cvt_pk_bf16_f32 v27, v30, v31
    buffer_store_dwordx4 v[24:27], v65, s[20:23], s26 offen
    v_add_u32 v65, 48, v2
    v_mul_u32_u24 v66, 2341, v65
    v_lshrrev_b32 v66, 16, v66
    v_mul_u32_u24 v67, 28, v66
    v_sub_u32 v65, v65, v67
    v_lshrrev_b32 v67, 4, v65
    v_and_b32 v65, 15, v65
    v_lshl_add_u32 v65, v65, 4, v64
    v_lshl_add_u32 v65, v67, 10, v65
    v_lshl_add_u32 v65, v66, 17, v65
    v_cvt_pk_bf16_f32 v32, v32, v33
    v_cvt_pk_bf16_f32 v33, v34, v35
    v_cvt_pk_bf16_f32 v34, v36, v37
    v_cvt_pk_bf16_f32 v35, v38, v39
    buffer_store_dwordx4 v[32:35], v65, s[20:23], s26 offen
    v_add_u32 v65, 64, v2
    v_mul_u32_u24 v66, 2341, v65
    v_lshrrev_b32 v66, 16, v66
    v_mul_u32_u24 v67, 28, v66
    v_sub_u32 v65, v65, v67
    v_lshrrev_b32 v67, 4, v65
    v_and_b32 v65, 15, v65
    v_lshl_add_u32 v65, v65, 4, v64
    v_lshl_add_u32 v65, v67, 10, v65
    v_lshl_add_u32 v65, v66, 17, v65
    v_cvt_pk_bf16_f32 v40, v40, v41
    v_cvt_pk_bf16_f32 v41, v42, v43
    v_cvt_pk_bf16_f32 v42, v44, v45
    v_cvt_pk_bf16_f32 v43, v46, v47
    buffer_store_dwordx4 v[40:43], v65, s[20:23], s26 offen
    v_add_u32 v65, 80, v2
    v_mul_u32_u24 v66, 2341, v65
    v_lshrrev_b32 v66, 16, v66
    v_mul_u32_u24 v67, 28, v66
    v_sub_u32 v65, v65, v67
    v_lshrrev_b32 v67, 4, v65
    v_and_b32 v65, 15, v65
    v_lshl_add_u32 v65, v65, 4, v64
    v_lshl_add_u32 v65, v67, 10, v65
    v_lshl_add_u32 v65, v66, 17, v65
    v_cvt_pk_bf16_f32 v48, v48, v49
    v_cvt_pk_bf16_f32 v49, v50, v51
    v_cvt_pk_bf16_f32 v50, v52, v53
    v_cvt_pk_bf16_f32 v51, v54, v55
    buffer_store_dwordx4 v[48:51], v65, s[20:23], s26 offen
    v_add_u32 v65, 96, v2
    v_mul_u32_u24 v66, 2341, v65
    v_lshrrev_b32 v66, 16, v66
    v_mul_u32_u24 v67, 28, v66
    v_sub_u32 v65, v65, v67
    v_lshrrev_b32 v67, 4, v65
    v_and_b32 v65, 15, v65
    v_lshl_add_u32 v65, v65, 4, v64
    v_lshl_add_u32 v65, v67, 10, v65
    v_lshl_add_u32 v65, v66, 17, v65
    v_cvt_pk_bf16_f32 v56, v56, v57
    v_cvt_pk_bf16_f32 v57, v58, v59
    v_cvt_pk_bf16_f32 v58, v60, v61
    v_cvt_pk_bf16_f32 v59, v62, v63
    buffer_store_dwordx4 v[56:59], v65, s[20:23], s26 offen
    s_endpgm
.globl k3_kernel
.p2align 8
.type k3_kernel,@function
k3_kernel:
    s_cmp_ge_u32 s2, 736
    s_cbranch_scc1 k3_end
    s_cmp_ge_u32 s2, 224
    s_cbranch_scc1 k3_go
g3u_start:
    s_load_dwordx4 s[4:7], s[0:1], 40
    s_load_dwordx2 s[12:13], s[0:1], 56
    s_load_dwordx2 s[14:15], s[0:1], 96
    v_and_b32 v1, 63, v0
    v_lshrrev_b32 v2, 6, v0
    s_nop 0
    v_readfirstlane_b32 s3, v2
    v_and_b32 v2, 15, v1
    v_lshrrev_b32 v3, 4, v1
    s_mul_hi_u32 s26, s2, 306783379
    s_mul_i32 s27, s26, 14
    s_sub_u32 s27, s2, s27
    s_and_b32 s28, s27, 1
    s_lshr_b32 s27, s27, 1
    s_waitcnt lgkmcnt(0)
    s_mov_b32 s20, s14
    s_and_b32 s21, s15, 0xffff
    s_mov_b32 s22, 268435456
    s_mov_b32 s23, 0x20000
    s_mov_b32 s8, s12
    s_and_b32 s9, s13, 0xffff
    s_mov_b32 s10, 3670016
    s_mov_b32 s11, 0x20000
    s_mov_b32 s16, s14
    s_and_b32 s17, s15, 0xffff
    s_mov_b32 s18, 268435456
    s_mov_b32 s19, 0x20000
    s_mul_i32 s30, s26, 229376
    s_add_u32 s30, s30, 1605632
    s_mov_b32 s31, 0x3f800000
    v_lshrrev_b32 v4, 3, v1
    v_and_b32 v5, 7, v1
    v_xor_b32 v5, v5, v4
    v_lshlrev_b32 v5, 4, v5
    v_lshl_add_u32 v6, v4, 13, v5
    v_mul_u32_u24 v7, 512, v4
    v_add_u32 v7, v7, v5
    s_lshl_b32 s32, s27, 6
    s_lshl_b32 s33, s3, 4
    s_add_u32 s32, s32, s33
    s_lshl_b32 s32, s32, 13
    s_lshl_b32 s33, s26, 9
    s_add_u32 s32, s32, s33
    s_mul_i32 s33, s28, 224
    s_mul_i32 s29, s3, 56
    s_add_u32 s33, s33, s29
    s_mul_i32 s33, s33, 512
    s_add_u32 s33, s33, s30
    s_lshl_b32 s34, s3, 11
    s_mul_i32 s35, s3, 7168
    s_add_u32 s35, s35, 8192
    v_and_b32 v8, 7, v2
    v_xor_b32 v9, v3, v8
    v_lshlrev_b32 v9, 4, v9
    v_lshl_add_u32 v9, v2, 7, v9
    v_add_u32 v10, 4, v3
    v_xor_b32 v10, v10, v8
    v_lshlrev_b32 v10, 4, v10
    v_lshl_add_u32 v10, v2, 7, v10
    s_and_b32 s38, s3, 1
    s_mul_i32 s38, s38, 14336
    s_add_u32 s38, s38, 8192
    v_add_u32 v11, s38, v9
    v_add_u32 v12, s38, v10
    s_lshr_b32 s38, s3, 1
    s_lshl_b32 s38, s38, 12
    v_add_u32 v9, s38, v9
    v_add_u32 v10, s38, v10
    s_add_u32 s36, s34, 0
    s_mov_b32 m0, s36
    s_add_u32 s37, s32, 0
    buffer_load_dwordx4 v6, s[8:11], s37 offen lds
    s_add_u32 s36, s34, 1024
    s_mov_b32 m0, s36
    s_add_u32 s37, s32, 65536
    buffer_load_dwordx4 v6, s[8:11], s37 offen lds
    s_add_u32 s36, s35, 0
    s_mov_b32 m0, s36
    s_add_u32 s37, s33, 0
    buffer_load_dwordx4 v7, s[16:19], s37 offen lds
    s_add_u32 s36, s35, 1024
    s_mov_b32 m0, s36
    s_add_u32 s37, s33, 4096
    buffer_load_dwordx4 v7, s[16:19], s37 offen lds
    s_add_u32 s36, s35, 2048
    s_mov_b32 m0, s36
    s_add_u32 s37, s33, 8192
    buffer_load_dwordx4 v7, s[16:19], s37 offen lds
    s_add_u32 s36, s35, 3072
    s_mov_b32 m0, s36
    s_add_u32 s37, s33, 12288
    buffer_load_dwordx4 v7, s[16:19], s37 offen lds
    s_add_u32 s36, s35, 4096
    s_mov_b32 m0, s36
    s_add_u32 s37, s33, 16384
    buffer_load_dwordx4 v7, s[16:19], s37 offen lds
    s_add_u32 s36, s35, 5120
    s_mov_b32 m0, s36
    s_add_u32 s37, s33, 20480
    buffer_load_dwordx4 v7, s[16:19], s37 offen lds
    s_add_u32 s36, s35, 6144
    s_mov_b32 m0, s36
    s_add_u32 s37, s33, 24576
    buffer_load_dwordx4 v7, s[16:19], s37 offen lds
    s_add_u32 s36, s34, 36864
    s_mov_b32 m0, s36
    s_add_u32 s37, s32, 128
    buffer_load_dwordx4 v6, s[8:11], s37 offen lds
    s_add_u32 s36, s34, 37888
    s_mov_b32 m0, s36
    s_add_u32 s37, s32, 65664
    buffer_load_dwordx4 v6, s[8:11], s37 offen lds
    s_add_u32 s36, s35, 36864
    s_mov_b32 m0, s36
    s_add_u32 s37, s33, 128
    buffer_load_dwordx4 v7, s[16:19], s37 offen lds
    s_add_u32 s36, s35, 37888
    s_mov_b32 m0, s36
    s_add_u32 s37, s33, 4224
    buffer_load_dwordx4 v7, s[16:19], s37 offen lds
    s_add_u32 s36, s35, 38912
    s_mov_b32 m0, s36
    s_add_u32 s37, s33, 8320
    buffer_load_dwordx4 v7, s[16:19], s37 offen lds
    s_add_u32 s36, s35, 39936
    s_mov_b32 m0, s36
    s_add_u32 s37, s33, 12416
    buffer_load_dwordx4 v7, s[16:19], s37 offen lds
    s_add_u32 s36, s35, 40960
    s_mov_b32 m0, s36
    s_add_u32 s37, s33, 16512
    buffer_load_dwordx4 v7, s[16:19], s37 offen lds
    s_add_u32 s36, s35, 41984
    s_mov_b32 m0, s36
    s_add_u32 s37, s33, 20608
    buffer_load_dwordx4 v7, s[16:19], s37 offen lds
    s_add_u32 s36, s35, 43008
    s_mov_b32 m0, s36
    s_add_u32 s37, s33, 24704
    buffer_load_dwordx4 v7, s[16:19], s37 offen lds
    s_waitcnt vmcnt(9)
    s_barrier
    ds_read_b128 v[72:75], v9 offset:0
    ds_read_b128 v[76:79], v9 offset:2048
    ds_read_b128 v[88:91], v11 offset:0
    ds_read_b128 v[92:95], v11 offset:2048
    ds_read_b128 v[96:99], v11 offset:4096
    ds_read_b128 v[100:103], v11 offset:6144
    ds_read_b128 v[104:107], v11 offset:8192
    ds_read_b128 v[108:111], v11 offset:10240
    ds_read_b128 v[112:115], v11 offset:12288
    ds_read_b128 v[80:83], v10 offset:0
    ds_read_b128 v[84:87], v10 offset:2048
    ds_read_b128 v[116:119], v12 offset:0
    ds_read_b128 v[120:123], v12 offset:2048
    ds_read_b128 v[124:127], v12 offset:4096
    ds_read_b128 v[128:131], v12 offset:6144
    ds_read_b128 v[132:135], v12 offset:8192
    ds_read_b128 v[136:139], v12 offset:10240
    ds_read_b128 v[140:143], v12 offset:12288
    s_waitcnt lgkmcnt(0)
    s_barrier
    s_add_u32 s36, s34, 0
    s_mov_b32 m0, s36
    s_add_u32 s37, s32, 256
    buffer_load_dwordx4 v6, s[8:11], s37 offen lds
    s_add_u32 s36, s34, 1024
    s_mov_b32 m0, s36
    s_add_u32 s37, s32, 65792
    buffer_load_dwordx4 v6, s[8:11], s37 offen lds
    s_add_u32 s36, s35, 0
    s_mov_b32 m0, s36
    s_add_u32 s37, s33, 256
    buffer_load_dwordx4 v7, s[16:19], s37 offen lds
    s_add_u32 s36, s35, 1024
    s_mov_b32 m0, s36
    s_add_u32 s37, s33, 4352
    buffer_load_dwordx4 v7, s[16:19], s37 offen lds
    s_add_u32 s36, s35, 2048
    s_mov_b32 m0, s36
    s_add_u32 s37, s33, 8448
    buffer_load_dwordx4 v7, s[16:19], s37 offen lds
    s_add_u32 s36, s35, 3072
    s_mov_b32 m0, s36
    s_add_u32 s37, s33, 12544
    buffer_load_dwordx4 v7, s[16:19], s37 offen lds
    s_add_u32 s36, s35, 4096
    s_mov_b32 m0, s36
    s_add_u32 s37, s33, 16640
    buffer_load_dwordx4 v7, s[16:19], s37 offen lds
    s_add_u32 s36, s35, 5120
    s_mov_b32 m0, s36
    s_add_u32 s37, s33, 20736
    buffer_load_dwordx4 v7, s[16:19], s37 offen lds
    s_add_u32 s36, s35, 6144
    s_mov_b32 m0, s36
    s_add_u32 s37, s33, 24832
    buffer_load_dwordx4 v7, s[16:19], s37 offen lds
    v_mfma_f32_16x16x32_bf16 v[16:19], v[72:75], v[88:91], 0
    v_mfma_f32_16x16x32_bf16 v[20:23], v[72:75], v[92:95], 0
    v_mfma_f32_16x16x32_bf16 v[24:27], v[72:75], v[96:99], 0
    v_mfma_f32_16x16x32_bf16 v[28:31], v[72:75], v[100:103], 0
    v_mfma_f32_16x16x32_bf16 v[32:35], v[72:75], v[104:107], 0
    v_mfma_f32_16x16x32_bf16 v[36:39], v[72:75], v[108:111], 0
    v_mfma_f32_16x16x32_bf16 v[40:43], v[72:75], v[112:115], 0
    v_mfma_f32_16x16x32_bf16 v[44:47], v[76:79], v[88:91], 0
    v_mfma_f32_16x16x32_bf16 v[48:51], v[76:79], v[92:95], 0
    v_mfma_f32_16x16x32_bf16 v[52:55], v[76:79], v[96:99], 0
    v_mfma_f32_16x16x32_bf16 v[56:59], v[76:79], v[100:103], 0
    v_mfma_f32_16x16x32_bf16 v[60:63], v[76:79], v[104:107], 0
    v_mfma_f32_16x16x32_bf16 v[64:67], v[76:79], v[108:111], 0
    v_mfma_f32_16x16x32_bf16 v[68:71], v[76:79], v[112:115], 0
    v_mfma_f32_16x16x32_bf16 v[16:19], v[80:83], v[116:119], v[16:19]
    v_mfma_f32_16x16x32_bf16 v[20:23], v[80:83], v[120:123], v[20:23]
    v_mfma_f32_16x16x32_bf16 v[24:27], v[80:83], v[124:127], v[24:27]
    v_mfma_f32_16x16x32_bf16 v[28:31], v[80:83], v[128:131], v[28:31]
    v_mfma_f32_16x16x32_bf16 v[32:35], v[80:83], v[132:135], v[32:35]
    v_mfma_f32_16x16x32_bf16 v[36:39], v[80:83], v[136:139], v[36:39]
    v_mfma_f32_16x16x32_bf16 v[40:43], v[80:83], v[140:143], v[40:43]
    v_mfma_f32_16x16x32_bf16 v[44:47], v[84:87], v[116:119], v[44:47]
    v_mfma_f32_16x16x32_bf16 v[48:51], v[84:87], v[120:123], v[48:51]
    v_mfma_f32_16x16x32_bf16 v[52:55], v[84:87], v[124:127], v[52:55]
    v_mfma_f32_16x16x32_bf16 v[56:59], v[84:87], v[128:131], v[56:59]
    v_mfma_f32_16x16x32_bf16 v[60:63], v[84:87], v[132:135], v[60:63]
    v_mfma_f32_16x16x32_bf16 v[64:67], v[84:87], v[136:139], v[64:67]
    v_mfma_f32_16x16x32_bf16 v[68:71], v[84:87], v[140:143], v[68:71]
    s_waitcnt vmcnt(9)
    s_barrier
    ds_read_b128 v[72:75], v9 offset:36864
    ds_read_b128 v[76:79], v9 offset:38912
    ds_read_b128 v[88:91], v11 offset:36864
    ds_read_b128 v[92:95], v11 offset:38912
    ds_read_b128 v[96:99], v11 offset:40960
    ds_read_b128 v[100:103], v11 offset:43008
    ds_read_b128 v[104:107], v11 offset:45056
    ds_read_b128 v[108:111], v11 offset:47104
    ds_read_b128 v[112:115], v11 offset:49152
    ds_read_b128 v[80:83], v10 offset:36864
    ds_read_b128 v[84:87], v10 offset:38912
    ds_read_b128 v[116:119], v12 offset:36864
    ds_read_b128 v[120:123], v12 offset:38912
    ds_read_b128 v[124:127], v12 offset:40960
    ds_read_b128 v[128:131], v12 offset:43008
    ds_read_b128 v[132:135], v12 offset:45056
    ds_read_b128 v[136:139], v12 offset:47104
    ds_read_b128 v[140:143], v12 offset:49152
    s_waitcnt lgkmcnt(0)
    s_barrier
    s_add_u32 s36, s34, 36864
    s_mov_b32 m0, s36
    s_add_u32 s37, s32, 384
    buffer_load_dwordx4 v6, s[8:11], s37 offen lds
    s_add_u32 s36, s34, 37888
    s_mov_b32 m0, s36
    s_add_u32 s37, s32, 65920
    buffer_load_dwordx4 v6, s[8:11], s37 offen lds
    s_add_u32 s36, s35, 36864
    s_mov_b32 m0, s36
    s_add_u32 s37, s33, 384
    buffer_load_dwordx4 v7, s[16:19], s37 offen lds
    s_add_u32 s36, s35, 37888
    s_mov_b32 m0, s36
    s_add_u32 s37, s33, 4480
    buffer_load_dwordx4 v7, s[16:19], s37 offen lds
    s_add_u32 s36, s35, 38912
    s_mov_b32 m0, s36
    s_add_u32 s37, s33, 8576
    buffer_load_dwordx4 v7, s[16:19], s37 offen lds
    s_add_u32 s36, s35, 39936
    s_mov_b32 m0, s36
    s_add_u32 s37, s33, 12672
    buffer_load_dwordx4 v7, s[16:19], s37 offen lds
    s_add_u32 s36, s35, 40960
    s_mov_b32 m0, s36
    s_add_u32 s37, s33, 16768
    buffer_load_dwordx4 v7, s[16:19], s37 offen lds
    s_add_u32 s36, s35, 41984
    s_mov_b32 m0, s36
    s_add_u32 s37, s33, 20864
    buffer_load_dwordx4 v7, s[16:19], s37 offen lds
    s_add_u32 s36, s35, 43008
    s_mov_b32 m0, s36
    s_add_u32 s37, s33, 24960
    buffer_load_dwordx4 v7, s[16:19], s37 offen lds
    v_mfma_f32_16x16x32_bf16 v[16:19], v[72:75], v[88:91], v[16:19]
    v_mfma_f32_16x16x32_bf16 v[20:23], v[72:75], v[92:95], v[20:23]
    v_mfma_f32_16x16x32_bf16 v[24:27], v[72:75], v[96:99], v[24:27]
    v_mfma_f32_16x16x32_bf16 v[28:31], v[72:75], v[100:103], v[28:31]
    v_mfma_f32_16x16x32_bf16 v[32:35], v[72:75], v[104:107], v[32:35]
    v_mfma_f32_16x16x32_bf16 v[36:39], v[72:75], v[108:111], v[36:39]
    v_mfma_f32_16x16x32_bf16 v[40:43], v[72:75], v[112:115], v[40:43]
    v_mfma_f32_16x16x32_bf16 v[44:47], v[76:79], v[88:91], v[44:47]
    v_mfma_f32_16x16x32_bf16 v[48:51], v[76:79], v[92:95], v[48:51]
    v_mfma_f32_16x16x32_bf16 v[52:55], v[76:79], v[96:99], v[52:55]
    v_mfma_f32_16x16x32_bf16 v[56:59], v[76:79], v[100:103], v[56:59]
    v_mfma_f32_16x16x32_bf16 v[60:63], v[76:79], v[104:107], v[60:63]
    v_mfma_f32_16x16x32_bf16 v[64:67], v[76:79], v[108:111], v[64:67]
    v_mfma_f32_16x16x32_bf16 v[68:71], v[76:79], v[112:115], v[68:71]
    v_mfma_f32_16x16x32_bf16 v[16:19], v[80:83], v[116:119], v[16:19]
    v_mfma_f32_16x16x32_bf16 v[20:23], v[80:83], v[120:123], v[20:23]
    v_mfma_f32_16x16x32_bf16 v[24:27], v[80:83], v[124:127], v[24:27]
    v_mfma_f32_16x16x32_bf16 v[28:31], v[80:83], v[128:131], v[28:31]
    v_mfma_f32_16x16x32_bf16 v[32:35], v[80:83], v[132:135], v[32:35]
    v_mfma_f32_16x16x32_bf16 v[36:39], v[80:83], v[136:139], v[36:39]
    v_mfma_f32_16x16x32_bf16 v[40:43], v[80:83], v[140:143], v[40:43]
    v_mfma_f32_16x16x32_bf16 v[44:47], v[84:87], v[116:119], v[44:47]
    v_mfma_f32_16x16x32_bf16 v[48:51], v[84:87], v[120:123], v[48:51]
    v_mfma_f32_16x16x32_bf16 v[52:55], v[84:87], v[124:127], v[52:55]
    v_mfma_f32_16x16x32_bf16 v[56:59], v[84:87], v[128:131], v[56:59]
    v_mfma_f32_16x16x32_bf16 v[60:63], v[84:87], v[132:135], v[60:63]
    v_mfma_f32_16x16x32_bf16 v[64:67], v[84:87], v[136:139], v[64:67]
    v_mfma_f32_16x16x32_bf16 v[68:71], v[84:87], v[140:143], v[68:71]
    s_waitcnt vmcnt(9)
    s_barrier
    ds_read_b128 v[72:75], v9 offset:0
    ds_read_b128 v[76:79], v9 offset:2048
    ds_read_b128 v[88:91], v11 offset:0
    ds_read_b128 v[92:95], v11 offset:2048
    ds_read_b128 v[96:99], v11 offset:4096
    ds_read_b128 v[100:103], v11 offset:6144
    ds_read_b128 v[104:107], v11 offset:8192
    ds_read_b128 v[108:111], v11 offset:10240
    ds_read_b128 v[112:115], v11 offset:12288
    ds_read_b128 v[80:83], v10 offset:0
    ds_read_b128 v[84:87], v10 offset:2048
    ds_read_b128 v[116:119], v12 offset:0
    ds_read_b128 v[120:123], v12 offset:2048
    ds_read_b128 v[124:127], v12 offset:4096
    ds_read_b128 v[128:131], v12 offset:6144
    ds_read_b128 v[132:135], v12 offset:8192
    ds_read_b128 v[136:139], v12 offset:10240
    ds_read_b128 v[140:143], v12 offset:12288
    s_waitcnt lgkmcnt(0)
    s_barrier
    v_mfma_f32_16x16x32_bf16 v[16:19], v[72:75], v[88:91], v[16:19]
    v_mfma_f32_16x16x32_bf16 v[20:23], v[72:75], v[92:95], v[20:23]
    v_mfma_f32_16x16x32_bf16 v[24:27], v[72:75], v[96:99], v[24:27]
    v_mfma_f32_16x16x32_bf16 v[28:31], v[72:75], v[100:103], v[28:31]
    v_mfma_f32_16x16x32_bf16 v[32:35], v[72:75], v[104:107], v[32:35]
    v_mfma_f32_16x16x32_bf16 v[36:39], v[72:75], v[108:111], v[36:39]
    v_mfma_f32_16x16x32_bf16 v[40:43], v[72:75], v[112:115], v[40:43]
    v_mfma_f32_16x16x32_bf16 v[44:47], v[76:79], v[88:91], v[44:47]
    v_mfma_f32_16x16x32_bf16 v[48:51], v[76:79], v[92:95], v[48:51]
    v_mfma_f32_16x16x32_bf16 v[52:55], v[76:79], v[96:99], v[52:55]
    v_mfma_f32_16x16x32_bf16 v[56:59], v[76:79], v[100:103], v[56:59]
    v_mfma_f32_16x16x32_bf16 v[60:63], v[76:79], v[104:107], v[60:63]
    v_mfma_f32_16x16x32_bf16 v[64:67], v[76:79], v[108:111], v[64:67]
    v_mfma_f32_16x16x32_bf16 v[68:71], v[76:79], v[112:115], v[68:71]
    v_mfma_f32_16x16x32_bf16 v[16:19], v[80:83], v[116:119], v[16:19]
    v_mfma_f32_16x16x32_bf16 v[20:23], v[80:83], v[120:123], v[20:23]
    v_mfma_f32_16x16x32_bf16 v[24:27], v[80:83], v[124:127], v[24:27]
    v_mfma_f32_16x16x32_bf16 v[28:31], v[80:83], v[128:131], v[28:31]
    v_mfma_f32_16x16x32_bf16 v[32:35], v[80:83], v[132:135], v[32:35]
    v_mfma_f32_16x16x32_bf16 v[36:39], v[80:83], v[136:139], v[36:39]
    v_mfma_f32_16x16x32_bf16 v[40:43], v[80:83], v[140:143], v[40:43]
    v_mfma_f32_16x16x32_bf16 v[44:47], v[84:87], v[116:119], v[44:47]
    v_mfma_f32_16x16x32_bf16 v[48:51], v[84:87], v[120:123], v[48:51]
    v_mfma_f32_16x16x32_bf16 v[52:55], v[84:87], v[124:127], v[52:55]
    v_mfma_f32_16x16x32_bf16 v[56:59], v[84:87], v[128:131], v[56:59]
    v_mfma_f32_16x16x32_bf16 v[60:63], v[84:87], v[132:135], v[60:63]
    v_mfma_f32_16x16x32_bf16 v[64:67], v[84:87], v[136:139], v[64:67]
    v_mfma_f32_16x16x32_bf16 v[68:71], v[84:87], v[140:143], v[68:71]
    s_waitcnt vmcnt(0)
    s_barrier
    ds_read_b128 v[72:75], v9 offset:36864
    ds_read_b128 v[76:79], v9 offset:38912
    ds_read_b128 v[88:91], v11 offset:36864
    ds_read_b128 v[92:95], v11 offset:38912
    ds_read_b128 v[96:99], v11 offset:40960
    ds_read_b128 v[100:103], v11 offset:43008
    ds_read_b128 v[104:107], v11 offset:45056
    ds_read_b128 v[108:111], v11 offset:47104
    ds_read_b128 v[112:115], v11 offset:49152
    ds_read_b128 v[80:83], v10 offset:36864
    ds_read_b128 v[84:87], v10 offset:38912
    ds_read_b128 v[116:119], v12 offset:36864
    ds_read_b128 v[120:123], v12 offset:38912
    ds_read_b128 v[124:127], v12 offset:40960
    ds_read_b128 v[128:131], v12 offset:43008
    ds_read_b128 v[132:135], v12 offset:45056
    ds_read_b128 v[136:139], v12 offset:47104
    ds_read_b128 v[140:143], v12 offset:49152
    s_waitcnt lgkmcnt(0)
    s_barrier
    v_mfma_f32_16x16x32_bf16 v[16:19], v[72:75], v[88:91], v[16:19]
    v_mfma_f32_16x16x32_bf16 v[20:23], v[72:75], v[92:95], v[20:23]
    v_mfma_f32_16x16x32_bf16 v[24:27], v[72:75], v[96:99], v[24:27]
    v_mfma_f32_16x16x32_bf16 v[28:31], v[72:75], v[100:103], v[28:31]
    v_mfma_f32_16x16x32_bf16 v[32:35], v[72:75], v[104:107], v[32:35]
    v_mfma_f32_16x16x32_bf16 v[36:39], v[72:75], v[108:111], v[36:39]
    v_mfma_f32_16x16x32_bf16 v[40:43], v[72:75], v[112:115], v[40:43]
    v_mfma_f32_16x16x32_bf16 v[44:47], v[76:79], v[88:91], v[44:47]
    v_mfma_f32_16x16x32_bf16 v[48:51], v[76:79], v[92:95], v[48:51]
    v_mfma_f32_16x16x32_bf16 v[52:55], v[76:79], v[96:99], v[52:55]
    v_mfma_f32_16x16x32_bf16 v[56:59], v[76:79], v[100:103], v[56:59]
    v_mfma_f32_16x16x32_bf16 v[60:63], v[76:79], v[104:107], v[60:63]
    v_mfma_f32_16x16x32_bf16 v[64:67], v[76:79], v[108:111], v[64:67]
    v_mfma_f32_16x16x32_bf16 v[68:71], v[76:79], v[112:115], v[68:71]
    v_mfma_f32_16x16x32_bf16 v[16:19], v[80:83], v[116:119], v[16:19]
    v_mfma_f32_16x16x32_bf16 v[20:23], v[80:83], v[120:123], v[20:23]
    v_mfma_f32_16x16x32_bf16 v[24:27], v[80:83], v[124:127], v[24:27]
    v_mfma_f32_16x16x32_bf16 v[28:31], v[80:83], v[128:131], v[28:31]
    v_mfma_f32_16x16x32_bf16 v[32:35], v[80:83], v[132:135], v[32:35]
    v_mfma_f32_16x16x32_bf16 v[36:39], v[80:83], v[136:139], v[36:39]
    v_mfma_f32_16x16x32_bf16 v[40:43], v[80:83], v[140:143], v[40:43]
    v_mfma_f32_16x16x32_bf16 v[44:47], v[84:87], v[116:119], v[44:47]
    v_mfma_f32_16x16x32_bf16 v[48:51], v[84:87], v[120:123], v[48:51]
    v_mfma_f32_16x16x32_bf16 v[52:55], v[84:87], v[124:127], v[52:55]
    v_mfma_f32_16x16x32_bf16 v[56:59], v[84:87], v[128:131], v[56:59]
    v_mfma_f32_16x16x32_bf16 v[60:63], v[84:87], v[132:135], v[60:63]
    v_mfma_f32_16x16x32_bf16 v[64:67], v[84:87], v[136:139], v[64:67]
    v_mfma_f32_16x16x32_bf16 v[68:71], v[84:87], v[140:143], v[68:71]
    s_nop 7
    v_lshrrev_b32 v6, 1, v3
    v_lshlrev_b32 v6, 8, v6
    v_lshl_add_u32 v6, v2, 4, v6
    v_and_b32 v7, 1, v3
    v_lshl_add_u32 v6, v7, 3, v6
    s_add_u32 s40, s26, 16
    s_mul_i32 s40, s40, 28
    s_mul_i32 s41, s28, 14
    s_add_u32 s40, s40, s41
    s_and_b32 s41, s3, 1
    s_mul_i32 s41, s41, 7
    s_add_u32 s40, s40, s41
    s_mul_i32 s40, s40, 14336
    s_lshl_b32 s41, s27, 11
    s_add_u32 s40, s40, s41
    s_lshr_b32 s41, s3, 1
    s_lshl_b32 s41, s41, 10
    s_add_u32 s40, s40, s41
    s_add_u32 s40, s40, 5275648
    v_mul_f32 v16, s31, v16
    v_mul_f32 v17, s31, v17
    v_mul_f32 v18, s31, v18
    v_mul_f32 v19, s31, v19
    v_cvt_pk_bf16_f32 v16, v16, v17
    v_cvt_pk_bf16_f32 v17, v18, v19
    buffer_store_dwordx2 v[16:17], v6, s[20:23], s40 offen offset:0
    v_mul_f32 v44, s31, v44
    v_mul_f32 v45, s31, v45
    v_mul_f32 v46, s31, v46
    v_mul_f32 v47, s31, v47
    v_cvt_pk_bf16_f32 v44, v44, v45
    v_cvt_pk_bf16_f32 v45, v46, v47
    buffer_store_dwordx2 v[44:45], v6, s[20:23], s40 offen offset:512
    s_add_u32 s40, s40, 14336
    v_mul_f32 v20, s31, v20
    v_mul_f32 v21, s31, v21
    v_mul_f32 v22, s31, v22
    v_mul_f32 v23, s31, v23
    v_cvt_pk_bf16_f32 v20, v20, v21
    v_cvt_pk_bf16_f32 v21, v22, v23
    buffer_store_dwordx2 v[20:21], v6, s[20:23], s40 offen offset:0
    v_mul_f32 v48, s31, v48
    v_mul_f32 v49, s31, v49
    v_mul_f32 v50, s31, v50
    v_mul_f32 v51, s31, v51
    v_cvt_pk_bf16_f32 v48, v48, v49
    v_cvt_pk_bf16_f32 v49, v50, v51
    buffer_store_dwordx2 v[48:49], v6, s[20:23], s40 offen offset:512
    s_add_u32 s40, s40, 14336
    v_mul_f32 v24, s31, v24
    v_mul_f32 v25, s31, v25
    v_mul_f32 v26, s31, v26
    v_mul_f32 v27, s31, v27
    v_cvt_pk_bf16_f32 v24, v24, v25
    v_cvt_pk_bf16_f32 v25, v26, v27
    buffer_store_dwordx2 v[24:25], v6, s[20:23], s40 offen offset:0
    v_mul_f32 v52, s31, v52
    v_mul_f32 v53, s31, v53
    v_mul_f32 v54, s31, v54
    v_mul_f32 v55, s31, v55
    v_cvt_pk_bf16_f32 v52, v52, v53
    v_cvt_pk_bf16_f32 v53, v54, v55
    buffer_store_dwordx2 v[52:53], v6, s[20:23], s40 offen offset:512
    s_add_u32 s40, s40, 14336
    v_mul_f32 v28, s31, v28
    v_mul_f32 v29, s31, v29
    v_mul_f32 v30, s31, v30
    v_mul_f32 v31, s31, v31
    v_cvt_pk_bf16_f32 v28, v28, v29
    v_cvt_pk_bf16_f32 v29, v30, v31
    buffer_store_dwordx2 v[28:29], v6, s[20:23], s40 offen offset:0
    v_mul_f32 v56, s31, v56
    v_mul_f32 v57, s31, v57
    v_mul_f32 v58, s31, v58
    v_mul_f32 v59, s31, v59
    v_cvt_pk_bf16_f32 v56, v56, v57
    v_cvt_pk_bf16_f32 v57, v58, v59
    buffer_store_dwordx2 v[56:57], v6, s[20:23], s40 offen offset:512
    s_add_u32 s40, s40, 14336
    v_mul_f32 v32, s31, v32
    v_mul_f32 v33, s31, v33
    v_mul_f32 v34, s31, v34
    v_mul_f32 v35, s31, v35
    v_cvt_pk_bf16_f32 v32, v32, v33
    v_cvt_pk_bf16_f32 v33, v34, v35
    buffer_store_dwordx2 v[32:33], v6, s[20:23], s40 offen offset:0
    v_mul_f32 v60, s31, v60
    v_mul_f32 v61, s31, v61
    v_mul_f32 v62, s31, v62
    v_mul_f32 v63, s31, v63
    v_cvt_pk_bf16_f32 v60, v60, v61
    v_cvt_pk_bf16_f32 v61, v62, v63
    buffer_store_dwordx2 v[60:61], v6, s[20:23], s40 offen offset:512
    s_add_u32 s40, s40, 14336
    v_mul_f32 v36, s31, v36
    v_mul_f32 v37, s31, v37
    v_mul_f32 v38, s31, v38
    v_mul_f32 v39, s31, v39
    v_cvt_pk_bf16_f32 v36, v36, v37
    v_cvt_pk_bf16_f32 v37, v38, v39
    buffer_store_dwordx2 v[36:37], v6, s[20:23], s40 offen offset:0
    v_mul_f32 v64, s31, v64
    v_mul_f32 v65, s31, v65
    v_mul_f32 v66, s31, v66
    v_mul_f32 v67, s31, v67
    v_cvt_pk_bf16_f32 v64, v64, v65
    v_cvt_pk_bf16_f32 v65, v66, v67
    buffer_store_dwordx2 v[64:65], v6, s[20:23], s40 offen offset:512
    s_add_u32 s40, s40, 14336
    v_mul_f32 v40, s31, v40
    v_mul_f32 v41, s31, v41
    v_mul_f32 v42, s31, v42
    v_mul_f32 v43, s31, v43
    v_cvt_pk_bf16_f32 v40, v40, v41
    v_cvt_pk_bf16_f32 v41, v42, v43
    buffer_store_dwordx2 v[40:41], v6, s[20:23], s40 offen offset:0
    v_mul_f32 v68, s31, v68
    v_mul_f32 v69, s31, v69
    v_mul_f32 v70, s31, v70
    v_mul_f32 v71, s31, v71
    v_cvt_pk_bf16_f32 v68, v68, v69
    v_cvt_pk_bf16_f32 v69, v70, v71
    buffer_store_dwordx2 v[68:69], v6, s[20:23], s40 offen offset:512
    s_endpgm
k3_go:
    s_sub_u32 s2, s2, 224
    s_load_dwordx2 s[14:15], s[0:1], 96
    v_and_b32 v1, 63, v0
    v_lshrrev_b32 v2, 6, v0
    s_nop 0
    v_readfirstlane_b32 s3, v2
    v_and_b32 v2, 15, v1
    v_lshrrev_b32 v3, 4, v1
    s_lshl_b32 s24, s2, 2
    s_add_u32 s24, s24, s3
    s_lshr_b32 s25, s24, 7
    s_and_b32 s24, s24, 127
    s_waitcnt lgkmcnt(0)
    s_mov_b32 s20, s14
    s_and_b32 s21, s15, 0xffff
    s_mov_b32 s22, 268435456
    s_mov_b32 s23, 0x20000
    v_lshlrev_b32 v4, 6, v2
    v_lshl_add_u32 v4, v3, 4, v4
    s_lshl_b32 s26, s25, 17
    s_lshl_b32 s27, s24, 10
    s_add_u32 s28, s26, s27
    s_add_u32 s28, s28, 18120704
    buffer_load_dwordx4 v[8:11], v4, s[20:23], s28 offen
    v_lshlrev_b32 v5, 4, v1
    s_lshr_b32 s34, s24, 1
    s_sub_i32 s29, s34, 8
    s_max_i32 s29, s29, 0
    s_lshl_b32 s30, s29, 11
    s_add_u32 s30, s30, s26
    s_add_u32 s31, s30, 20217856
    s_add_u32 s30, s30, 22315008
    buffer_load_dwordx4 v[12:15], v4, s[20:23], s31 offen
    buffer_load_dwordx4 v[16:19], v4, s[20:23], s31 offen offset:1024
    buffer_load_dwordx4 v[84:87], v5, s[20:23], s30 offen
    buffer_load_dwordx4 v[88:91], v5, s[20:23], s30 offen offset:1024
    s_sub_i32 s29, s34, 7
    s_max_i32 s29, s29, 0
    s_lshl_b32 s30, s29, 11
    s_add_u32 s30, s30, s26
    s_add_u32 s31, s30, 20217856
    s_add_u32 s30, s30, 22315008
    buffer_load_dwordx4 v[20:23], v4, s[20:23], s31 offen
    buffer_load_dwordx4 v[24:27], v4, s[20:23], s31 offen offset:1024
    buffer_load_dwordx4 v[92:95], v5, s[20:23], s30 offen
    buffer_load_dwordx4 v[96:99], v5, s[20:23], s30 offen offset:1024
    s_sub_i32 s29, s34, 6
    s_max_i32 s29, s29, 0
    s_lshl_b32 s30, s29, 11
    s_add_u32 s30, s30, s26
    s_add_u32 s31, s30, 20217856
    s_add_u32 s30, s30, 22315008
    buffer_load_dwordx4 v[28:31], v4, s[20:23], s31 offen
    buffer_load_dwordx4 v[32:35], v4, s[20:23], s31 offen offset:1024
    buffer_load_dwordx4 v[100:103], v5, s[20:23], s30 offen
    buffer_load_dwordx4 v[104:107], v5, s[20:23], s30 offen offset:1024
    s_sub_i32 s29, s34, 5
    s_max_i32 s29, s29, 0
    s_lshl_b32 s30, s29, 11
    s_add_u32 s30, s30, s26
    s_add_u32 s31, s30, 20217856
    s_add_u32 s30, s30, 22315008
    buffer_load_dwordx4 v[36:39], v4, s[20:23], s31 offen
    buffer_load_dwordx4 v[40:43], v4, s[20:23], s31 offen offset:1024
    buffer_load_dwordx4 v[108:111], v5, s[20:23], s30 offen
    buffer_load_dwordx4 v[112:115], v5, s[20:23], s30 offen offset:1024
    s_sub_i32 s29, s34, 4
    s_max_i32 s29, s29, 0
    s_lshl_b32 s30, s29, 11
    s_add_u32 s30, s30, s26
    s_add_u32 s31, s30, 20217856
    s_add_u32 s30, s30, 22315008
    buffer_load_dwordx4 v[44:47], v4, s[20:23], s31 offen
    buffer_load_dwordx4 v[48:51], v4, s[20:23], s31 offen offset:1024
    buffer_load_dwordx4 v[116:119], v5, s[20:23], s30 offen
    buffer_load_dwordx4 v[120:123], v5, s[20:23], s30 offen offset:1024
    s_sub_i32 s29, s34, 3
    s_max_i32 s29, s29, 0
    s_lshl_b32 s30, s29, 11
    s_add_u32 s30, s30, s26
    s_add_u32 s31, s30, 20217856
    s_add_u32 s30, s30, 22315008
    buffer_load_dwordx4 v[52:55], v4, s[20:23], s31 offen
    buffer_load_dwordx4 v[56:59], v4, s[20:23], s31 offen offset:1024
    buffer_load_dwordx4 v[124:127], v5, s[20:23], s30 offen
    buffer_load_dwordx4 v[128:131], v5, s[20:23], s30 offen offset:1024
    s_sub_i32 s29, s34, 2
    s_max_i32 s29, s29, 0
    s_lshl_b32 s30, s29, 11
    s_add_u32 s30, s30, s26
    s_add_u32 s31, s30, 20217856
    s_add_u32 s30, s30, 22315008
    buffer_load_dwordx4 v[60:63], v4, s[20:23], s31 offen
    buffer_load_dwordx4 v[64:67], v4, s[20:23], s31 offen offset:1024
    buffer_load_dwordx4 v[132:135], v5, s[20:23], s30 offen
    buffer_load_dwordx4 v[136:139], v5, s[20:23], s30 offen offset:1024
    s_sub_i32 s29, s34, 1
    s_max_i32 s29, s29, 0
    s_lshl_b32 s30, s29, 11
    s_add_u32 s30, s30, s26
    s_add_u32 s31, s30, 20217856
    s_add_u32 s30, s30, 22315008
    buffer_load_dwordx4 v[68:71], v4, s[20:23], s31 offen
    buffer_load_dwordx4 v[72:75], v4, s[20:23], s31 offen offset:1024
    buffer_load_dwordx4 v[140:143], v5, s[20:23], s30 offen
    buffer_load_dwordx4 v[144:147], v5, s[20:23], s30 offen offset:1024
    s_sub_i32 s29, s34, 0
    s_max_i32 s29, s29, 0
    s_lshl_b32 s30, s29, 11
    s_add_u32 s30, s30, s26
    s_add_u32 s31, s30, 20217856
    s_add_u32 s30, s30, 22315008
    buffer_load_dwordx4 v[76:79], v4, s[20:23], s31 offen
    buffer_load_dwordx4 v[80:83], v4, s[20:23], s31 offen offset:1024
    buffer_load_dwordx4 v[148:151], v5, s[20:23], s30 offen
    buffer_load_dwordx4 v[152:155], v5, s[20:23], s30 offen offset:1024
    s_waitcnt vmcnt(0)
    v_mfma_f32_16x16x32_bf16 v[156:159], v[12:15], v[8:11], 0
    v_mfma_f32_16x16x32_bf16 v[160:163], v[16:19], v[8:11], 0
    v_mfma_f32_16x16x32_bf16 v[164:167], v[20:23], v[8:11], 0
    v_mfma_f32_16x16x32_bf16 v[168:171], v[24:27], v[8:11], 0
    v_mfma_f32_16x16x32_bf16 v[172:175], v[28:31], v[8:11], 0
    v_mfma_f32_16x16x32_bf16 v[176:179], v[32:35], v[8:11], 0
    v_mfma_f32_16x16x32_bf16 v[180:183], v[36:39], v[8:11], 0
    v_mfma_f32_16x16x32_bf16 v[184:187], v[40:43], v[8:11], 0
    v_mfma_f32_16x16x32_bf16 v[188:191], v[44:47], v[8:11], 0
    v_mfma_f32_16x16x32_bf16 v[192:195], v[48:51], v[8:11], 0
    v_mfma_f32_16x16x32_bf16 v[196:199], v[52:55], v[8:11], 0
    v_mfma_f32_16x16x32_bf16 v[200:203], v[56:59], v[8:11], 0
    v_mfma_f32_16x16x32_bf16 v[204:207], v[60:63], v[8:11], 0
    v_mfma_f32_16x16x32_bf16 v[208:211], v[64:67], v[8:11], 0
    v_mfma_f32_16x16x32_bf16 v[212:215], v[68:71], v[8:11], 0
    v_mfma_f32_16x16x32_bf16 v[216:219], v[72:75], v[8:11], 0
    v_mfma_f32_16x16x32_bf16 v[220:223], v[76:79], v[8:11], 0
    v_mfma_f32_16x16x32_bf16 v[224:227], v[80:83], v[8:11], 0
    s_and_b32 s35, s24, 1
    s_lshl_b32 s35, s35, 4
    v_lshlrev_b32 v7, 2, v3
    v_sub_u32 v7, v2, v7
    v_add_u32 v7, s35, v7
    v_mov_b32 v6, 0xff800000
    s_movk_i32 s36, 256
    s_nop 4
    v_add_u32 v229, 256, v7
    v_cmp_gt_u32 vcc, s36, v229
    s_nop 1
    v_cndmask_b32 v156, v6, v156, vcc
    v_add_u32 v229, 255, v7
    v_cmp_gt_u32 vcc, s36, v229
    s_nop 1
    v_cndmask_b32 v157, v6, v157, vcc
    v_add_u32 v229, 254, v7
    v_cmp_gt_u32 vcc, s36, v229
    s_nop 1
    v_cndmask_b32 v158, v6, v158, vcc
    v_add_u32 v229, 253, v7
    v_cmp_gt_u32 vcc, s36, v229
    s_nop 1
    v_cndmask_b32 v159, v6, v159, vcc
    v_add_u32 v229, 240, v7
    v_cmp_gt_u32 vcc, s36, v229
    s_nop 1
    v_cndmask_b32 v160, v6, v160, vcc
    v_add_u32 v229, 239, v7
    v_cmp_gt_u32 vcc, s36, v229
    s_nop 1
    v_cndmask_b32 v161, v6, v161, vcc
    v_add_u32 v229, 238, v7
    v_cmp_gt_u32 vcc, s36, v229
    s_nop 1
    v_cndmask_b32 v162, v6, v162, vcc
    v_add_u32 v229, 237, v7
    v_cmp_gt_u32 vcc, s36, v229
    s_nop 1
    v_cndmask_b32 v163, v6, v163, vcc
    v_add_u32 v229, 0, v7
    v_cmp_gt_u32 vcc, s36, v229
    s_nop 1
    v_cndmask_b32 v220, v6, v220, vcc
    v_add_u32 v229, -1, v7
    v_cmp_gt_u32 vcc, s36, v229
    s_nop 1
    v_cndmask_b32 v221, v6, v221, vcc
    v_add_u32 v229, -2, v7
    v_cmp_gt_u32 vcc, s36, v229
    s_nop 1
    v_cndmask_b32 v222, v6, v222, vcc
    v_add_u32 v229, -3, v7
    v_cmp_gt_u32 vcc, s36, v229
    s_nop 1
    v_cndmask_b32 v223, v6, v223, vcc
    v_add_u32 v229, -16, v7
    v_cmp_gt_u32 vcc, s36, v229
    s_nop 1
    v_cndmask_b32 v224, v6, v224, vcc
    v_add_u32 v229, -17, v7
    v_cmp_gt_u32 vcc, s36, v229
    s_nop 1
    v_cndmask_b32 v225, v6, v225, vcc
    v_add_u32 v229, -18, v7
    v_cmp_gt_u32 vcc, s36, v229
    s_nop 1
    v_cndmask_b32 v226, v6, v226, vcc
    v_add_u32 v229, -19, v7
    v_cmp_gt_u32 vcc, s36, v229
    s_nop 1
    v_cndmask_b32 v227, v6, v227, vcc
    s_cmp_ge_u32 s34, 8
    s_cbranch_scc1 k3_kernel_m1
    v_mov_b32 v156, v6
    v_mov_b32 v157, v6
    v_mov_b32 v158, v6
    v_mov_b32 v159, v6
    v_mov_b32 v160, v6
    v_mov_b32 v161, v6
    v_mov_b32 v162, v6
    v_mov_b32 v163, v6
k3_kernel_m1:
    s_cmp_ge_u32 s34, 7
    s_cbranch_scc1 k3_kernel_m2
    v_mov_b32 v164, v6
    v_mov_b32 v165, v6
    v_mov_b32 v166, v6
    v_mov_b32 v167, v6
    v_mov_b32 v168, v6
    v_mov_b32 v169, v6
    v_mov_b32 v170, v6
    v_mov_b32 v171, v6
k3_kernel_m2:
    s_cmp_ge_u32 s34, 6
    s_cbranch_scc1 k3_kernel_m3
    v_mov_b32 v172, v6
    v_mov_b32 v173, v6
    v_mov_b32 v174, v6
    v_mov_b32 v175, v6
    v_mov_b32 v176, v6
    v_mov_b32 v177, v6
    v_mov_b32 v178, v6
    v_mov_b32 v179, v6
k3_kernel_m3:
    s_cmp_ge_u32 s34, 5
    s_cbranch_scc1 k3_kernel_m4
    v_mov_b32 v180, v6
    v_mov_b32 v181, v6
    v_mov_b32 v182, v6
    v_mov_b32 v183, v6
    v_mov_b32 v184, v6
    v_mov_b32 v185, v6
    v_mov_b32 v186, v6
    v_mov_b32 v187, v6
k3_kernel_m4:
    s_cmp_ge_u32 s34, 4
    s_cbranch_scc1 k3_kernel_m5
    v_mov_b32 v188, v6
    v_mov_b32 v189, v6
    v_mov_b32 v190, v6
    v_mov_b32 v191, v6
    v_mov_b32 v192, v6
    v_mov_b32 v193, v6
    v_mov_b32 v194, v6
    v_mov_b32 v195, v6
k3_kernel_m5:
    s_cmp_ge_u32 s34, 3
    s_cbranch_scc1 k3_kernel_m6
    v_mov_b32 v196, v6
    v_mov_b32 v197, v6
    v_mov_b32 v198, v6
    v_mov_b32 v199, v6
    v_mov_b32 v200, v6
    v_mov_b32 v201, v6
    v_mov_b32 v202, v6
    v_mov_b32 v203, v6
k3_kernel_m6:
    s_cmp_ge_u32 s34, 2
    s_cbranch_scc1 k3_kernel_m7
    v_mov_b32 v204, v6
    v_mov_b32 v205, v6
    v_mov_b32 v206, v6
    v_mov_b32 v207, v6
    v_mov_b32 v208, v6
    v_mov_b32 v209, v6
    v_mov_b32 v210, v6
    v_mov_b32 v211, v6
k3_kernel_m7:
    s_cmp_ge_u32 s34, 1
    s_cbranch_scc1 k3_kernel_m8
    v_mov_b32 v212, v6
    v_mov_b32 v213, v6
    v_mov_b32 v214, v6
    v_mov_b32 v215, v6
    v_mov_b32 v216, v6
    v_mov_b32 v217, v6
    v_mov_b32 v218, v6
    v_mov_b32 v219, v6
k3_kernel_m8:
    v_max3_f32 v228, v156, v157, v158
    v_max3_f32 v228, v228, v159, v160
    v_max3_f32 v228, v228, v161, v162
    v_max3_f32 v228, v228, v163, v164
    v_max3_f32 v228, v228, v165, v166
    v_max3_f32 v228, v228, v167, v168
    v_max3_f32 v228, v228, v169, v170
    v_max3_f32 v228, v228, v171, v172
    v_max3_f32 v228, v228, v173, v174
    v_max3_f32 v228, v228, v175, v176
    v_max3_f32 v228, v228, v177, v178
    v_max3_f32 v228, v228, v179, v180
    v_max3_f32 v228, v228, v181, v182
    v_max3_f32 v228, v228, v183, v184
    v_max3_f32 v228, v228, v185, v186
    v_max3_f32 v228, v228, v187, v188
    v_max3_f32 v228, v228, v189, v190
    v_max3_f32 v228, v228, v191, v192
    v_max3_f32 v228, v228, v193, v194
    v_max3_f32 v228, v228, v195, v196
    v_max3_f32 v228, v228, v197, v198
    v_max3_f32 v228, v228, v199, v200
    v_max3_f32 v228, v228, v201, v202
    v_max3_f32 v228, v228, v203, v204
    v_max3_f32 v228, v228, v205, v206
    v_max3_f32 v228, v228, v207, v208
    v_max3_f32 v228, v228, v209, v210
    v_max3_f32 v228, v228, v211, v212
    v_max3_f32 v228, v228, v213, v214
    v_max3_f32 v228, v228, v215, v216
    v_max3_f32 v228, v228, v217, v218
    v_max3_f32 v228, v228, v219, v220
    v_max3_f32 v228, v228, v221, v222
    v_max3_f32 v228, v228, v223, v224
    v_max3_f32 v228, v228, v225, v226
    v_max_f32 v228, v228, v227
    v_mov_b32 v229, v228
    s_nop 1
    v_permlane16_swap_b32 v228, v229
    v_max_f32 v228, v228, v229
    v_mov_b32 v229, v228
    s_nop 1
    v_permlane32_swap_b32 v228, v229
    v_max_f32 v228, v228, v229
    s_mov_b32 s40, 1049335798
    v_mul_f32 v228, s40, v228
    v_sub_f32 v228, 0, v228
    v_fma_f32 v156, v156, s40, v228
    v_fma_f32 v157, v157, s40, v228
    v_fma_f32 v158, v158, s40, v228
    v_fma_f32 v159, v159, s40, v228
    v_fma_f32 v160, v160, s40, v228
    v_fma_f32 v161, v161, s40, v228
    v_fma_f32 v162, v162, s40, v228
    v_fma_f32 v163, v163, s40, v228
    v_fma_f32 v164, v164, s40, v228
    v_fma_f32 v165, v165, s40, v228
    v_fma_f32 v166, v166, s40, v228
    v_fma_f32 v167, v167, s40, v228
    v_fma_f32 v168, v168, s40, v228
    v_fma_f32 v169, v169, s40, v228
    v_fma_f32 v170, v170, s40, v228
    v_fma_f32 v171, v171, s40, v228
    v_fma_f32 v172, v172, s40, v228
    v_fma_f32 v173, v173, s40, v228
    v_fma_f32 v174, v174, s40, v228
    v_fma_f32 v175, v175, s40, v228
    v_fma_f32 v176, v176, s40, v228
    v_fma_f32 v177, v177, s40, v228
    v_fma_f32 v178, v178, s40, v228
    v_fma_f32 v179, v179, s40, v228
    v_fma_f32 v180, v180, s40, v228
    v_fma_f32 v181, v181, s40, v228
    v_fma_f32 v182, v182, s40, v228
    v_fma_f32 v183, v183, s40, v228
    v_fma_f32 v184, v184, s40, v228
    v_fma_f32 v185, v185, s40, v228
    v_fma_f32 v186, v186, s40, v228
    v_fma_f32 v187, v187, s40, v228
    v_fma_f32 v188, v188, s40, v228
    v_fma_f32 v189, v189, s40, v228
    v_fma_f32 v190, v190, s40, v228
    v_fma_f32 v191, v191, s40, v228
    v_fma_f32 v192, v192, s40, v228
    v_fma_f32 v193, v193, s40, v228
    v_fma_f32 v194, v194, s40, v228
    v_fma_f32 v195, v195, s40, v228
    v_fma_f32 v196, v196, s40, v228
    v_fma_f32 v197, v197, s40, v228
    v_fma_f32 v198, v198, s40, v228
    v_fma_f32 v199, v199, s40, v228
    v_fma_f32 v200, v200, s40, v228
    v_fma_f32 v201, v201, s40, v228
    v_fma_f32 v202, v202, s40, v228
    v_fma_f32 v203, v203, s40, v228
    v_fma_f32 v204, v204, s40, v228
    v_fma_f32 v205, v205, s40, v228
    v_fma_f32 v206, v206, s40, v228
    v_fma_f32 v207, v207, s40, v228
    v_fma_f32 v208, v208, s40, v228
    v_fma_f32 v209, v209, s40, v228
    v_fma_f32 v210, v210, s40, v228
    v_fma_f32 v211, v211, s40, v228
    v_fma_f32 v212, v212, s40, v228
    v_fma_f32 v213, v213, s40, v228
    v_fma_f32 v214, v214, s40, v228
    v_fma_f32 v215, v215, s40, v228
    v_fma_f32 v216, v216, s40, v228
    v_fma_f32 v217, v217, s40, v228
    v_fma_f32 v218, v218, s40, v228
    v_fma_f32 v219, v219, s40, v228
    v_fma_f32 v220, v220, s40, v228
    v_fma_f32 v221, v221, s40, v228
    v_fma_f32 v222, v222, s40, v228
    v_fma_f32 v223, v223, s40, v228
    v_fma_f32 v224, v224, s40, v228
    v_fma_f32 v225, v225, s40, v228
    v_fma_f32 v226, v226, s40, v228
    v_fma_f32 v227, v227, s40, v228
    v_exp_f32 v156, v156
    v_exp_f32 v157, v157
    v_exp_f32 v158, v158
    v_exp_f32 v159, v159
    v_exp_f32 v160, v160
    v_exp_f32 v161, v161
    v_exp_f32 v162, v162
    v_exp_f32 v163, v163
    v_exp_f32 v164, v164
    v_exp_f32 v165, v165
    v_exp_f32 v166, v166
    v_exp_f32 v167, v167
    v_exp_f32 v168, v168
    v_exp_f32 v169, v169
    v_exp_f32 v170, v170
    v_exp_f32 v171, v171
    v_exp_f32 v172, v172
    v_exp_f32 v173, v173
    v_exp_f32 v174, v174
    v_exp_f32 v175, v175
    v_exp_f32 v176, v176
    v_exp_f32 v177, v177
    v_exp_f32 v178, v178
    v_exp_f32 v179, v179
    v_exp_f32 v180, v180
    v_exp_f32 v181, v181
    v_exp_f32 v182, v182
    v_exp_f32 v183, v183
    v_exp_f32 v184, v184
    v_exp_f32 v185, v185
    v_exp_f32 v186, v186
    v_exp_f32 v187, v187
    v_exp_f32 v188, v188
    v_exp_f32 v189, v189
    v_exp_f32 v190, v190
    v_exp_f32 v191, v191
    v_exp_f32 v192, v192
    v_exp_f32 v193, v193
    v_exp_f32 v194, v194
    v_exp_f32 v195, v195
    v_exp_f32 v196, v196
    v_exp_f32 v197, v197
    v_exp_f32 v198, v198
    v_exp_f32 v199, v199
    v_exp_f32 v200, v200
    v_exp_f32 v201, v201
    v_exp_f32 v202, v202
    v_exp_f32 v203, v203
    v_exp_f32 v204, v204
    v_exp_f32 v205, v205
    v_exp_f32 v206, v206
    v_exp_f32 v207, v207
    v_exp_f32 v208, v208
    v_exp_f32 v209, v209
    v_exp_f32 v210, v210
    v_exp_f32 v211, v211
    v_exp_f32 v212, v212
    v_exp_f32 v213, v213
    v_exp_f32 v214, v214
    v_exp_f32 v215, v215
    v_exp_f32 v216, v216
    v_exp_f32 v217, v217
    v_exp_f32 v218, v218
    v_exp_f32 v219, v219
    v_exp_f32 v220, v220
    v_exp_f32 v221, v221
    v_exp_f32 v222, v222
    v_exp_f32 v223, v223
    v_exp_f32 v224, v224
    v_exp_f32 v225, v225
    v_exp_f32 v226, v226
    v_exp_f32 v227, v227
    s_nop 0
    v_cvt_pk_bf16_f32 v12, v156, v157
    v_cvt_pk_bf16_f32 v13, v158, v159
    v_cvt_pk_bf16_f32 v14, v160, v161
    v_cvt_pk_bf16_f32 v15, v162, v163
    v_cvt_pk_bf16_f32 v16, v164, v165
    v_cvt_pk_bf16_f32 v17, v166, v167
    v_cvt_pk_bf16_f32 v18, v168, v169
    v_cvt_pk_bf16_f32 v19, v170, v171
    v_cvt_pk_bf16_f32 v20, v172, v173
    v_cvt_pk_bf16_f32 v21, v174, v175
    v_cvt_pk_bf16_f32 v22, v176, v177
    v_cvt_pk_bf16_f32 v23, v178, v179
    v_cvt_pk_bf16_f32 v24, v180, v181
    v_cvt_pk_bf16_f32 v25, v182, v183
    v_cvt_pk_bf16_f32 v26, v184, v185
    v_cvt_pk_bf16_f32 v27, v186, v187
    v_cvt_pk_bf16_f32 v28, v188, v189
    v_cvt_pk_bf16_f32 v29, v190, v191
    v_cvt_pk_bf16_f32 v30, v192, v193
    v_cvt_pk_bf16_f32 v31, v194, v195
    v_cvt_pk_bf16_f32 v32, v196, v197
    v_cvt_pk_bf16_f32 v33, v198, v199
    v_cvt_pk_bf16_f32 v34, v200, v201
    v_cvt_pk_bf16_f32 v35, v202, v203
    v_cvt_pk_bf16_f32 v36, v204, v205
    v_cvt_pk_bf16_f32 v37, v206, v207
    v_cvt_pk_bf16_f32 v38, v208, v209
    v_cvt_pk_bf16_f32 v39, v210, v211
    v_cvt_pk_bf16_f32 v40, v212, v213
    v_cvt_pk_bf16_f32 v41, v214, v215
    v_cvt_pk_bf16_f32 v42, v216, v217
    v_cvt_pk_bf16_f32 v43, v218, v219
    v_cvt_pk_bf16_f32 v44, v220, v221
    v_cvt_pk_bf16_f32 v45, v222, v223
    v_cvt_pk_bf16_f32 v46, v224, v225
    v_cvt_pk_bf16_f32 v47, v226, v227
    v_add_f32 v230, v156, v157
    v_add_f32 v230, v230, v158
    v_add_f32 v230, v230, v159
    v_add_f32 v230, v230, v160
    v_add_f32 v230, v230, v161
    v_add_f32 v230, v230, v162
    v_add_f32 v230, v230, v163
    v_add_f32 v230, v230, v164
    v_add_f32 v230, v230, v165
    v_add_f32 v230, v230, v166
    v_add_f32 v230, v230, v167
    v_add_f32 v230, v230, v168
    v_add_f32 v230, v230, v169
    v_add_f32 v230, v230, v170
    v_add_f32 v230, v230, v171
    v_add_f32 v230, v230, v172
    v_add_f32 v230, v230, v173
    v_add_f32 v230, v230, v174
    v_add_f32 v230, v230, v175
    v_add_f32 v230, v230, v176
    v_add_f32 v230, v230, v177
    v_add_f32 v230, v230, v178
    v_add_f32 v230, v230, v179
    v_add_f32 v230, v230, v180
    v_add_f32 v230, v230, v181
    v_add_f32 v230, v230, v182
    v_add_f32 v230, v230, v183
    v_add_f32 v230, v230, v184
    v_add_f32 v230, v230, v185
    v_add_f32 v230, v230, v186
    v_add_f32 v230, v230, v187
    v_add_f32 v230, v230, v188
    v_add_f32 v230, v230, v189
    v_add_f32 v230, v230, v190
    v_add_f32 v230, v230, v191
    v_add_f32 v230, v230, v192
    v_add_f32 v230, v230, v193
    v_add_f32 v230, v230, v194
    v_add_f32 v230, v230, v195
    v_add_f32 v230, v230, v196
    v_add_f32 v230, v230, v197
    v_add_f32 v230, v230, v198
    v_add_f32 v230, v230, v199
    v_add_f32 v230, v230, v200
    v_add_f32 v230, v230, v201
    v_add_f32 v230, v230, v202
    v_add_f32 v230, v230, v203
    v_add_f32 v230, v230, v204
    v_add_f32 v230, v230, v205
    v_add_f32 v230, v230, v206
    v_add_f32 v230, v230, v207
    v_add_f32 v230, v230, v208
    v_add_f32 v230, v230, v209
    v_add_f32 v230, v230, v210
    v_add_f32 v230, v230, v211
    v_add_f32 v230, v230, v212
    v_add_f32 v230, v230, v213
    v_add_f32 v230, v230, v214
    v_add_f32 v230, v230, v215
    v_add_f32 v230, v230, v216
    v_add_f32 v230, v230, v217
    v_add_f32 v230, v230, v218
    v_add_f32 v230, v230, v219
    v_add_f32 v230, v230, v220
    v_add_f32 v230, v230, v221
    v_add_f32 v230, v230, v222
    v_add_f32 v230, v230, v223
    v_add_f32 v230, v230, v224
    v_add_f32 v230, v230, v225
    v_add_f32 v230, v230, v226
    v_add_f32 v230, v230, v227
    v_mfma_f32_16x16x32_bf16 v[232:235], v[84:87], v[12:15], 0
    v_mfma_f32_16x16x32_bf16 v[236:239], v[88:91], v[12:15], 0
    v_mfma_f32_16x16x32_bf16 v[232:235], v[92:95], v[16:19], v[232:235]
    v_mfma_f32_16x16x32_bf16 v[236:239], v[96:99], v[16:19], v[236:239]
    v_mfma_f32_16x16x32_bf16 v[232:235], v[100:103], v[20:23], v[232:235]
    v_mfma_f32_16x16x32_bf16 v[236:239], v[104:107], v[20:23], v[236:239]
    v_mfma_f32_16x16x32_bf16 v[232:235], v[108:111], v[24:27], v[232:235]
    v_mfma_f32_16x16x32_bf16 v[236:239], v[112:115], v[24:27], v[236:239]
    v_mfma_f32_16x16x32_bf16 v[232:235], v[116:119], v[28:31], v[232:235]
    v_mfma_f32_16x16x32_bf16 v[236:239], v[120:123], v[28:31], v[236:239]
    v_mfma_f32_16x16x32_bf16 v[232:235], v[124:127], v[32:35], v[232:235]
    v_mfma_f32_16x16x32_bf16 v[236:239], v[128:131], v[32:35], v[236:239]
    v_mfma_f32_16x16x32_bf16 v[232:235], v[132:135], v[36:39], v[232:235]
    v_mfma_f32_16x16x32_bf16 v[236:239], v[136:139], v[36:39], v[236:239]
    v_mfma_f32_16x16x32_bf16 v[232:235], v[140:143], v[40:43], v[232:235]
    v_mfma_f32_16x16x32_bf16 v[236:239], v[144:147], v[40:43], v[236:239]
    v_mfma_f32_16x16x32_bf16 v[232:235], v[148:151], v[44:47], v[232:235]
    v_mfma_f32_16x16x32_bf16 v[236:239], v[152:155], v[44:47], v[236:239]
    v_mov_b32 v229, v230
    s_nop 1
    v_permlane16_swap_b32 v230, v229
    v_add_f32 v230, v230, v229
    v_mov_b32 v229, v230
    s_nop 1
    v_permlane32_swap_b32 v230, v229
    v_add_f32 v230, v230, v229
    v_rcp_f32 v230, v230
    s_mul_i32 s29, s25, 28
    v_lshlrev_b32 v4, 2, v3
    v_add_u32 v4, s29, v4
    v_add_u32 v5, 16, v4
    v_lshrrev_b32 v6, 3, v4
    v_lshlrev_b32 v6, 8, v6
    v_bfe_u32 v7, v4, 2, 1
    v_lshl_add_u32 v6, v7, 3, v6
    v_lshl_add_u32 v6, v2, 4, v6
    v_lshrrev_b32 v7, 3, v5
    v_lshlrev_b32 v7, 8, v7
    v_bfe_u32 v4, v5, 2, 1
    v_lshl_add_u32 v7, v4, 3, v7
    v_lshl_add_u32 v7, v2, 4, v7
    s_mul_i32 s29, s24, 14336
    s_add_u32 s29, s29, 24412160
    v_mul_f32 v232, v232, v230
    v_mul_f32 v233, v233, v230
    v_mul_f32 v234, v234, v230
    v_mul_f32 v235, v235, v230
    v_mul_f32 v236, v236, v230
    v_mul_f32 v237, v237, v230
    v_mul_f32 v238, v238, v230
    v_mul_f32 v239, v239, v230
    v_cvt_pk_bf16_f32 v232, v232, v233
    v_cvt_pk_bf16_f32 v233, v234, v235
    v_cvt_pk_bf16_f32 v234, v236, v237
    v_cvt_pk_bf16_f32 v235, v238, v239
    buffer_store_dwordx2 v[232:233], v6, s[20:23], s29 offen
    v_cmp_gt_u32 vcc, 3, v3
    s_and_saveexec_b64 s[32:33], vcc
    buffer_store_dwordx2 v[234:235], v7, s[20:23], s29 offen
    s_mov_b64 exec, -1
k3_end:
    s_endpgm
.globl k4_kernel
.p2align 8
.type k4_kernel,@function
k4_kernel:
    s_cmp_ge_u32 s2, 128
    s_cbranch_scc1 k4_end
    s_load_dwordx2 s[12:13], s[0:1], 0
    s_load_dwordx2 s[14:15], s[0:1], 96
    v_and_b32 v1, 63, v0
    v_lshrrev_b32 v2, 6, v0
    s_nop 0
    v_readfirstlane_b32 s3, v2
    v_and_b32 v2, 15, v1
    v_lshrrev_b32 v3, 4, v1
    s_waitcnt lgkmcnt(0)
    s_mov_b32 s20, s14
    s_and_b32 s21, s15, 0xffff
    s_mov_b32 s22, 268435456
    s_mov_b32 s23, 0x20000
    s_mov_b32 s8, s12
    s_and_b32 s9, s13, 0xffff
    s_mov_b32 s10, 1835008
    s_mov_b32 s11, 0x20000
    v_mul_u32_u24 v7, 896, v2
    v_lshl_add_u32 v7, v3, 4, v7
    s_mul_i32 s26, s2, 14336
    s_add_u32 s27, s26, 24412160
    s_mul_i32 s28, s3, 100352
    s_add_u32 s28, s28, 1204224
    v_mul_u32_u24 v6, 896, v2
    v_lshl_add_u32 v6, v3, 3, v6
    s_mul_i32 s36, s3, 224
    s_add_u32 s37, s26, s36
    v_lshlrev_b32 v106, 4, v1
    v_add_u32 v107, 4096, v106
    v_add_u32 v108, 8192, v106
    v_add_u32 v109, 12288, v106
    s_add_u32 s29, s28, 14336
    s_add_u32 s30, s29, 14336
    s_add_u32 s31, s30, 14336
    s_add_u32 s32, s31, 14336
    s_add_u32 s33, s32, 14336
    s_add_u32 s34, s33, 14336
    buffer_load_dwordx2 v[92:93], v6, s[8:11], s37 offen offset:0
    buffer_load_dwordx2 v[94:95], v6, s[8:11], s37 offen offset:32
    buffer_load_dwordx2 v[96:97], v6, s[8:11], s37 offen offset:64
    buffer_load_dwordx2 v[98:99], v6, s[8:11], s37 offen offset:96
    buffer_load_dwordx2 v[100:101], v6, s[8:11], s37 offen offset:128
    buffer_load_dwordx2 v[102:103], v6, s[8:11], s37 offen offset:160
    buffer_load_dwordx2 v[104:105], v6, s[8:11], s37 offen offset:192
    buffer_load_dwordx4 v[8:11], v106, s[20:23], s27 offen offset:0
    buffer_load_dwordx4 a[0:3], v106, s[20:23], s28 offen offset:0
    buffer_load_dwordx4 a[56:59], v106, s[20:23], s29 offen offset:0
    buffer_load_dwordx4 a[112:115], v106, s[20:23], s30 offen offset:0
    buffer_load_dwordx4 a[168:171], v106, s[20:23], s31 offen offset:0
    buffer_load_dwordx4 a[224:227], v106, s[20:23], s32 offen offset:0
    buffer_load_dwordx4 v[134:137], v106, s[20:23], s33 offen offset:0
    buffer_load_dwordx4 v[190:193], v106, s[20:23], s34 offen offset:0
    buffer_load_dwordx4 v[12:15], v106, s[20:23], s27 offen offset:1024
    buffer_load_dwordx4 a[4:7], v106, s[20:23], s28 offen offset:1024
    buffer_load_dwordx4 a[60:63], v106, s[20:23], s29 offen offset:1024
    buffer_load_dwordx4 a[116:119], v106, s[20:23], s30 offen offset:1024
    buffer_load_dwordx4 a[172:175], v106, s[20:23], s31 offen offset:1024
    buffer_load_dwordx4 a[228:231], v106, s[20:23], s32 offen offset:1024
    buffer_load_dwordx4 v[138:141], v106, s[20:23], s33 offen offset:1024
    buffer_load_dwordx4 v[194:197], v106, s[20:23], s34 offen offset:1024
    buffer_load_dwordx4 v[16:19], v106, s[20:23], s27 offen offset:2048
    buffer_load_dwordx4 a[8:11], v106, s[20:23], s28 offen offset:2048
    buffer_load_dwordx4 a[64:67], v106, s[20:23], s29 offen offset:2048
    buffer_load_dwordx4 a[120:123], v106, s[20:23], s30 offen offset:2048
    buffer_load_dwordx4 a[176:179], v106, s[20:23], s31 offen offset:2048
    buffer_load_dwordx4 a[232:235], v106, s[20:23], s32 offen offset:2048
    buffer_load_dwordx4 v[142:145], v106, s[20:23], s33 offen offset:2048
    buffer_load_dwordx4 v[198:201], v106, s[20:23], s34 offen offset:2048
    buffer_load_dwordx4 v[20:23], v106, s[20:23], s27 offen offset:3072
    buffer_load_dwordx4 a[12:15], v106, s[20:23], s28 offen offset:3072
    buffer_load_dwordx4 a[68:71], v106, s[20:23], s29 offen offset:3072
    buffer_load_dwordx4 a[124:127], v106, s[20:23], s30 offen offset:3072
    buffer_load_dwordx4 a[180:183], v106, s[20:23], s31 offen offset:3072
    buffer_load_dwordx4 a[236:239], v106, s[20:23], s32 offen offset:3072
    buffer_load_dwordx4 v[146:149], v106, s[20:23], s33 offen offset:3072
    buffer_load_dwordx4 v[202:205], v106, s[20:23], s34 offen offset:3072
    buffer_load_dwordx4 v[24:27], v107, s[20:23], s27 offen offset:0
    buffer_load_dwordx4 a[16:19], v107, s[20:23], s28 offen offset:0
    buffer_load_dwordx4 a[72:75], v107, s[20:23], s29 offen offset:0
    buffer_load_dwordx4 a[128:131], v107, s[20:23], s30 offen offset:0
    buffer_load_dwordx4 a[184:187], v107, s[20:23], s31 offen offset:0
    buffer_load_dwordx4 a[240:243], v107, s[20:23], s32 offen offset:0
    buffer_load_dwordx4 v[150:153], v107, s[20:23], s33 offen offset:0
    buffer_load_dwordx4 v[206:209], v107, s[20:23], s34 offen offset:0
    buffer_load_dwordx4 v[28:31], v107, s[20:23], s27 offen offset:1024
    buffer_load_dwordx4 a[20:23], v107, s[20:23], s28 offen offset:1024
    buffer_load_dwordx4 a[76:79], v107, s[20:23], s29 offen offset:1024
    buffer_load_dwordx4 a[132:135], v107, s[20:23], s30 offen offset:1024
    buffer_load_dwordx4 a[188:191], v107, s[20:23], s31 offen offset:1024
    buffer_load_dwordx4 a[244:247], v107, s[20:23], s32 offen offset:1024
    buffer_load_dwordx4 v[154:157], v107, s[20:23], s33 offen offset:1024
    buffer_load_dwordx4 v[210:213], v107, s[20:23], s34 offen offset:1024
    buffer_load_dwordx4 v[32:35], v107, s[20:23], s27 offen offset:2048
    buffer_load_dwordx4 a[24:27], v107, s[20:23], s28 offen offset:2048
    buffer_load_dwordx4 a[80:83], v107, s[20:23], s29 offen offset:2048
    buffer_load_dwordx4 a[136:139], v107, s[20:23], s30 offen offset:2048
    buffer_load_dwordx4 a[192:195], v107, s[20:23], s31 offen offset:2048
    buffer_load_dwordx4 a[248:251], v107, s[20:23], s32 offen offset:2048
    buffer_load_dwordx4 v[158:161], v107, s[20:23], s33 offen offset:2048
    buffer_load_dwordx4 v[214:217], v107, s[20:23], s34 offen offset:2048
    buffer_load_dwordx4 v[36:39], v107, s[20:23], s27 offen offset:3072
    buffer_load_dwordx4 a[28:31], v107, s[20:23], s28 offen offset:3072
    buffer_load_dwordx4 a[84:87], v107, s[20:23], s29 offen offset:3072
    buffer_load_dwordx4 a[140:143], v107, s[20:23], s30 offen offset:3072
    buffer_load_dwordx4 a[196:199], v107, s[20:23], s31 offen offset:3072
    buffer_load_dwordx4 a[252:255], v107, s[20:23], s32 offen offset:3072
    buffer_load_dwordx4 v[162:165], v107, s[20:23], s33 offen offset:3072
    buffer_load_dwordx4 v[218:221], v107, s[20:23], s34 offen offset:3072
    buffer_load_dwordx4 v[40:43], v108, s[20:23], s27 offen offset:0
    buffer_load_dwordx4 a[32:35], v108, s[20:23], s28 offen offset:0
    buffer_load_dwordx4 a[88:91], v108, s[20:23], s29 offen offset:0
    buffer_load_dwordx4 a[144:147], v108, s[20:23], s30 offen offset:0
    buffer_load_dwordx4 a[200:203], v108, s[20:23], s31 offen offset:0
    buffer_load_dwordx4 v[110:113], v108, s[20:23], s32 offen offset:0
    buffer_load_dwordx4 v[166:169], v108, s[20:23], s33 offen offset:0
    buffer_load_dwordx4 v[222:225], v108, s[20:23], s34 offen offset:0
    buffer_load_dwordx4 v[44:47], v108, s[20:23], s27 offen offset:1024
    buffer_load_dwordx4 a[36:39], v108, s[20:23], s28 offen offset:1024
    buffer_load_dwordx4 a[92:95], v108, s[20:23], s29 offen offset:1024
    buffer_load_dwordx4 a[148:151], v108, s[20:23], s30 offen offset:1024
    buffer_load_dwordx4 a[204:207], v108, s[20:23], s31 offen offset:1024
    buffer_load_dwordx4 v[114:117], v108, s[20:23], s32 offen offset:1024
    buffer_load_dwordx4 v[170:173], v108, s[20:23], s33 offen offset:1024
    buffer_load_dwordx4 v[226:229], v108, s[20:23], s34 offen offset:1024
    buffer_load_dwordx4 v[48:51], v108, s[20:23], s27 offen offset:2048
    buffer_load_dwordx4 a[40:43], v108, s[20:23], s28 offen offset:2048
    buffer_load_dwordx4 a[96:99], v108, s[20:23], s29 offen offset:2048
    buffer_load_dwordx4 a[152:155], v108, s[20:23], s30 offen offset:2048
    buffer_load_dwordx4 a[208:211], v108, s[20:23], s31 offen offset:2048
    buffer_load_dwordx4 v[118:121], v108, s[20:23], s32 offen offset:2048
    buffer_load_dwordx4 v[174:177], v108, s[20:23], s33 offen offset:2048
    buffer_load_dwordx4 v[230:233], v108, s[20:23], s34 offen offset:2048
    buffer_load_dwordx4 v[52:55], v108, s[20:23], s27 offen offset:3072
    buffer_load_dwordx4 a[44:47], v108, s[20:23], s28 offen offset:3072
    buffer_load_dwordx4 a[100:103], v108, s[20:23], s29 offen offset:3072
    buffer_load_dwordx4 a[156:159], v108, s[20:23], s30 offen offset:3072
    buffer_load_dwordx4 a[212:215], v108, s[20:23], s31 offen offset:3072
    buffer_load_dwordx4 v[122:125], v108, s[20:23], s32 offen offset:3072
    buffer_load_dwordx4 v[178:181], v108, s[20:23], s33 offen offset:3072
    buffer_load_dwordx4 v[234:237], v108, s[20:23], s34 offen offset:3072
    buffer_load_dwordx4 v[56:59], v109, s[20:23], s27 offen offset:0
    buffer_load_dwordx4 a[48:51], v109, s[20:23], s28 offen offset:0
    buffer_load_dwordx4 a[104:107], v109, s[20:23], s29 offen offset:0
    buffer_load_dwordx4 a[160:163], v109, s[20:23], s30 offen offset:0
    buffer_load_dwordx4 a[216:219], v109, s[20:23], s31 offen offset:0
    buffer_load_dwordx4 v[126:129], v109, s[20:23], s32 offen offset:0
    buffer_load_dwordx4 v[182:185], v109, s[20:23], s33 offen offset:0
    buffer_load_dwordx4 v[238:241], v109, s[20:23], s34 offen offset:0
    buffer_load_dwordx4 v[60:63], v109, s[20:23], s27 offen offset:1024
    buffer_load_dwordx4 a[52:55], v109, s[20:23], s28 offen offset:1024
    buffer_load_dwordx4 a[108:111], v109, s[20:23], s29 offen offset:1024
    buffer_load_dwordx4 a[164:167], v109, s[20:23], s30 offen offset:1024
    buffer_load_dwordx4 a[220:223], v109, s[20:23], s31 offen offset:1024
    buffer_load_dwordx4 v[130:133], v109, s[20:23], s32 offen offset:1024
    buffer_load_dwordx4 v[186:189], v109, s[20:23], s33 offen offset:1024
    buffer_load_dwordx4 v[242:245], v109, s[20:23], s34 offen offset:1024
    s_waitcnt vmcnt(63)
    v_mfma_f32_16x16x32_bf16 v[64:67], a[0:3], v[8:11], 0
    v_mfma_f32_16x16x32_bf16 v[68:71], a[56:59], v[8:11], 0
    v_mfma_f32_16x16x32_bf16 v[72:75], a[112:115], v[8:11], 0
    v_mfma_f32_16x16x32_bf16 v[76:79], a[168:171], v[8:11], 0
    v_mfma_f32_16x16x32_bf16 v[80:83], a[224:227], v[8:11], 0
    v_mfma_f32_16x16x32_bf16 v[84:87], v[134:137], v[8:11], 0
    v_mfma_f32_16x16x32_bf16 v[88:91], v[190:193], v[8:11], 0
    s_waitcnt vmcnt(63)
    v_mfma_f32_16x16x32_bf16 v[64:67], a[4:7], v[12:15], v[64:67]
    v_mfma_f32_16x16x32_bf16 v[68:71], a[60:63], v[12:15], v[68:71]
    v_mfma_f32_16x16x32_bf16 v[72:75], a[116:119], v[12:15], v[72:75]
    v_mfma_f32_16x16x32_bf16 v[76:79], a[172:175], v[12:15], v[76:79]
    v_mfma_f32_16x16x32_bf16 v[80:83], a[228:231], v[12:15], v[80:83]
    v_mfma_f32_16x16x32_bf16 v[84:87], v[138:141], v[12:15], v[84:87]
    v_mfma_f32_16x16x32_bf16 v[88:91], v[194:197], v[12:15], v[88:91]
    s_waitcnt vmcnt(63)
    v_mfma_f32_16x16x32_bf16 v[64:67], a[8:11], v[16:19], v[64:67]
    v_mfma_f32_16x16x32_bf16 v[68:71], a[64:67], v[16:19], v[68:71]
    v_mfma_f32_16x16x32_bf16 v[72:75], a[120:123], v[16:19], v[72:75]
    v_mfma_f32_16x16x32_bf16 v[76:79], a[176:179], v[16:19], v[76:79]
    v_mfma_f32_16x16x32_bf16 v[80:83], a[232:235], v[16:19], v[80:83]
    v_mfma_f32_16x16x32_bf16 v[84:87], v[142:145], v[16:19], v[84:87]
    v_mfma_f32_16x16x32_bf16 v[88:91], v[198:201], v[16:19], v[88:91]
    s_waitcnt vmcnt(63)
    v_mfma_f32_16x16x32_bf16 v[64:67], a[12:15], v[20:23], v[64:67]
    v_mfma_f32_16x16x32_bf16 v[68:71], a[68:71], v[20:23], v[68:71]
    v_mfma_f32_16x16x32_bf16 v[72:75], a[124:127], v[20:23], v[72:75]
    v_mfma_f32_16x16x32_bf16 v[76:79], a[180:183], v[20:23], v[76:79]
    v_mfma_f32_16x16x32_bf16 v[80:83], a[236:239], v[20:23], v[80:83]
    v_mfma_f32_16x16x32_bf16 v[84:87], v[146:149], v[20:23], v[84:87]
    v_mfma_f32_16x16x32_bf16 v[88:91], v[202:205], v[20:23], v[88:91]
    s_waitcnt vmcnt(63)
    v_mfma_f32_16x16x32_bf16 v[64:67], a[16:19], v[24:27], v[64:67]
    v_mfma_f32_16x16x32_bf16 v[68:71], a[72:75], v[24:27], v[68:71]
    v_mfma_f32_16x16x32_bf16 v[72:75], a[128:131], v[24:27], v[72:75]
    v_mfma_f32_16x16x32_bf16 v[76:79], a[184:187], v[24:27], v[76:79]
    v_mfma_f32_16x16x32_bf16 v[80:83], a[240:243], v[24:27], v[80:83]
    v_mfma_f32_16x16x32_bf16 v[84:87], v[150:153], v[24:27], v[84:87]
    v_mfma_f32_16x16x32_bf16 v[88:91], v[206:209], v[24:27], v[88:91]
    s_waitcnt vmcnt(63)
    v_mfma_f32_16x16x32_bf16 v[64:67], a[20:23], v[28:31], v[64:67]
    v_mfma_f32_16x16x32_bf16 v[68:71], a[76:79], v[28:31], v[68:71]
    v_mfma_f32_16x16x32_bf16 v[72:75], a[132:135], v[28:31], v[72:75]
    v_mfma_f32_16x16x32_bf16 v[76:79], a[188:191], v[28:31], v[76:79]
    v_mfma_f32_16x16x32_bf16 v[80:83], a[244:247], v[28:31], v[80:83]
    v_mfma_f32_16x16x32_bf16 v[84:87], v[154:157], v[28:31], v[84:87]
    v_mfma_f32_16x16x32_bf16 v[88:91], v[210:213], v[28:31], v[88:91]
    s_waitcnt vmcnt(56)
    v_mfma_f32_16x16x32_bf16 v[64:67], a[24:27], v[32:35], v[64:67]
    v_mfma_f32_16x16x32_bf16 v[68:71], a[80:83], v[32:35], v[68:71]
    v_mfma_f32_16x16x32_bf16 v[72:75], a[136:139], v[32:35], v[72:75]
    v_mfma_f32_16x16x32_bf16 v[76:79], a[192:195], v[32:35], v[76:79]
    v_mfma_f32_16x16x32_bf16 v[80:83], a[248:251], v[32:35], v[80:83]
    v_mfma_f32_16x16x32_bf16 v[84:87], v[158:161], v[32:35], v[84:87]
    v_mfma_f32_16x16x32_bf16 v[88:91], v[214:217], v[32:35], v[88:91]
    s_waitcnt vmcnt(48)
    v_mfma_f32_16x16x32_bf16 v[64:67], a[28:31], v[36:39], v[64:67]
    v_mfma_f32_16x16x32_bf16 v[68:71], a[84:87], v[36:39], v[68:71]
    v_mfma_f32_16x16x32_bf16 v[72:75], a[140:143], v[36:39], v[72:75]
    v_mfma_f32_16x16x32_bf16 v[76:79], a[196:199], v[36:39], v[76:79]
    v_mfma_f32_16x16x32_bf16 v[80:83], a[252:255], v[36:39], v[80:83]
    v_mfma_f32_16x16x32_bf16 v[84:87], v[162:165], v[36:39], v[84:87]
    v_mfma_f32_16x16x32_bf16 v[88:91], v[218:221], v[36:39], v[88:91]
    s_waitcnt vmcnt(40)
    v_mfma_f32_16x16x32_bf16 v[64:67], a[32:35], v[40:43], v[64:67]
    v_mfma_f32_16x16x32_bf16 v[68:71], a[88:91], v[40:43], v[68:71]
    v_mfma_f32_16x16x32_bf16 v[72:75], a[144:147], v[40:43], v[72:75]
    v_mfma_f32_16x16x32_bf16 v[76:79], a[200:203], v[40:43], v[76:79]
    v_mfma_f32_16x16x32_bf16 v[80:83], v[110:113], v[40:43], v[80:83]
    v_mfma_f32_16x16x32_bf16 v[84:87], v[166:169], v[40:43], v[84:87]
    v_mfma_f32_16x16x32_bf16 v[88:91], v[222:225], v[40:43], v[88:91]
    s_waitcnt vmcnt(32)
    v_mfma_f32_16x16x32_bf16 v[64:67], a[36:39], v[44:47], v[64:67]
    v_mfma_f32_16x16x32_bf16 v[68:71], a[92:95], v[44:47], v[68:71]
    v_mfma_f32_16x16x32_bf16 v[72:75], a[148:151], v[44:47], v[72:75]
    v_mfma_f32_16x16x32_bf16 v[76:79], a[204:207], v[44:47], v[76:79]
    v_mfma_f32_16x16x32_bf16 v[80:83], v[114:117], v[44:47], v[80:83]
    v_mfma_f32_16x16x32_bf16 v[84:87], v[170:173], v[44:47], v[84:87]
    v_mfma_f32_16x16x32_bf16 v[88:91], v[226:229], v[44:47], v[88:91]
    s_waitcnt vmcnt(24)
    v_mfma_f32_16x16x32_bf16 v[64:67], a[40:43], v[48:51], v[64:67]
    v_mfma_f32_16x16x32_bf16 v[68:71], a[96:99], v[48:51], v[68:71]
    v_mfma_f32_16x16x32_bf16 v[72:75], a[152:155], v[48:51], v[72:75]
    v_mfma_f32_16x16x32_bf16 v[76:79], a[208:211], v[48:51], v[76:79]
    v_mfma_f32_16x16x32_bf16 v[80:83], v[118:121], v[48:51], v[80:83]
    v_mfma_f32_16x16x32_bf16 v[84:87], v[174:177], v[48:51], v[84:87]
    v_mfma_f32_16x16x32_bf16 v[88:91], v[230:233], v[48:51], v[88:91]
    s_waitcnt vmcnt(16)
    v_mfma_f32_16x16x32_bf16 v[64:67], a[44:47], v[52:55], v[64:67]
    v_mfma_f32_16x16x32_bf16 v[68:71], a[100:103], v[52:55], v[68:71]
    v_mfma_f32_16x16x32_bf16 v[72:75], a[156:159], v[52:55], v[72:75]
    v_mfma_f32_16x16x32_bf16 v[76:79], a[212:215], v[52:55], v[76:79]
    v_mfma_f32_16x16x32_bf16 v[80:83], v[122:125], v[52:55], v[80:83]
    v_mfma_f32_16x16x32_bf16 v[84:87], v[178:181], v[52:55], v[84:87]
    v_mfma_f32_16x16x32_bf16 v[88:91], v[234:237], v[52:55], v[88:91]
    s_waitcnt vmcnt(8)
    v_mfma_f32_16x16x32_bf16 v[64:67], a[48:51], v[56:59], v[64:67]
    v_mfma_f32_16x16x32_bf16 v[68:71], a[104:107], v[56:59], v[68:71]
    v_mfma_f32_16x16x32_bf16 v[72:75], a[160:163], v[56:59], v[72:75]
    v_mfma_f32_16x16x32_bf16 v[76:79], a[216:219], v[56:59], v[76:79]
    v_mfma_f32_16x16x32_bf16 v[80:83], v[126:129], v[56:59], v[80:83]
    v_mfma_f32_16x16x32_bf16 v[84:87], v[182:185], v[56:59], v[84:87]
    v_mfma_f32_16x16x32_bf16 v[88:91], v[238:241], v[56:59], v[88:91]
    s_waitcnt vmcnt(0)
    v_mfma_f32_16x16x32_bf16 v[64:67], a[52:55], v[60:63], v[64:67]
    v_mfma_f32_16x16x32_bf16 v[68:71], a[108:111], v[60:63], v[68:71]
    v_mfma_f32_16x16x32_bf16 v[72:75], a[164:167], v[60:63], v[72:75]
    v_mfma_f32_16x16x32_bf16 v[76:79], a[220:223], v[60:63], v[76:79]
    v_mfma_f32_16x16x32_bf16 v[80:83], v[130:133], v[60:63], v[80:83]
    v_mfma_f32_16x16x32_bf16 v[84:87], v[186:189], v[60:63], v[84:87]
    v_mfma_f32_16x16x32_bf16 v[88:91], v[242:245], v[60:63], v[88:91]
    s_nop 7
    v_cvt_pk_bf16_f32 v64, v64, v65
    v_cvt_pk_bf16_f32 v65, v66, v67
    v_lshlrev_b32 v50, 16, v64
    v_and_b32 v51, 0xffff0000, v64
    v_lshlrev_b32 v52, 16, v92
    v_and_b32 v53, 0xffff0000, v92
    v_add_f32 v50, v50, v52
    v_add_f32 v51, v51, v53
    v_cvt_pk_bf16_f32 v36, v50, v51
    v_lshlrev_b32 v8, 16, v36
    v_and_b32 v9, 0xffff0000, v36
    v_lshlrev_b32 v50, 16, v65
    v_and_b32 v51, 0xffff0000, v65
    v_lshlrev_b32 v52, 16, v93
    v_and_b32 v53, 0xffff0000, v93
    v_add_f32 v50, v50, v52
    v_add_f32 v51, v51, v53
    v_cvt_pk_bf16_f32 v37, v50, v51
    v_lshlrev_b32 v10, 16, v37
    v_and_b32 v11, 0xffff0000, v37
    v_cvt_pk_bf16_f32 v68, v68, v69
    v_cvt_pk_bf16_f32 v69, v70, v71
    v_lshlrev_b32 v50, 16, v68
    v_and_b32 v51, 0xffff0000, v68
    v_lshlrev_b32 v52, 16, v94
    v_and_b32 v53, 0xffff0000, v94
    v_add_f32 v50, v50, v52
    v_add_f32 v51, v51, v53
    v_cvt_pk_bf16_f32 v38, v50, v51
    v_lshlrev_b32 v12, 16, v38
    v_and_b32 v13, 0xffff0000, v38
    v_lshlrev_b32 v50, 16, v69
    v_and_b32 v51, 0xffff0000, v69
    v_lshlrev_b32 v52, 16, v95
    v_and_b32 v53, 0xffff0000, v95
    v_add_f32 v50, v50, v52
    v_add_f32 v51, v51, v53
    v_cvt_pk_bf16_f32 v39, v50, v51
    v_lshlrev_b32 v14, 16, v39
    v_and_b32 v15, 0xffff0000, v39
    v_cvt_pk_bf16_f32 v72, v72, v73
    v_cvt_pk_bf16_f32 v73, v74, v75
    v_lshlrev_b32 v50, 16, v72
    v_and_b32 v51, 0xffff0000, v72
    v_lshlrev_b32 v52, 16, v96
    v_and_b32 v53, 0xffff0000, v96
    v_add_f32 v50, v50, v52
    v_add_f32 v51, v51, v53
    v_cvt_pk_bf16_f32 v40, v50, v51
    v_lshlrev_b32 v16, 16, v40
    v_and_b32 v17, 0xffff0000, v40
    v_lshlrev_b32 v50, 16, v73
    v_and_b32 v51, 0xffff0000, v73
    v_lshlrev_b32 v52, 16, v97
    v_and_b32 v53, 0xffff0000, v97
    v_add_f32 v50, v50, v52
    v_add_f32 v51, v51, v53
    v_cvt_pk_bf16_f32 v41, v50, v51
    v_lshlrev_b32 v18, 16, v41
    v_and_b32 v19, 0xffff0000, v41
    v_cvt_pk_bf16_f32 v76, v76, v77
    v_cvt_pk_bf16_f32 v77, v78, v79
    v_lshlrev_b32 v50, 16, v76
    v_and_b32 v51, 0xffff0000, v76
    v_lshlrev_b32 v52, 16, v98
    v_and_b32 v53, 0xffff0000, v98
    v_add_f32 v50, v50, v52
    v_add_f32 v51, v51, v53
    v_cvt_pk_bf16_f32 v42, v50, v51
    v_lshlrev_b32 v20, 16, v42
    v_and_b32 v21, 0xffff0000, v42
    v_lshlrev_b32 v50, 16, v77
    v_and_b32 v51, 0xffff0000, v77
    v_lshlrev_b32 v52, 16, v99
    v_and_b32 v53, 0xffff0000, v99
    v_add_f32 v50, v50, v52
    v_add_f32 v51, v51, v53
    v_cvt_pk_bf16_f32 v43, v50, v51
    v_lshlrev_b32 v22, 16, v43
    v_and_b32 v23, 0xffff0000, v43
    v_cvt_pk_bf16_f32 v80, v80, v81
    v_cvt_pk_bf16_f32 v81, v82, v83
    v_lshlrev_b32 v50, 16, v80
    v_and_b32 v51, 0xffff0000, v80
    v_lshlrev_b32 v52, 16, v100
    v_and_b32 v53, 0xffff0000, v100
    v_add_f32 v50, v50, v52
    v_add_f32 v51, v51, v53
    v_cvt_pk_bf16_f32 v44, v50, v51
    v_lshlrev_b32 v24, 16, v44
    v_and_b32 v25, 0xffff0000, v44
    v_lshlrev_b32 v50, 16, v81
    v_and_b32 v51, 0xffff0000, v81
    v_lshlrev_b32 v52, 16, v101
    v_and_b32 v53, 0xffff0000, v101
    v_add_f32 v50, v50, v52
    v_add_f32 v51, v51, v53
    v_cvt_pk_bf16_f32 v45, v50, v51
    v_lshlrev_b32 v26, 16, v45
    v_and_b32 v27, 0xffff0000, v45
    v_cvt_pk_bf16_f32 v84, v84, v85
    v_cvt_pk_bf16_f32 v85, v86, v87
    v_lshlrev_b32 v50, 16, v84
    v_and_b32 v51, 0xffff0000, v84
    v_lshlrev_b32 v52, 16, v102
    v_and_b32 v53, 0xffff0000, v102
    v_add_f32 v50, v50, v52
    v_add_f32 v51, v51, v53
    v_cvt_pk_bf16_f32 v46, v50, v51
    v_lshlrev_b32 v28, 16, v46
    v_and_b32 v29, 0xffff0000, v46
    v_lshlrev_b32 v50, 16, v85
    v_and_b32 v51, 0xffff0000, v85
    v_lshlrev_b32 v52, 16, v103
    v_and_b32 v53, 0xffff0000, v103
    v_add_f32 v50, v50, v52
    v_add_f32 v51, v51, v53
    v_cvt_pk_bf16_f32 v47, v50, v51
    v_lshlrev_b32 v30, 16, v47
    v_and_b32 v31, 0xffff0000, v47
    v_cvt_pk_bf16_f32 v88, v88, v89
    v_cvt_pk_bf16_f32 v89, v90, v91
    v_lshlrev_b32 v50, 16, v88
    v_and_b32 v51, 0xffff0000, v88
    v_lshlrev_b32 v52, 16, v104
    v_and_b32 v53, 0xffff0000, v104
    v_add_f32 v50, v50, v52
    v_add_f32 v51, v51, v53
    v_cvt_pk_bf16_f32 v48, v50, v51
    v_lshlrev_b32 v32, 16, v48
    v_and_b32 v33, 0xffff0000, v48
    v_lshlrev_b32 v50, 16, v89
    v_and_b32 v51, 0xffff0000, v89
    v_lshlrev_b32 v52, 16, v105
    v_and_b32 v53, 0xffff0000, v105
    v_add_f32 v50, v50, v52
    v_add_f32 v51, v51, v53
    v_cvt_pk_bf16_f32 v49, v50, v51
    v_lshlrev_b32 v34, 16, v49
    v_and_b32 v35, 0xffff0000, v49
    s_add_u32 s38, s37, 26247168
    buffer_store_dwordx2 v[36:37], v6, s[20:23], s38 offen offset:0
    buffer_store_dwordx2 v[38:39], v6, s[20:23], s38 offen offset:32
    buffer_store_dwordx2 v[40:41], v6, s[20:23], s38 offen offset:64
    buffer_store_dwordx2 v[42:43], v6, s[20:23], s38 offen offset:96
    buffer_store_dwordx2 v[44:45], v6, s[20:23], s38 offen offset:128
    buffer_store_dwordx2 v[46:47], v6, s[20:23], s38 offen offset:160
    buffer_store_dwordx2 v[48:49], v6, s[20:23], s38 offen offset:192
    v_lshlrev_b32 v57, 2, v2
    s_lshl_b32 s39, s3, 6
    v_add_u32 v56, s39, v57
    v_add_f32 v54, v8, v9
    v_add_f32 v54, v54, v10
    v_add_f32 v54, v54, v11
    v_add_f32 v54, v54, v12
    v_add_f32 v54, v54, v13
    v_add_f32 v54, v54, v14
    v_add_f32 v54, v54, v15
    v_add_f32 v54, v54, v16
    v_add_f32 v54, v54, v17
    v_add_f32 v54, v54, v18
    v_add_f32 v54, v54, v19
    v_add_f32 v54, v54, v20
    v_add_f32 v54, v54, v21
    v_add_f32 v54, v54, v22
    v_add_f32 v54, v54, v23
    v_add_f32 v54, v54, v24
    v_add_f32 v54, v54, v25
    v_add_f32 v54, v54, v26
    v_add_f32 v54, v54, v27
    v_add_f32 v54, v54, v28
    v_add_f32 v54, v54, v29
    v_add_f32 v54, v54, v30
    v_add_f32 v54, v54, v31
    v_add_f32 v54, v54, v32
    v_add_f32 v54, v54, v33
    v_add_f32 v54, v54, v34
    v_add_f32 v54, v54, v35
    v_mov_b32 v55, v54
    s_nop 1
    v_permlane16_swap_b32 v54, v55
    v_add_f32 v54, v54, v55
    v_mov_b32 v55, v54
    s_nop 1
    v_permlane32_swap_b32 v54, v55
    v_add_f32 v54, v54, v55
    ds_write_b32 v56, v54 offset:0
    s_waitcnt lgkmcnt(0)
    s_barrier
    ds_read_b32 v54, v57 offset:0
    ds_read_b32 v55, v57 offset:64
    ds_read_b32 v58, v57 offset:128
    ds_read_b32 v59, v57 offset:192
    s_waitcnt lgkmcnt(0)
    v_add_f32 v54, v54, v55
    v_add_f32 v58, v58, v59
    v_add_f32 v54, v54, v58
    v_mul_f32 v54, 0x3b124925, v54
    v_mov_b32 v60, 0
    v_sub_f32 v61, v8, v54
    v_fmac_f32 v60, v61, v61
    v_sub_f32 v61, v9, v54
    v_fmac_f32 v60, v61, v61
    v_sub_f32 v61, v10, v54
    v_fmac_f32 v60, v61, v61
    v_sub_f32 v61, v11, v54
    v_fmac_f32 v60, v61, v61
    v_sub_f32 v61, v12, v54
    v_fmac_f32 v60, v61, v61
    v_sub_f32 v61, v13, v54
    v_fmac_f32 v60, v61, v61
    v_sub_f32 v61, v14, v54
    v_fmac_f32 v60, v61, v61
    v_sub_f32 v61, v15, v54
    v_fmac_f32 v60, v61, v61
    v_sub_f32 v61, v16, v54
    v_fmac_f32 v60, v61, v61
    v_sub_f32 v61, v17, v54
    v_fmac_f32 v60, v61, v61
    v_sub_f32 v61, v18, v54
    v_fmac_f32 v60, v61, v61
    v_sub_f32 v61, v19, v54
    v_fmac_f32 v60, v61, v61
    v_sub_f32 v61, v20, v54
    v_fmac_f32 v60, v61, v61
    v_sub_f32 v61, v21, v54
    v_fmac_f32 v60, v61, v61
    v_sub_f32 v61, v22, v54
    v_fmac_f32 v60, v61, v61
    v_sub_f32 v61, v23, v54
    v_fmac_f32 v60, v61, v61
    v_sub_f32 v61, v24, v54
    v_fmac_f32 v60, v61, v61
    v_sub_f32 v61, v25, v54
    v_fmac_f32 v60, v61, v61
    v_sub_f32 v61, v26, v54
    v_fmac_f32 v60, v61, v61
    v_sub_f32 v61, v27, v54
    v_fmac_f32 v60, v61, v61
    v_sub_f32 v61, v28, v54
    v_fmac_f32 v60, v61, v61
    v_sub_f32 v61, v29, v54
    v_fmac_f32 v60, v61, v61
    v_sub_f32 v61, v30, v54
    v_fmac_f32 v60, v61, v61
    v_sub_f32 v61, v31, v54
    v_fmac_f32 v60, v61, v61
    v_sub_f32 v61, v32, v54
    v_fmac_f32 v60, v61, v61
    v_sub_f32 v61, v33, v54
    v_fmac_f32 v60, v61, v61
    v_sub_f32 v61, v34, v54
    v_fmac_f32 v60, v61, v61
    v_sub_f32 v61, v35, v54
    v_fmac_f32 v60, v61, v61
    v_mov_b32 v55, v60
    s_nop 1
    v_permlane16_swap_b32 v60, v55
    v_add_f32 v60, v60, v55
    v_mov_b32 v55, v60
    s_nop 1
    v_permlane32_swap_b32 v60, v55
    v_add_f32 v60, v60, v55
    ds_write_b32 v56, v60 offset:256
    s_waitcnt lgkmcnt(0)
    s_barrier
    ds_read_b32 v60, v57 offset:256
    ds_read_b32 v55, v57 offset:320
    ds_read_b32 v58, v57 offset:384
    ds_read_b32 v59, v57 offset:448
    s_waitcnt lgkmcnt(0)
    v_add_f32 v60, v60, v55
    v_add_f32 v58, v58, v59
    v_add_f32 v60, v60, v58
    v_mul_f32 v60, 0x3b124925, v60
    v_cvt_pk_bf16_f32 v54, v54, v54
    v_and_b32 v54, 0xffff0000, v54
    v_cvt_pk_bf16_f32 v60, v60, v60
    v_and_b32 v60, 0xffff0000, v60
    v_add_f32 v60, 0x3727c5ac, v60
    v_cvt_pk_bf16_f32 v60, v60, v60
    v_and_b32 v60, 0xffff0000, v60
    v_sqrt_f32 v60, v60
    s_nop 0
    v_cvt_pk_bf16_f32 v60, v60, v60
    v_and_b32 v60, 0xffff0000, v60
    v_rcp_f32 v60, v60
    s_nop 0
    v_sub_f32 v8, v8, v54
    v_sub_f32 v9, v9, v54
    v_sub_f32 v10, v10, v54
    v_sub_f32 v11, v11, v54
    v_sub_f32 v12, v12, v54
    v_sub_f32 v13, v13, v54
    v_sub_f32 v14, v14, v54
    v_sub_f32 v15, v15, v54
    v_sub_f32 v16, v16, v54
    v_sub_f32 v17, v17, v54
    v_sub_f32 v18, v18, v54
    v_sub_f32 v19, v19, v54
    v_sub_f32 v20, v20, v54
    v_sub_f32 v21, v21, v54
    v_sub_f32 v22, v22, v54
    v_sub_f32 v23, v23, v54
    v_sub_f32 v24, v24, v54
    v_sub_f32 v25, v25, v54
    v_sub_f32 v26, v26, v54
    v_sub_f32 v27, v27, v54
    v_sub_f32 v28, v28, v54
    v_sub_f32 v29, v29, v54
    v_sub_f32 v30, v30, v54
    v_sub_f32 v31, v31, v54
    v_sub_f32 v32, v32, v54
    v_sub_f32 v33, v33, v54
    v_sub_f32 v34, v34, v54
    v_sub_f32 v35, v35, v54
    v_cvt_pk_bf16_f32 v36, v8, v9
    v_lshlrev_b32 v8, 16, v36
    v_and_b32 v9, 0xffff0000, v36
    v_cvt_pk_bf16_f32 v37, v10, v11
    v_lshlrev_b32 v10, 16, v37
    v_and_b32 v11, 0xffff0000, v37
    v_cvt_pk_bf16_f32 v38, v12, v13
    v_lshlrev_b32 v12, 16, v38
    v_and_b32 v13, 0xffff0000, v38
    v_cvt_pk_bf16_f32 v39, v14, v15
    v_lshlrev_b32 v14, 16, v39
    v_and_b32 v15, 0xffff0000, v39
    v_cvt_pk_bf16_f32 v40, v16, v17
    v_lshlrev_b32 v16, 16, v40
    v_and_b32 v17, 0xffff0000, v40
    v_cvt_pk_bf16_f32 v41, v18, v19
    v_lshlrev_b32 v18, 16, v41
    v_and_b32 v19, 0xffff0000, v41
    v_cvt_pk_bf16_f32 v42, v20, v21
    v_lshlrev_b32 v20, 16, v42
    v_and_b32 v21, 0xffff0000, v42
    v_cvt_pk_bf16_f32 v43, v22, v23
    v_lshlrev_b32 v22, 16, v43
    v_and_b32 v23, 0xffff0000, v43
    v_cvt_pk_bf16_f32 v44, v24, v25
    v_lshlrev_b32 v24, 16, v44
    v_and_b32 v25, 0xffff0000, v44
    v_cvt_pk_bf16_f32 v45, v26, v27
    v_lshlrev_b32 v26, 16, v45
    v_and_b32 v27, 0xffff0000, v45
    v_cvt_pk_bf16_f32 v46, v28, v29
    v_lshlrev_b32 v28, 16, v46
    v_and_b32 v29, 0xffff0000, v46
    v_cvt_pk_bf16_f32 v47, v30, v31
    v_lshlrev_b32 v30, 16, v47
    v_and_b32 v31, 0xffff0000, v47
    v_cvt_pk_bf16_f32 v48, v32, v33
    v_lshlrev_b32 v32, 16, v48
    v_and_b32 v33, 0xffff0000, v48
    v_cvt_pk_bf16_f32 v49, v34, v35
    v_lshlrev_b32 v34, 16, v49
    v_and_b32 v35, 0xffff0000, v49
    v_mul_f32 v8, v8, v60
    v_mul_f32 v9, v9, v60
    v_mul_f32 v10, v10, v60
    v_mul_f32 v11, v11, v60
    v_mul_f32 v12, v12, v60
    v_mul_f32 v13, v13, v60
    v_mul_f32 v14, v14, v60
    v_mul_f32 v15, v15, v60
    v_mul_f32 v16, v16, v60
    v_mul_f32 v17, v17, v60
    v_mul_f32 v18, v18, v60
    v_mul_f32 v19, v19, v60
    v_mul_f32 v20, v20, v60
    v_mul_f32 v21, v21, v60
    v_mul_f32 v22, v22, v60
    v_mul_f32 v23, v23, v60
    v_mul_f32 v24, v24, v60
    v_mul_f32 v25, v25, v60
    v_mul_f32 v26, v26, v60
    v_mul_f32 v27, v27, v60
    v_mul_f32 v28, v28, v60
    v_mul_f32 v29, v29, v60
    v_mul_f32 v30, v30, v60
    v_mul_f32 v31, v31, v60
    v_mul_f32 v32, v32, v60
    v_mul_f32 v33, v33, v60
    v_mul_f32 v34, v34, v60
    v_mul_f32 v35, v35, v60
    v_cvt_pk_bf16_f32 v36, v8, v9
    v_cvt_pk_bf16_f32 v37, v10, v11
    v_cvt_pk_bf16_f32 v38, v12, v13
    v_cvt_pk_bf16_f32 v39, v14, v15
    v_cvt_pk_bf16_f32 v40, v16, v17
    v_cvt_pk_bf16_f32 v41, v18, v19
    v_cvt_pk_bf16_f32 v42, v20, v21
    v_cvt_pk_bf16_f32 v43, v22, v23
    v_cvt_pk_bf16_f32 v44, v24, v25
    v_cvt_pk_bf16_f32 v45, v26, v27
    v_cvt_pk_bf16_f32 v46, v28, v29
    v_cvt_pk_bf16_f32 v47, v30, v31
    v_cvt_pk_bf16_f32 v48, v32, v33
    v_cvt_pk_bf16_f32 v49, v34, v35
    s_add_u32 s38, s37, 31752192
    buffer_store_dwordx2 v[36:37], v6, s[20:23], s38 offen offset:0
    buffer_store_dwordx2 v[38:39], v6, s[20:23], s38 offen offset:32
    buffer_store_dwordx2 v[40:41], v6, s[20:23], s38 offen offset:64
    buffer_store_dwordx2 v[42:43], v6, s[20:23], s38 offen offset:96
    buffer_store_dwordx2 v[44:45], v6, s[20:23], s38 offen offset:128
    buffer_store_dwordx2 v[46:47], v6, s[20:23], s38 offen offset:160
    buffer_store_dwordx2 v[48:49], v6, s[20:23], s38 offen offset:192
k4_end:
    s_endpgm
.globl mega_kernel
.p2align 8
.type mega_kernel,@function
mega_kernel:
    s_cmp_ge_u32 s2, 256
    s_cbranch_scc0 mega_go
    s_endpgm
mega_go:
    s_load_dwordx2 s[12:13], s[0:1], 80
    s_load_dwordx2 s[14:15], s[0:1], 96
    s_load_dwordx2 s[10:11], s[0:1], 88
    s_getreg_b32 s30, hwreg(HW_REG_XCC_ID)
    v_and_b32 v1, 63, v0
    v_lshrrev_b32 v2, 6, v0
    s_nop 0
    v_readfirstlane_b32 s3, v2
    v_and_b32 v2, 15, v1
    v_lshrrev_b32 v3, 4, v1
    v_and_b32 v4, 7, v1
    s_and_b32 s30, s30, 15
    s_waitcnt lgkmcnt(0)
    s_mov_b32 s20, s14
    s_and_b32 s21, s15, 0xffff
    s_mov_b32 s22, 268435456
    s_mov_b32 s23, 0x20000
    s_mov_b32 s16, s12
    s_and_b32 s17, s13, 0xffff
    s_mov_b32 s18, 1835008
    s_mov_b32 s19, 0x20000
    s_mov_b32 s24, s10
    s_and_b32 s25, s11, 0xffff
    s_mov_b32 s26, 256
    s_mov_b32 s27, 0x20000
    s_cmp_lg_u32 s3, 0
    s_cbranch_scc1 mega_rw
    s_mov_b64 exec, 1
    v_mov_b32 v5, 1
    v_mov_b32 v6, 0
    s_lshl_b32 s31, s30, 2
    buffer_atomic_add v5, v6, s[24:27], s31 offen sc0 sc1
    s_waitcnt vmcnt(0)
    v_readfirstlane_b32 s32, v5
    s_cmp_ge_u32 s30, 2
    s_cbranch_scc1 mega_tk
    s_cmp_ge_u32 s32, 30
    s_cbranch_scc1 mega_tk
    s_lshl_b32 s33, s30, 8
    s_add_u32 s33, s33, s32
    s_add_u32 s33, s33, 1024
    s_branch mega_rd
mega_tk:
    v_mov_b32 v5, 1
    s_mov_b32 s31, 128
    buffer_atomic_add v5, v6, s[24:27], s31 offen sc0 sc1
    s_waitcnt vmcnt(0)
    v_readfirstlane_b32 s33, v5
mega_rd:
    v_mov_b32 v5, s33
    ds_write_b32 v6, v5
    s_mov_b64 exec, -1
    s_waitcnt lgkmcnt(0)
mega_rw:
    s_barrier
    v_mov_b32 v6, 0
    ds_read_b32 v5, v6
    s_waitcnt lgkmcnt(0)
    v_readfirstlane_b32 s2, v5
    s_barrier
    s_cmp_lt_u32 s2, 1024
    s_cbranch_scc1 mega_wk
    s_sub_u32 s2, s2, 1024
    s_cmp_ge_u32 s2, 256
    s_cbranch_scc1 mega_c1
    s_getpc_b64 s[60:61]
mega_kernel_lj1:
    s_add_u32 s60, s60, ch0_start-mega_kernel_lj1
    s_addc_u32 s61, s61, 0
    s_setpc_b64 s[60:61]
mega_c1:
    s_sub_u32 s2, s2, 256
    s_getpc_b64 s[60:61]
mega_kernel_lj2:
    s_add_u32 s60, s60, ch1_start-mega_kernel_lj2
    s_addc_u32 s61, s61, 0
    s_setpc_b64 s[60:61]
mega_wk:
    s_cmp_ge_u32 s2, 28
    s_cbranch_scc1 mega_kernel_r3
    s_getpc_b64 s[60:61]
mega_kernel_lj4:
    s_add_u32 s60, s60, gx_start-mega_kernel_lj4
    s_addc_u32 s61, s61, 0
    s_setpc_b64 s[60:61]
mega_kernel_r3:
    s_sub_u32 s2, s2, 28
    s_cmp_ge_u32 s2, 28
    s_cbranch_scc1 mega_kernel_r5
    s_getpc_b64 s[60:61]
mega_kernel_lj6:
    s_add_u32 s60, s60, gm_start-mega_kernel_lj6
    s_addc_u32 s61, s61, 0
    s_setpc_b64 s[60:61]
mega_kernel_r5:
    s_sub_u32 s2, s2, 28
    s_cmp_ge_u32 s2, 28
    s_cbranch_scc1 mega_kernel_r7
    s_getpc_b64 s[60:61]
mega_kernel_lj8:
    s_add_u32 s60, s60, g2_start-mega_kernel_lj8
    s_addc_u32 s61, s61, 0
    s_setpc_b64 s[60:61]
mega_kernel_r7:
    s_sub_u32 s2, s2, 28
    s_cmp_ge_u32 s2, 16
    s_cbranch_scc1 mega_kernel_r9
    s_getpc_b64 s[60:61]
mega_kernel_lj10:
    s_add_u32 s60, s60, bs0_start-mega_kernel_lj10
    s_addc_u32 s61, s61, 0
    s_setpc_b64 s[60:61]
mega_kernel_r9:
    s_sub_u32 s2, s2, 16
    s_cmp_ge_u32 s2, 24
    s_cbranch_scc1 mega_kernel_r11
    s_getpc_b64 s[60:61]
mega_kernel_lj12:
    s_add_u32 s60, s60, bs1_start-mega_kernel_lj12
    s_addc_u32 s61, s61, 0
    s_setpc_b64 s[60:61]
mega_kernel_r11:
    s_sub_u32 s2, s2, 24
    s_cmp_ge_u32 s2, 14
    s_cbranch_scc1 mega_kernel_r13
    s_getpc_b64 s[60:61]
mega_kernel_lj14:
    s_add_u32 s60, s60, bv0_start-mega_kernel_lj14
    s_addc_u32 s61, s61, 0
    s_setpc_b64 s[60:61]
mega_kernel_r13:
    s_sub_u32 s2, s2, 14
    s_cmp_ge_u32 s2, 14
    s_cbranch_scc1 mega_kernel_r15
    s_getpc_b64 s[60:61]
mega_kernel_lj16:
    s_add_u32 s60, s60, bv1_start-mega_kernel_lj16
    s_addc_u32 s61, s61, 0
    s_setpc_b64 s[60:61]
mega_kernel_r15:
    s_sub_u32 s2, s2, 14
    s_cmp_ge_u32 s2, 12
    s_cbranch_scc1 mega_kernel_r17
    s_getpc_b64 s[60:61]
mega_kernel_lj18:
    s_add_u32 s60, s60, a1_start-mega_kernel_lj18
    s_addc_u32 s61, s61, 0
    s_setpc_b64 s[60:61]
mega_kernel_r17:
    s_sub_u32 s2, s2, 12
    s_cmp_ge_u32 s2, 24
    s_cbranch_scc1 mega_kernel_r19
    s_getpc_b64 s[60:61]
mega_kernel_lj20:
    s_add_u32 s60, s60, a2_start-mega_kernel_lj20
    s_addc_u32 s61, s61, 0
    s_setpc_b64 s[60:61]
mega_kernel_r19:
    s_sub_u32 s2, s2, 24
    s_cmp_ge_u32 s2, 8
    s_cbranch_scc1 mega_kernel_r21
    s_getpc_b64 s[60:61]
mega_kernel_lj22:
    s_add_u32 s60, s60, a3_start-mega_kernel_lj22
    s_addc_u32 s61, s61, 0
    s_setpc_b64 s[60:61]
mega_kernel_r21:
    s_sub_u32 s2, s2, 8
    s_endpgm
ch0_start:
    s_mov_b32 s50, 0x3fb8aa3b
    s_cmp_ge_u32 s2, 16
    s_cbranch_scc1 ch0_ucu
    v_mul_u32_u24 v5, 896, v2
    v_lshl_add_u32 v5, v3, 4, v5
    s_mul_i32 s24, s2, 448
    s_mul_i32 s25, s3, 112
    s_add_u32 s24, s24, s25
    s_mul_i32 s24, s24, 896
    s_add_u32 s24, s24, 5275648
    v_lshlrev_b32 v12, 4, v1
    v_add_u32 v13, 4096, v12
    v_add_u32 v14, 8192, v12
    v_add_u32 v15, 12288, v12
    buffer_load_dwordx4 a[0:3], v12, s[20:23], s24 offen offset:0
    buffer_load_dwordx4 a[4:7], v12, s[20:23], s24 offen offset:1024
    buffer_load_dwordx4 a[8:11], v12, s[20:23], s24 offen offset:2048
    buffer_load_dwordx4 a[12:15], v12, s[20:23], s24 offen offset:3072
    buffer_load_dwordx4 a[16:19], v13, s[20:23], s24 offen offset:0
    buffer_load_dwordx4 a[20:23], v13, s[20:23], s24 offen offset:1024
    buffer_load_dwordx4 a[24:27], v13, s[20:23], s24 offen offset:2048
    buffer_load_dwordx4 a[28:31], v13, s[20:23], s24 offen offset:3072
    buffer_load_dwordx4 a[32:35], v14, s[20:23], s24 offen offset:0
    buffer_load_dwordx4 a[36:39], v14, s[20:23], s24 offen offset:1024
    buffer_load_dwordx4 a[40:43], v14, s[20:23], s24 offen offset:2048
    buffer_load_dwordx4 a[44:47], v14, s[20:23], s24 offen offset:3072
    buffer_load_dwordx4 a[48:51], v15, s[20:23], s24 offen offset:0
    buffer_load_dwordx4 a[52:55], v15, s[20:23], s24 offen offset:1024
    s_add_u32 s24, s24, 14336
    buffer_load_dwordx4 a[56:59], v12, s[20:23], s24 offen offset:0
    buffer_load_dwordx4 a[60:63], v12, s[20:23], s24 offen offset:1024
    buffer_load_dwordx4 a[64:67], v12, s[20:23], s24 offen offset:2048
    buffer_load_dwordx4 a[68:71], v12, s[20:23], s24 offen offset:3072
    buffer_load_dwordx4 a[72:75], v13, s[20:23], s24 offen offset:0
    buffer_load_dwordx4 a[76:79], v13, s[20:23], s24 offen offset:1024
    buffer_load_dwordx4 a[80:83], v13, s[20:23], s24 offen offset:2048
    buffer_load_dwordx4 a[84:87], v13, s[20:23], s24 offen offset:3072
    buffer_load_dwordx4 a[88:91], v14, s[20:23], s24 offen offset:0
    buffer_load_dwordx4 a[92:95], v14, s[20:23], s24 offen offset:1024
    buffer_load_dwordx4 a[96:99], v14, s[20:23], s24 offen offset:2048
    buffer_load_dwordx4 a[100:103], v14, s[20:23], s24 offen offset:3072
    buffer_load_dwordx4 a[104:107], v15, s[20:23], s24 offen offset:0
    buffer_load_dwordx4 a[108:111], v15, s[20:23], s24 offen offset:1024
    s_add_u32 s24, s24, 14336
    buffer_load_dwordx4 a[112:115], v12, s[20:23], s24 offen offset:0
    buffer_load_dwordx4 a[116:119], v12, s[20:23], s24 offen offset:1024
    buffer_load_dwordx4 a[120:123], v12, s[20:23], s24 offen offset:2048
    buffer_load_dwordx4 a[124:127], v12, s[20:23], s24 offen offset:3072
    buffer_load_dwordx4 a[128:131], v13, s[20:23], s24 offen offset:0
    buffer_load_dwordx4 a[132:135], v13, s[20:23], s24 offen offset:1024
    buffer_load_dwordx4 a[136:139], v13, s[20:23], s24 offen offset:2048
    buffer_load_dwordx4 a[140:143], v13, s[20:23], s24 offen offset:3072
    buffer_load_dwordx4 a[144:147], v14, s[20:23], s24 offen offset:0
    buffer_load_dwordx4 a[148:151], v14, s[20:23], s24 offen offset:1024
    buffer_load_dwordx4 a[152:155], v14, s[20:23], s24 offen offset:2048
    buffer_load_dwordx4 a[156:159], v14, s[20:23], s24 offen offset:3072
    buffer_load_dwordx4 a[160:163], v15, s[20:23], s24 offen offset:0
    buffer_load_dwordx4 a[164:167], v15, s[20:23], s24 offen offset:1024
    s_add_u32 s24, s24, 14336
    buffer_load_dwordx4 a[168:171], v12, s[20:23], s24 offen offset:0
    buffer_load_dwordx4 a[172:175], v12, s[20:23], s24 offen offset:1024
    buffer_load_dwordx4 a[176:179], v12, s[20:23], s24 offen offset:2048
    buffer_load_dwordx4 a[180:183], v12, s[20:23], s24 offen offset:3072
    buffer_load_dwordx4 a[184:187], v13, s[20:23], s24 offen offset:0
    buffer_load_dwordx4 a[188:191], v13, s[20:23], s24 offen offset:1024
    buffer_load_dwordx4 a[192:195], v13, s[20:23], s24 offen offset:2048
    buffer_load_dwordx4 a[196:199], v13, s[20:23], s24 offen offset:3072
    buffer_load_dwordx4 a[200:203], v14, s[20:23], s24 offen offset:0
    buffer_load_dwordx4 a[204:207], v14, s[20:23], s24 offen offset:1024
    buffer_load_dwordx4 a[208:211], v14, s[20:23], s24 offen offset:2048
    buffer_load_dwordx4 a[212:215], v14, s[20:23], s24 offen offset:3072
    buffer_load_dwordx4 a[216:219], v15, s[20:23], s24 offen offset:0
    buffer_load_dwordx4 a[220:223], v15, s[20:23], s24 offen offset:1024
    s_add_u32 s24, s24, 14336
    buffer_load_dwordx4 a[224:227], v12, s[20:23], s24 offen offset:0
    buffer_load_dwordx4 a[228:231], v12, s[20:23], s24 offen offset:1024
    buffer_load_dwordx4 a[232:235], v12, s[20:23], s24 offen offset:2048
    buffer_load_dwordx4 a[236:239], v12, s[20:23], s24 offen offset:3072
    buffer_load_dwordx4 a[240:243], v13, s[20:23], s24 offen offset:0
    buffer_load_dwordx4 a[244:247], v13, s[20:23], s24 offen offset:1024
    buffer_load_dwordx4 a[248:251], v13, s[20:23], s24 offen offset:2048
    buffer_load_dwordx4 a[252:255], v13, s[20:23], s24 offen offset:3072
    buffer_load_dwordx4 v[110:113], v14, s[20:23], s24 offen offset:0
    buffer_load_dwordx4 v[114:117], v14, s[20:23], s24 offen offset:1024
    buffer_load_dwordx4 v[118:121], v14, s[20:23], s24 offen offset:2048
    buffer_load_dwordx4 v[122:125], v14, s[20:23], s24 offen offset:3072
    buffer_load_dwordx4 v[126:129], v15, s[20:23], s24 offen offset:0
    buffer_load_dwordx4 v[130:133], v15, s[20:23], s24 offen offset:1024
    s_add_u32 s24, s24, 14336
    buffer_load_dwordx4 v[134:137], v12, s[20:23], s24 offen offset:0
    buffer_load_dwordx4 v[138:141], v12, s[20:23], s24 offen offset:1024
    buffer_load_dwordx4 v[142:145], v12, s[20:23], s24 offen offset:2048
    buffer_load_dwordx4 v[146:149], v12, s[20:23], s24 offen offset:3072
    buffer_load_dwordx4 v[150:153], v13, s[20:23], s24 offen offset:0
    buffer_load_dwordx4 v[154:157], v13, s[20:23], s24 offen offset:1024
    buffer_load_dwordx4 v[158:161], v13, s[20:23], s24 offen offset:2048
    buffer_load_dwordx4 v[162:165], v13, s[20:23], s24 offen offset:3072
    buffer_load_dwordx4 v[166:169], v14, s[20:23], s24 offen offset:0
    buffer_load_dwordx4 v[170:173], v14, s[20:23], s24 offen offset:1024
    buffer_load_dwordx4 v[174:177], v14, s[20:23], s24 offen offset:2048
    buffer_load_dwordx4 v[178:181], v14, s[20:23], s24 offen offset:3072
    buffer_load_dwordx4 v[182:185], v15, s[20:23], s24 offen offset:0
    buffer_load_dwordx4 v[186:189], v15, s[20:23], s24 offen offset:1024
    s_add_u32 s24, s24, 14336
    buffer_load_dwordx4 v[190:193], v12, s[20:23], s24 offen offset:0
    buffer_load_dwordx4 v[194:197], v12, s[20:23], s24 offen offset:1024
    buffer_load_dwordx4 v[198:201], v12, s[20:23], s24 offen offset:2048
    buffer_load_dwordx4 v[202:205], v12, s[20:23], s24 offen offset:3072
    buffer_load_dwordx4 v[206:209], v13, s[20:23], s24 offen offset:0
    buffer_load_dwordx4 v[210:213], v13, s[20:23], s24 offen offset:1024
    buffer_load_dwordx4 v[214:217], v13, s[20:23], s24 offen offset:2048
    buffer_load_dwordx4 v[218:221], v13, s[20:23], s24 offen offset:3072
    buffer_load_dwordx4 v[222:225], v14, s[20:23], s24 offen offset:0
    buffer_load_dwordx4 v[226:229], v14, s[20:23], s24 offen offset:1024
    buffer_load_dwordx4 v[230:233], v14, s[20:23], s24 offen offset:2048
    buffer_load_dwordx4 v[234:237], v14, s[20:23], s24 offen offset:3072
    buffer_load_dwordx4 v[238:241], v15, s[20:23], s24 offen offset:0
    buffer_load_dwordx4 v[242:245], v15, s[20:23], s24 offen offset:1024
    s_mul_i32 s25, s3, 1792
    v_lshlrev_b32 v6, 4, v1
    v_add_u32 v6, s25, v6
    v_add_u32 v251, 70656, v6
    v_lshrrev_b32 v7, 1, v3
    v_lshlrev_b32 v7, 8, v7
    v_lshl_add_u32 v7, v4, 5, v7
    v_and_b32 v252, 1, v3
    v_lshl_add_u32 v7, v252, 4, v7
    v_add_u32 v7, 70656, v7
    v_lshlrev_b32 v252, 5, v4
    v_lshl_add_u32 v252, v3, 3, v252
    v_add_u32 v252, s25, v252
    v_add_u32 v252, 70656, v252
    s_mov_b32 s36, -1
    s_mov_b32 s37, 0x0000ffff
    s_mul_i32 s25, s3, 224
    v_mul_u32_u24 v8, 912, v2
    v_lshl_add_u32 v8, v3, 3, v8
    v_add_u32 v8, s25, v8
    v_add_u32 v9, 14592, v8
    v_lshlrev_b32 v10, 4, v1
    s_mul_i32 s26, s3, 3072
    s_add_u32 s26, s26, 58368
    v_add_u32 v11, s26, v10
    v_lshl_add_u32 v246, v3, 3, v4
    v_lshlrev_b32 v247, 3, v246
    v_add_u32 v247, 512, v247
    v_lshlrev_b32 v246, 4, v246
    v_cmp_gt_u32 s[30:31], 8, v2
    v_cmp_gt_u32 s[32:33], 2, v3
    s_mov_b32 s34, -1
    s_mov_b32 s35, 0x00ffffff
    s_and_b32 s40, s2, 0
    s_mul_i32 s40, s40, 7168
    s_add_u32 s40, s40, 173965312
    s_lshl_b32 s41, s2, 10
    s_add_u32 s41, s41, 175828992
    s_mov_b32 s42, 0
    s_mul_i32 s43, s3, 7168
    s_add_u32 s43, s43, 31752192
    s_mul_i32 s44, s3, 7296
    v_mov_b32 v253, 0
    s_mov_b32 s47, 0
    s_mov_b64 exec, s[34:35]
    s_add_u32 s45, s44, s47
    s_mov_b32 s46, s43
    s_mov_b32 m0, s45
    s_nop 0
    buffer_load_dwordx4 v10, s[20:23], s46 offen lds
    s_add_u32 s45, s45, 912
    s_add_u32 s46, s46, 896
    s_mov_b32 m0, s45
    s_nop 0
    buffer_load_dwordx4 v10, s[20:23], s46 offen lds
    s_add_u32 s45, s45, 912
    s_add_u32 s46, s46, 896
    s_mov_b32 m0, s45
    s_nop 0
    buffer_load_dwordx4 v10, s[20:23], s46 offen lds
    s_add_u32 s45, s45, 912
    s_add_u32 s46, s46, 896
    s_mov_b32 m0, s45
    s_nop 0
    buffer_load_dwordx4 v10, s[20:23], s46 offen lds
    s_add_u32 s45, s45, 912
    s_add_u32 s46, s46, 896
    s_mov_b32 m0, s45
    s_nop 0
    buffer_load_dwordx4 v10, s[20:23], s46 offen lds
    s_add_u32 s45, s45, 912
    s_add_u32 s46, s46, 896
    s_mov_b32 m0, s45
    s_nop 0
    buffer_load_dwordx4 v10, s[20:23], s46 offen lds
    s_add_u32 s45, s45, 912
    s_add_u32 s46, s46, 896
    s_mov_b32 m0, s45
    s_nop 0
    buffer_load_dwordx4 v10, s[20:23], s46 offen lds
    s_add_u32 s45, s45, 912
    s_add_u32 s46, s46, 896
    s_mov_b32 m0, s45
    s_nop 0
    buffer_load_dwordx4 v10, s[20:23], s46 offen lds
    s_mov_b64 exec, -1
    s_add_u32 s43, s43, 28672
    s_waitcnt vmcnt(0)
    s_barrier
ch0_sloop:
    s_xor_b32 s48, s47, 29184
    s_cmp_ge_u32 s42, 63
    s_cbranch_scc1 ch0_snodma
    s_mov_b64 exec, s[34:35]
    s_add_u32 s45, s44, s48
    s_mov_b32 s46, s43
    s_mov_b32 m0, s45
    s_nop 0
    buffer_load_dwordx4 v10, s[20:23], s46 offen lds
    s_add_u32 s45, s45, 912
    s_add_u32 s46, s46, 896
    s_mov_b32 m0, s45
    s_nop 0
    buffer_load_dwordx4 v10, s[20:23], s46 offen lds
    s_add_u32 s45, s45, 912
    s_add_u32 s46, s46, 896
    s_mov_b32 m0, s45
    s_nop 0
    buffer_load_dwordx4 v10, s[20:23], s46 offen lds
    s_add_u32 s45, s45, 912
    s_add_u32 s46, s46, 896
    s_mov_b32 m0, s45
    s_nop 0
    buffer_load_dwordx4 v10, s[20:23], s46 offen lds
    s_add_u32 s45, s45, 912
    s_add_u32 s46, s46, 896
    s_mov_b32 m0, s45
    s_nop 0
    buffer_load_dwordx4 v10, s[20:23], s46 offen lds
    s_add_u32 s45, s45, 912
    s_add_u32 s46, s46, 896
    s_mov_b32 m0, s45
    s_nop 0
    buffer_load_dwordx4 v10, s[20:23], s46 offen lds
    s_add_u32 s45, s45, 912
    s_add_u32 s46, s46, 896
    s_mov_b32 m0, s45
    s_nop 0
    buffer_load_dwordx4 v10, s[20:23], s46 offen lds
    s_add_u32 s45, s45, 912
    s_add_u32 s46, s46, 896
    s_mov_b32 m0, s45
    s_nop 0
    buffer_load_dwordx4 v10, s[20:23], s46 offen lds
    s_mov_b64 exec, -1
    s_add_u32 s43, s43, 28672
ch0_snodma:
    v_add_u32 v249, s47, v8
    v_add_u32 v250, s47, v9
    ds_read2_b64 v[56:59], v249 offset0:0 offset1:4
    ds_read2_b64 v[60:63], v249 offset0:8 offset1:12
    ds_read2_b64 v[64:67], v249 offset0:16 offset1:20
    ds_read_b64 v[68:69], v249 offset:192
    ds_read2_b64 v[70:73], v250 offset0:0 offset1:4
    ds_read2_b64 v[74:77], v250 offset0:8 offset1:12
    ds_read2_b64 v[78:81], v250 offset0:16 offset1:20
    ds_read_b64 v[82:83], v250 offset:192
    v_mov_b32 v88, 0
    v_mov_b32 v89, 0
    v_mov_b32 v90, 0
    v_mov_b32 v91, 0
    buffer_load_dwordx4 v[84:87], v6, s[20:23], s40 offen sc1
    s_mov_b64 exec, s[36:37]
    buffer_load_dwordx4 v[88:91], v6, s[20:23], s40 offen offset:1024 sc1
    s_mov_b64 exec, -1
    s_sleep 1
ch0_spoll:
    s_waitcnt vmcnt(0)
    v_max3_u32 v248, v84, v86, v88
    v_max_u32 v248, v248, v90
    v_cmp_eq_u32 vcc, -1, v248
    s_cbranch_vccz ch0_sg0
    buffer_load_dwordx4 v[84:87], v6, s[20:23], s40 offen sc1
    s_mov_b64 exec, s[36:37]
    buffer_load_dwordx4 v[88:91], v6, s[20:23], s40 offen offset:1024 sc1
    s_mov_b64 exec, -1
    s_branch ch0_spoll
ch0_sg0:
    ds_write_b128 v251, v[84:87]
    s_mov_b64 exec, s[36:37]
    ds_write_b128 v251, v[88:91] offset:1024
    s_mov_b64 exec, -1
ch0_sgot:
    s_waitcnt lgkmcnt(0)
    s_barrier
    ds_read_b128 v[40:43], v7 offset:0
    ds_read_b128 v[44:47], v7 offset:512
    ds_read_b128 v[48:51], v7 offset:1024
    ds_read_b128 v[52:55], v7 offset:1536
    s_waitcnt lgkmcnt(3)
    v_mfma_f32_16x16x32_bf16 v[12:15], a[0:3], v[40:43], 0
    v_mfma_f32_16x16x32_bf16 v[16:19], a[56:59], v[40:43], 0
    v_mfma_f32_16x16x32_bf16 v[20:23], a[112:115], v[40:43], 0
    v_mfma_f32_16x16x32_bf16 v[24:27], a[168:171], v[40:43], 0
    v_mfma_f32_16x16x32_bf16 v[28:31], a[224:227], v[40:43], 0
    v_mfma_f32_16x16x32_bf16 v[32:35], v[134:137], v[40:43], 0
    v_mfma_f32_16x16x32_bf16 v[36:39], v[190:193], v[40:43], 0
    ds_read_b128 v[40:43], v7 offset:2048
    s_waitcnt lgkmcnt(3)
    v_mfma_f32_16x16x32_bf16 v[12:15], a[4:7], v[44:47], v[12:15]
    v_mfma_f32_16x16x32_bf16 v[16:19], a[60:63], v[44:47], v[16:19]
    v_mfma_f32_16x16x32_bf16 v[20:23], a[116:119], v[44:47], v[20:23]
    v_mfma_f32_16x16x32_bf16 v[24:27], a[172:175], v[44:47], v[24:27]
    v_mfma_f32_16x16x32_bf16 v[28:31], a[228:231], v[44:47], v[28:31]
    v_mfma_f32_16x16x32_bf16 v[32:35], v[138:141], v[44:47], v[32:35]
    v_mfma_f32_16x16x32_bf16 v[36:39], v[194:197], v[44:47], v[36:39]
    ds_read_b128 v[44:47], v7 offset:2560
    s_waitcnt lgkmcnt(3)
    v_mfma_f32_16x16x32_bf16 v[12:15], a[8:11], v[48:51], v[12:15]
    v_mfma_f32_16x16x32_bf16 v[16:19], a[64:67], v[48:51], v[16:19]
    v_mfma_f32_16x16x32_bf16 v[20:23], a[120:123], v[48:51], v[20:23]
    v_mfma_f32_16x16x32_bf16 v[24:27], a[176:179], v[48:51], v[24:27]
    v_mfma_f32_16x16x32_bf16 v[28:31], a[232:235], v[48:51], v[28:31]
    v_mfma_f32_16x16x32_bf16 v[32:35], v[142:145], v[48:51], v[32:35]
    v_mfma_f32_16x16x32_bf16 v[36:39], v[198:201], v[48:51], v[36:39]
    ds_read_b128 v[48:51], v7 offset:3072
    s_waitcnt lgkmcnt(3)
    v_mfma_f32_16x16x32_bf16 v[12:15], a[12:15], v[52:55], v[12:15]
    v_mfma_f32_16x16x32_bf16 v[16:19], a[68:71], v[52:55], v[16:19]
    v_mfma_f32_16x16x32_bf16 v[20:23], a[124:127], v[52:55], v[20:23]
    v_mfma_f32_16x16x32_bf16 v[24:27], a[180:183], v[52:55], v[24:27]
    v_mfma_f32_16x16x32_bf16 v[28:31], a[236:239], v[52:55], v[28:31]
    v_mfma_f32_16x16x32_bf16 v[32:35], v[146:149], v[52:55], v[32:35]
    v_mfma_f32_16x16x32_bf16 v[36:39], v[202:205], v[52:55], v[36:39]
    ds_read_b128 v[52:55], v7 offset:3584
    s_waitcnt lgkmcnt(3)
    v_mfma_f32_16x16x32_bf16 v[12:15], a[16:19], v[40:43], v[12:15]
    v_mfma_f32_16x16x32_bf16 v[16:19], a[72:75], v[40:43], v[16:19]
    v_mfma_f32_16x16x32_bf16 v[20:23], a[128:131], v[40:43], v[20:23]
    v_mfma_f32_16x16x32_bf16 v[24:27], a[184:187], v[40:43], v[24:27]
    v_mfma_f32_16x16x32_bf16 v[28:31], a[240:243], v[40:43], v[28:31]
    v_mfma_f32_16x16x32_bf16 v[32:35], v[150:153], v[40:43], v[32:35]
    v_mfma_f32_16x16x32_bf16 v[36:39], v[206:209], v[40:43], v[36:39]
    ds_read_b128 v[40:43], v7 offset:4096
    s_waitcnt lgkmcnt(3)
    v_mfma_f32_16x16x32_bf16 v[12:15], a[20:23], v[44:47], v[12:15]
    v_mfma_f32_16x16x32_bf16 v[16:19], a[76:79], v[44:47], v[16:19]
    v_mfma_f32_16x16x32_bf16 v[20:23], a[132:135], v[44:47], v[20:23]
    v_mfma_f32_16x16x32_bf16 v[24:27], a[188:191], v[44:47], v[24:27]
    v_mfma_f32_16x16x32_bf16 v[28:31], a[244:247], v[44:47], v[28:31]
    v_mfma_f32_16x16x32_bf16 v[32:35], v[154:157], v[44:47], v[32:35]
    v_mfma_f32_16x16x32_bf16 v[36:39], v[210:213], v[44:47], v[36:39]
    ds_read_b128 v[44:47], v7 offset:4608
    s_waitcnt lgkmcnt(3)
    v_mfma_f32_16x16x32_bf16 v[12:15], a[24:27], v[48:51], v[12:15]
    v_mfma_f32_16x16x32_bf16 v[16:19], a[80:83], v[48:51], v[16:19]
    v_mfma_f32_16x16x32_bf16 v[20:23], a[136:139], v[48:51], v[20:23]
    v_mfma_f32_16x16x32_bf16 v[24:27], a[192:195], v[48:51], v[24:27]
    v_mfma_f32_16x16x32_bf16 v[28:31], a[248:251], v[48:51], v[28:31]
    v_mfma_f32_16x16x32_bf16 v[32:35], v[158:161], v[48:51], v[32:35]
    v_mfma_f32_16x16x32_bf16 v[36:39], v[214:217], v[48:51], v[36:39]
    s_waitcnt vmcnt(0)
    ds_read_b64 v[84:85], v252 offset:0
    ds_read_b64 v[86:87], v252 offset:256
    ds_read_b64 v[88:89], v252 offset:512
    ds_read_b64 v[90:91], v252 offset:768
    ds_read_b64 v[92:93], v252 offset:1024
    ds_read_b64 v[94:95], v252 offset:1280
    ds_read_b64 v[96:97], v252 offset:1536
    ds_read_b128 v[48:51], v7 offset:5120
    s_waitcnt lgkmcnt(10)
    v_mfma_f32_16x16x32_bf16 v[12:15], a[28:31], v[52:55], v[12:15]
    v_mfma_f32_16x16x32_bf16 v[16:19], a[84:87], v[52:55], v[16:19]
    v_mfma_f32_16x16x32_bf16 v[20:23], a[140:143], v[52:55], v[20:23]
    v_mfma_f32_16x16x32_bf16 v[24:27], a[196:199], v[52:55], v[24:27]
    v_mfma_f32_16x16x32_bf16 v[28:31], a[252:255], v[52:55], v[28:31]
    v_mfma_f32_16x16x32_bf16 v[32:35], v[162:165], v[52:55], v[32:35]
    v_mfma_f32_16x16x32_bf16 v[36:39], v[218:221], v[52:55], v[36:39]
    ds_read_b128 v[52:55], v7 offset:5632
    s_waitcnt lgkmcnt(10)
    v_mfma_f32_16x16x32_bf16 v[12:15], a[32:35], v[40:43], v[12:15]
    v_mfma_f32_16x16x32_bf16 v[16:19], a[88:91], v[40:43], v[16:19]
    v_mfma_f32_16x16x32_bf16 v[20:23], a[144:147], v[40:43], v[20:23]
    v_mfma_f32_16x16x32_bf16 v[24:27], a[200:203], v[40:43], v[24:27]
    v_mfma_f32_16x16x32_bf16 v[28:31], v[110:113], v[40:43], v[28:31]
    v_mfma_f32_16x16x32_bf16 v[32:35], v[166:169], v[40:43], v[32:35]
    v_mfma_f32_16x16x32_bf16 v[36:39], v[222:225], v[40:43], v[36:39]
    ds_read_b128 v[40:43], v7 offset:6144
    s_waitcnt lgkmcnt(10)
    v_mfma_f32_16x16x32_bf16 v[12:15], a[36:39], v[44:47], v[12:15]
    v_mfma_f32_16x16x32_bf16 v[16:19], a[92:95], v[44:47], v[16:19]
    v_mfma_f32_16x16x32_bf16 v[20:23], a[148:151], v[44:47], v[20:23]
    v_mfma_f32_16x16x32_bf16 v[24:27], a[204:207], v[44:47], v[24:27]
    v_mfma_f32_16x16x32_bf16 v[28:31], v[114:117], v[44:47], v[28:31]
    v_mfma_f32_16x16x32_bf16 v[32:35], v[170:173], v[44:47], v[32:35]
    v_mfma_f32_16x16x32_bf16 v[36:39], v[226:229], v[44:47], v[36:39]
    ds_read_b128 v[44:47], v7 offset:6656
    s_waitcnt lgkmcnt(3)
    v_mfma_f32_16x16x32_bf16 v[12:15], a[40:43], v[48:51], v[12:15]
    v_mfma_f32_16x16x32_bf16 v[16:19], a[96:99], v[48:51], v[16:19]
    v_mfma_f32_16x16x32_bf16 v[20:23], a[152:155], v[48:51], v[20:23]
    v_mfma_f32_16x16x32_bf16 v[24:27], a[208:211], v[48:51], v[24:27]
    v_mfma_f32_16x16x32_bf16 v[28:31], v[118:121], v[48:51], v[28:31]
    v_mfma_f32_16x16x32_bf16 v[32:35], v[174:177], v[48:51], v[32:35]
    v_mfma_f32_16x16x32_bf16 v[36:39], v[230:233], v[48:51], v[36:39]
    s_waitcnt lgkmcnt(2)
    v_mfma_f32_16x16x32_bf16 v[12:15], a[44:47], v[52:55], v[12:15]
    v_mfma_f32_16x16x32_bf16 v[16:19], a[100:103], v[52:55], v[16:19]
    v_mfma_f32_16x16x32_bf16 v[20:23], a[156:159], v[52:55], v[20:23]
    v_mfma_f32_16x16x32_bf16 v[24:27], a[212:215], v[52:55], v[24:27]
    v_mfma_f32_16x16x32_bf16 v[28:31], v[122:125], v[52:55], v[28:31]
    v_mfma_f32_16x16x32_bf16 v[32:35], v[178:181], v[52:55], v[32:35]
    v_mfma_f32_16x16x32_bf16 v[36:39], v[234:237], v[52:55], v[36:39]
    s_waitcnt lgkmcnt(1)
    v_mfma_f32_16x16x32_bf16 v[12:15], a[48:51], v[40:43], v[12:15]
    v_mfma_f32_16x16x32_bf16 v[16:19], a[104:107], v[40:43], v[16:19]
    v_mfma_f32_16x16x32_bf16 v[20:23], a[160:163], v[40:43], v[20:23]
    v_mfma_f32_16x16x32_bf16 v[24:27], a[216:219], v[40:43], v[24:27]
    v_mfma_f32_16x16x32_bf16 v[28:31], v[126:129], v[40:43], v[28:31]
    v_mfma_f32_16x16x32_bf16 v[32:35], v[182:185], v[40:43], v[32:35]
    v_mfma_f32_16x16x32_bf16 v[36:39], v[238:241], v[40:43], v[36:39]
    s_waitcnt lgkmcnt(0)
    v_mfma_f32_16x16x32_bf16 v[12:15], a[52:55], v[44:47], v[12:15]
    v_mfma_f32_16x16x32_bf16 v[16:19], a[108:111], v[44:47], v[16:19]
    v_mfma_f32_16x16x32_bf16 v[20:23], a[164:167], v[44:47], v[20:23]
    v_mfma_f32_16x16x32_bf16 v[24:27], a[220:223], v[44:47], v[24:27]
    v_mfma_f32_16x16x32_bf16 v[28:31], v[130:133], v[44:47], v[28:31]
    v_mfma_f32_16x16x32_bf16 v[32:35], v[186:189], v[44:47], v[32:35]
    v_mfma_f32_16x16x32_bf16 v[36:39], v[242:245], v[44:47], v[36:39]
    s_nop 7
    v_cvt_pk_bf16_f32 v12, v12, v13
    v_cvt_pk_bf16_f32 v13, v14, v15
    v_cvt_pk_bf16_f32 v14, v16, v17
    v_cvt_pk_bf16_f32 v15, v18, v19
    v_cvt_pk_bf16_f32 v20, v20, v21
    v_cvt_pk_bf16_f32 v21, v22, v23
    v_cvt_pk_bf16_f32 v22, v24, v25
    v_cvt_pk_bf16_f32 v23, v26, v27
    v_cvt_pk_bf16_f32 v28, v28, v29
    v_cvt_pk_bf16_f32 v29, v30, v31
    v_cvt_pk_bf16_f32 v30, v32, v33
    v_cvt_pk_bf16_f32 v31, v34, v35
    v_cvt_pk_bf16_f32 v36, v36, v37
    v_cvt_pk_bf16_f32 v37, v38, v39
    s_waitcnt lgkmcnt(0)
    s_nop 1
    v_mfma_f32_16x16x32_bf16 v[98:101], v[84:87], v[12:15], 0
    v_mfma_f32_16x16x32_bf16 v[102:105], v[56:59], v[12:15], 0
    v_mfma_f32_16x16x32_bf16 v[106:109], v[70:73], v[12:15], 0
    v_mfma_f32_16x16x32_bf16 v[98:101], v[88:91], v[20:23], v[98:101]
    v_mfma_f32_16x16x32_bf16 v[102:105], v[60:63], v[20:23], v[102:105]
    v_mfma_f32_16x16x32_bf16 v[106:109], v[74:77], v[20:23], v[106:109]
    v_mfma_f32_16x16x32_bf16 v[98:101], v[92:95], v[28:31], v[98:101]
    v_mfma_f32_16x16x32_bf16 v[102:105], v[64:67], v[28:31], v[102:105]
    v_mfma_f32_16x16x32_bf16 v[106:109], v[78:81], v[28:31], v[106:109]
    v_mfma_f32_16x16x16_bf16 v[98:101], v[96:97], v[36:37], v[98:101]
    v_mfma_f32_16x16x16_bf16 v[102:105], v[68:69], v[36:37], v[102:105]
    v_mfma_f32_16x16x16_bf16 v[106:109], v[82:83], v[36:37], v[106:109]
    s_nop 7
    s_nop 1
    ds_write_b128 v11, v[98:101]
    ds_write_b128 v11, v[102:105] offset:1024
    ds_write_b128 v11, v[106:109] offset:2048
    s_waitcnt lgkmcnt(0)
    s_barrier
    s_cmp_lg_u32 s3, 0
    s_cbranch_scc1 ch0_snext
    ds_read_b128 v[12:15], v11 offset:3072
    ds_read_b128 v[16:19], v11 offset:4096
    ds_read_b128 v[20:23], v11 offset:5120
    ds_read_b128 v[24:27], v11 offset:6144
    ds_read_b128 v[28:31], v11 offset:7168
    ds_read_b128 v[32:35], v11 offset:8192
    ds_read_b128 v[36:39], v11 offset:9216
    ds_read_b128 v[40:43], v11 offset:10240
    ds_read_b128 v[44:47], v11 offset:11264
    s_waitcnt lgkmcnt(0)
    v_pk_add_f32 v[98:99], v[98:99], v[12:13]
    v_pk_add_f32 v[24:25], v[24:25], v[36:37]
    v_pk_add_f32 v[100:101], v[100:101], v[14:15]
    v_pk_add_f32 v[26:27], v[26:27], v[38:39]
    v_pk_add_f32 v[102:103], v[102:103], v[16:17]
    v_pk_add_f32 v[28:29], v[28:29], v[40:41]
    v_pk_add_f32 v[104:105], v[104:105], v[18:19]
    v_pk_add_f32 v[30:31], v[30:31], v[42:43]
    v_pk_add_f32 v[106:107], v[106:107], v[20:21]
    v_pk_add_f32 v[32:33], v[32:33], v[44:45]
    v_pk_add_f32 v[108:109], v[108:109], v[22:23]
    v_pk_add_f32 v[34:35], v[34:35], v[46:47]
    v_pk_add_f32 v[98:99], v[98:99], v[24:25]
    v_pk_add_f32 v[100:101], v[100:101], v[26:27]
    v_pk_add_f32 v[102:103], v[102:103], v[28:29]
    v_pk_add_f32 v[104:105], v[104:105], v[30:31]
    v_pk_add_f32 v[106:107], v[106:107], v[32:33]
    v_pk_add_f32 v[108:109], v[108:109], v[34:35]
    v_mov_b32 v40, 0xff800000
    v_cndmask_b32 v98, v40, v98, s[32:33]
    v_cndmask_b32 v99, v40, v99, s[32:33]
    v_cndmask_b32 v100, v40, v100, s[32:33]
    v_cndmask_b32 v101, v40, v101, s[32:33]
    v_max3_f32 v41, v98, v99, v100
    v_max3_f32 v41, v41, v101, v102
    v_max3_f32 v41, v41, v103, v104
    v_max3_f32 v41, v41, v105, v106
    v_max3_f32 v41, v41, v107, v108
    v_max_f32 v41, v41, v109
    v_mov_b32 v42, v41
    s_nop 1
    v_permlane16_swap_b32 v41, v42
    v_max_f32 v41, v41, v42
    v_mov_b32 v42, v41
    s_nop 1
    v_permlane32_swap_b32 v41, v42
    v_max_f32 v41, v41, v42
    v_mul_f32 v41, 0xbfb8aa3b, v41
    v_fma_f32 v98, v98, s50, v41
    v_fma_f32 v99, v99, s50, v41
    v_fma_f32 v100, v100, s50, v41
    v_fma_f32 v101, v101, s50, v41
    v_fma_f32 v102, v102, s50, v41
    v_fma_f32 v103, v103, s50, v41
    v_fma_f32 v104, v104, s50, v41
    v_fma_f32 v105, v105, s50, v41
    v_fma_f32 v106, v106, s50, v41
    v_fma_f32 v107, v107, s50, v41
    v_fma_f32 v108, v108, s50, v41
    v_fma_f32 v109, v109, s50, v41
    v_exp_f32 v98, v98
    v_exp_f32 v99, v99
    v_exp_f32 v100, v100
    v_exp_f32 v101, v101
    v_exp_f32 v102, v102
    v_exp_f32 v103, v103
    v_exp_f32 v104, v104
    v_exp_f32 v105, v105
    v_exp_f32 v106, v106
    v_exp_f32 v107, v107
    v_exp_f32 v108, v108
    v_exp_f32 v109, v109
    s_nop 0
    v_pk_add_f32 v[12:13], v[98:99], v[100:101]
    v_pk_add_f32 v[14:15], v[102:103], v[104:105]
    v_pk_add_f32 v[16:17], v[106:107], v[108:109]
    v_pk_add_f32 v[12:13], v[12:13], v[14:15]
    v_pk_add_f32 v[12:13], v[12:13], v[16:17]
    v_add_f32 v42, v12, v13
    v_mov_b32 v43, v42
    s_nop 1
    v_permlane16_swap_b32 v42, v43
    v_add_f32 v42, v42, v43
    v_mov_b32 v43, v42
    s_nop 1
    v_permlane32_swap_b32 v42, v43
    v_add_f32 v42, v42, v43
    v_rcp_f32 v42, v42
    s_nop 0
    v_mov_b32 v43, v42
    v_pk_mul_f32 v[98:99], v[98:99], v[42:43]
    v_pk_mul_f32 v[100:101], v[100:101], v[42:43]
    v_pk_mul_f32 v[102:103], v[102:103], v[42:43]
    v_pk_mul_f32 v[104:105], v[104:105], v[42:43]
    v_pk_mul_f32 v[106:107], v[106:107], v[42:43]
    v_pk_mul_f32 v[108:109], v[108:109], v[42:43]
    v_cvt_pk_bf16_f32 v44, v102, v103
    v_cvt_pk_bf16_f32 v45, v104, v105
    v_cvt_pk_bf16_f32 v46, v106, v107
    v_cvt_pk_bf16_f32 v47, v108, v109
    v_cvt_pk_bf16_f32 v48, v98, v99
    v_cvt_pk_bf16_f32 v49, v100, v101
    s_mov_b64 exec, s[30:31]
    buffer_store_dwordx4 v[44:47], v246, s[20:23], s41 offen
    buffer_store_dwordx2 v[48:49], v247, s[20:23], s41 offen
    s_mov_b64 exec, -1
ch0_snext:
    s_add_u32 s40, s40, 7168
    s_add_u32 s41, s41, 16384
    s_mov_b32 s47, s48
    s_add_u32 s42, s42, 1
    s_cmp_lt_u32 s42, 64
    s_cbranch_scc1 ch0_sloop
    s_endpgm
ch0_ucu:
    s_sub_u32 s24, s2, 16
    v_mul_u32_u24 v5, 896, v2
    v_lshl_add_u32 v5, v3, 4, v5
    s_lshl_b32 s25, s3, 2
    s_add_u32 s25, s25, 16
    s_mul_i32 s25, s25, 448
    s_lshl_b32 s26, s24, 5
    s_add_u32 s25, s25, s26
    s_mul_i32 s25, s25, 896
    s_add_u32 s25, s25, 5275648
    s_mul_i32 s27, s3, 22528
    s_add_u32 s27, s27, 16384
    s_add_u32 s52, s25, 0
    s_add_u32 s53, s25, 14336
    s_add_u32 s54, s25, 401408
    s_add_u32 s55, s25, 415744
    s_add_u32 s56, s25, 802816
    s_add_u32 s57, s25, 817152
    s_add_u32 s58, s25, 1204224
    s_add_u32 s59, s25, 1218560
    v_lshlrev_b32 v12, 4, v1
    v_add_u32 v13, 4096, v12
    v_add_u32 v14, 8192, v12
    v_add_u32 v15, 12288, v12
    buffer_load_dwordx4 a[0:3], v12, s[20:23], s52 offen offset:0
    buffer_load_dwordx4 a[4:7], v12, s[20:23], s53 offen offset:0
    buffer_load_dwordx4 a[8:11], v12, s[20:23], s54 offen offset:0
    buffer_load_dwordx4 a[12:15], v12, s[20:23], s55 offen offset:0
    buffer_load_dwordx4 a[16:19], v12, s[20:23], s56 offen offset:0
    buffer_load_dwordx4 a[20:23], v12, s[20:23], s57 offen offset:0
    buffer_load_dwordx4 a[24:27], v12, s[20:23], s58 offen offset:0
    buffer_load_dwordx4 a[28:31], v12, s[20:23], s59 offen offset:0
    buffer_load_dwordx4 a[32:35], v12, s[20:23], s52 offen offset:1024
    buffer_load_dwordx4 a[36:39], v12, s[20:23], s53 offen offset:1024
    buffer_load_dwordx4 a[40:43], v12, s[20:23], s54 offen offset:1024
    buffer_load_dwordx4 a[44:47], v12, s[20:23], s55 offen offset:1024
    buffer_load_dwordx4 a[48:51], v12, s[20:23], s56 offen offset:1024
    buffer_load_dwordx4 a[52:55], v12, s[20:23], s57 offen offset:1024
    buffer_load_dwordx4 a[56:59], v12, s[20:23], s58 offen offset:1024
    buffer_load_dwordx4 a[60:63], v12, s[20:23], s59 offen offset:1024
    buffer_load_dwordx4 a[64:67], v12, s[20:23], s52 offen offset:2048
    buffer_load_dwordx4 a[68:71], v12, s[20:23], s53 offen offset:2048
    buffer_load_dwordx4 a[72:75], v12, s[20:23], s54 offen offset:2048
    buffer_load_dwordx4 a[76:79], v12, s[20:23], s55 offen offset:2048
    buffer_load_dwordx4 a[80:83], v12, s[20:23], s56 offen offset:2048
    buffer_load_dwordx4 a[84:87], v12, s[20:23], s57 offen offset:2048
    buffer_load_dwordx4 a[88:91], v12, s[20:23], s58 offen offset:2048
    buffer_load_dwordx4 a[92:95], v12, s[20:23], s59 offen offset:2048
    buffer_load_dwordx4 a[96:99], v12, s[20:23], s52 offen offset:3072
    buffer_load_dwordx4 a[100:103], v12, s[20:23], s53 offen offset:3072
    buffer_load_dwordx4 a[104:107], v12, s[20:23], s54 offen offset:3072
    buffer_load_dwordx4 a[108:111], v12, s[20:23], s55 offen offset:3072
    buffer_load_dwordx4 a[112:115], v12, s[20:23], s56 offen offset:3072
    buffer_load_dwordx4 a[116:119], v12, s[20:23], s57 offen offset:3072
    buffer_load_dwordx4 a[120:123], v12, s[20:23], s58 offen offset:3072
    buffer_load_dwordx4 a[124:127], v12, s[20:23], s59 offen offset:3072
    buffer_load_dwordx4 a[128:131], v13, s[20:23], s52 offen offset:0
    buffer_load_dwordx4 a[132:135], v13, s[20:23], s53 offen offset:0
    buffer_load_dwordx4 a[136:139], v13, s[20:23], s54 offen offset:0
    buffer_load_dwordx4 a[140:143], v13, s[20:23], s55 offen offset:0
    buffer_load_dwordx4 a[144:147], v13, s[20:23], s56 offen offset:0
    buffer_load_dwordx4 a[148:151], v13, s[20:23], s57 offen offset:0
    buffer_load_dwordx4 a[152:155], v13, s[20:23], s58 offen offset:0
    buffer_load_dwordx4 a[156:159], v13, s[20:23], s59 offen offset:0
    buffer_load_dwordx4 a[160:163], v13, s[20:23], s52 offen offset:1024
    buffer_load_dwordx4 a[164:167], v13, s[20:23], s53 offen offset:1024
    buffer_load_dwordx4 a[168:171], v13, s[20:23], s54 offen offset:1024
    buffer_load_dwordx4 a[172:175], v13, s[20:23], s55 offen offset:1024
    buffer_load_dwordx4 a[176:179], v13, s[20:23], s56 offen offset:1024
    buffer_load_dwordx4 a[180:183], v13, s[20:23], s57 offen offset:1024
    buffer_load_dwordx4 a[184:187], v13, s[20:23], s58 offen offset:1024
    buffer_load_dwordx4 a[188:191], v13, s[20:23], s59 offen offset:1024
    buffer_load_dwordx4 a[192:195], v13, s[20:23], s52 offen offset:2048
    buffer_load_dwordx4 a[196:199], v13, s[20:23], s53 offen offset:2048
    buffer_load_dwordx4 a[200:203], v13, s[20:23], s54 offen offset:2048
    buffer_load_dwordx4 a[204:207], v13, s[20:23], s55 offen offset:2048
    buffer_load_dwordx4 a[208:211], v13, s[20:23], s56 offen offset:2048
    buffer_load_dwordx4 a[212:215], v13, s[20:23], s57 offen offset:2048
    buffer_load_dwordx4 a[216:219], v13, s[20:23], s58 offen offset:2048
    buffer_load_dwordx4 a[220:223], v13, s[20:23], s59 offen offset:2048
    buffer_load_dwordx4 a[224:227], v13, s[20:23], s52 offen offset:3072
    buffer_load_dwordx4 a[228:231], v13, s[20:23], s53 offen offset:3072
    buffer_load_dwordx4 a[232:235], v13, s[20:23], s54 offen offset:3072
    buffer_load_dwordx4 a[236:239], v13, s[20:23], s55 offen offset:3072
    buffer_load_dwordx4 a[240:243], v13, s[20:23], s56 offen offset:3072
    buffer_load_dwordx4 a[244:247], v13, s[20:23], s57 offen offset:3072
    buffer_load_dwordx4 a[248:251], v13, s[20:23], s58 offen offset:3072
    buffer_load_dwordx4 a[252:255], v13, s[20:23], s59 offen offset:3072
    buffer_load_dwordx4 v[152:155], v14, s[20:23], s52 offen offset:0
    buffer_load_dwordx4 v[156:159], v14, s[20:23], s53 offen offset:0
    buffer_load_dwordx4 v[160:163], v14, s[20:23], s54 offen offset:0
    buffer_load_dwordx4 v[164:167], v14, s[20:23], s55 offen offset:0
    buffer_load_dwordx4 v[168:171], v14, s[20:23], s56 offen offset:0
    buffer_load_dwordx4 v[172:175], v14, s[20:23], s57 offen offset:0
    buffer_load_dwordx4 v[176:179], v14, s[20:23], s58 offen offset:0
    buffer_load_dwordx4 v[180:183], v14, s[20:23], s59 offen offset:0
    buffer_load_dwordx4 v[184:187], v14, s[20:23], s52 offen offset:1024
    buffer_load_dwordx4 v[188:191], v14, s[20:23], s53 offen offset:1024
    buffer_load_dwordx4 v[192:195], v14, s[20:23], s54 offen offset:1024
    buffer_load_dwordx4 v[196:199], v14, s[20:23], s55 offen offset:1024
    buffer_load_dwordx4 v[200:203], v14, s[20:23], s56 offen offset:1024
    buffer_load_dwordx4 v[204:207], v14, s[20:23], s57 offen offset:1024
    buffer_load_dwordx4 v[208:211], v14, s[20:23], s58 offen offset:1024
    buffer_load_dwordx4 v[212:215], v14, s[20:23], s59 offen offset:1024
    buffer_load_dwordx4 v[216:219], v14, s[20:23], s52 offen offset:2048
    buffer_load_dwordx4 v[220:223], v14, s[20:23], s53 offen offset:2048
    buffer_load_dwordx4 v[224:227], v14, s[20:23], s54 offen offset:2048
    buffer_load_dwordx4 v[228:231], v14, s[20:23], s55 offen offset:2048
    buffer_load_dwordx4 v[232:235], v14, s[20:23], s56 offen offset:2048
    buffer_load_dwordx4 v[236:239], v14, s[20:23], s57 offen offset:2048
    buffer_load_dwordx4 v[240:243], v14, s[20:23], s58 offen offset:2048
    buffer_load_dwordx4 v[244:247], v14, s[20:23], s59 offen offset:2048
    buffer_load_dwordx4 v[248:251], v14, s[20:23], s52 offen offset:3072
    buffer_load_dwordx4 v[252:255], v14, s[20:23], s53 offen offset:3072
    s_add_u32 s28, s27, 0
    s_mov_b32 m0, s28
    s_add_u32 s29, s54, 11264
    buffer_load_dwordx4 v12, s[20:23], s29 offen lds
    s_add_u32 s28, s27, 1024
    s_mov_b32 m0, s28
    s_add_u32 s29, s55, 11264
    buffer_load_dwordx4 v12, s[20:23], s29 offen lds
    s_add_u32 s28, s27, 2048
    s_mov_b32 m0, s28
    s_add_u32 s29, s56, 11264
    buffer_load_dwordx4 v12, s[20:23], s29 offen lds
    s_add_u32 s28, s27, 3072
    s_mov_b32 m0, s28
    s_add_u32 s29, s57, 11264
    buffer_load_dwordx4 v12, s[20:23], s29 offen lds
    s_add_u32 s28, s27, 4096
    s_mov_b32 m0, s28
    s_add_u32 s29, s58, 11264
    buffer_load_dwordx4 v12, s[20:23], s29 offen lds
    s_add_u32 s28, s27, 5120
    s_mov_b32 m0, s28
    s_add_u32 s29, s59, 11264
    buffer_load_dwordx4 v12, s[20:23], s29 offen lds
    s_add_u32 s28, s27, 6144
    s_mov_b32 m0, s28
    s_add_u32 s29, s52, 12288
    buffer_load_dwordx4 v12, s[20:23], s29 offen lds
    s_add_u32 s28, s27, 7168
    s_mov_b32 m0, s28
    s_add_u32 s29, s53, 12288
    buffer_load_dwordx4 v12, s[20:23], s29 offen lds
    s_add_u32 s28, s27, 8192
    s_mov_b32 m0, s28
    s_add_u32 s29, s54, 12288
    buffer_load_dwordx4 v12, s[20:23], s29 offen lds
    s_add_u32 s28, s27, 9216
    s_mov_b32 m0, s28
    s_add_u32 s29, s55, 12288
    buffer_load_dwordx4 v12, s[20:23], s29 offen lds
    s_add_u32 s28, s27, 10240
    s_mov_b32 m0, s28
    s_add_u32 s29, s56, 12288
    buffer_load_dwordx4 v12, s[20:23], s29 offen lds
    s_add_u32 s28, s27, 11264
    s_mov_b32 m0, s28
    s_add_u32 s29, s57, 12288
    buffer_load_dwordx4 v12, s[20:23], s29 offen lds
    s_add_u32 s28, s27, 12288
    s_mov_b32 m0, s28
    s_add_u32 s29, s58, 12288
    buffer_load_dwordx4 v12, s[20:23], s29 offen lds
    s_add_u32 s28, s27, 13312
    s_mov_b32 m0, s28
    s_add_u32 s29, s59, 12288
    buffer_load_dwordx4 v12, s[20:23], s29 offen lds
    s_add_u32 s28, s27, 14336
    s_mov_b32 m0, s28
    s_add_u32 s29, s52, 13312
    buffer_load_dwordx4 v12, s[20:23], s29 offen lds
    s_add_u32 s28, s27, 15360
    s_mov_b32 m0, s28
    s_add_u32 s29, s53, 13312
    buffer_load_dwordx4 v12, s[20:23], s29 offen lds
    s_add_u32 s28, s27, 16384
    s_mov_b32 m0, s28
    s_add_u32 s29, s54, 13312
    buffer_load_dwordx4 v12, s[20:23], s29 offen lds
    s_add_u32 s28, s27, 17408
    s_mov_b32 m0, s28
    s_add_u32 s29, s55, 13312
    buffer_load_dwordx4 v12, s[20:23], s29 offen lds
    s_add_u32 s28, s27, 18432
    s_mov_b32 m0, s28
    s_add_u32 s29, s56, 13312
    buffer_load_dwordx4 v12, s[20:23], s29 offen lds
    s_add_u32 s28, s27, 19456
    s_mov_b32 m0, s28
    s_add_u32 s29, s57, 13312
    buffer_load_dwordx4 v12, s[20:23], s29 offen lds
    s_add_u32 s28, s27, 20480
    s_mov_b32 m0, s28
    s_add_u32 s29, s58, 13312
    buffer_load_dwordx4 v12, s[20:23], s29 offen lds
    s_add_u32 s28, s27, 21504
    s_mov_b32 m0, s28
    s_add_u32 s29, s59, 13312
    buffer_load_dwordx4 v12, s[20:23], s29 offen lds
    s_mul_i32 s25, s3, 1792
    v_lshlrev_b32 v6, 4, v1
    v_add_u32 v6, s25, v6
    s_mov_b32 s36, -1
    s_mov_b32 s37, 0x0000ffff
    v_lshl_add_u32 v7, v3, 3, v4
    v_lshlrev_b32 v8, 3, v7
    v_add_u32 v8, 512, v8
    v_lshlrev_b32 v7, 4, v7
    v_lshlrev_b32 v9, 5, v2
    v_lshl_add_u32 v9, v3, 3, v9
    s_lshl_b32 s26, s24, 9
    v_add_u32 v9, s26, v9
    v_lshlrev_b32 v10, 4, v2
    v_lshl_add_u32 v10, v3, 8, v10
    v_add_u32 v10, s26, v10
    v_lshlrev_b32 v4, 5, v4
    v_lshrrev_b32 v11, 1, v3
    v_lshl_add_u32 v4, v11, 8, v4
    v_and_b32 v11, 1, v3
    v_lshl_add_u32 v4, v11, 4, v4
    v_add_u32 v4, 8192, v4
    v_lshlrev_b32 v11, 4, v1
    s_lshl_b32 s26, s3, 11
    v_add_u32 v12, s26, v11
    v_add_u32 v13, s27, v11
    v_lshlrev_b32 v5, 6, v2
    v_lshl_add_u32 v5, v3, 4, v5
    v_cmp_gt_u32 s[30:31], 8, v2
    v_cmp_gt_u32 s[32:33], 2, v3
    s_mov_b32 s40, 173965312
    s_mov_b32 s75, 173972480
    s_mov_b32 s76, 174904320
    s_lshl_b32 s41, s3, 12
    s_add_u32 s41, s41, 175828992
    s_mov_b32 s42, 0
    s_mul_i32 s44, s3, 28672
    s_add_u32 s44, s44, 94142464
    s_mul_i32 s43, s3, 114688
    s_lshl_b32 s26, s24, 11
    s_add_u32 s43, s43, s26
    s_add_u32 s43, s43, 64782336
    v_mov_b32 v15, 0
    s_waitcnt vmcnt(0)
    s_barrier
    s_lshl_b32 s48, s3, 13
    s_add_u32 s48, s48, 106496
    v_add_u32 v144, s48, v11
    s_mov_b32 s49, 167632896
    s_lshl_b32 s28, s3, 12
    s_add_u32 s28, s28, 139264
    v_lshlrev_b32 v146, 3, v1
    v_add_u32 v146, s28, v146
mega_kernel_vw23:
    buffer_load_dword v145, v15, s[20:23], s49 offen sc1
    s_waitcnt vmcnt(0)
    v_readfirstlane_b32 s71, v145
    s_cmp_ge_u32 s71, 28
    s_cbranch_scc0 mega_kernel_vw23
    s_add_u32 s28, s48, 0
    s_mov_b32 m0, s28
    s_add_u32 s45, s43, 0
    buffer_load_dwordx4 v5, s[20:23], s45 offen sc1 lds
    s_add_u32 s28, s48, 1024
    s_mov_b32 m0, s28
    s_add_u32 s45, s43, 1024
    buffer_load_dwordx4 v5, s[20:23], s45 offen sc1 lds
    s_add_u32 s28, s48, 2048
    s_mov_b32 m0, s28
    s_add_u32 s45, s43, 28672
    buffer_load_dwordx4 v5, s[20:23], s45 offen sc1 lds
    s_add_u32 s28, s48, 3072
    s_mov_b32 m0, s28
    s_add_u32 s45, s43, 29696
    buffer_load_dwordx4 v5, s[20:23], s45 offen sc1 lds
    s_add_u32 s28, s48, 4096
    s_mov_b32 m0, s28
    s_add_u32 s45, s43, 57344
    buffer_load_dwordx4 v5, s[20:23], s45 offen sc1 lds
    s_add_u32 s28, s48, 5120
    s_mov_b32 m0, s28
    s_add_u32 s45, s43, 58368
    buffer_load_dwordx4 v5, s[20:23], s45 offen sc1 lds
    s_add_u32 s28, s48, 6144
    s_mov_b32 m0, s28
    s_add_u32 s45, s43, 86016
    buffer_load_dwordx4 v5, s[20:23], s45 offen sc1 lds
    s_add_u32 s28, s48, 7168
    s_mov_b32 m0, s28
    s_add_u32 s45, s43, 87040
    buffer_load_dwordx4 v5, s[20:23], s45 offen sc1 lds
    s_add_u32 s43, s43, 458752
    s_add_u32 s49, s49, 128
    buffer_load_dword v145, v15, s[20:23], s49 offen sc1
    s_waitcnt vmcnt(0)
ch0_uloop:
    ds_read_b128 v[80:83], v144 offset:0
    ds_read_b128 v[84:87], v144 offset:1024
    ds_read_b128 v[88:91], v144 offset:2048
    ds_read_b128 v[92:95], v144 offset:3072
    ds_read_b128 v[96:99], v144 offset:4096
    ds_read_b128 v[100:103], v144 offset:5120
    ds_read_b128 v[104:107], v144 offset:6144
    ds_read_b128 v[108:111], v144 offset:7168
    ds_read_b64 v[112:113], v146 offset:0
    ds_read_b64 v[114:115], v146 offset:512
    ds_read_b64 v[116:117], v146 offset:1024
    ds_read_b64 v[118:119], v146 offset:1536
    ds_read_b64 v[120:121], v146 offset:2048
    ds_read_b64 v[122:123], v146 offset:2560
    ds_read_b64 v[124:125], v146 offset:3072
    ds_read_b64 v[126:127], v146 offset:3584
    v_mov_b32 v140, 0
    v_mov_b32 v141, 0
    v_mov_b32 v142, 0
    v_mov_b32 v143, 0
ch0_upoll:
    buffer_load_dwordx4 v[136:139], v6, s[20:23], s40 offen sc1
    s_mov_b64 exec, s[36:37]
    buffer_load_dwordx4 v[140:143], v6, s[20:23], s40 offen offset:1024 sc1
    s_mov_b64 exec, -1
    s_waitcnt vmcnt(0)
    v_max3_u32 v14, v136, v138, v140
    v_max_u32 v14, v14, v142
    v_cmp_eq_u32 vcc, -1, v14
    s_cbranch_vccnz ch0_upoll
    ds_write_b128 v6, v[136:139] offset:8192
    s_mov_b64 exec, s[36:37]
    ds_write_b128 v6, v[140:143] offset:9216
    s_mov_b64 exec, -1
    s_waitcnt lgkmcnt(0)
    s_barrier
    ds_read_b128 v[16:19], v4 offset:0
    ds_read_b128 v[20:23], v4 offset:512
    ds_read_b128 v[24:27], v4 offset:1024
    ds_read_b128 v[28:31], v4 offset:1536
    s_waitcnt lgkmcnt(3)
    v_mfma_f32_16x16x32_bf16 v[48:51], v[16:19], a[0:3], 0
    v_mfma_f32_16x16x32_bf16 v[52:55], v[16:19], a[4:7], 0
    v_mfma_f32_16x16x32_bf16 v[56:59], v[16:19], a[8:11], 0
    v_mfma_f32_16x16x32_bf16 v[60:63], v[16:19], a[12:15], 0
    v_mfma_f32_16x16x32_bf16 v[64:67], v[16:19], a[16:19], 0
    v_mfma_f32_16x16x32_bf16 v[68:71], v[16:19], a[20:23], 0
    v_mfma_f32_16x16x32_bf16 v[72:75], v[16:19], a[24:27], 0
    v_mfma_f32_16x16x32_bf16 v[76:79], v[16:19], a[28:31], 0
    s_cmp_eq_u32 s42, 0
    s_cbranch_scc1 ch0_nofl
    v_permlane16_swap_b32 v112, v114
    v_permlane16_swap_b32 v113, v115
    v_permlane16_swap_b32 v116, v118
    v_permlane16_swap_b32 v117, v119
    v_permlane16_swap_b32 v120, v122
    v_permlane16_swap_b32 v121, v123
    v_permlane16_swap_b32 v124, v126
    v_permlane16_swap_b32 v125, v127
    s_mov_b64 exec, s[32:33]
    s_mov_b32 s45, s44
    buffer_store_dwordx4 v[112:115], v10, s[20:23], s45 offen sc1
    s_add_u32 s45, s45, 7168
    buffer_store_dwordx4 v[116:119], v10, s[20:23], s45 offen sc1
    s_add_u32 s45, s45, 7168
    buffer_store_dwordx4 v[120:123], v10, s[20:23], s45 offen sc1
    s_add_u32 s45, s45, 7168
    buffer_store_dwordx4 v[124:127], v10, s[20:23], s45 offen sc1
    s_mov_b64 exec, -1
    s_add_u32 s44, s44, 114688
ch0_nofl:
    ds_read_b128 v[16:19], v4 offset:2048
    s_waitcnt lgkmcnt(3)
    v_mfma_f32_16x16x32_bf16 v[48:51], v[20:23], a[32:35], v[48:51]
    v_mfma_f32_16x16x32_bf16 v[52:55], v[20:23], a[36:39], v[52:55]
    v_mfma_f32_16x16x32_bf16 v[56:59], v[20:23], a[40:43], v[56:59]
    v_mfma_f32_16x16x32_bf16 v[60:63], v[20:23], a[44:47], v[60:63]
    v_mfma_f32_16x16x32_bf16 v[64:67], v[20:23], a[48:51], v[64:67]
    v_mfma_f32_16x16x32_bf16 v[68:71], v[20:23], a[52:55], v[68:71]
    v_mfma_f32_16x16x32_bf16 v[72:75], v[20:23], a[56:59], v[72:75]
    v_mfma_f32_16x16x32_bf16 v[76:79], v[20:23], a[60:63], v[76:79]
    s_cmp_eq_u32 s42, 0
    s_cbranch_scc1 ch0_nog
    s_cmp_ge_u32 s3, 2
    s_cbranch_scc1 ch0_nog
    s_mov_b64 exec, s[30:31]
    buffer_store_dwordx2 v[148:149], v9, s[20:23], s47 offen sc1
    s_mov_b64 exec, -1
    s_cmp_lt_u32 s42, 2
    s_cbranch_scc1 ch0_nog
    s_sub_u32 s73, s42, 2
    s_cmp_lg_u32 s3, 0
    s_cbranch_scc1 mega_kernel_sg24
    s_lshl_b32 s70, s73, 7
    s_add_u32 s70, s70, 167591936
    v_mov_b32 v14, 1
    v_mov_b32 v15, 0
    s_mov_b64 exec, 1
    buffer_atomic_add v14, v15, s[20:23], s70 offen sc1
    s_mov_b64 exec, -1
mega_kernel_sg24:
ch0_nog:
    ds_read_b128 v[20:23], v4 offset:2560
    s_waitcnt lgkmcnt(3)
    v_mfma_f32_16x16x32_bf16 v[48:51], v[24:27], a[64:67], v[48:51]
    v_mfma_f32_16x16x32_bf16 v[52:55], v[24:27], a[68:71], v[52:55]
    v_mfma_f32_16x16x32_bf16 v[56:59], v[24:27], a[72:75], v[56:59]
    v_mfma_f32_16x16x32_bf16 v[60:63], v[24:27], a[76:79], v[60:63]
    v_mfma_f32_16x16x32_bf16 v[64:67], v[24:27], a[80:83], v[64:67]
    v_mfma_f32_16x16x32_bf16 v[68:71], v[24:27], a[84:87], v[68:71]
    v_mfma_f32_16x16x32_bf16 v[72:75], v[24:27], a[88:91], v[72:75]
    v_mfma_f32_16x16x32_bf16 v[76:79], v[24:27], a[92:95], v[76:79]
    s_mov_b32 s51, 1
    s_cmp_ge_u32 s42, 63
    s_cbranch_scc1 ch0_nov
    v_readfirstlane_b32 s71, v145
    s_mov_b32 s51, 0
    s_cmp_ge_u32 s71, 28
    s_cbranch_scc0 ch0_nov
    s_mov_b32 s51, 1
    s_add_u32 s28, s48, 0
    s_mov_b32 m0, s28
    s_add_u32 s45, s43, 0
    buffer_load_dwordx4 v5, s[20:23], s45 offen sc1 lds
    s_add_u32 s28, s48, 1024
    s_mov_b32 m0, s28
    s_add_u32 s45, s43, 1024
    buffer_load_dwordx4 v5, s[20:23], s45 offen sc1 lds
    s_add_u32 s28, s48, 2048
    s_mov_b32 m0, s28
    s_add_u32 s45, s43, 28672
    buffer_load_dwordx4 v5, s[20:23], s45 offen sc1 lds
    s_add_u32 s28, s48, 3072
    s_mov_b32 m0, s28
    s_add_u32 s45, s43, 29696
    buffer_load_dwordx4 v5, s[20:23], s45 offen sc1 lds
    s_add_u32 s28, s48, 4096
    s_mov_b32 m0, s28
    s_add_u32 s45, s43, 57344
    buffer_load_dwordx4 v5, s[20:23], s45 offen sc1 lds
    s_add_u32 s28, s48, 5120
    s_mov_b32 m0, s28
    s_add_u32 s45, s43, 58368
    buffer_load_dwordx4 v5, s[20:23], s45 offen sc1 lds
    s_add_u32 s28, s48, 6144
    s_mov_b32 m0, s28
    s_add_u32 s45, s43, 86016
    buffer_load_dwordx4 v5, s[20:23], s45 offen sc1 lds
    s_add_u32 s28, s48, 7168
    s_mov_b32 m0, s28
    s_add_u32 s45, s43, 87040
    buffer_load_dwordx4 v5, s[20:23], s45 offen sc1 lds
    s_add_u32 s43, s43, 458752
    s_add_u32 s49, s49, 128
ch0_nov:
    buffer_load_dword v145, v15, s[20:23], s49 offen sc1
    ds_read_b128 v[24:27], v4 offset:3072
    s_waitcnt lgkmcnt(3)
    v_mfma_f32_16x16x32_bf16 v[48:51], v[28:31], a[96:99], v[48:51]
    v_mfma_f32_16x16x32_bf16 v[52:55], v[28:31], a[100:103], v[52:55]
    v_mfma_f32_16x16x32_bf16 v[56:59], v[28:31], a[104:107], v[56:59]
    v_mfma_f32_16x16x32_bf16 v[60:63], v[28:31], a[108:111], v[60:63]
    v_mfma_f32_16x16x32_bf16 v[64:67], v[28:31], a[112:115], v[64:67]
    v_mfma_f32_16x16x32_bf16 v[68:71], v[28:31], a[116:119], v[68:71]
    v_mfma_f32_16x16x32_bf16 v[72:75], v[28:31], a[120:123], v[72:75]
    v_mfma_f32_16x16x32_bf16 v[76:79], v[28:31], a[124:127], v[76:79]
    ds_read_b128 v[28:31], v4 offset:3584
    s_waitcnt lgkmcnt(3)
    v_mfma_f32_16x16x32_bf16 v[48:51], v[16:19], a[128:131], v[48:51]
    v_mfma_f32_16x16x32_bf16 v[52:55], v[16:19], a[132:135], v[52:55]
    v_mfma_f32_16x16x32_bf16 v[56:59], v[16:19], a[136:139], v[56:59]
    v_mfma_f32_16x16x32_bf16 v[60:63], v[16:19], a[140:143], v[60:63]
    v_mfma_f32_16x16x32_bf16 v[64:67], v[16:19], a[144:147], v[64:67]
    v_mfma_f32_16x16x32_bf16 v[68:71], v[16:19], a[148:151], v[68:71]
    v_mfma_f32_16x16x32_bf16 v[72:75], v[16:19], a[152:155], v[72:75]
    v_mfma_f32_16x16x32_bf16 v[76:79], v[16:19], a[156:159], v[76:79]
    ds_read_b128 v[16:19], v4 offset:4096
    s_waitcnt lgkmcnt(3)
    v_mfma_f32_16x16x32_bf16 v[48:51], v[20:23], a[160:163], v[48:51]
    v_mfma_f32_16x16x32_bf16 v[52:55], v[20:23], a[164:167], v[52:55]
    v_mfma_f32_16x16x32_bf16 v[56:59], v[20:23], a[168:171], v[56:59]
    v_mfma_f32_16x16x32_bf16 v[60:63], v[20:23], a[172:175], v[60:63]
    v_mfma_f32_16x16x32_bf16 v[64:67], v[20:23], a[176:179], v[64:67]
    v_mfma_f32_16x16x32_bf16 v[68:71], v[20:23], a[180:183], v[68:71]
    v_mfma_f32_16x16x32_bf16 v[72:75], v[20:23], a[184:187], v[72:75]
    v_mfma_f32_16x16x32_bf16 v[76:79], v[20:23], a[188:191], v[76:79]
    ds_read_b128 v[20:23], v4 offset:4608
    s_waitcnt lgkmcnt(3)
    v_mfma_f32_16x16x32_bf16 v[48:51], v[24:27], a[192:195], v[48:51]
    v_mfma_f32_16x16x32_bf16 v[52:55], v[24:27], a[196:199], v[52:55]
    v_mfma_f32_16x16x32_bf16 v[56:59], v[24:27], a[200:203], v[56:59]
    v_mfma_f32_16x16x32_bf16 v[60:63], v[24:27], a[204:207], v[60:63]
    v_mfma_f32_16x16x32_bf16 v[64:67], v[24:27], a[208:211], v[64:67]
    v_mfma_f32_16x16x32_bf16 v[68:71], v[24:27], a[212:215], v[68:71]
    v_mfma_f32_16x16x32_bf16 v[72:75], v[24:27], a[216:219], v[72:75]
    v_mfma_f32_16x16x32_bf16 v[76:79], v[24:27], a[220:223], v[76:79]
    ds_read_b128 v[24:27], v4 offset:5120
    s_waitcnt lgkmcnt(3)
    v_mfma_f32_16x16x32_bf16 v[48:51], v[28:31], a[224:227], v[48:51]
    v_mfma_f32_16x16x32_bf16 v[52:55], v[28:31], a[228:231], v[52:55]
    v_mfma_f32_16x16x32_bf16 v[56:59], v[28:31], a[232:235], v[56:59]
    v_mfma_f32_16x16x32_bf16 v[60:63], v[28:31], a[236:239], v[60:63]
    v_mfma_f32_16x16x32_bf16 v[64:67], v[28:31], a[240:243], v[64:67]
    v_mfma_f32_16x16x32_bf16 v[68:71], v[28:31], a[244:247], v[68:71]
    v_mfma_f32_16x16x32_bf16 v[72:75], v[28:31], a[248:251], v[72:75]
    v_mfma_f32_16x16x32_bf16 v[76:79], v[28:31], a[252:255], v[76:79]
    ds_read_b128 v[28:31], v4 offset:5632
    s_waitcnt lgkmcnt(3)
    v_mfma_f32_16x16x32_bf16 v[48:51], v[16:19], v[152:155], v[48:51]
    v_mfma_f32_16x16x32_bf16 v[52:55], v[16:19], v[156:159], v[52:55]
    v_mfma_f32_16x16x32_bf16 v[56:59], v[16:19], v[160:163], v[56:59]
    v_mfma_f32_16x16x32_bf16 v[60:63], v[16:19], v[164:167], v[60:63]
    v_mfma_f32_16x16x32_bf16 v[64:67], v[16:19], v[168:171], v[64:67]
    v_mfma_f32_16x16x32_bf16 v[68:71], v[16:19], v[172:175], v[68:71]
    v_mfma_f32_16x16x32_bf16 v[72:75], v[16:19], v[176:179], v[72:75]
    v_mfma_f32_16x16x32_bf16 v[76:79], v[16:19], v[180:183], v[76:79]
    ds_read_b128 v[32:35], v13 offset:0
    ds_read_b128 v[36:39], v13 offset:1024
    ds_read_b128 v[40:43], v13 offset:2048
    ds_read_b128 v[44:47], v13 offset:3072
    ds_read_b128 v[112:115], v13 offset:4096
    ds_read_b128 v[116:119], v13 offset:5120
    ds_read_b128 v[120:123], v13 offset:6144
    ds_read_b128 v[124:127], v13 offset:7168
    ds_read_b128 v[128:131], v13 offset:8192
    ds_read_b128 v[132:135], v13 offset:9216
    ds_read_b128 v[16:19], v4 offset:6144
    s_waitcnt lgkmcnt(13)
    v_mfma_f32_16x16x32_bf16 v[48:51], v[20:23], v[184:187], v[48:51]
    v_mfma_f32_16x16x32_bf16 v[52:55], v[20:23], v[188:191], v[52:55]
    v_mfma_f32_16x16x32_bf16 v[56:59], v[20:23], v[192:195], v[56:59]
    v_mfma_f32_16x16x32_bf16 v[60:63], v[20:23], v[196:199], v[60:63]
    v_mfma_f32_16x16x32_bf16 v[64:67], v[20:23], v[200:203], v[64:67]
    v_mfma_f32_16x16x32_bf16 v[68:71], v[20:23], v[204:207], v[68:71]
    v_mfma_f32_16x16x32_bf16 v[72:75], v[20:23], v[208:211], v[72:75]
    v_mfma_f32_16x16x32_bf16 v[76:79], v[20:23], v[212:215], v[76:79]
    ds_read_b128 v[20:23], v4 offset:6656
    s_waitcnt lgkmcnt(13)
    v_mfma_f32_16x16x32_bf16 v[48:51], v[24:27], v[216:219], v[48:51]
    v_mfma_f32_16x16x32_bf16 v[52:55], v[24:27], v[220:223], v[52:55]
    v_mfma_f32_16x16x32_bf16 v[56:59], v[24:27], v[224:227], v[56:59]
    v_mfma_f32_16x16x32_bf16 v[60:63], v[24:27], v[228:231], v[60:63]
    v_mfma_f32_16x16x32_bf16 v[64:67], v[24:27], v[232:235], v[64:67]
    v_mfma_f32_16x16x32_bf16 v[68:71], v[24:27], v[236:239], v[68:71]
    v_mfma_f32_16x16x32_bf16 v[72:75], v[24:27], v[240:243], v[72:75]
    v_mfma_f32_16x16x32_bf16 v[76:79], v[24:27], v[244:247], v[76:79]
    s_waitcnt lgkmcnt(0)
    v_mfma_f32_16x16x32_bf16 v[48:51], v[28:31], v[248:251], v[48:51]
    v_mfma_f32_16x16x32_bf16 v[52:55], v[28:31], v[252:255], v[52:55]
    v_mfma_f32_16x16x32_bf16 v[56:59], v[28:31], v[32:35], v[56:59]
    ds_read_b128 v[32:35], v13 offset:10240
    v_mfma_f32_16x16x32_bf16 v[60:63], v[28:31], v[36:39], v[60:63]
    ds_read_b128 v[36:39], v13 offset:11264
    v_mfma_f32_16x16x32_bf16 v[64:67], v[28:31], v[40:43], v[64:67]
    ds_read_b128 v[40:43], v13 offset:12288
    v_mfma_f32_16x16x32_bf16 v[68:71], v[28:31], v[44:47], v[68:71]
    ds_read_b128 v[44:47], v13 offset:13312
    v_mfma_f32_16x16x32_bf16 v[72:75], v[28:31], v[112:115], v[72:75]
    ds_read_b128 v[112:115], v13 offset:14336
    v_mfma_f32_16x16x32_bf16 v[76:79], v[28:31], v[116:119], v[76:79]
    ds_read_b128 v[116:119], v13 offset:15360
    v_mfma_f32_16x16x32_bf16 v[48:51], v[16:19], v[120:123], v[48:51]
    ds_read_b128 v[120:123], v13 offset:16384
    v_mfma_f32_16x16x32_bf16 v[52:55], v[16:19], v[124:127], v[52:55]
    ds_read_b128 v[124:127], v13 offset:17408
    v_mfma_f32_16x16x32_bf16 v[56:59], v[16:19], v[128:131], v[56:59]
    ds_read_b128 v[128:131], v13 offset:18432
    v_mfma_f32_16x16x32_bf16 v[60:63], v[16:19], v[132:135], v[60:63]
    ds_read_b128 v[132:135], v13 offset:19456
    s_waitcnt lgkmcnt(9)
    v_mfma_f32_16x16x32_bf16 v[64:67], v[16:19], v[32:35], v[64:67]
    ds_read_b128 v[32:35], v13 offset:20480
    s_waitcnt lgkmcnt(9)
    v_mfma_f32_16x16x32_bf16 v[68:71], v[16:19], v[36:39], v[68:71]
    ds_read_b128 v[36:39], v13 offset:21504
    s_waitcnt lgkmcnt(9)
    v_mfma_f32_16x16x32_bf16 v[72:75], v[16:19], v[40:43], v[72:75]
    s_waitcnt lgkmcnt(8)
    v_mfma_f32_16x16x32_bf16 v[76:79], v[16:19], v[44:47], v[76:79]
    s_waitcnt lgkmcnt(7)
    v_mfma_f32_16x16x32_bf16 v[48:51], v[20:23], v[112:115], v[48:51]
    s_waitcnt lgkmcnt(6)
    v_mfma_f32_16x16x32_bf16 v[52:55], v[20:23], v[116:119], v[52:55]
    s_waitcnt lgkmcnt(5)
    v_mfma_f32_16x16x32_bf16 v[56:59], v[20:23], v[120:123], v[56:59]
    s_waitcnt lgkmcnt(4)
    v_mfma_f32_16x16x32_bf16 v[60:63], v[20:23], v[124:127], v[60:63]
    s_waitcnt lgkmcnt(3)
    v_mfma_f32_16x16x32_bf16 v[64:67], v[20:23], v[128:131], v[64:67]
    s_waitcnt lgkmcnt(2)
    v_mfma_f32_16x16x32_bf16 v[68:71], v[20:23], v[132:135], v[68:71]
    s_waitcnt lgkmcnt(1)
    v_mfma_f32_16x16x32_bf16 v[72:75], v[20:23], v[32:35], v[72:75]
    s_waitcnt lgkmcnt(0)
    v_mfma_f32_16x16x32_bf16 v[76:79], v[20:23], v[36:39], v[76:79]
    s_nop 7
    v_cvt_pk_bf16_f32 v48, v48, v49
    v_cvt_pk_bf16_f32 v49, v50, v51
    v_cvt_pk_bf16_f32 v50, v52, v53
    v_cvt_pk_bf16_f32 v51, v54, v55
    v_cvt_pk_bf16_f32 v52, v56, v57
    v_cvt_pk_bf16_f32 v53, v58, v59
    v_cvt_pk_bf16_f32 v54, v60, v61
    v_cvt_pk_bf16_f32 v55, v62, v63
    v_cvt_pk_bf16_f32 v56, v64, v65
    v_cvt_pk_bf16_f32 v57, v66, v67
    v_cvt_pk_bf16_f32 v58, v68, v69
    v_cvt_pk_bf16_f32 v59, v70, v71
    v_cvt_pk_bf16_f32 v60, v72, v73
    v_cvt_pk_bf16_f32 v61, v74, v75
    v_cvt_pk_bf16_f32 v62, v76, v77
    v_cvt_pk_bf16_f32 v63, v78, v79
    ds_write_b64 v146, v[48:49] offset:0
    ds_write_b64 v146, v[50:51] offset:512
    ds_write_b64 v146, v[52:53] offset:1024
    ds_write_b64 v146, v[54:55] offset:1536
    ds_write_b64 v146, v[56:57] offset:2048
    ds_write_b64 v146, v[58:59] offset:2560
    ds_write_b64 v146, v[60:61] offset:3072
    ds_write_b64 v146, v[62:63] offset:3584
ch0_ppoll:
    buffer_load_dwordx4 v[112:115], v7, s[20:23], s41 offen offset:0 sc1
    buffer_load_dwordx2 v[116:117], v8, s[20:23], s41 offen offset:0 sc1
    buffer_load_dwordx4 v[118:121], v7, s[20:23], s41 offen offset:1024 sc1
    buffer_load_dwordx2 v[122:123], v8, s[20:23], s41 offen offset:1024 sc1
    buffer_load_dwordx4 v[124:127], v7, s[20:23], s41 offen offset:2048 sc1
    buffer_load_dwordx2 v[128:129], v8, s[20:23], s41 offen offset:2048 sc1
    buffer_load_dwordx4 v[130:133], v7, s[20:23], s41 offen offset:3072 sc1
    buffer_load_dwordx2 v[134:135], v8, s[20:23], s41 offen offset:3072 sc1
    s_waitcnt vmcnt(0)
    v_max3_u32 v14, v112, v113, v114
    v_max3_u32 v14, v14, v115, v116
    v_max3_u32 v14, v14, v117, v118
    v_max3_u32 v14, v14, v119, v120
    v_max3_u32 v14, v14, v121, v122
    v_max3_u32 v14, v14, v123, v124
    v_max3_u32 v14, v14, v125, v126
    v_max3_u32 v14, v14, v127, v128
    v_max3_u32 v14, v14, v129, v130
    v_max3_u32 v14, v14, v131, v132
    v_max3_u32 v14, v14, v133, v134
    v_max_u32 v14, v14, v135
    v_cmp_eq_u32 vcc, -1, v14
    s_cbranch_vccnz ch0_ppoll
    v_mfma_f32_16x16x32_bf16 v[64:67], v[80:83], v[112:115], 0
    v_mfma_f32_16x16x16_bf16 v[68:71], v[48:49], v[116:117], 0
    v_mfma_f32_16x16x32_bf16 v[72:75], v[84:87], v[112:115], 0
    v_mfma_f32_16x16x16_bf16 v[76:79], v[50:51], v[116:117], 0
    v_mfma_f32_16x16x32_bf16 v[64:67], v[88:91], v[118:121], v[64:67]
    v_mfma_f32_16x16x16_bf16 v[68:71], v[52:53], v[122:123], v[68:71]
    v_mfma_f32_16x16x32_bf16 v[72:75], v[92:95], v[118:121], v[72:75]
    v_mfma_f32_16x16x16_bf16 v[76:79], v[54:55], v[122:123], v[76:79]
    v_mfma_f32_16x16x32_bf16 v[64:67], v[96:99], v[124:127], v[64:67]
    v_mfma_f32_16x16x16_bf16 v[68:71], v[56:57], v[128:129], v[68:71]
    v_mfma_f32_16x16x32_bf16 v[72:75], v[100:103], v[124:127], v[72:75]
    v_mfma_f32_16x16x16_bf16 v[76:79], v[58:59], v[128:129], v[76:79]
    v_mfma_f32_16x16x32_bf16 v[64:67], v[104:107], v[130:133], v[64:67]
    v_mfma_f32_16x16x16_bf16 v[68:71], v[60:61], v[134:135], v[68:71]
    v_mfma_f32_16x16x32_bf16 v[72:75], v[108:111], v[130:133], v[72:75]
    v_mfma_f32_16x16x16_bf16 v[76:79], v[62:63], v[134:135], v[76:79]
    s_nop 7
    s_nop 1
    v_add_f32 v64, v64, v68
    v_add_f32 v65, v65, v69
    v_add_f32 v66, v66, v70
    v_add_f32 v67, v67, v71
    v_add_f32 v72, v72, v76
    v_add_f32 v73, v73, v77
    v_add_f32 v74, v74, v78
    v_add_f32 v75, v75, v79
    ds_write_b128 v12, v[64:67]
    ds_write_b128 v12, v[72:75] offset:1024
    s_waitcnt lgkmcnt(0)
    s_barrier
    s_cmp_ge_u32 s3, 2
    s_cbranch_scc1 ch0_unext
    s_lshl_b32 s45, s3, 10
    v_add_u32 v14, s45, v11
    ds_read_b128 v[16:19], v14
    ds_read_b128 v[20:23], v14 offset:2048
    ds_read_b128 v[24:27], v14 offset:4096
    ds_read_b128 v[28:31], v14 offset:6144
    s_lshl_b32 s45, s3, 8
    s_add_u32 s46, s75, s45
    s_add_u32 s47, s76, s45
    s_waitcnt lgkmcnt(0)
    v_add_f32 v16, v16, v20
    v_add_f32 v24, v24, v28
    v_add_f32 v17, v17, v21
    v_add_f32 v25, v25, v29
    v_add_f32 v18, v18, v22
    v_add_f32 v26, v26, v30
    v_add_f32 v19, v19, v23
    v_add_f32 v27, v27, v31
    v_add_f32 v16, v16, v24
    v_add_f32 v17, v17, v25
    v_add_f32 v18, v18, v26
    v_add_f32 v19, v19, v27
    v_cvt_pk_bf16_f32 v16, v16, v17
    v_cvt_pk_bf16_f32 v17, v18, v19
    s_mov_b64 exec, s[30:31]
    buffer_store_dwordx2 v[16:17], v9, s[20:23], s46 offen
    s_mov_b64 exec, -1
    v_mov_b32 v148, v16
    v_mov_b32 v149, v17
ch0_unext:
    s_cmp_eq_u32 s51, 1
    s_cbranch_scc1 ch0_vok
mega_kernel_vw25:
    buffer_load_dword v145, v15, s[20:23], s49 offen sc1
    s_waitcnt vmcnt(0)
    v_readfirstlane_b32 s71, v145
    s_cmp_ge_u32 s71, 28
    s_cbranch_scc0 mega_kernel_vw25
    s_add_u32 s28, s48, 0
    s_mov_b32 m0, s28
    s_add_u32 s45, s43, 0
    buffer_load_dwordx4 v5, s[20:23], s45 offen sc1 lds
    s_add_u32 s28, s48, 1024
    s_mov_b32 m0, s28
    s_add_u32 s45, s43, 1024
    buffer_load_dwordx4 v5, s[20:23], s45 offen sc1 lds
    s_add_u32 s28, s48, 2048
    s_mov_b32 m0, s28
    s_add_u32 s45, s43, 28672
    buffer_load_dwordx4 v5, s[20:23], s45 offen sc1 lds
    s_add_u32 s28, s48, 3072
    s_mov_b32 m0, s28
    s_add_u32 s45, s43, 29696
    buffer_load_dwordx4 v5, s[20:23], s45 offen sc1 lds
    s_add_u32 s28, s48, 4096
    s_mov_b32 m0, s28
    s_add_u32 s45, s43, 57344
    buffer_load_dwordx4 v5, s[20:23], s45 offen sc1 lds
    s_add_u32 s28, s48, 5120
    s_mov_b32 m0, s28
    s_add_u32 s45, s43, 58368
    buffer_load_dwordx4 v5, s[20:23], s45 offen sc1 lds
    s_add_u32 s28, s48, 6144
    s_mov_b32 m0, s28
    s_add_u32 s45, s43, 86016
    buffer_load_dwordx4 v5, s[20:23], s45 offen sc1 lds
    s_add_u32 s28, s48, 7168
    s_mov_b32 m0, s28
    s_add_u32 s45, s43, 87040
    buffer_load_dwordx4 v5, s[20:23], s45 offen sc1 lds
    s_add_u32 s43, s43, 458752
    s_add_u32 s49, s49, 128
    buffer_load_dword v145, v15, s[20:23], s49 offen sc1
    s_waitcnt vmcnt(0)
ch0_vok:
    s_barrier
    s_add_u32 s40, s40, 7168
    s_add_u32 s75, s75, 7168
    s_add_u32 s76, s76, 7168
    s_add_u32 s41, s41, 16384
    s_add_u32 s42, s42, 1
    s_cmp_lt_u32 s42, 64
    s_cbranch_scc1 ch0_uloop
    s_mov_b32 s73, 62
    s_cmp_lg_u32 s3, 0
    s_cbranch_scc1 mega_kernel_sg26
    s_lshl_b32 s70, s73, 7
    s_add_u32 s70, s70, 167591936
    v_mov_b32 v14, 1
    v_mov_b32 v15, 0
    s_mov_b64 exec, 1
    buffer_atomic_add v14, v15, s[20:23], s70 offen sc1
    s_mov_b64 exec, -1
mega_kernel_sg26:
    ds_read_b64 v[112:113], v146 offset:0
    ds_read_b64 v[114:115], v146 offset:512
    ds_read_b64 v[116:117], v146 offset:1024
    ds_read_b64 v[118:119], v146 offset:1536
    ds_read_b64 v[120:121], v146 offset:2048
    ds_read_b64 v[122:123], v146 offset:2560
    ds_read_b64 v[124:125], v146 offset:3072
    ds_read_b64 v[126:127], v146 offset:3584
    s_waitcnt lgkmcnt(0)
    v_permlane16_swap_b32 v112, v114
    v_permlane16_swap_b32 v113, v115
    v_permlane16_swap_b32 v116, v118
    v_permlane16_swap_b32 v117, v119
    v_permlane16_swap_b32 v120, v122
    v_permlane16_swap_b32 v121, v123
    v_permlane16_swap_b32 v124, v126
    v_permlane16_swap_b32 v125, v127
    s_mov_b64 exec, s[32:33]
    s_mov_b32 s45, s44
    buffer_store_dwordx4 v[112:115], v10, s[20:23], s45 offen sc1
    s_add_u32 s45, s45, 7168
    buffer_store_dwordx4 v[116:119], v10, s[20:23], s45 offen sc1
    s_add_u32 s45, s45, 7168
    buffer_store_dwordx4 v[120:123], v10, s[20:23], s45 offen sc1
    s_add_u32 s45, s45, 7168
    buffer_store_dwordx4 v[124:127], v10, s[20:23], s45 offen sc1
    s_mov_b64 exec, -1
    s_add_u32 s44, s44, 114688
    s_mov_b32 s73, 63
    s_waitcnt vmcnt(0)
    s_barrier
    s_cmp_lg_u32 s3, 0
    s_cbranch_scc1 mega_kernel_sg27
    s_lshl_b32 s70, s73, 7
    s_add_u32 s70, s70, 167591936
    v_mov_b32 v14, 1
    v_mov_b32 v15, 0
    s_mov_b64 exec, 1
    buffer_atomic_add v14, v15, s[20:23], s70 offen sc1
    s_mov_b64 exec, -1
mega_kernel_sg27:
    s_endpgm
ch1_start:
    s_mov_b32 s50, 0x3fb8aa3b
    s_cmp_ge_u32 s2, 16
    s_cbranch_scc1 ch1_ucu
    v_mul_u32_u24 v5, 896, v2
    v_lshl_add_u32 v5, v3, 4, v5
    s_mul_i32 s24, s2, 448
    s_mul_i32 s25, s3, 112
    s_add_u32 s24, s24, s25
    s_mul_i32 s24, s24, 896
    s_add_u32 s24, s24, 5275648
    v_lshlrev_b32 v12, 4, v1
    v_add_u32 v13, 4096, v12
    v_add_u32 v14, 8192, v12
    v_add_u32 v15, 12288, v12
    buffer_load_dwordx4 a[0:3], v12, s[20:23], s24 offen offset:0
    buffer_load_dwordx4 a[4:7], v12, s[20:23], s24 offen offset:1024
    buffer_load_dwordx4 a[8:11], v12, s[20:23], s24 offen offset:2048
    buffer_load_dwordx4 a[12:15], v12, s[20:23], s24 offen offset:3072
    buffer_load_dwordx4 a[16:19], v13, s[20:23], s24 offen offset:0
    buffer_load_dwordx4 a[20:23], v13, s[20:23], s24 offen offset:1024
    buffer_load_dwordx4 a[24:27], v13, s[20:23], s24 offen offset:2048
    buffer_load_dwordx4 a[28:31], v13, s[20:23], s24 offen offset:3072
    buffer_load_dwordx4 a[32:35], v14, s[20:23], s24 offen offset:0
    buffer_load_dwordx4 a[36:39], v14, s[20:23], s24 offen offset:1024
    buffer_load_dwordx4 a[40:43], v14, s[20:23], s24 offen offset:2048
    buffer_load_dwordx4 a[44:47], v14, s[20:23], s24 offen offset:3072
    buffer_load_dwordx4 a[48:51], v15, s[20:23], s24 offen offset:0
    buffer_load_dwordx4 a[52:55], v15, s[20:23], s24 offen offset:1024
    s_add_u32 s24, s24, 14336
    buffer_load_dwordx4 a[56:59], v12, s[20:23], s24 offen offset:0
    buffer_load_dwordx4 a[60:63], v12, s[20:23], s24 offen offset:1024
    buffer_load_dwordx4 a[64:67], v12, s[20:23], s24 offen offset:2048
    buffer_load_dwordx4 a[68:71], v12, s[20:23], s24 offen offset:3072
    buffer_load_dwordx4 a[72:75], v13, s[20:23], s24 offen offset:0
    buffer_load_dwordx4 a[76:79], v13, s[20:23], s24 offen offset:1024
    buffer_load_dwordx4 a[80:83], v13, s[20:23], s24 offen offset:2048
    buffer_load_dwordx4 a[84:87], v13, s[20:23], s24 offen offset:3072
    buffer_load_dwordx4 a[88:91], v14, s[20:23], s24 offen offset:0
    buffer_load_dwordx4 a[92:95], v14, s[20:23], s24 offen offset:1024
    buffer_load_dwordx4 a[96:99], v14, s[20:23], s24 offen offset:2048
    buffer_load_dwordx4 a[100:103], v14, s[20:23], s24 offen offset:3072
    buffer_load_dwordx4 a[104:107], v15, s[20:23], s24 offen offset:0
    buffer_load_dwordx4 a[108:111], v15, s[20:23], s24 offen offset:1024
    s_add_u32 s24, s24, 14336
    buffer_load_dwordx4 a[112:115], v12, s[20:23], s24 offen offset:0
    buffer_load_dwordx4 a[116:119], v12, s[20:23], s24 offen offset:1024
    buffer_load_dwordx4 a[120:123], v12, s[20:23], s24 offen offset:2048
    buffer_load_dwordx4 a[124:127], v12, s[20:23], s24 offen offset:3072
    buffer_load_dwordx4 a[128:131], v13, s[20:23], s24 offen offset:0
    buffer_load_dwordx4 a[132:135], v13, s[20:23], s24 offen offset:1024
    buffer_load_dwordx4 a[136:139], v13, s[20:23], s24 offen offset:2048
    buffer_load_dwordx4 a[140:143], v13, s[20:23], s24 offen offset:3072
    buffer_load_dwordx4 a[144:147], v14, s[20:23], s24 offen offset:0
    buffer_load_dwordx4 a[148:151], v14, s[20:23], s24 offen offset:1024
    buffer_load_dwordx4 a[152:155], v14, s[20:23], s24 offen offset:2048
    buffer_load_dwordx4 a[156:159], v14, s[20:23], s24 offen offset:3072
    buffer_load_dwordx4 a[160:163], v15, s[20:23], s24 offen offset:0
    buffer_load_dwordx4 a[164:167], v15, s[20:23], s24 offen offset:1024
    s_add_u32 s24, s24, 14336
    buffer_load_dwordx4 a[168:171], v12, s[20:23], s24 offen offset:0
    buffer_load_dwordx4 a[172:175], v12, s[20:23], s24 offen offset:1024
    buffer_load_dwordx4 a[176:179], v12, s[20:23], s24 offen offset:2048
    buffer_load_dwordx4 a[180:183], v12, s[20:23], s24 offen offset:3072
    buffer_load_dwordx4 a[184:187], v13, s[20:23], s24 offen offset:0
    buffer_load_dwordx4 a[188:191], v13, s[20:23], s24 offen offset:1024
    buffer_load_dwordx4 a[192:195], v13, s[20:23], s24 offen offset:2048
    buffer_load_dwordx4 a[196:199], v13, s[20:23], s24 offen offset:3072
    buffer_load_dwordx4 a[200:203], v14, s[20:23], s24 offen offset:0
    buffer_load_dwordx4 a[204:207], v14, s[20:23], s24 offen offset:1024
    buffer_load_dwordx4 a[208:211], v14, s[20:23], s24 offen offset:2048
    buffer_load_dwordx4 a[212:215], v14, s[20:23], s24 offen offset:3072
    buffer_load_dwordx4 a[216:219], v15, s[20:23], s24 offen offset:0
    buffer_load_dwordx4 a[220:223], v15, s[20:23], s24 offen offset:1024
    s_add_u32 s24, s24, 14336
    buffer_load_dwordx4 a[224:227], v12, s[20:23], s24 offen offset:0
    buffer_load_dwordx4 a[228:231], v12, s[20:23], s24 offen offset:1024
    buffer_load_dwordx4 a[232:235], v12, s[20:23], s24 offen offset:2048
    buffer_load_dwordx4 a[236:239], v12, s[20:23], s24 offen offset:3072
    buffer_load_dwordx4 a[240:243], v13, s[20:23], s24 offen offset:0
    buffer_load_dwordx4 a[244:247], v13, s[20:23], s24 offen offset:1024
    buffer_load_dwordx4 a[248:251], v13, s[20:23], s24 offen offset:2048
    buffer_load_dwordx4 a[252:255], v13, s[20:23], s24 offen offset:3072
    buffer_load_dwordx4 v[110:113], v14, s[20:23], s24 offen offset:0
    buffer_load_dwordx4 v[114:117], v14, s[20:23], s24 offen offset:1024
    buffer_load_dwordx4 v[118:121], v14, s[20:23], s24 offen offset:2048
    buffer_load_dwordx4 v[122:125], v14, s[20:23], s24 offen offset:3072
    buffer_load_dwordx4 v[126:129], v15, s[20:23], s24 offen offset:0
    buffer_load_dwordx4 v[130:133], v15, s[20:23], s24 offen offset:1024
    s_add_u32 s24, s24, 14336
    buffer_load_dwordx4 v[134:137], v12, s[20:23], s24 offen offset:0
    buffer_load_dwordx4 v[138:141], v12, s[20:23], s24 offen offset:1024
    buffer_load_dwordx4 v[142:145], v12, s[20:23], s24 offen offset:2048
    buffer_load_dwordx4 v[146:149], v12, s[20:23], s24 offen offset:3072
    buffer_load_dwordx4 v[150:153], v13, s[20:23], s24 offen offset:0
    buffer_load_dwordx4 v[154:157], v13, s[20:23], s24 offen offset:1024
    buffer_load_dwordx4 v[158:161], v13, s[20:23], s24 offen offset:2048
    buffer_load_dwordx4 v[162:165], v13, s[20:23], s24 offen offset:3072
    buffer_load_dwordx4 v[166:169], v14, s[20:23], s24 offen offset:0
    buffer_load_dwordx4 v[170:173], v14, s[20:23], s24 offen offset:1024
    buffer_load_dwordx4 v[174:177], v14, s[20:23], s24 offen offset:2048
    buffer_load_dwordx4 v[178:181], v14, s[20:23], s24 offen offset:3072
    buffer_load_dwordx4 v[182:185], v15, s[20:23], s24 offen offset:0
    buffer_load_dwordx4 v[186:189], v15, s[20:23], s24 offen offset:1024
    s_add_u32 s24, s24, 14336
    buffer_load_dwordx4 v[190:193], v12, s[20:23], s24 offen offset:0
    buffer_load_dwordx4 v[194:197], v12, s[20:23], s24 offen offset:1024
    buffer_load_dwordx4 v[198:201], v12, s[20:23], s24 offen offset:2048
    buffer_load_dwordx4 v[202:205], v12, s[20:23], s24 offen offset:3072
    buffer_load_dwordx4 v[206:209], v13, s[20:23], s24 offen offset:0
    buffer_load_dwordx4 v[210:213], v13, s[20:23], s24 offen offset:1024
    buffer_load_dwordx4 v[214:217], v13, s[20:23], s24 offen offset:2048
    buffer_load_dwordx4 v[218:221], v13, s[20:23], s24 offen offset:3072
    buffer_load_dwordx4 v[222:225], v14, s[20:23], s24 offen offset:0
    buffer_load_dwordx4 v[226:229], v14, s[20:23], s24 offen offset:1024
    buffer_load_dwordx4 v[230:233], v14, s[20:23], s24 offen offset:2048
    buffer_load_dwordx4 v[234:237], v14, s[20:23], s24 offen offset:3072
    buffer_load_dwordx4 v[238:241], v15, s[20:23], s24 offen offset:0
    buffer_load_dwordx4 v[242:245], v15, s[20:23], s24 offen offset:1024
    s_mul_i32 s25, s3, 1792
    v_lshlrev_b32 v6, 4, v1
    v_add_u32 v6, s25, v6
    v_add_u32 v251, 70656, v6
    v_lshrrev_b32 v7, 1, v3
    v_lshlrev_b32 v7, 8, v7
    v_lshl_add_u32 v7, v4, 5, v7
    v_and_b32 v252, 1, v3
    v_lshl_add_u32 v7, v252, 4, v7
    v_add_u32 v7, 70656, v7
    v_lshlrev_b32 v252, 5, v4
    v_lshl_add_u32 v252, v3, 3, v252
    v_add_u32 v252, s25, v252
    v_add_u32 v252, 70656, v252
    s_mov_b32 s36, -1
    s_mov_b32 s37, 0x0000ffff
    s_mul_i32 s25, s3, 224
    v_mul_u32_u24 v8, 912, v2
    v_lshl_add_u32 v8, v3, 3, v8
    v_add_u32 v8, s25, v8
    v_add_u32 v9, 14592, v8
    v_lshlrev_b32 v10, 4, v1
    s_mul_i32 s26, s3, 3072
    s_add_u32 s26, s26, 58368
    v_add_u32 v11, s26, v10
    v_lshl_add_u32 v246, v3, 3, v4
    v_lshlrev_b32 v247, 3, v246
    v_add_u32 v247, 512, v247
    v_lshlrev_b32 v246, 4, v246
    v_cmp_gt_u32 s[30:31], 8, v2
    v_cmp_gt_u32 s[32:33], 2, v3
    s_mov_b32 s34, -1
    s_mov_b32 s35, 0x00ffffff
    s_and_b32 s40, s2, 0
    s_mul_i32 s40, s40, 7168
    s_add_u32 s40, s40, 174431232
    s_lshl_b32 s41, s2, 10
    s_add_u32 s41, s41, 176877568
    s_mov_b32 s42, 0
    s_mul_i32 s43, s3, 7168
    s_add_u32 s43, s43, 33587200
    s_mul_i32 s44, s3, 7296
    v_mov_b32 v253, 0
    s_mov_b32 s47, 0
    s_cmp_lg_u32 s3, 0
    s_cbranch_scc1 mega_kernel_wd29
    s_lshl_b32 s70, s42, 7
    s_add_u32 s70, s70, 167567360
mega_kernel_wc28:
    buffer_load_dword v254, v253, s[20:23], s70 offen sc1
    s_waitcnt vmcnt(0)
    v_readfirstlane_b32 s71, v254
    s_cmp_ge_u32 s71, 2
    s_cbranch_scc1 mega_kernel_wd29
    s_sleep 6
    s_branch mega_kernel_wc28
mega_kernel_wd29:
    s_barrier
    s_mov_b64 exec, s[34:35]
    s_add_u32 s45, s44, s47
    s_mov_b32 s46, s43
    s_mov_b32 m0, s45
    s_nop 0
    buffer_load_dwordx4 v10, s[20:23], s46 offen sc1 lds
    s_add_u32 s45, s45, 912
    s_add_u32 s46, s46, 896
    s_mov_b32 m0, s45
    s_nop 0
    buffer_load_dwordx4 v10, s[20:23], s46 offen sc1 lds
    s_add_u32 s45, s45, 912
    s_add_u32 s46, s46, 896
    s_mov_b32 m0, s45
    s_nop 0
    buffer_load_dwordx4 v10, s[20:23], s46 offen sc1 lds
    s_add_u32 s45, s45, 912
    s_add_u32 s46, s46, 896
    s_mov_b32 m0, s45
    s_nop 0
    buffer_load_dwordx4 v10, s[20:23], s46 offen sc1 lds
    s_add_u32 s45, s45, 912
    s_add_u32 s46, s46, 896
    s_mov_b32 m0, s45
    s_nop 0
    buffer_load_dwordx4 v10, s[20:23], s46 offen sc1 lds
    s_add_u32 s45, s45, 912
    s_add_u32 s46, s46, 896
    s_mov_b32 m0, s45
    s_nop 0
    buffer_load_dwordx4 v10, s[20:23], s46 offen sc1 lds
    s_add_u32 s45, s45, 912
    s_add_u32 s46, s46, 896
    s_mov_b32 m0, s45
    s_nop 0
    buffer_load_dwordx4 v10, s[20:23], s46 offen sc1 lds
    s_add_u32 s45, s45, 912
    s_add_u32 s46, s46, 896
    s_mov_b32 m0, s45
    s_nop 0
    buffer_load_dwordx4 v10, s[20:23], s46 offen sc1 lds
    s_mov_b64 exec, -1
    s_add_u32 s43, s43, 28672
    s_waitcnt vmcnt(0)
    s_barrier
ch1_sloop:
    s_xor_b32 s48, s47, 29184
    s_cmp_ge_u32 s42, 63
    s_cbranch_scc1 ch1_snodma
    s_add_u32 s72, s42, 1
    s_cmp_lg_u32 s3, 0
    s_cbranch_scc1 mega_kernel_wd31
    s_lshl_b32 s70, s72, 7
    s_add_u32 s70, s70, 167567360
mega_kernel_wc30:
    buffer_load_dword v254, v253, s[20:23], s70 offen sc1
    s_waitcnt vmcnt(0)
    v_readfirstlane_b32 s71, v254
    s_cmp_ge_u32 s71, 2
    s_cbranch_scc1 mega_kernel_wd31
    s_sleep 6
    s_branch mega_kernel_wc30
mega_kernel_wd31:
    s_barrier
    s_mov_b64 exec, s[34:35]
    s_add_u32 s45, s44, s48
    s_mov_b32 s46, s43
    s_mov_b32 m0, s45
    s_nop 0
    buffer_load_dwordx4 v10, s[20:23], s46 offen sc1 lds
    s_add_u32 s45, s45, 912
    s_add_u32 s46, s46, 896
    s_mov_b32 m0, s45
    s_nop 0
    buffer_load_dwordx4 v10, s[20:23], s46 offen sc1 lds
    s_add_u32 s45, s45, 912
    s_add_u32 s46, s46, 896
    s_mov_b32 m0, s45
    s_nop 0
    buffer_load_dwordx4 v10, s[20:23], s46 offen sc1 lds
    s_add_u32 s45, s45, 912
    s_add_u32 s46, s46, 896
    s_mov_b32 m0, s45
    s_nop 0
    buffer_load_dwordx4 v10, s[20:23], s46 offen sc1 lds
    s_add_u32 s45, s45, 912
    s_add_u32 s46, s46, 896
    s_mov_b32 m0, s45
    s_nop 0
    buffer_load_dwordx4 v10, s[20:23], s46 offen sc1 lds
    s_add_u32 s45, s45, 912
    s_add_u32 s46, s46, 896
    s_mov_b32 m0, s45
    s_nop 0
    buffer_load_dwordx4 v10, s[20:23], s46 offen sc1 lds
    s_add_u32 s45, s45, 912
    s_add_u32 s46, s46, 896
    s_mov_b32 m0, s45
    s_nop 0
    buffer_load_dwordx4 v10, s[20:23], s46 offen sc1 lds
    s_add_u32 s45, s45, 912
    s_add_u32 s46, s46, 896
    s_mov_b32 m0, s45
    s_nop 0
    buffer_load_dwordx4 v10, s[20:23], s46 offen sc1 lds
    s_mov_b64 exec, -1
    s_add_u32 s43, s43, 28672
ch1_snodma:
    v_add_u32 v249, s47, v8
    v_add_u32 v250, s47, v9
    ds_read2_b64 v[56:59], v249 offset0:0 offset1:4
    ds_read2_b64 v[60:63], v249 offset0:8 offset1:12
    ds_read2_b64 v[64:67], v249 offset0:16 offset1:20
    ds_read_b64 v[68:69], v249 offset:192
    ds_read2_b64 v[70:73], v250 offset0:0 offset1:4
    ds_read2_b64 v[74:77], v250 offset0:8 offset1:12
    ds_read2_b64 v[78:81], v250 offset0:16 offset1:20
    ds_read_b64 v[82:83], v250 offset:192
    v_mov_b32 v88, 0
    v_mov_b32 v89, 0
    v_mov_b32 v90, 0
    v_mov_b32 v91, 0
    buffer_load_dwordx4 v[84:87], v6, s[20:23], s40 offen sc1
    s_mov_b64 exec, s[36:37]
    buffer_load_dwordx4 v[88:91], v6, s[20:23], s40 offen offset:1024 sc1
    s_mov_b64 exec, -1
    s_sleep 1
ch1_spoll:
    s_waitcnt vmcnt(0)
    v_max3_u32 v248, v84, v86, v88
    v_max_u32 v248, v248, v90
    v_cmp_eq_u32 vcc, -1, v248
    s_cbranch_vccz ch1_sg0
    buffer_load_dwordx4 v[84:87], v6, s[20:23], s40 offen sc1
    s_mov_b64 exec, s[36:37]
    buffer_load_dwordx4 v[88:91], v6, s[20:23], s40 offen offset:1024 sc1
    s_mov_b64 exec, -1
    s_branch ch1_spoll
ch1_sg0:
    ds_write_b128 v251, v[84:87]
    s_mov_b64 exec, s[36:37]
    ds_write_b128 v251, v[88:91] offset:1024
    s_mov_b64 exec, -1
ch1_sgot:
    s_waitcnt lgkmcnt(0)
    s_barrier
    ds_read_b128 v[40:43], v7 offset:0
    ds_read_b128 v[44:47], v7 offset:512
    ds_read_b128 v[48:51], v7 offset:1024
    ds_read_b128 v[52:55], v7 offset:1536
    s_waitcnt lgkmcnt(3)
    v_mfma_f32_16x16x32_bf16 v[12:15], a[0:3], v[40:43], 0
    v_mfma_f32_16x16x32_bf16 v[16:19], a[56:59], v[40:43], 0
    v_mfma_f32_16x16x32_bf16 v[20:23], a[112:115], v[40:43], 0
    v_mfma_f32_16x16x32_bf16 v[24:27], a[168:171], v[40:43], 0
    v_mfma_f32_16x16x32_bf16 v[28:31], a[224:227], v[40:43], 0
    v_mfma_f32_16x16x32_bf16 v[32:35], v[134:137], v[40:43], 0
    v_mfma_f32_16x16x32_bf16 v[36:39], v[190:193], v[40:43], 0
    ds_read_b128 v[40:43], v7 offset:2048
    s_waitcnt lgkmcnt(3)
    v_mfma_f32_16x16x32_bf16 v[12:15], a[4:7], v[44:47], v[12:15]
    v_mfma_f32_16x16x32_bf16 v[16:19], a[60:63], v[44:47], v[16:19]
    v_mfma_f32_16x16x32_bf16 v[20:23], a[116:119], v[44:47], v[20:23]
    v_mfma_f32_16x16x32_bf16 v[24:27], a[172:175], v[44:47], v[24:27]
    v_mfma_f32_16x16x32_bf16 v[28:31], a[228:231], v[44:47], v[28:31]
    v_mfma_f32_16x16x32_bf16 v[32:35], v[138:141], v[44:47], v[32:35]
    v_mfma_f32_16x16x32_bf16 v[36:39], v[194:197], v[44:47], v[36:39]
    ds_read_b128 v[44:47], v7 offset:2560
    s_waitcnt lgkmcnt(3)
    v_mfma_f32_16x16x32_bf16 v[12:15], a[8:11], v[48:51], v[12:15]
    v_mfma_f32_16x16x32_bf16 v[16:19], a[64:67], v[48:51], v[16:19]
    v_mfma_f32_16x16x32_bf16 v[20:23], a[120:123], v[48:51], v[20:23]
    v_mfma_f32_16x16x32_bf16 v[24:27], a[176:179], v[48:51], v[24:27]
    v_mfma_f32_16x16x32_bf16 v[28:31], a[232:235], v[48:51], v[28:31]
    v_mfma_f32_16x16x32_bf16 v[32:35], v[142:145], v[48:51], v[32:35]
    v_mfma_f32_16x16x32_bf16 v[36:39], v[198:201], v[48:51], v[36:39]
    ds_read_b128 v[48:51], v7 offset:3072
    s_waitcnt lgkmcnt(3)
    v_mfma_f32_16x16x32_bf16 v[12:15], a[12:15], v[52:55], v[12:15]
    v_mfma_f32_16x16x32_bf16 v[16:19], a[68:71], v[52:55], v[16:19]
    v_mfma_f32_16x16x32_bf16 v[20:23], a[124:127], v[52:55], v[20:23]
    v_mfma_f32_16x16x32_bf16 v[24:27], a[180:183], v[52:55], v[24:27]
    v_mfma_f32_16x16x32_bf16 v[28:31], a[236:239], v[52:55], v[28:31]
    v_mfma_f32_16x16x32_bf16 v[32:35], v[146:149], v[52:55], v[32:35]
    v_mfma_f32_16x16x32_bf16 v[36:39], v[202:205], v[52:55], v[36:39]
    ds_read_b128 v[52:55], v7 offset:3584
    s_waitcnt lgkmcnt(3)
    v_mfma_f32_16x16x32_bf16 v[12:15], a[16:19], v[40:43], v[12:15]
    v_mfma_f32_16x16x32_bf16 v[16:19], a[72:75], v[40:43], v[16:19]
    v_mfma_f32_16x16x32_bf16 v[20:23], a[128:131], v[40:43], v[20:23]
    v_mfma_f32_16x16x32_bf16 v[24:27], a[184:187], v[40:43], v[24:27]
    v_mfma_f32_16x16x32_bf16 v[28:31], a[240:243], v[40:43], v[28:31]
    v_mfma_f32_16x16x32_bf16 v[32:35], v[150:153], v[40:43], v[32:35]
    v_mfma_f32_16x16x32_bf16 v[36:39], v[206:209], v[40:43], v[36:39]
    ds_read_b128 v[40:43], v7 offset:4096
    s_waitcnt lgkmcnt(3)
    v_mfma_f32_16x16x32_bf16 v[12:15], a[20:23], v[44:47], v[12:15]
    v_mfma_f32_16x16x32_bf16 v[16:19], a[76:79], v[44:47], v[16:19]
    v_mfma_f32_16x16x32_bf16 v[20:23], a[132:135], v[44:47], v[20:23]
    v_mfma_f32_16x16x32_bf16 v[24:27], a[188:191], v[44:47], v[24:27]
    v_mfma_f32_16x16x32_bf16 v[28:31], a[244:247], v[44:47], v[28:31]
    v_mfma_f32_16x16x32_bf16 v[32:35], v[154:157], v[44:47], v[32:35]
    v_mfma_f32_16x16x32_bf16 v[36:39], v[210:213], v[44:47], v[36:39]
    ds_read_b128 v[44:47], v7 offset:4608
    s_waitcnt lgkmcnt(3)
    v_mfma_f32_16x16x32_bf16 v[12:15], a[24:27], v[48:51], v[12:15]
    v_mfma_f32_16x16x32_bf16 v[16:19], a[80:83], v[48:51], v[16:19]
    v_mfma_f32_16x16x32_bf16 v[20:23], a[136:139], v[48:51], v[20:23]
    v_mfma_f32_16x16x32_bf16 v[24:27], a[192:195], v[48:51], v[24:27]
    v_mfma_f32_16x16x32_bf16 v[28:31], a[248:251], v[48:51], v[28:31]
    v_mfma_f32_16x16x32_bf16 v[32:35], v[158:161], v[48:51], v[32:35]
    v_mfma_f32_16x16x32_bf16 v[36:39], v[214:217], v[48:51], v[36:39]
    s_waitcnt vmcnt(0)
    ds_read_b64 v[84:85], v252 offset:0
    ds_read_b64 v[86:87], v252 offset:256
    ds_read_b64 v[88:89], v252 offset:512
    ds_read_b64 v[90:91], v252 offset:768
    ds_read_b64 v[92:93], v252 offset:1024
    ds_read_b64 v[94:95], v252 offset:1280
    ds_read_b64 v[96:97], v252 offset:1536
    ds_read_b128 v[48:51], v7 offset:5120
    s_waitcnt lgkmcnt(10)
    v_mfma_f32_16x16x32_bf16 v[12:15], a[28:31], v[52:55], v[12:15]
    v_mfma_f32_16x16x32_bf16 v[16:19], a[84:87], v[52:55], v[16:19]
    v_mfma_f32_16x16x32_bf16 v[20:23], a[140:143], v[52:55], v[20:23]
    v_mfma_f32_16x16x32_bf16 v[24:27], a[196:199], v[52:55], v[24:27]
    v_mfma_f32_16x16x32_bf16 v[28:31], a[252:255], v[52:55], v[28:31]
    v_mfma_f32_16x16x32_bf16 v[32:35], v[162:165], v[52:55], v[32:35]
    v_mfma_f32_16x16x32_bf16 v[36:39], v[218:221], v[52:55], v[36:39]
    ds_read_b128 v[52:55], v7 offset:5632
    s_waitcnt lgkmcnt(10)
    v_mfma_f32_16x16x32_bf16 v[12:15], a[32:35], v[40:43], v[12:15]
    v_mfma_f32_16x16x32_bf16 v[16:19], a[88:91], v[40:43], v[16:19]
    v_mfma_f32_16x16x32_bf16 v[20:23], a[144:147], v[40:43], v[20:23]
    v_mfma_f32_16x16x32_bf16 v[24:27], a[200:203], v[40:43], v[24:27]
    v_mfma_f32_16x16x32_bf16 v[28:31], v[110:113], v[40:43], v[28:31]
    v_mfma_f32_16x16x32_bf16 v[32:35], v[166:169], v[40:43], v[32:35]
    v_mfma_f32_16x16x32_bf16 v[36:39], v[222:225], v[40:43], v[36:39]
    ds_read_b128 v[40:43], v7 offset:6144
    s_waitcnt lgkmcnt(10)
    v_mfma_f32_16x16x32_bf16 v[12:15], a[36:39], v[44:47], v[12:15]
    v_mfma_f32_16x16x32_bf16 v[16:19], a[92:95], v[44:47], v[16:19]
    v_mfma_f32_16x16x32_bf16 v[20:23], a[148:151], v[44:47], v[20:23]
    v_mfma_f32_16x16x32_bf16 v[24:27], a[204:207], v[44:47], v[24:27]
    v_mfma_f32_16x16x32_bf16 v[28:31], v[114:117], v[44:47], v[28:31]
    v_mfma_f32_16x16x32_bf16 v[32:35], v[170:173], v[44:47], v[32:35]
    v_mfma_f32_16x16x32_bf16 v[36:39], v[226:229], v[44:47], v[36:39]
    ds_read_b128 v[44:47], v7 offset:6656
    s_waitcnt lgkmcnt(3)
    v_mfma_f32_16x16x32_bf16 v[12:15], a[40:43], v[48:51], v[12:15]
    v_mfma_f32_16x16x32_bf16 v[16:19], a[96:99], v[48:51], v[16:19]
    v_mfma_f32_16x16x32_bf16 v[20:23], a[152:155], v[48:51], v[20:23]
    v_mfma_f32_16x16x32_bf16 v[24:27], a[208:211], v[48:51], v[24:27]
    v_mfma_f32_16x16x32_bf16 v[28:31], v[118:121], v[48:51], v[28:31]
    v_mfma_f32_16x16x32_bf16 v[32:35], v[174:177], v[48:51], v[32:35]
    v_mfma_f32_16x16x32_bf16 v[36:39], v[230:233], v[48:51], v[36:39]
    s_waitcnt lgkmcnt(2)
    v_mfma_f32_16x16x32_bf16 v[12:15], a[44:47], v[52:55], v[12:15]
    v_mfma_f32_16x16x32_bf16 v[16:19], a[100:103], v[52:55], v[16:19]
    v_mfma_f32_16x16x32_bf16 v[20:23], a[156:159], v[52:55], v[20:23]
    v_mfma_f32_16x16x32_bf16 v[24:27], a[212:215], v[52:55], v[24:27]
    v_mfma_f32_16x16x32_bf16 v[28:31], v[122:125], v[52:55], v[28:31]
    v_mfma_f32_16x16x32_bf16 v[32:35], v[178:181], v[52:55], v[32:35]
    v_mfma_f32_16x16x32_bf16 v[36:39], v[234:237], v[52:55], v[36:39]
    s_waitcnt lgkmcnt(1)
    v_mfma_f32_16x16x32_bf16 v[12:15], a[48:51], v[40:43], v[12:15]
    v_mfma_f32_16x16x32_bf16 v[16:19], a[104:107], v[40:43], v[16:19]
    v_mfma_f32_16x16x32_bf16 v[20:23], a[160:163], v[40:43], v[20:23]
    v_mfma_f32_16x16x32_bf16 v[24:27], a[216:219], v[40:43], v[24:27]
    v_mfma_f32_16x16x32_bf16 v[28:31], v[126:129], v[40:43], v[28:31]
    v_mfma_f32_16x16x32_bf16 v[32:35], v[182:185], v[40:43], v[32:35]
    v_mfma_f32_16x16x32_bf16 v[36:39], v[238:241], v[40:43], v[36:39]
    s_waitcnt lgkmcnt(0)
    v_mfma_f32_16x16x32_bf16 v[12:15], a[52:55], v[44:47], v[12:15]
    v_mfma_f32_16x16x32_bf16 v[16:19], a[108:111], v[44:47], v[16:19]
    v_mfma_f32_16x16x32_bf16 v[20:23], a[164:167], v[44:47], v[20:23]
    v_mfma_f32_16x16x32_bf16 v[24:27], a[220:223], v[44:47], v[24:27]
    v_mfma_f32_16x16x32_bf16 v[28:31], v[130:133], v[44:47], v[28:31]
    v_mfma_f32_16x16x32_bf16 v[32:35], v[186:189], v[44:47], v[32:35]
    v_mfma_f32_16x16x32_bf16 v[36:39], v[242:245], v[44:47], v[36:39]
    s_nop 7
    v_cvt_pk_bf16_f32 v12, v12, v13
    v_cvt_pk_bf16_f32 v13, v14, v15
    v_cvt_pk_bf16_f32 v14, v16, v17
    v_cvt_pk_bf16_f32 v15, v18, v19
    v_cvt_pk_bf16_f32 v20, v20, v21
    v_cvt_pk_bf16_f32 v21, v22, v23
    v_cvt_pk_bf16_f32 v22, v24, v25
    v_cvt_pk_bf16_f32 v23, v26, v27
    v_cvt_pk_bf16_f32 v28, v28, v29
    v_cvt_pk_bf16_f32 v29, v30, v31
    v_cvt_pk_bf16_f32 v30, v32, v33
    v_cvt_pk_bf16_f32 v31, v34, v35
    v_cvt_pk_bf16_f32 v36, v36, v37
    v_cvt_pk_bf16_f32 v37, v38, v39
    s_waitcnt lgkmcnt(0)
    s_nop 1
    v_mfma_f32_16x16x32_bf16 v[98:101], v[84:87], v[12:15], 0
    v_mfma_f32_16x16x32_bf16 v[102:105], v[56:59], v[12:15], 0
    v_mfma_f32_16x16x32_bf16 v[106:109], v[70:73], v[12:15], 0
    v_mfma_f32_16x16x32_bf16 v[98:101], v[88:91], v[20:23], v[98:101]
    v_mfma_f32_16x16x32_bf16 v[102:105], v[60:63], v[20:23], v[102:105]
    v_mfma_f32_16x16x32_bf16 v[106:109], v[74:77], v[20:23], v[106:109]
    v_mfma_f32_16x16x32_bf16 v[98:101], v[92:95], v[28:31], v[98:101]
    v_mfma_f32_16x16x32_bf16 v[102:105], v[64:67], v[28:31], v[102:105]
    v_mfma_f32_16x16x32_bf16 v[106:109], v[78:81], v[28:31], v[106:109]
    v_mfma_f32_16x16x16_bf16 v[98:101], v[96:97], v[36:37], v[98:101]
    v_mfma_f32_16x16x16_bf16 v[102:105], v[68:69], v[36:37], v[102:105]
    v_mfma_f32_16x16x16_bf16 v[106:109], v[82:83], v[36:37], v[106:109]
    s_nop 7
    s_nop 1
    ds_write_b128 v11, v[98:101]
    ds_write_b128 v11, v[102:105] offset:1024
    ds_write_b128 v11, v[106:109] offset:2048
    s_waitcnt lgkmcnt(0)
    s_barrier
    s_cmp_lg_u32 s3, 0
    s_cbranch_scc1 ch1_snext
    ds_read_b128 v[12:15], v11 offset:3072
    ds_read_b128 v[16:19], v11 offset:4096
    ds_read_b128 v[20:23], v11 offset:5120
    ds_read_b128 v[24:27], v11 offset:6144
    ds_read_b128 v[28:31], v11 offset:7168
    ds_read_b128 v[32:35], v11 offset:8192
    ds_read_b128 v[36:39], v11 offset:9216
    ds_read_b128 v[40:43], v11 offset:10240
    ds_read_b128 v[44:47], v11 offset:11264
    s_waitcnt lgkmcnt(0)
    v_pk_add_f32 v[98:99], v[98:99], v[12:13]
    v_pk_add_f32 v[24:25], v[24:25], v[36:37]
    v_pk_add_f32 v[100:101], v[100:101], v[14:15]
    v_pk_add_f32 v[26:27], v[26:27], v[38:39]
    v_pk_add_f32 v[102:103], v[102:103], v[16:17]
    v_pk_add_f32 v[28:29], v[28:29], v[40:41]
    v_pk_add_f32 v[104:105], v[104:105], v[18:19]
    v_pk_add_f32 v[30:31], v[30:31], v[42:43]
    v_pk_add_f32 v[106:107], v[106:107], v[20:21]
    v_pk_add_f32 v[32:33], v[32:33], v[44:45]
    v_pk_add_f32 v[108:109], v[108:109], v[22:23]
    v_pk_add_f32 v[34:35], v[34:35], v[46:47]
    v_pk_add_f32 v[98:99], v[98:99], v[24:25]
    v_pk_add_f32 v[100:101], v[100:101], v[26:27]
    v_pk_add_f32 v[102:103], v[102:103], v[28:29]
    v_pk_add_f32 v[104:105], v[104:105], v[30:31]
    v_pk_add_f32 v[106:107], v[106:107], v[32:33]
    v_pk_add_f32 v[108:109], v[108:109], v[34:35]
    v_mov_b32 v40, 0xff800000
    v_cndmask_b32 v98, v40, v98, s[32:33]
    v_cndmask_b32 v99, v40, v99, s[32:33]
    v_cndmask_b32 v100, v40, v100, s[32:33]
    v_cndmask_b32 v101, v40, v101, s[32:33]
    v_max3_f32 v41, v98, v99, v100
    v_max3_f32 v41, v41, v101, v102
    v_max3_f32 v41, v41, v103, v104
    v_max3_f32 v41, v41, v105, v106
    v_max3_f32 v41, v41, v107, v108
    v_max_f32 v41, v41, v109
    v_mov_b32 v42, v41
    s_nop 1
    v_permlane16_swap_b32 v41, v42
    v_max_f32 v41, v41, v42
    v_mov_b32 v42, v41
    s_nop 1
    v_permlane32_swap_b32 v41, v42
    v_max_f32 v41, v41, v42
    v_mul_f32 v41, 0xbfb8aa3b, v41
    v_fma_f32 v98, v98, s50, v41
    v_fma_f32 v99, v99, s50, v41
    v_fma_f32 v100, v100, s50, v41
    v_fma_f32 v101, v101, s50, v41
    v_fma_f32 v102, v102, s50, v41
    v_fma_f32 v103, v103, s50, v41
    v_fma_f32 v104, v104, s50, v41
    v_fma_f32 v105, v105, s50, v41
    v_fma_f32 v106, v106, s50, v41
    v_fma_f32 v107, v107, s50, v41
    v_fma_f32 v108, v108, s50, v41
    v_fma_f32 v109, v109, s50, v41
    v_exp_f32 v98, v98
    v_exp_f32 v99, v99
    v_exp_f32 v100, v100
    v_exp_f32 v101, v101
    v_exp_f32 v102, v102
    v_exp_f32 v103, v103
    v_exp_f32 v104, v104
    v_exp_f32 v105, v105
    v_exp_f32 v106, v106
    v_exp_f32 v107, v107
    v_exp_f32 v108, v108
    v_exp_f32 v109, v109
    s_nop 0
    v_pk_add_f32 v[12:13], v[98:99], v[100:101]
    v_pk_add_f32 v[14:15], v[102:103], v[104:105]
    v_pk_add_f32 v[16:17], v[106:107], v[108:109]
    v_pk_add_f32 v[12:13], v[12:13], v[14:15]
    v_pk_add_f32 v[12:13], v[12:13], v[16:17]
    v_add_f32 v42, v12, v13
    v_mov_b32 v43, v42
    s_nop 1
    v_permlane16_swap_b32 v42, v43
    v_add_f32 v42, v42, v43
    v_mov_b32 v43, v42
    s_nop 1
    v_permlane32_swap_b32 v42, v43
    v_add_f32 v42, v42, v43
    v_rcp_f32 v42, v42
    s_nop 0
    v_mov_b32 v43, v42
    v_pk_mul_f32 v[98:99], v[98:99], v[42:43]
    v_pk_mul_f32 v[100:101], v[100:101], v[42:43]
    v_pk_mul_f32 v[102:103], v[102:103], v[42:43]
    v_pk_mul_f32 v[104:105], v[104:105], v[42:43]
    v_pk_mul_f32 v[106:107], v[106:107], v[42:43]
    v_pk_mul_f32 v[108:109], v[108:109], v[42:43]
    v_cvt_pk_bf16_f32 v44, v102, v103
    v_cvt_pk_bf16_f32 v45, v104, v105
    v_cvt_pk_bf16_f32 v46, v106, v107
    v_cvt_pk_bf16_f32 v47, v108, v109
    v_cvt_pk_bf16_f32 v48, v98, v99
    v_cvt_pk_bf16_f32 v49, v100, v101
    s_mov_b64 exec, s[30:31]
    buffer_store_dwordx4 v[44:47], v246, s[20:23], s41 offen
    buffer_store_dwordx2 v[48:49], v247, s[20:23], s41 offen
    s_mov_b64 exec, -1
ch1_snext:
    s_add_u32 s40, s40, 7168
    s_add_u32 s41, s41, 16384
    s_mov_b32 s47, s48
    s_add_u32 s42, s42, 1
    s_cmp_lt_u32 s42, 64
    s_cbranch_scc1 ch1_sloop
    s_endpgm
ch1_ucu:
    s_sub_u32 s24, s2, 16
    v_mul_u32_u24 v5, 896, v2
    v_lshl_add_u32 v5, v3, 4, v5
    s_lshl_b32 s25, s3, 2
    s_add_u32 s25, s25, 16
    s_mul_i32 s25, s25, 448
    s_lshl_b32 s26, s24, 5
    s_add_u32 s25, s25, s26
    s_mul_i32 s25, s25, 896
    s_add_u32 s25, s25, 5275648
    s_mul_i32 s27, s3, 22528
    s_add_u32 s27, s27, 16384
    s_add_u32 s52, s25, 0
    s_add_u32 s53, s25, 14336
    s_add_u32 s54, s25, 401408
    s_add_u32 s55, s25, 415744
    s_add_u32 s56, s25, 802816
    s_add_u32 s57, s25, 817152
    s_add_u32 s58, s25, 1204224
    s_add_u32 s59, s25, 1218560
    v_lshlrev_b32 v12, 4, v1
    v_add_u32 v13, 4096, v12
    v_add_u32 v14, 8192, v12
    v_add_u32 v15, 12288, v12
    buffer_load_dwordx4 a[0:3], v12, s[20:23], s52 offen offset:0
    buffer_load_dwordx4 a[4:7], v12, s[20:23], s53 offen offset:0
    buffer_load_dwordx4 a[8:11], v12, s[20:23], s54 offen offset:0
    buffer_load_dwordx4 a[12:15], v12, s[20:23], s55 offen offset:0
    buffer_load_dwordx4 a[16:19], v12, s[20:23], s56 offen offset:0
    buffer_load_dwordx4 a[20:23], v12, s[20:23], s57 offen offset:0
    buffer_load_dwordx4 a[24:27], v12, s[20:23], s58 offen offset:0
    buffer_load_dwordx4 a[28:31], v12, s[20:23], s59 offen offset:0
    buffer_load_dwordx4 a[32:35], v12, s[20:23], s52 offen offset:1024
    buffer_load_dwordx4 a[36:39], v12, s[20:23], s53 offen offset:1024
    buffer_load_dwordx4 a[40:43], v12, s[20:23], s54 offen offset:1024
    buffer_load_dwordx4 a[44:47], v12, s[20:23], s55 offen offset:1024
    buffer_load_dwordx4 a[48:51], v12, s[20:23], s56 offen offset:1024
    buffer_load_dwordx4 a[52:55], v12, s[20:23], s57 offen offset:1024
    buffer_load_dwordx4 a[56:59], v12, s[20:23], s58 offen offset:1024
    buffer_load_dwordx4 a[60:63], v12, s[20:23], s59 offen offset:1024
    buffer_load_dwordx4 a[64:67], v12, s[20:23], s52 offen offset:2048
    buffer_load_dwordx4 a[68:71], v12, s[20:23], s53 offen offset:2048
    buffer_load_dwordx4 a[72:75], v12, s[20:23], s54 offen offset:2048
    buffer_load_dwordx4 a[76:79], v12, s[20:23], s55 offen offset:2048
    buffer_load_dwordx4 a[80:83], v12, s[20:23], s56 offen offset:2048
    buffer_load_dwordx4 a[84:87], v12, s[20:23], s57 offen offset:2048
    buffer_load_dwordx4 a[88:91], v12, s[20:23], s58 offen offset:2048
    buffer_load_dwordx4 a[92:95], v12, s[20:23], s59 offen offset:2048
    buffer_load_dwordx4 a[96:99], v12, s[20:23], s52 offen offset:3072
    buffer_load_dwordx4 a[100:103], v12, s[20:23], s53 offen offset:3072
    buffer_load_dwordx4 a[104:107], v12, s[20:23], s54 offen offset:3072
    buffer_load_dwordx4 a[108:111], v12, s[20:23], s55 offen offset:3072
    buffer_load_dwordx4 a[112:115], v12, s[20:23], s56 offen offset:3072
    buffer_load_dwordx4 a[116:119], v12, s[20:23], s57 offen offset:3072
    buffer_load_dwordx4 a[120:123], v12, s[20:23], s58 offen offset:3072
    buffer_load_dwordx4 a[124:127], v12, s[20:23], s59 offen offset:3072
    buffer_load_dwordx4 a[128:131], v13, s[20:23], s52 offen offset:0
    buffer_load_dwordx4 a[132:135], v13, s[20:23], s53 offen offset:0
    buffer_load_dwordx4 a[136:139], v13, s[20:23], s54 offen offset:0
    buffer_load_dwordx4 a[140:143], v13, s[20:23], s55 offen offset:0
    buffer_load_dwordx4 a[144:147], v13, s[20:23], s56 offen offset:0
    buffer_load_dwordx4 a[148:151], v13, s[20:23], s57 offen offset:0
    buffer_load_dwordx4 a[152:155], v13, s[20:23], s58 offen offset:0
    buffer_load_dwordx4 a[156:159], v13, s[20:23], s59 offen offset:0
    buffer_load_dwordx4 a[160:163], v13, s[20:23], s52 offen offset:1024
    buffer_load_dwordx4 a[164:167], v13, s[20:23], s53 offen offset:1024
    buffer_load_dwordx4 a[168:171], v13, s[20:23], s54 offen offset:1024
    buffer_load_dwordx4 a[172:175], v13, s[20:23], s55 offen offset:1024
    buffer_load_dwordx4 a[176:179], v13, s[20:23], s56 offen offset:1024
    buffer_load_dwordx4 a[180:183], v13, s[20:23], s57 offen offset:1024
    buffer_load_dwordx4 a[184:187], v13, s[20:23], s58 offen offset:1024
    buffer_load_dwordx4 a[188:191], v13, s[20:23], s59 offen offset:1024
    buffer_load_dwordx4 a[192:195], v13, s[20:23], s52 offen offset:2048
    buffer_load_dwordx4 a[196:199], v13, s[20:23], s53 offen offset:2048
    buffer_load_dwordx4 a[200:203], v13, s[20:23], s54 offen offset:2048
    buffer_load_dwordx4 a[204:207], v13, s[20:23], s55 offen offset:2048
    buffer_load_dwordx4 a[208:211], v13, s[20:23], s56 offen offset:2048
    buffer_load_dwordx4 a[212:215], v13, s[20:23], s57 offen offset:2048
    buffer_load_dwordx4 a[216:219], v13, s[20:23], s58 offen offset:2048
    buffer_load_dwordx4 a[220:223], v13, s[20:23], s59 offen offset:2048
    buffer_load_dwordx4 a[224:227], v13, s[20:23], s52 offen offset:3072
    buffer_load_dwordx4 a[228:231], v13, s[20:23], s53 offen offset:3072
    buffer_load_dwordx4 a[232:235], v13, s[20:23], s54 offen offset:3072
    buffer_load_dwordx4 a[236:239], v13, s[20:23], s55 offen offset:3072
    buffer_load_dwordx4 a[240:243], v13, s[20:23], s56 offen offset:3072
    buffer_load_dwordx4 a[244:247], v13, s[20:23], s57 offen offset:3072
    buffer_load_dwordx4 a[248:251], v13, s[20:23], s58 offen offset:3072
    buffer_load_dwordx4 a[252:255], v13, s[20:23], s59 offen offset:3072
    buffer_load_dwordx4 v[152:155], v14, s[20:23], s52 offen offset:0
    buffer_load_dwordx4 v[156:159], v14, s[20:23], s53 offen offset:0
    buffer_load_dwordx4 v[160:163], v14, s[20:23], s54 offen offset:0
    buffer_load_dwordx4 v[164:167], v14, s[20:23], s55 offen offset:0
    buffer_load_dwordx4 v[168:171], v14, s[20:23], s56 offen offset:0
    buffer_load_dwordx4 v[172:175], v14, s[20:23], s57 offen offset:0
    buffer_load_dwordx4 v[176:179], v14, s[20:23], s58 offen offset:0
    buffer_load_dwordx4 v[180:183], v14, s[20:23], s59 offen offset:0
    buffer_load_dwordx4 v[184:187], v14, s[20:23], s52 offen offset:1024
    buffer_load_dwordx4 v[188:191], v14, s[20:23], s53 offen offset:1024
    buffer_load_dwordx4 v[192:195], v14, s[20:23], s54 offen offset:1024
    buffer_load_dwordx4 v[196:199], v14, s[20:23], s55 offen offset:1024
    buffer_load_dwordx4 v[200:203], v14, s[20:23], s56 offen offset:1024
    buffer_load_dwordx4 v[204:207], v14, s[20:23], s57 offen offset:1024
    buffer_load_dwordx4 v[208:211], v14, s[20:23], s58 offen offset:1024
    buffer_load_dwordx4 v[212:215], v14, s[20:23], s59 offen offset:1024
    buffer_load_dwordx4 v[216:219], v14, s[20:23], s52 offen offset:2048
    buffer_load_dwordx4 v[220:223], v14, s[20:23], s53 offen offset:2048
    buffer_load_dwordx4 v[224:227], v14, s[20:23], s54 offen offset:2048
    buffer_load_dwordx4 v[228:231], v14, s[20:23], s55 offen offset:2048
    buffer_load_dwordx4 v[232:235], v14, s[20:23], s56 offen offset:2048
    buffer_load_dwordx4 v[236:239], v14, s[20:23], s57 offen offset:2048
    buffer_load_dwordx4 v[240:243], v14, s[20:23], s58 offen offset:2048
    buffer_load_dwordx4 v[244:247], v14, s[20:23], s59 offen offset:2048
    buffer_load_dwordx4 v[248:251], v14, s[20:23], s52 offen offset:3072
    buffer_load_dwordx4 v[252:255], v14, s[20:23], s53 offen offset:3072
    s_add_u32 s28, s27, 0
    s_mov_b32 m0, s28
    s_add_u32 s29, s54, 11264
    buffer_load_dwordx4 v12, s[20:23], s29 offen lds
    s_add_u32 s28, s27, 1024
    s_mov_b32 m0, s28
    s_add_u32 s29, s55, 11264
    buffer_load_dwordx4 v12, s[20:23], s29 offen lds
    s_add_u32 s28, s27, 2048
    s_mov_b32 m0, s28
    s_add_u32 s29, s56, 11264
    buffer_load_dwordx4 v12, s[20:23], s29 offen lds
    s_add_u32 s28, s27, 3072
    s_mov_b32 m0, s28
    s_add_u32 s29, s57, 11264
    buffer_load_dwordx4 v12, s[20:23], s29 offen lds
    s_add_u32 s28, s27, 4096
    s_mov_b32 m0, s28
    s_add_u32 s29, s58, 11264
    buffer_load_dwordx4 v12, s[20:23], s29 offen lds
    s_add_u32 s28, s27, 5120
    s_mov_b32 m0, s28
    s_add_u32 s29, s59, 11264
    buffer_load_dwordx4 v12, s[20:23], s29 offen lds
    s_add_u32 s28, s27, 6144
    s_mov_b32 m0, s28
    s_add_u32 s29, s52, 12288
    buffer_load_dwordx4 v12, s[20:23], s29 offen lds
    s_add_u32 s28, s27, 7168
    s_mov_b32 m0, s28
    s_add_u32 s29, s53, 12288
    buffer_load_dwordx4 v12, s[20:23], s29 offen lds
    s_add_u32 s28, s27, 8192
    s_mov_b32 m0, s28
    s_add_u32 s29, s54, 12288
    buffer_load_dwordx4 v12, s[20:23], s29 offen lds
    s_add_u32 s28, s27, 9216
    s_mov_b32 m0, s28
    s_add_u32 s29, s55, 12288
    buffer_load_dwordx4 v12, s[20:23], s29 offen lds
    s_add_u32 s28, s27, 10240
    s_mov_b32 m0, s28
    s_add_u32 s29, s56, 12288
    buffer_load_dwordx4 v12, s[20:23], s29 offen lds
    s_add_u32 s28, s27, 11264
    s_mov_b32 m0, s28
    s_add_u32 s29, s57, 12288
    buffer_load_dwordx4 v12, s[20:23], s29 offen lds
    s_add_u32 s28, s27, 12288
    s_mov_b32 m0, s28
    s_add_u32 s29, s58, 12288
    buffer_load_dwordx4 v12, s[20:23], s29 offen lds
    s_add_u32 s28, s27, 13312
    s_mov_b32 m0, s28
    s_add_u32 s29, s59, 12288
    buffer_load_dwordx4 v12, s[20:23], s29 offen lds
    s_add_u32 s28, s27, 14336
    s_mov_b32 m0, s28
    s_add_u32 s29, s52, 13312
    buffer_load_dwordx4 v12, s[20:23], s29 offen lds
    s_add_u32 s28, s27, 15360
    s_mov_b32 m0, s28
    s_add_u32 s29, s53, 13312
    buffer_load_dwordx4 v12, s[20:23], s29 offen lds
    s_add_u32 s28, s27, 16384
    s_mov_b32 m0, s28
    s_add_u32 s29, s54, 13312
    buffer_load_dwordx4 v12, s[20:23], s29 offen lds
    s_add_u32 s28, s27, 17408
    s_mov_b32 m0, s28
    s_add_u32 s29, s55, 13312
    buffer_load_dwordx4 v12, s[20:23], s29 offen lds
    s_add_u32 s28, s27, 18432
    s_mov_b32 m0, s28
    s_add_u32 s29, s56, 13312
    buffer_load_dwordx4 v12, s[20:23], s29 offen lds
    s_add_u32 s28, s27, 19456
    s_mov_b32 m0, s28
    s_add_u32 s29, s57, 13312
    buffer_load_dwordx4 v12, s[20:23], s29 offen lds
    s_add_u32 s28, s27, 20480
    s_mov_b32 m0, s28
    s_add_u32 s29, s58, 13312
    buffer_load_dwordx4 v12, s[20:23], s29 offen lds
    s_add_u32 s28, s27, 21504
    s_mov_b32 m0, s28
    s_add_u32 s29, s59, 13312
    buffer_load_dwordx4 v12, s[20:23], s29 offen lds
    s_mul_i32 s25, s3, 1792
    v_lshlrev_b32 v6, 4, v1
    v_add_u32 v6, s25, v6
    s_mov_b32 s36, -1
    s_mov_b32 s37, 0x0000ffff
    v_lshl_add_u32 v7, v3, 3, v4
    v_lshlrev_b32 v8, 3, v7
    v_add_u32 v8, 512, v8
    v_lshlrev_b32 v7, 4, v7
    v_lshlrev_b32 v9, 5, v2
    v_lshl_add_u32 v9, v3, 3, v9
    s_lshl_b32 s26, s24, 9
    v_add_u32 v9, s26, v9
    v_lshlrev_b32 v10, 4, v2
    v_lshl_add_u32 v10, v3, 8, v10
    v_add_u32 v10, s26, v10
    v_lshlrev_b32 v4, 5, v4
    v_lshrrev_b32 v11, 1, v3
    v_lshl_add_u32 v4, v11, 8, v4
    v_and_b32 v11, 1, v3
    v_lshl_add_u32 v4, v11, 4, v4
    v_add_u32 v4, 8192, v4
    v_lshlrev_b32 v11, 4, v1
    s_lshl_b32 s26, s3, 11
    v_add_u32 v12, s26, v11
    v_add_u32 v13, s27, v11
    v_lshlrev_b32 v5, 6, v2
    v_lshl_add_u32 v5, v3, 4, v5
    v_cmp_gt_u32 s[30:31], 8, v2
    v_cmp_gt_u32 s[32:33], 2, v3
    s_mov_b32 s40, 174431232
    s_mov_b32 s75, 174438400
    s_mov_b32 s76, 175370240
    s_lshl_b32 s41, s3, 12
    s_add_u32 s41, s41, 176877568
    s_mov_b32 s42, 0
    s_mul_i32 s44, s3, 28672
    s_add_u32 s44, s44, 160202752
    s_mul_i32 s43, s3, 114688
    s_lshl_b32 s26, s24, 11
    s_add_u32 s43, s43, s26
    s_add_u32 s43, s43, 130842624
    v_mov_b32 v15, 0
    s_waitcnt vmcnt(0)
    s_barrier
    s_lshl_b32 s48, s3, 13
    s_add_u32 s48, s48, 106496
    v_add_u32 v144, s48, v11
    s_mov_b32 s49, 167624704
    s_lshl_b32 s28, s3, 12
    s_add_u32 s28, s28, 139264
    v_lshlrev_b32 v146, 3, v1
    v_add_u32 v146, s28, v146
mega_kernel_vw32:
    buffer_load_dword v145, v15, s[20:23], s49 offen sc1
    s_waitcnt vmcnt(0)
    v_readfirstlane_b32 s71, v145
    s_cmp_ge_u32 s71, 28
    s_cbranch_scc0 mega_kernel_vw32
    s_add_u32 s28, s48, 0
    s_mov_b32 m0, s28
    s_add_u32 s45, s43, 0
    buffer_load_dwordx4 v5, s[20:23], s45 offen sc1 lds
    s_add_u32 s28, s48, 1024
    s_mov_b32 m0, s28
    s_add_u32 s45, s43, 1024
    buffer_load_dwordx4 v5, s[20:23], s45 offen sc1 lds
    s_add_u32 s28, s48, 2048
    s_mov_b32 m0, s28
    s_add_u32 s45, s43, 28672
    buffer_load_dwordx4 v5, s[20:23], s45 offen sc1 lds
    s_add_u32 s28, s48, 3072
    s_mov_b32 m0, s28
    s_add_u32 s45, s43, 29696
    buffer_load_dwordx4 v5, s[20:23], s45 offen sc1 lds
    s_add_u32 s28, s48, 4096
    s_mov_b32 m0, s28
    s_add_u32 s45, s43, 57344
    buffer_load_dwordx4 v5, s[20:23], s45 offen sc1 lds
    s_add_u32 s28, s48, 5120
    s_mov_b32 m0, s28
    s_add_u32 s45, s43, 58368
    buffer_load_dwordx4 v5, s[20:23], s45 offen sc1 lds
    s_add_u32 s28, s48, 6144
    s_mov_b32 m0, s28
    s_add_u32 s45, s43, 86016
    buffer_load_dwordx4 v5, s[20:23], s45 offen sc1 lds
    s_add_u32 s28, s48, 7168
    s_mov_b32 m0, s28
    s_add_u32 s45, s43, 87040
    buffer_load_dwordx4 v5, s[20:23], s45 offen sc1 lds
    s_add_u32 s43, s43, 458752
    s_add_u32 s49, s49, 128
    buffer_load_dword v145, v15, s[20:23], s49 offen sc1
    s_waitcnt vmcnt(0)
ch1_uloop:
    ds_read_b128 v[80:83], v144 offset:0
    ds_read_b128 v[84:87], v144 offset:1024
    ds_read_b128 v[88:91], v144 offset:2048
    ds_read_b128 v[92:95], v144 offset:3072
    ds_read_b128 v[96:99], v144 offset:4096
    ds_read_b128 v[100:103], v144 offset:5120
    ds_read_b128 v[104:107], v144 offset:6144
    ds_read_b128 v[108:111], v144 offset:7168
    ds_read_b64 v[112:113], v146 offset:0
    ds_read_b64 v[114:115], v146 offset:512
    ds_read_b64 v[116:117], v146 offset:1024
    ds_read_b64 v[118:119], v146 offset:1536
    ds_read_b64 v[120:121], v146 offset:2048
    ds_read_b64 v[122:123], v146 offset:2560
    ds_read_b64 v[124:125], v146 offset:3072
    ds_read_b64 v[126:127], v146 offset:3584
    v_mov_b32 v140, 0
    v_mov_b32 v141, 0
    v_mov_b32 v142, 0
    v_mov_b32 v143, 0
ch1_upoll:
    buffer_load_dwordx4 v[136:139], v6, s[20:23], s40 offen sc1
    s_mov_b64 exec, s[36:37]
    buffer_load_dwordx4 v[140:143], v6, s[20:23], s40 offen offset:1024 sc1
    s_mov_b64 exec, -1
    s_waitcnt vmcnt(0)
    v_max3_u32 v14, v136, v138, v140
    v_max_u32 v14, v14, v142
    v_cmp_eq_u32 vcc, -1, v14
    s_cbranch_vccnz ch1_upoll
    ds_write_b128 v6, v[136:139] offset:8192
    s_mov_b64 exec, s[36:37]
    ds_write_b128 v6, v[140:143] offset:9216
    s_mov_b64 exec, -1
    s_waitcnt lgkmcnt(0)
    s_barrier
    ds_read_b128 v[16:19], v4 offset:0
    ds_read_b128 v[20:23], v4 offset:512
    ds_read_b128 v[24:27], v4 offset:1024
    ds_read_b128 v[28:31], v4 offset:1536
    s_waitcnt lgkmcnt(3)
    v_mfma_f32_16x16x32_bf16 v[48:51], v[16:19], a[0:3], 0
    v_mfma_f32_16x16x32_bf16 v[52:55], v[16:19], a[4:7], 0
    v_mfma_f32_16x16x32_bf16 v[56:59], v[16:19], a[8:11], 0
    v_mfma_f32_16x16x32_bf16 v[60:63], v[16:19], a[12:15], 0
    v_mfma_f32_16x16x32_bf16 v[64:67], v[16:19], a[16:19], 0
    v_mfma_f32_16x16x32_bf16 v[68:71], v[16:19], a[20:23], 0
    v_mfma_f32_16x16x32_bf16 v[72:75], v[16:19], a[24:27], 0
    v_mfma_f32_16x16x32_bf16 v[76:79], v[16:19], a[28:31], 0
    s_cmp_eq_u32 s42, 0
    s_cbranch_scc1 ch1_nofl
    v_permlane16_swap_b32 v112, v114
    v_permlane16_swap_b32 v113, v115
    v_permlane16_swap_b32 v116, v118
    v_permlane16_swap_b32 v117, v119
    v_permlane16_swap_b32 v120, v122
    v_permlane16_swap_b32 v121, v123
    v_permlane16_swap_b32 v124, v126
    v_permlane16_swap_b32 v125, v127
    s_mov_b64 exec, s[32:33]
    s_mov_b32 s45, s44
    buffer_store_dwordx4 v[112:115], v10, s[20:23], s45 offen sc1
    s_add_u32 s45, s45, 7168
    buffer_store_dwordx4 v[116:119], v10, s[20:23], s45 offen sc1
    s_add_u32 s45, s45, 7168
    buffer_store_dwordx4 v[120:123], v10, s[20:23], s45 offen sc1
    s_add_u32 s45, s45, 7168
    buffer_store_dwordx4 v[124:127], v10, s[20:23], s45 offen sc1
    s_mov_b64 exec, -1
    s_add_u32 s44, s44, 114688
ch1_nofl:
    ds_read_b128 v[16:19], v4 offset:2048
    s_waitcnt lgkmcnt(3)
    v_mfma_f32_16x16x32_bf16 v[48:51], v[20:23], a[32:35], v[48:51]
    v_mfma_f32_16x16x32_bf16 v[52:55], v[20:23], a[36:39], v[52:55]
    v_mfma_f32_16x16x32_bf16 v[56:59], v[20:23], a[40:43], v[56:59]
    v_mfma_f32_16x16x32_bf16 v[60:63], v[20:23], a[44:47], v[60:63]
    v_mfma_f32_16x16x32_bf16 v[64:67], v[20:23], a[48:51], v[64:67]
    v_mfma_f32_16x16x32_bf16 v[68:71], v[20:23], a[52:55], v[68:71]
    v_mfma_f32_16x16x32_bf16 v[72:75], v[20:23], a[56:59], v[72:75]
    v_mfma_f32_16x16x32_bf16 v[76:79], v[20:23], a[60:63], v[76:79]
    s_cmp_eq_u32 s42, 0
    s_cbranch_scc1 ch1_nog
    s_cmp_ge_u32 s3, 2
    s_cbranch_scc1 ch1_nog
    s_mov_b64 exec, s[30:31]
    buffer_store_dwordx2 v[148:149], v9, s[20:23], s47 offen sc1
    s_mov_b64 exec, -1
    s_cmp_lt_u32 s42, 2
    s_cbranch_scc1 ch1_nog
    s_sub_u32 s73, s42, 2
    s_cmp_lg_u32 s3, 0
    s_cbranch_scc1 mega_kernel_sg33
    s_lshl_b32 s70, s73, 7
    s_add_u32 s70, s70, 167600128
    v_mov_b32 v14, 1
    v_mov_b32 v15, 0
    s_mov_b64 exec, 1
    buffer_atomic_add v14, v15, s[20:23], s70 offen sc1
    s_mov_b64 exec, -1
mega_kernel_sg33:
ch1_nog:
    ds_read_b128 v[20:23], v4 offset:2560
    s_waitcnt lgkmcnt(3)
    v_mfma_f32_16x16x32_bf16 v[48:51], v[24:27], a[64:67], v[48:51]
    v_mfma_f32_16x16x32_bf16 v[52:55], v[24:27], a[68:71], v[52:55]
    v_mfma_f32_16x16x32_bf16 v[56:59], v[24:27], a[72:75], v[56:59]
    v_mfma_f32_16x16x32_bf16 v[60:63], v[24:27], a[76:79], v[60:63]
    v_mfma_f32_16x16x32_bf16 v[64:67], v[24:27], a[80:83], v[64:67]
    v_mfma_f32_16x16x32_bf16 v[68:71], v[24:27], a[84:87], v[68:71]
    v_mfma_f32_16x16x32_bf16 v[72:75], v[24:27], a[88:91], v[72:75]
    v_mfma_f32_16x16x32_bf16 v[76:79], v[24:27], a[92:95], v[76:79]
    s_mov_b32 s51, 1
    s_cmp_ge_u32 s42, 63
    s_cbranch_scc1 ch1_nov
    v_readfirstlane_b32 s71, v145
    s_mov_b32 s51, 0
    s_cmp_ge_u32 s71, 28
    s_cbranch_scc0 ch1_nov
    s_mov_b32 s51, 1
    s_add_u32 s28, s48, 0
    s_mov_b32 m0, s28
    s_add_u32 s45, s43, 0
    buffer_load_dwordx4 v5, s[20:23], s45 offen sc1 lds
    s_add_u32 s28, s48, 1024
    s_mov_b32 m0, s28
    s_add_u32 s45, s43, 1024
    buffer_load_dwordx4 v5, s[20:23], s45 offen sc1 lds
    s_add_u32 s28, s48, 2048
    s_mov_b32 m0, s28
    s_add_u32 s45, s43, 28672
    buffer_load_dwordx4 v5, s[20:23], s45 offen sc1 lds
    s_add_u32 s28, s48, 3072
    s_mov_b32 m0, s28
    s_add_u32 s45, s43, 29696
    buffer_load_dwordx4 v5, s[20:23], s45 offen sc1 lds
    s_add_u32 s28, s48, 4096
    s_mov_b32 m0, s28
    s_add_u32 s45, s43, 57344
    buffer_load_dwordx4 v5, s[20:23], s45 offen sc1 lds
    s_add_u32 s28, s48, 5120
    s_mov_b32 m0, s28
    s_add_u32 s45, s43, 58368
    buffer_load_dwordx4 v5, s[20:23], s45 offen sc1 lds
    s_add_u32 s28, s48, 6144
    s_mov_b32 m0, s28
    s_add_u32 s45, s43, 86016
    buffer_load_dwordx4 v5, s[20:23], s45 offen sc1 lds
    s_add_u32 s28, s48, 7168
    s_mov_b32 m0, s28
    s_add_u32 s45, s43, 87040
    buffer_load_dwordx4 v5, s[20:23], s45 offen sc1 lds
    s_add_u32 s43, s43, 458752
    s_add_u32 s49, s49, 128
ch1_nov:
    buffer_load_dword v145, v15, s[20:23], s49 offen sc1
    ds_read_b128 v[24:27], v4 offset:3072
    s_waitcnt lgkmcnt(3)
    v_mfma_f32_16x16x32_bf16 v[48:51], v[28:31], a[96:99], v[48:51]
    v_mfma_f32_16x16x32_bf16 v[52:55], v[28:31], a[100:103], v[52:55]
    v_mfma_f32_16x16x32_bf16 v[56:59], v[28:31], a[104:107], v[56:59]
    v_mfma_f32_16x16x32_bf16 v[60:63], v[28:31], a[108:111], v[60:63]
    v_mfma_f32_16x16x32_bf16 v[64:67], v[28:31], a[112:115], v[64:67]
    v_mfma_f32_16x16x32_bf16 v[68:71], v[28:31], a[116:119], v[68:71]
    v_mfma_f32_16x16x32_bf16 v[72:75], v[28:31], a[120:123], v[72:75]
    v_mfma_f32_16x16x32_bf16 v[76:79], v[28:31], a[124:127], v[76:79]
    ds_read_b128 v[28:31], v4 offset:3584
    s_waitcnt lgkmcnt(3)
    v_mfma_f32_16x16x32_bf16 v[48:51], v[16:19], a[128:131], v[48:51]
    v_mfma_f32_16x16x32_bf16 v[52:55], v[16:19], a[132:135], v[52:55]
    v_mfma_f32_16x16x32_bf16 v[56:59], v[16:19], a[136:139], v[56:59]
    v_mfma_f32_16x16x32_bf16 v[60:63], v[16:19], a[140:143], v[60:63]
    v_mfma_f32_16x16x32_bf16 v[64:67], v[16:19], a[144:147], v[64:67]
    v_mfma_f32_16x16x32_bf16 v[68:71], v[16:19], a[148:151], v[68:71]
    v_mfma_f32_16x16x32_bf16 v[72:75], v[16:19], a[152:155], v[72:75]
    v_mfma_f32_16x16x32_bf16 v[76:79], v[16:19], a[156:159], v[76:79]
    ds_read_b128 v[16:19], v4 offset:4096
    s_waitcnt lgkmcnt(3)
    v_mfma_f32_16x16x32_bf16 v[48:51], v[20:23], a[160:163], v[48:51]
    v_mfma_f32_16x16x32_bf16 v[52:55], v[20:23], a[164:167], v[52:55]
    v_mfma_f32_16x16x32_bf16 v[56:59], v[20:23], a[168:171], v[56:59]
    v_mfma_f32_16x16x32_bf16 v[60:63], v[20:23], a[172:175], v[60:63]
    v_mfma_f32_16x16x32_bf16 v[64:67], v[20:23], a[176:179], v[64:67]
    v_mfma_f32_16x16x32_bf16 v[68:71], v[20:23], a[180:183], v[68:71]
    v_mfma_f32_16x16x32_bf16 v[72:75], v[20:23], a[184:187], v[72:75]
    v_mfma_f32_16x16x32_bf16 v[76:79], v[20:23], a[188:191], v[76:79]
    ds_read_b128 v[20:23], v4 offset:4608
    s_waitcnt lgkmcnt(3)
    v_mfma_f32_16x16x32_bf16 v[48:51], v[24:27], a[192:195], v[48:51]
    v_mfma_f32_16x16x32_bf16 v[52:55], v[24:27], a[196:199], v[52:55]
    v_mfma_f32_16x16x32_bf16 v[56:59], v[24:27], a[200:203], v[56:59]
    v_mfma_f32_16x16x32_bf16 v[60:63], v[24:27], a[204:207], v[60:63]
    v_mfma_f32_16x16x32_bf16 v[64:67], v[24:27], a[208:211], v[64:67]
    v_mfma_f32_16x16x32_bf16 v[68:71], v[24:27], a[212:215], v[68:71]
    v_mfma_f32_16x16x32_bf16 v[72:75], v[24:27], a[216:219], v[72:75]
    v_mfma_f32_16x16x32_bf16 v[76:79], v[24:27], a[220:223], v[76:79]
    ds_read_b128 v[24:27], v4 offset:5120
    s_waitcnt lgkmcnt(3)
    v_mfma_f32_16x16x32_bf16 v[48:51], v[28:31], a[224:227], v[48:51]
    v_mfma_f32_16x16x32_bf16 v[52:55], v[28:31], a[228:231], v[52:55]
    v_mfma_f32_16x16x32_bf16 v[56:59], v[28:31], a[232:235], v[56:59]
    v_mfma_f32_16x16x32_bf16 v[60:63], v[28:31], a[236:239], v[60:63]
    v_mfma_f32_16x16x32_bf16 v[64:67], v[28:31], a[240:243], v[64:67]
    v_mfma_f32_16x16x32_bf16 v[68:71], v[28:31], a[244:247], v[68:71]
    v_mfma_f32_16x16x32_bf16 v[72:75], v[28:31], a[248:251], v[72:75]
    v_mfma_f32_16x16x32_bf16 v[76:79], v[28:31], a[252:255], v[76:79]
    ds_read_b128 v[28:31], v4 offset:5632
    s_waitcnt lgkmcnt(3)
    v_mfma_f32_16x16x32_bf16 v[48:51], v[16:19], v[152:155], v[48:51]
    v_mfma_f32_16x16x32_bf16 v[52:55], v[16:19], v[156:159], v[52:55]
    v_mfma_f32_16x16x32_bf16 v[56:59], v[16:19], v[160:163], v[56:59]
    v_mfma_f32_16x16x32_bf16 v[60:63], v[16:19], v[164:167], v[60:63]
    v_mfma_f32_16x16x32_bf16 v[64:67], v[16:19], v[168:171], v[64:67]
    v_mfma_f32_16x16x32_bf16 v[68:71], v[16:19], v[172:175], v[68:71]
    v_mfma_f32_16x16x32_bf16 v[72:75], v[16:19], v[176:179], v[72:75]
    v_mfma_f32_16x16x32_bf16 v[76:79], v[16:19], v[180:183], v[76:79]
    ds_read_b128 v[32:35], v13 offset:0
    ds_read_b128 v[36:39], v13 offset:1024
    ds_read_b128 v[40:43], v13 offset:2048
    ds_read_b128 v[44:47], v13 offset:3072
    ds_read_b128 v[112:115], v13 offset:4096
    ds_read_b128 v[116:119], v13 offset:5120
    ds_read_b128 v[120:123], v13 offset:6144
    ds_read_b128 v[124:127], v13 offset:7168
    ds_read_b128 v[128:131], v13 offset:8192
    ds_read_b128 v[132:135], v13 offset:9216
    ds_read_b128 v[16:19], v4 offset:6144
    s_waitcnt lgkmcnt(13)
    v_mfma_f32_16x16x32_bf16 v[48:51], v[20:23], v[184:187], v[48:51]
    v_mfma_f32_16x16x32_bf16 v[52:55], v[20:23], v[188:191], v[52:55]
    v_mfma_f32_16x16x32_bf16 v[56:59], v[20:23], v[192:195], v[56:59]
    v_mfma_f32_16x16x32_bf16 v[60:63], v[20:23], v[196:199], v[60:63]
    v_mfma_f32_16x16x32_bf16 v[64:67], v[20:23], v[200:203], v[64:67]
    v_mfma_f32_16x16x32_bf16 v[68:71], v[20:23], v[204:207], v[68:71]
    v_mfma_f32_16x16x32_bf16 v[72:75], v[20:23], v[208:211], v[72:75]
    v_mfma_f32_16x16x32_bf16 v[76:79], v[20:23], v[212:215], v[76:79]
    ds_read_b128 v[20:23], v4 offset:6656
    s_waitcnt lgkmcnt(13)
    v_mfma_f32_16x16x32_bf16 v[48:51], v[24:27], v[216:219], v[48:51]
    v_mfma_f32_16x16x32_bf16 v[52:55], v[24:27], v[220:223], v[52:55]
    v_mfma_f32_16x16x32_bf16 v[56:59], v[24:27], v[224:227], v[56:59]
    v_mfma_f32_16x16x32_bf16 v[60:63], v[24:27], v[228:231], v[60:63]
    v_mfma_f32_16x16x32_bf16 v[64:67], v[24:27], v[232:235], v[64:67]
    v_mfma_f32_16x16x32_bf16 v[68:71], v[24:27], v[236:239], v[68:71]
    v_mfma_f32_16x16x32_bf16 v[72:75], v[24:27], v[240:243], v[72:75]
    v_mfma_f32_16x16x32_bf16 v[76:79], v[24:27], v[244:247], v[76:79]
    s_waitcnt lgkmcnt(0)
    v_mfma_f32_16x16x32_bf16 v[48:51], v[28:31], v[248:251], v[48:51]
    v_mfma_f32_16x16x32_bf16 v[52:55], v[28:31], v[252:255], v[52:55]
    v_mfma_f32_16x16x32_bf16 v[56:59], v[28:31], v[32:35], v[56:59]
    ds_read_b128 v[32:35], v13 offset:10240
    v_mfma_f32_16x16x32_bf16 v[60:63], v[28:31], v[36:39], v[60:63]
    ds_read_b128 v[36:39], v13 offset:11264
    v_mfma_f32_16x16x32_bf16 v[64:67], v[28:31], v[40:43], v[64:67]
    ds_read_b128 v[40:43], v13 offset:12288
    v_mfma_f32_16x16x32_bf16 v[68:71], v[28:31], v[44:47], v[68:71]
    ds_read_b128 v[44:47], v13 offset:13312
    v_mfma_f32_16x16x32_bf16 v[72:75], v[28:31], v[112:115], v[72:75]
    ds_read_b128 v[112:115], v13 offset:14336
    v_mfma_f32_16x16x32_bf16 v[76:79], v[28:31], v[116:119], v[76:79]
    ds_read_b128 v[116:119], v13 offset:15360
    v_mfma_f32_16x16x32_bf16 v[48:51], v[16:19], v[120:123], v[48:51]
    ds_read_b128 v[120:123], v13 offset:16384
    v_mfma_f32_16x16x32_bf16 v[52:55], v[16:19], v[124:127], v[52:55]
    ds_read_b128 v[124:127], v13 offset:17408
    v_mfma_f32_16x16x32_bf16 v[56:59], v[16:19], v[128:131], v[56:59]
    ds_read_b128 v[128:131], v13 offset:18432
    v_mfma_f32_16x16x32_bf16 v[60:63], v[16:19], v[132:135], v[60:63]
    ds_read_b128 v[132:135], v13 offset:19456
    s_waitcnt lgkmcnt(9)
    v_mfma_f32_16x16x32_bf16 v[64:67], v[16:19], v[32:35], v[64:67]
    ds_read_b128 v[32:35], v13 offset:20480
    s_waitcnt lgkmcnt(9)
    v_mfma_f32_16x16x32_bf16 v[68:71], v[16:19], v[36:39], v[68:71]
    ds_read_b128 v[36:39], v13 offset:21504
    s_waitcnt lgkmcnt(9)
    v_mfma_f32_16x16x32_bf16 v[72:75], v[16:19], v[40:43], v[72:75]
    s_waitcnt lgkmcnt(8)
    v_mfma_f32_16x16x32_bf16 v[76:79], v[16:19], v[44:47], v[76:79]
    s_waitcnt lgkmcnt(7)
    v_mfma_f32_16x16x32_bf16 v[48:51], v[20:23], v[112:115], v[48:51]
    s_waitcnt lgkmcnt(6)
    v_mfma_f32_16x16x32_bf16 v[52:55], v[20:23], v[116:119], v[52:55]
    s_waitcnt lgkmcnt(5)
    v_mfma_f32_16x16x32_bf16 v[56:59], v[20:23], v[120:123], v[56:59]
    s_waitcnt lgkmcnt(4)
    v_mfma_f32_16x16x32_bf16 v[60:63], v[20:23], v[124:127], v[60:63]
    s_waitcnt lgkmcnt(3)
    v_mfma_f32_16x16x32_bf16 v[64:67], v[20:23], v[128:131], v[64:67]
    s_waitcnt lgkmcnt(2)
    v_mfma_f32_16x16x32_bf16 v[68:71], v[20:23], v[132:135], v[68:71]
    s_waitcnt lgkmcnt(1)
    v_mfma_f32_16x16x32_bf16 v[72:75], v[20:23], v[32:35], v[72:75]
    s_waitcnt lgkmcnt(0)
    v_mfma_f32_16x16x32_bf16 v[76:79], v[20:23], v[36:39], v[76:79]
    s_nop 7
    v_cvt_pk_bf16_f32 v48, v48, v49
    v_cvt_pk_bf16_f32 v49, v50, v51
    v_cvt_pk_bf16_f32 v50, v52, v53
    v_cvt_pk_bf16_f32 v51, v54, v55
    v_cvt_pk_bf16_f32 v52, v56, v57
    v_cvt_pk_bf16_f32 v53, v58, v59
    v_cvt_pk_bf16_f32 v54, v60, v61
    v_cvt_pk_bf16_f32 v55, v62, v63
    v_cvt_pk_bf16_f32 v56, v64, v65
    v_cvt_pk_bf16_f32 v57, v66, v67
    v_cvt_pk_bf16_f32 v58, v68, v69
    v_cvt_pk_bf16_f32 v59, v70, v71
    v_cvt_pk_bf16_f32 v60, v72, v73
    v_cvt_pk_bf16_f32 v61, v74, v75
    v_cvt_pk_bf16_f32 v62, v76, v77
    v_cvt_pk_bf16_f32 v63, v78, v79
    ds_write_b64 v146, v[48:49] offset:0
    ds_write_b64 v146, v[50:51] offset:512
    ds_write_b64 v146, v[52:53] offset:1024
    ds_write_b64 v146, v[54:55] offset:1536
    ds_write_b64 v146, v[56:57] offset:2048
    ds_write_b64 v146, v[58:59] offset:2560
    ds_write_b64 v146, v[60:61] offset:3072
    ds_write_b64 v146, v[62:63] offset:3584
ch1_ppoll:
    buffer_load_dwordx4 v[112:115], v7, s[20:23], s41 offen offset:0 sc1
    buffer_load_dwordx2 v[116:117], v8, s[20:23], s41 offen offset:0 sc1
    buffer_load_dwordx4 v[118:121], v7, s[20:23], s41 offen offset:1024 sc1
    buffer_load_dwordx2 v[122:123], v8, s[20:23], s41 offen offset:1024 sc1
    buffer_load_dwordx4 v[124:127], v7, s[20:23], s41 offen offset:2048 sc1
    buffer_load_dwordx2 v[128:129], v8, s[20:23], s41 offen offset:2048 sc1
    buffer_load_dwordx4 v[130:133], v7, s[20:23], s41 offen offset:3072 sc1
    buffer_load_dwordx2 v[134:135], v8, s[20:23], s41 offen offset:3072 sc1
    s_waitcnt vmcnt(0)
    v_max3_u32 v14, v112, v113, v114
    v_max3_u32 v14, v14, v115, v116
    v_max3_u32 v14, v14, v117, v118
    v_max3_u32 v14, v14, v119, v120
    v_max3_u32 v14, v14, v121, v122
    v_max3_u32 v14, v14, v123, v124
    v_max3_u32 v14, v14, v125, v126
    v_max3_u32 v14, v14, v127, v128
    v_max3_u32 v14, v14, v129, v130
    v_max3_u32 v14, v14, v131, v132
    v_max3_u32 v14, v14, v133, v134
    v_max_u32 v14, v14, v135
    v_cmp_eq_u32 vcc, -1, v14
    s_cbranch_vccnz ch1_ppoll
    v_mfma_f32_16x16x32_bf16 v[64:67], v[80:83], v[112:115], 0
    v_mfma_f32_16x16x16_bf16 v[68:71], v[48:49], v[116:117], 0
    v_mfma_f32_16x16x32_bf16 v[72:75], v[84:87], v[112:115], 0
    v_mfma_f32_16x16x16_bf16 v[76:79], v[50:51], v[116:117], 0
    v_mfma_f32_16x16x32_bf16 v[64:67], v[88:91], v[118:121], v[64:67]
    v_mfma_f32_16x16x16_bf16 v[68:71], v[52:53], v[122:123], v[68:71]
    v_mfma_f32_16x16x32_bf16 v[72:75], v[92:95], v[118:121], v[72:75]
    v_mfma_f32_16x16x16_bf16 v[76:79], v[54:55], v[122:123], v[76:79]
    v_mfma_f32_16x16x32_bf16 v[64:67], v[96:99], v[124:127], v[64:67]
    v_mfma_f32_16x16x16_bf16 v[68:71], v[56:57], v[128:129], v[68:71]
    v_mfma_f32_16x16x32_bf16 v[72:75], v[100:103], v[124:127], v[72:75]
    v_mfma_f32_16x16x16_bf16 v[76:79], v[58:59], v[128:129], v[76:79]
    v_mfma_f32_16x16x32_bf16 v[64:67], v[104:107], v[130:133], v[64:67]
    v_mfma_f32_16x16x16_bf16 v[68:71], v[60:61], v[134:135], v[68:71]
    v_mfma_f32_16x16x32_bf16 v[72:75], v[108:111], v[130:133], v[72:75]
    v_mfma_f32_16x16x16_bf16 v[76:79], v[62:63], v[134:135], v[76:79]
    s_nop 7
    s_nop 1
    v_add_f32 v64, v64, v68
    v_add_f32 v65, v65, v69
    v_add_f32 v66, v66, v70
    v_add_f32 v67, v67, v71
    v_add_f32 v72, v72, v76
    v_add_f32 v73, v73, v77
    v_add_f32 v74, v74, v78
    v_add_f32 v75, v75, v79
    ds_write_b128 v12, v[64:67]
    ds_write_b128 v12, v[72:75] offset:1024
    s_waitcnt lgkmcnt(0)
    s_barrier
    s_cmp_ge_u32 s3, 2
    s_cbranch_scc1 ch1_unext
    s_lshl_b32 s45, s3, 10
    v_add_u32 v14, s45, v11
    ds_read_b128 v[16:19], v14
    ds_read_b128 v[20:23], v14 offset:2048
    ds_read_b128 v[24:27], v14 offset:4096
    ds_read_b128 v[28:31], v14 offset:6144
    s_lshl_b32 s45, s3, 8
    s_add_u32 s46, s75, s45
    s_add_u32 s47, s76, s45
    s_waitcnt lgkmcnt(0)
    v_add_f32 v16, v16, v20
    v_add_f32 v24, v24, v28
    v_add_f32 v17, v17, v21
    v_add_f32 v25, v25, v29
    v_add_f32 v18, v18, v22
    v_add_f32 v26, v26, v30
    v_add_f32 v19, v19, v23
    v_add_f32 v27, v27, v31
    v_add_f32 v16, v16, v24
    v_add_f32 v17, v17, v25
    v_add_f32 v18, v18, v26
    v_add_f32 v19, v19, v27
    v_cvt_pk_bf16_f32 v16, v16, v17
    v_cvt_pk_bf16_f32 v17, v18, v19
    s_mov_b64 exec, s[30:31]
    buffer_store_dwordx2 v[16:17], v9, s[20:23], s46 offen
    s_mov_b64 exec, -1
    v_mov_b32 v148, v16
    v_mov_b32 v149, v17
ch1_unext:
    s_cmp_eq_u32 s51, 1
    s_cbranch_scc1 ch1_vok
mega_kernel_vw34:
    buffer_load_dword v145, v15, s[20:23], s49 offen sc1
    s_waitcnt vmcnt(0)
    v_readfirstlane_b32 s71, v145
    s_cmp_ge_u32 s71, 28
    s_cbranch_scc0 mega_kernel_vw34
    s_add_u32 s28, s48, 0
    s_mov_b32 m0, s28
    s_add_u32 s45, s43, 0
    buffer_load_dwordx4 v5, s[20:23], s45 offen sc1 lds
    s_add_u32 s28, s48, 1024
    s_mov_b32 m0, s28
    s_add_u32 s45, s43, 1024
    buffer_load_dwordx4 v5, s[20:23], s45 offen sc1 lds
    s_add_u32 s28, s48, 2048
    s_mov_b32 m0, s28
    s_add_u32 s45, s43, 28672
    buffer_load_dwordx4 v5, s[20:23], s45 offen sc1 lds
    s_add_u32 s28, s48, 3072
    s_mov_b32 m0, s28
    s_add_u32 s45, s43, 29696
    buffer_load_dwordx4 v5, s[20:23], s45 offen sc1 lds
    s_add_u32 s28, s48, 4096
    s_mov_b32 m0, s28
    s_add_u32 s45, s43, 57344
    buffer_load_dwordx4 v5, s[20:23], s45 offen sc1 lds
    s_add_u32 s28, s48, 5120
    s_mov_b32 m0, s28
    s_add_u32 s45, s43, 58368
    buffer_load_dwordx4 v5, s[20:23], s45 offen sc1 lds
    s_add_u32 s28, s48, 6144
    s_mov_b32 m0, s28
    s_add_u32 s45, s43, 86016
    buffer_load_dwordx4 v5, s[20:23], s45 offen sc1 lds
    s_add_u32 s28, s48, 7168
    s_mov_b32 m0, s28
    s_add_u32 s45, s43, 87040
    buffer_load_dwordx4 v5, s[20:23], s45 offen sc1 lds
    s_add_u32 s43, s43, 458752
    s_add_u32 s49, s49, 128
    buffer_load_dword v145, v15, s[20:23], s49 offen sc1
    s_waitcnt vmcnt(0)
ch1_vok:
    s_barrier
    s_add_u32 s40, s40, 7168
    s_add_u32 s75, s75, 7168
    s_add_u32 s76, s76, 7168
    s_add_u32 s41, s41, 16384
    s_add_u32 s42, s42, 1
    s_cmp_lt_u32 s42, 64
    s_cbranch_scc1 ch1_uloop
    s_mov_b32 s73, 62
    s_cmp_lg_u32 s3, 0
    s_cbranch_scc1 mega_kernel_sg35
    s_lshl_b32 s70, s73, 7
    s_add_u32 s70, s70, 167600128
    v_mov_b32 v14, 1
    v_mov_b32 v15, 0
    s_mov_b64 exec, 1
    buffer_atomic_add v14, v15, s[20:23], s70 offen sc1
    s_mov_b64 exec, -1
mega_kernel_sg35:
    ds_read_b64 v[112:113], v146 offset:0
    ds_read_b64 v[114:115], v146 offset:512
    ds_read_b64 v[116:117], v146 offset:1024
    ds_read_b64 v[118:119], v146 offset:1536
    ds_read_b64 v[120:121], v146 offset:2048
    ds_read_b64 v[122:123], v146 offset:2560
    ds_read_b64 v[124:125], v146 offset:3072
    ds_read_b64 v[126:127], v146 offset:3584
    s_waitcnt lgkmcnt(0)
    v_permlane16_swap_b32 v112, v114
    v_permlane16_swap_b32 v113, v115
    v_permlane16_swap_b32 v116, v118
    v_permlane16_swap_b32 v117, v119
    v_permlane16_swap_b32 v120, v122
    v_permlane16_swap_b32 v121, v123
    v_permlane16_swap_b32 v124, v126
    v_permlane16_swap_b32 v125, v127
    s_mov_b64 exec, s[32:33]
    s_mov_b32 s45, s44
    buffer_store_dwordx4 v[112:115], v10, s[20:23], s45 offen sc1
    s_add_u32 s45, s45, 7168
    buffer_store_dwordx4 v[116:119], v10, s[20:23], s45 offen sc1
    s_add_u32 s45, s45, 7168
    buffer_store_dwordx4 v[120:123], v10, s[20:23], s45 offen sc1
    s_add_u32 s45, s45, 7168
    buffer_store_dwordx4 v[124:127], v10, s[20:23], s45 offen sc1
    s_mov_b64 exec, -1
    s_add_u32 s44, s44, 114688
    s_mov_b32 s73, 63
    s_waitcnt vmcnt(0)
    s_barrier
    s_cmp_lg_u32 s3, 0
    s_cbranch_scc1 mega_kernel_sg36
    s_lshl_b32 s70, s73, 7
    s_add_u32 s70, s70, 167600128
    v_mov_b32 v14, 1
    v_mov_b32 v15, 0
    s_mov_b64 exec, 1
    buffer_atomic_add v14, v15, s[20:23], s70 offen sc1
    s_mov_b64 exec, -1
mega_kernel_sg36:
    s_endpgm
gm_start:
    s_add_u32 s2, s2, 28
    v_mul_u32_u24 v5, 896, v2
    v_lshl_add_u32 v5, v3, 4, v5
    s_lshl_b32 s24, s2, 8
    s_lshl_b32 s25, s3, 6
    s_add_u32 s24, s24, s25
    s_mul_i32 s25, s24, 896
    s_add_u32 s25, s25, 5275648
    v_lshlrev_b32 v12, 4, v1
    v_add_u32 v13, 4096, v12
    v_add_u32 v14, 8192, v12
    v_add_u32 v15, 12288, v12
    buffer_load_dwordx4 a[0:3], v12, s[20:23], s25 offen offset:0
    buffer_load_dwordx4 a[4:7], v12, s[20:23], s25 offen offset:1024
    buffer_load_dwordx4 a[8:11], v12, s[20:23], s25 offen offset:2048
    buffer_load_dwordx4 a[12:15], v12, s[20:23], s25 offen offset:3072
    buffer_load_dwordx4 a[16:19], v13, s[20:23], s25 offen offset:0
    buffer_load_dwordx4 a[20:23], v13, s[20:23], s25 offen offset:1024
    buffer_load_dwordx4 a[24:27], v13, s[20:23], s25 offen offset:2048
    buffer_load_dwordx4 a[28:31], v13, s[20:23], s25 offen offset:3072
    buffer_load_dwordx4 a[32:35], v14, s[20:23], s25 offen offset:0
    buffer_load_dwordx4 a[36:39], v14, s[20:23], s25 offen offset:1024
    buffer_load_dwordx4 a[40:43], v14, s[20:23], s25 offen offset:2048
    buffer_load_dwordx4 a[44:47], v14, s[20:23], s25 offen offset:3072
    buffer_load_dwordx4 a[48:51], v15, s[20:23], s25 offen offset:0
    buffer_load_dwordx4 a[52:55], v15, s[20:23], s25 offen offset:1024
    s_add_u32 s25, s25, 14336
    buffer_load_dwordx4 a[56:59], v12, s[20:23], s25 offen offset:0
    buffer_load_dwordx4 a[60:63], v12, s[20:23], s25 offen offset:1024
    buffer_load_dwordx4 a[64:67], v12, s[20:23], s25 offen offset:2048
    buffer_load_dwordx4 a[68:71], v12, s[20:23], s25 offen offset:3072
    buffer_load_dwordx4 a[72:75], v13, s[20:23], s25 offen offset:0
    buffer_load_dwordx4 a[76:79], v13, s[20:23], s25 offen offset:1024
    buffer_load_dwordx4 a[80:83], v13, s[20:23], s25 offen offset:2048
    buffer_load_dwordx4 a[84:87], v13, s[20:23], s25 offen offset:3072
    buffer_load_dwordx4 a[88:91], v14, s[20:23], s25 offen offset:0
    buffer_load_dwordx4 a[92:95], v14, s[20:23], s25 offen offset:1024
    buffer_load_dwordx4 a[96:99], v14, s[20:23], s25 offen offset:2048
    buffer_load_dwordx4 a[100:103], v14, s[20:23], s25 offen offset:3072
    buffer_load_dwordx4 a[104:107], v15, s[20:23], s25 offen offset:0
    buffer_load_dwordx4 a[108:111], v15, s[20:23], s25 offen offset:1024
    s_add_u32 s25, s25, 14336
    buffer_load_dwordx4 a[112:115], v12, s[20:23], s25 offen offset:0
    buffer_load_dwordx4 a[116:119], v12, s[20:23], s25 offen offset:1024
    buffer_load_dwordx4 a[120:123], v12, s[20:23], s25 offen offset:2048
    buffer_load_dwordx4 a[124:127], v12, s[20:23], s25 offen offset:3072
    buffer_load_dwordx4 a[128:131], v13, s[20:23], s25 offen offset:0
    buffer_load_dwordx4 a[132:135], v13, s[20:23], s25 offen offset:1024
    buffer_load_dwordx4 a[136:139], v13, s[20:23], s25 offen offset:2048
    buffer_load_dwordx4 a[140:143], v13, s[20:23], s25 offen offset:3072
    buffer_load_dwordx4 a[144:147], v14, s[20:23], s25 offen offset:0
    buffer_load_dwordx4 a[148:151], v14, s[20:23], s25 offen offset:1024
    buffer_load_dwordx4 a[152:155], v14, s[20:23], s25 offen offset:2048
    buffer_load_dwordx4 a[156:159], v14, s[20:23], s25 offen offset:3072
    buffer_load_dwordx4 a[160:163], v15, s[20:23], s25 offen offset:0
    buffer_load_dwordx4 a[164:167], v15, s[20:23], s25 offen offset:1024
    s_add_u32 s25, s25, 14336
    buffer_load_dwordx4 a[168:171], v12, s[20:23], s25 offen offset:0
    buffer_load_dwordx4 a[172:175], v12, s[20:23], s25 offen offset:1024
    buffer_load_dwordx4 a[176:179], v12, s[20:23], s25 offen offset:2048
    buffer_load_dwordx4 a[180:183], v12, s[20:23], s25 offen offset:3072
    buffer_load_dwordx4 a[184:187], v13, s[20:23], s25 offen offset:0
    buffer_load_dwordx4 a[188:191], v13, s[20:23], s25 offen offset:1024
    buffer_load_dwordx4 a[192:195], v13, s[20:23], s25 offen offset:2048
    buffer_load_dwordx4 a[196:199], v13, s[20:23], s25 offen offset:3072
    buffer_load_dwordx4 a[200:203], v14, s[20:23], s25 offen offset:0
    buffer_load_dwordx4 a[204:207], v14, s[20:23], s25 offen offset:1024
    buffer_load_dwordx4 a[208:211], v14, s[20:23], s25 offen offset:2048
    buffer_load_dwordx4 a[212:215], v14, s[20:23], s25 offen offset:3072
    buffer_load_dwordx4 a[216:219], v15, s[20:23], s25 offen offset:0
    buffer_load_dwordx4 a[220:223], v15, s[20:23], s25 offen offset:1024
    s_mov_b32 s34, -1
    s_mov_b32 s35, 0x00ffffff
    v_lshlrev_b32 v6, 4, v1
    s_mul_i32 s46, s3, 7296
    v_mul_u32_u24 v5, 912, v2
    v_lshl_add_u32 v5, v3, 4, v5
    v_mov_b32 v15, 0
    s_mov_b32 s52, 0
    s_cmp_ge_u32 s2, 28
    s_cbranch_scc1 gm_vo
    v_mul_u32_u24 v7, 14336, v2
    v_and_b32 v8, 1, v3
    v_lshl_add_u32 v7, v8, 5, v7
    v_lshrrev_b32 v8, 1, v3
    v_lshl_add_u32 v7, v8, 4, v7
    s_lshl_b32 s26, s24, 1
gma_layer:
    s_mul_i32 s43, s52, 1835008
    s_add_u32 s43, s43, 31752192
    s_mul_i32 s44, s52, 66060288
    s_add_u32 s44, s44, 35422208
    s_mul_i32 s53, s52, 8192
    s_add_u32 s53, s53, 167632896
    s_mul_i32 s25, s3, 7168
    s_add_u32 s43, s43, s25
    s_add_u32 s44, s44, s26
    s_mov_b32 s42, 0
    s_mov_b32 s47, 0
    s_mov_b32 s51, 29184
    s_mov_b32 s54, 58368
    s_waitcnt vmcnt(0)
    s_barrier
    s_cmp_eq_u32 s52, 0
    s_cbranch_scc1 mega_kernel_nw37
    s_cmp_lg_u32 s3, 0
    s_cbranch_scc1 mega_kernel_wd39
    s_lshl_b32 s70, s42, 7
    s_add_u32 s70, s70, 167567360
mega_kernel_wc38:
    buffer_load_dword v14, v15, s[20:23], s70 offen sc1
    s_waitcnt vmcnt(0)
    v_readfirstlane_b32 s71, v14
    s_cmp_ge_u32 s71, 2
    s_cbranch_scc1 mega_kernel_wd39
    s_sleep 6
    s_branch mega_kernel_wc38
mega_kernel_wd39:
    s_barrier
mega_kernel_nw37:
    s_mov_b64 exec, s[34:35]
    s_add_u32 s48, s46, s47
    s_mov_b32 s49, s43
    s_mov_b32 m0, s48
    s_nop 0
    buffer_load_dwordx4 v6, s[20:23], s49 offen sc1 lds
    s_add_u32 s48, s48, 912
    s_add_u32 s49, s49, 896
    s_mov_b32 m0, s48
    s_nop 0
    buffer_load_dwordx4 v6, s[20:23], s49 offen sc1 lds
    s_add_u32 s48, s48, 912
    s_add_u32 s49, s49, 896
    s_mov_b32 m0, s48
    s_nop 0
    buffer_load_dwordx4 v6, s[20:23], s49 offen sc1 lds
    s_add_u32 s48, s48, 912
    s_add_u32 s49, s49, 896
    s_mov_b32 m0, s48
    s_nop 0
    buffer_load_dwordx4 v6, s[20:23], s49 offen sc1 lds
    s_add_u32 s48, s48, 912
    s_add_u32 s49, s49, 896
    s_mov_b32 m0, s48
    s_nop 0
    buffer_load_dwordx4 v6, s[20:23], s49 offen sc1 lds
    s_add_u32 s48, s48, 912
    s_add_u32 s49, s49, 896
    s_mov_b32 m0, s48
    s_nop 0
    buffer_load_dwordx4 v6, s[20:23], s49 offen sc1 lds
    s_add_u32 s48, s48, 912
    s_add_u32 s49, s49, 896
    s_mov_b32 m0, s48
    s_nop 0
    buffer_load_dwordx4 v6, s[20:23], s49 offen sc1 lds
    s_add_u32 s48, s48, 912
    s_add_u32 s49, s49, 896
    s_mov_b32 m0, s48
    s_nop 0
    buffer_load_dwordx4 v6, s[20:23], s49 offen sc1 lds
    s_mov_b64 exec, -1
    s_add_u32 s43, s43, 28672
    s_mov_b32 s72, 1
    s_cmp_eq_u32 s52, 0
    s_cbranch_scc1 mega_kernel_nw40
    s_cmp_lg_u32 s3, 0
    s_cbranch_scc1 mega_kernel_wd42
    s_lshl_b32 s70, s72, 7
    s_add_u32 s70, s70, 167567360
mega_kernel_wc41:
    buffer_load_dword v14, v15, s[20:23], s70 offen sc1
    s_waitcnt vmcnt(0)
    v_readfirstlane_b32 s71, v14
    s_cmp_ge_u32 s71, 2
    s_cbranch_scc1 mega_kernel_wd42
    s_sleep 6
    s_branch mega_kernel_wc41
mega_kernel_wd42:
    s_barrier
mega_kernel_nw40:
    s_waitcnt vmcnt(0)
    s_mov_b64 exec, s[34:35]
    s_add_u32 s48, s46, s51
    s_mov_b32 s49, s43
    s_mov_b32 m0, s48
    s_nop 0
    buffer_load_dwordx4 v6, s[20:23], s49 offen sc1 lds
    s_add_u32 s48, s48, 912
    s_add_u32 s49, s49, 896
    s_mov_b32 m0, s48
    s_nop 0
    buffer_load_dwordx4 v6, s[20:23], s49 offen sc1 lds
    s_add_u32 s48, s48, 912
    s_add_u32 s49, s49, 896
    s_mov_b32 m0, s48
    s_nop 0
    buffer_load_dwordx4 v6, s[20:23], s49 offen sc1 lds
    s_add_u32 s48, s48, 912
    s_add_u32 s49, s49, 896
    s_mov_b32 m0, s48
    s_nop 0
    buffer_load_dwordx4 v6, s[20:23], s49 offen sc1 lds
    s_add_u32 s48, s48, 912
    s_add_u32 s49, s49, 896
    s_mov_b32 m0, s48
    s_nop 0
    buffer_load_dwordx4 v6, s[20:23], s49 offen sc1 lds
    s_add_u32 s48, s48, 912
    s_add_u32 s49, s49, 896
    s_mov_b32 m0, s48
    s_nop 0
    buffer_load_dwordx4 v6, s[20:23], s49 offen sc1 lds
    s_add_u32 s48, s48, 912
    s_add_u32 s49, s49, 896
    s_mov_b32 m0, s48
    s_nop 0
    buffer_load_dwordx4 v6, s[20:23], s49 offen sc1 lds
    s_add_u32 s48, s48, 912
    s_add_u32 s49, s49, 896
    s_mov_b32 m0, s48
    s_nop 0
    buffer_load_dwordx4 v6, s[20:23], s49 offen sc1 lds
    s_mov_b64 exec, -1
    s_add_u32 s43, s43, 28672
gma_loop:
    s_lshl_b32 s67, s52, 6
    s_add_u32 s67, s67, s42
    s_waitcnt vmcnt(12)
    s_cmp_lt_u32 s42, 63
    s_cbranch_scc1 gma_w1
    s_waitcnt vmcnt(0)
gma_w1:
    s_barrier
    s_cmp_lt_u32 s42, 4
    s_cbranch_scc1 mega_kernel_ns43
    s_cmp_lg_u32 s3, 0
    s_cbranch_scc1 mega_kernel_ns43
    s_sub_u32 s70, s42, 2
    s_lshl_b32 s70, s70, 7
    s_add_u32 s70, s70, s53
    v_mov_b32 v14, 1
    s_mov_b64 exec, 1
    buffer_atomic_add v14, v15, s[20:23], s70 offen sc1
    s_mov_b64 exec, -1
mega_kernel_ns43:
    s_cmp_ge_u32 s42, 62
    s_cbranch_scc1 gma_nodma
    s_add_u32 s72, s42, 2
    s_cmp_eq_u32 s52, 0
    s_cbranch_scc1 mega_kernel_nw44
    s_cmp_lg_u32 s3, 0
    s_cbranch_scc1 mega_kernel_wd46
    s_lshl_b32 s70, s72, 7
    s_add_u32 s70, s70, 167567360
mega_kernel_wc45:
    buffer_load_dword v14, v15, s[20:23], s70 offen sc1
    s_waitcnt vmcnt(0)
    v_readfirstlane_b32 s71, v14
    s_cmp_ge_u32 s71, 2
    s_cbranch_scc1 mega_kernel_wd46
    s_sleep 6
    s_branch mega_kernel_wc45
mega_kernel_wd46:
    s_barrier
mega_kernel_nw44:
    s_mov_b64 exec, s[34:35]
    s_add_u32 s48, s46, s54
    s_mov_b32 s49, s43
    s_mov_b32 m0, s48
    s_nop 0
    buffer_load_dwordx4 v6, s[20:23], s49 offen sc1 lds
    s_add_u32 s48, s48, 912
    s_add_u32 s49, s49, 896
    s_mov_b32 m0, s48
    s_nop 0
    buffer_load_dwordx4 v6, s[20:23], s49 offen sc1 lds
    s_add_u32 s48, s48, 912
    s_add_u32 s49, s49, 896
    s_mov_b32 m0, s48
    s_nop 0
    buffer_load_dwordx4 v6, s[20:23], s49 offen sc1 lds
    s_add_u32 s48, s48, 912
    s_add_u32 s49, s49, 896
    s_mov_b32 m0, s48
    s_nop 0
    buffer_load_dwordx4 v6, s[20:23], s49 offen sc1 lds
    s_add_u32 s48, s48, 912
    s_add_u32 s49, s49, 896
    s_mov_b32 m0, s48
    s_nop 0
    buffer_load_dwordx4 v6, s[20:23], s49 offen sc1 lds
    s_add_u32 s48, s48, 912
    s_add_u32 s49, s49, 896
    s_mov_b32 m0, s48
    s_nop 0
    buffer_load_dwordx4 v6, s[20:23], s49 offen sc1 lds
    s_add_u32 s48, s48, 912
    s_add_u32 s49, s49, 896
    s_mov_b32 m0, s48
    s_nop 0
    buffer_load_dwordx4 v6, s[20:23], s49 offen sc1 lds
    s_add_u32 s48, s48, 912
    s_add_u32 s49, s49, 896
    s_mov_b32 m0, s48
    s_nop 0
    buffer_load_dwordx4 v6, s[20:23], s49 offen sc1 lds
    s_mov_b64 exec, -1
    s_add_u32 s43, s43, 28672
gma_nodma:
    v_add_u32 v49, s47, v5
    v_add_u32 v50, 14592, v49
    ds_read_b128 v[16:19], v49 offset:0
    ds_read_b128 v[20:23], v50 offset:0
    ds_read_b128 v[24:27], v49 offset:64
    ds_read_b128 v[28:31], v50 offset:64
    ds_read_b128 v[32:35], v49 offset:128
    ds_read_b128 v[36:39], v50 offset:128
    ds_read_b128 v[40:43], v49 offset:192
    ds_read_b128 v[44:47], v50 offset:192
    s_waitcnt lgkmcnt(6)
    v_mfma_f32_16x16x32_bf16 v[64:67], a[0:3], v[16:19], 0
    v_mfma_f32_16x16x32_bf16 v[68:71], a[56:59], v[16:19], 0
    v_mfma_f32_16x16x32_bf16 v[72:75], a[112:115], v[16:19], 0
    v_mfma_f32_16x16x32_bf16 v[76:79], a[168:171], v[16:19], 0
    v_mfma_f32_16x16x32_bf16 v[80:83], a[0:3], v[20:23], 0
    v_mfma_f32_16x16x32_bf16 v[84:87], a[56:59], v[20:23], 0
    v_mfma_f32_16x16x32_bf16 v[88:91], a[112:115], v[20:23], 0
    v_mfma_f32_16x16x32_bf16 v[92:95], a[168:171], v[20:23], 0
    ds_read_b128 v[16:19], v49 offset:256
    ds_read_b128 v[20:23], v50 offset:256
    s_waitcnt lgkmcnt(6)
    v_mfma_f32_16x16x32_bf16 v[64:67], a[4:7], v[24:27], v[64:67]
    v_mfma_f32_16x16x32_bf16 v[68:71], a[60:63], v[24:27], v[68:71]
    v_mfma_f32_16x16x32_bf16 v[72:75], a[116:119], v[24:27], v[72:75]
    v_mfma_f32_16x16x32_bf16 v[76:79], a[172:175], v[24:27], v[76:79]
    v_mfma_f32_16x16x32_bf16 v[80:83], a[4:7], v[28:31], v[80:83]
    v_mfma_f32_16x16x32_bf16 v[84:87], a[60:63], v[28:31], v[84:87]
    v_mfma_f32_16x16x32_bf16 v[88:91], a[116:119], v[28:31], v[88:91]
    v_mfma_f32_16x16x32_bf16 v[92:95], a[172:175], v[28:31], v[92:95]
    ds_read_b128 v[24:27], v49 offset:320
    ds_read_b128 v[28:31], v50 offset:320
    s_waitcnt lgkmcnt(6)
    v_mfma_f32_16x16x32_bf16 v[64:67], a[8:11], v[32:35], v[64:67]
    v_mfma_f32_16x16x32_bf16 v[68:71], a[64:67], v[32:35], v[68:71]
    v_mfma_f32_16x16x32_bf16 v[72:75], a[120:123], v[32:35], v[72:75]
    v_mfma_f32_16x16x32_bf16 v[76:79], a[176:179], v[32:35], v[76:79]
    v_mfma_f32_16x16x32_bf16 v[80:83], a[8:11], v[36:39], v[80:83]
    v_mfma_f32_16x16x32_bf16 v[84:87], a[64:67], v[36:39], v[84:87]
    v_mfma_f32_16x16x32_bf16 v[88:91], a[120:123], v[36:39], v[88:91]
    v_mfma_f32_16x16x32_bf16 v[92:95], a[176:179], v[36:39], v[92:95]
    ds_read_b128 v[32:35], v49 offset:384
    ds_read_b128 v[36:39], v50 offset:384
    s_waitcnt lgkmcnt(6)
    v_mfma_f32_16x16x32_bf16 v[64:67], a[12:15], v[40:43], v[64:67]
    v_mfma_f32_16x16x32_bf16 v[68:71], a[68:71], v[40:43], v[68:71]
    v_mfma_f32_16x16x32_bf16 v[72:75], a[124:127], v[40:43], v[72:75]
    v_mfma_f32_16x16x32_bf16 v[76:79], a[180:183], v[40:43], v[76:79]
    v_mfma_f32_16x16x32_bf16 v[80:83], a[12:15], v[44:47], v[80:83]
    v_mfma_f32_16x16x32_bf16 v[84:87], a[68:71], v[44:47], v[84:87]
    v_mfma_f32_16x16x32_bf16 v[88:91], a[124:127], v[44:47], v[88:91]
    v_mfma_f32_16x16x32_bf16 v[92:95], a[180:183], v[44:47], v[92:95]
    ds_read_b128 v[40:43], v49 offset:448
    ds_read_b128 v[44:47], v50 offset:448
    s_waitcnt lgkmcnt(6)
    v_mfma_f32_16x16x32_bf16 v[64:67], a[16:19], v[16:19], v[64:67]
    v_mfma_f32_16x16x32_bf16 v[68:71], a[72:75], v[16:19], v[68:71]
    v_mfma_f32_16x16x32_bf16 v[72:75], a[128:131], v[16:19], v[72:75]
    v_mfma_f32_16x16x32_bf16 v[76:79], a[184:187], v[16:19], v[76:79]
    v_mfma_f32_16x16x32_bf16 v[80:83], a[16:19], v[20:23], v[80:83]
    v_mfma_f32_16x16x32_bf16 v[84:87], a[72:75], v[20:23], v[84:87]
    v_mfma_f32_16x16x32_bf16 v[88:91], a[128:131], v[20:23], v[88:91]
    v_mfma_f32_16x16x32_bf16 v[92:95], a[184:187], v[20:23], v[92:95]
    ds_read_b128 v[16:19], v49 offset:512
    ds_read_b128 v[20:23], v50 offset:512
    s_waitcnt lgkmcnt(6)
    v_mfma_f32_16x16x32_bf16 v[64:67], a[20:23], v[24:27], v[64:67]
    v_mfma_f32_16x16x32_bf16 v[68:71], a[76:79], v[24:27], v[68:71]
    v_mfma_f32_16x16x32_bf16 v[72:75], a[132:135], v[24:27], v[72:75]
    v_mfma_f32_16x16x32_bf16 v[76:79], a[188:191], v[24:27], v[76:79]
    v_mfma_f32_16x16x32_bf16 v[80:83], a[20:23], v[28:31], v[80:83]
    v_mfma_f32_16x16x32_bf16 v[84:87], a[76:79], v[28:31], v[84:87]
    v_mfma_f32_16x16x32_bf16 v[88:91], a[132:135], v[28:31], v[88:91]
    v_mfma_f32_16x16x32_bf16 v[92:95], a[188:191], v[28:31], v[92:95]
    ds_read_b128 v[24:27], v49 offset:576
    ds_read_b128 v[28:31], v50 offset:576
    s_waitcnt lgkmcnt(6)
    v_mfma_f32_16x16x32_bf16 v[64:67], a[24:27], v[32:35], v[64:67]
    v_mfma_f32_16x16x32_bf16 v[68:71], a[80:83], v[32:35], v[68:71]
    v_mfma_f32_16x16x32_bf16 v[72:75], a[136:139], v[32:35], v[72:75]
    v_mfma_f32_16x16x32_bf16 v[76:79], a[192:195], v[32:35], v[76:79]
    v_mfma_f32_16x16x32_bf16 v[80:83], a[24:27], v[36:39], v[80:83]
    v_mfma_f32_16x16x32_bf16 v[84:87], a[80:83], v[36:39], v[84:87]
    v_mfma_f32_16x16x32_bf16 v[88:91], a[136:139], v[36:39], v[88:91]
    v_mfma_f32_16x16x32_bf16 v[92:95], a[192:195], v[36:39], v[92:95]
    ds_read_b128 v[32:35], v49 offset:640
    ds_read_b128 v[36:39], v50 offset:640
    s_waitcnt lgkmcnt(6)
    v_mfma_f32_16x16x32_bf16 v[64:67], a[28:31], v[40:43], v[64:67]
    v_mfma_f32_16x16x32_bf16 v[68:71], a[84:87], v[40:43], v[68:71]
    v_mfma_f32_16x16x32_bf16 v[72:75], a[140:143], v[40:43], v[72:75]
    v_mfma_f32_16x16x32_bf16 v[76:79], a[196:199], v[40:43], v[76:79]
    v_mfma_f32_16x16x32_bf16 v[80:83], a[28:31], v[44:47], v[80:83]
    v_mfma_f32_16x16x32_bf16 v[84:87], a[84:87], v[44:47], v[84:87]
    v_mfma_f32_16x16x32_bf16 v[88:91], a[140:143], v[44:47], v[88:91]
    v_mfma_f32_16x16x32_bf16 v[92:95], a[196:199], v[44:47], v[92:95]
    ds_read_b128 v[40:43], v49 offset:704
    ds_read_b128 v[44:47], v50 offset:704
    s_waitcnt lgkmcnt(6)
    v_mfma_f32_16x16x32_bf16 v[64:67], a[32:35], v[16:19], v[64:67]
    v_mfma_f32_16x16x32_bf16 v[68:71], a[88:91], v[16:19], v[68:71]
    v_mfma_f32_16x16x32_bf16 v[72:75], a[144:147], v[16:19], v[72:75]
    v_mfma_f32_16x16x32_bf16 v[76:79], a[200:203], v[16:19], v[76:79]
    v_mfma_f32_16x16x32_bf16 v[80:83], a[32:35], v[20:23], v[80:83]
    v_mfma_f32_16x16x32_bf16 v[84:87], a[88:91], v[20:23], v[84:87]
    v_mfma_f32_16x16x32_bf16 v[88:91], a[144:147], v[20:23], v[88:91]
    v_mfma_f32_16x16x32_bf16 v[92:95], a[200:203], v[20:23], v[92:95]
    ds_read_b128 v[16:19], v49 offset:768
    ds_read_b128 v[20:23], v50 offset:768
    s_waitcnt lgkmcnt(6)
    v_mfma_f32_16x16x32_bf16 v[64:67], a[36:39], v[24:27], v[64:67]
    v_mfma_f32_16x16x32_bf16 v[68:71], a[92:95], v[24:27], v[68:71]
    v_mfma_f32_16x16x32_bf16 v[72:75], a[148:151], v[24:27], v[72:75]
    v_mfma_f32_16x16x32_bf16 v[76:79], a[204:207], v[24:27], v[76:79]
    v_mfma_f32_16x16x32_bf16 v[80:83], a[36:39], v[28:31], v[80:83]
    v_mfma_f32_16x16x32_bf16 v[84:87], a[92:95], v[28:31], v[84:87]
    v_mfma_f32_16x16x32_bf16 v[88:91], a[148:151], v[28:31], v[88:91]
    v_mfma_f32_16x16x32_bf16 v[92:95], a[204:207], v[28:31], v[92:95]
    ds_read_b128 v[24:27], v49 offset:832
    ds_read_b128 v[28:31], v50 offset:832
    s_waitcnt lgkmcnt(6)
    v_mfma_f32_16x16x32_bf16 v[64:67], a[40:43], v[32:35], v[64:67]
    v_mfma_f32_16x16x32_bf16 v[68:71], a[96:99], v[32:35], v[68:71]
    v_mfma_f32_16x16x32_bf16 v[72:75], a[152:155], v[32:35], v[72:75]
    v_mfma_f32_16x16x32_bf16 v[76:79], a[208:211], v[32:35], v[76:79]
    v_mfma_f32_16x16x32_bf16 v[80:83], a[40:43], v[36:39], v[80:83]
    v_mfma_f32_16x16x32_bf16 v[84:87], a[96:99], v[36:39], v[84:87]
    v_mfma_f32_16x16x32_bf16 v[88:91], a[152:155], v[36:39], v[88:91]
    v_mfma_f32_16x16x32_bf16 v[92:95], a[208:211], v[36:39], v[92:95]
    s_waitcnt lgkmcnt(4)
    v_mfma_f32_16x16x32_bf16 v[64:67], a[44:47], v[40:43], v[64:67]
    v_mfma_f32_16x16x32_bf16 v[68:71], a[100:103], v[40:43], v[68:71]
    v_mfma_f32_16x16x32_bf16 v[72:75], a[156:159], v[40:43], v[72:75]
    v_mfma_f32_16x16x32_bf16 v[76:79], a[212:215], v[40:43], v[76:79]
    v_mfma_f32_16x16x32_bf16 v[80:83], a[44:47], v[44:47], v[80:83]
    v_mfma_f32_16x16x32_bf16 v[84:87], a[100:103], v[44:47], v[84:87]
    v_mfma_f32_16x16x32_bf16 v[88:91], a[156:159], v[44:47], v[88:91]
    v_mfma_f32_16x16x32_bf16 v[92:95], a[212:215], v[44:47], v[92:95]
    s_waitcnt lgkmcnt(2)
    v_mfma_f32_16x16x32_bf16 v[64:67], a[48:51], v[16:19], v[64:67]
    v_mfma_f32_16x16x32_bf16 v[68:71], a[104:107], v[16:19], v[68:71]
    v_mfma_f32_16x16x32_bf16 v[72:75], a[160:163], v[16:19], v[72:75]
    v_mfma_f32_16x16x32_bf16 v[76:79], a[216:219], v[16:19], v[76:79]
    v_mfma_f32_16x16x32_bf16 v[80:83], a[48:51], v[20:23], v[80:83]
    v_mfma_f32_16x16x32_bf16 v[84:87], a[104:107], v[20:23], v[84:87]
    v_mfma_f32_16x16x32_bf16 v[88:91], a[160:163], v[20:23], v[88:91]
    v_mfma_f32_16x16x32_bf16 v[92:95], a[216:219], v[20:23], v[92:95]
    s_waitcnt lgkmcnt(0)
    v_mfma_f32_16x16x32_bf16 v[64:67], a[52:55], v[24:27], v[64:67]
    v_mfma_f32_16x16x32_bf16 v[68:71], a[108:111], v[24:27], v[68:71]
    v_mfma_f32_16x16x32_bf16 v[72:75], a[164:167], v[24:27], v[72:75]
    v_mfma_f32_16x16x32_bf16 v[76:79], a[220:223], v[24:27], v[76:79]
    v_mfma_f32_16x16x32_bf16 v[80:83], a[52:55], v[28:31], v[80:83]
    v_mfma_f32_16x16x32_bf16 v[84:87], a[108:111], v[28:31], v[84:87]
    v_mfma_f32_16x16x32_bf16 v[88:91], a[164:167], v[28:31], v[88:91]
    v_mfma_f32_16x16x32_bf16 v[92:95], a[220:223], v[28:31], v[92:95]
    s_mov_b32 s55, s47
    s_mov_b32 s47, s51
    s_mov_b32 s51, s54
    s_mov_b32 s54, s55
    s_nop 7
    s_add_u32 s45, s44, 229376
    v_cvt_pk_bf16_f32 v96, v64, v65
    v_cvt_pk_bf16_f32 v97, v66, v67
    v_cvt_pk_bf16_f32 v98, v68, v69
    v_cvt_pk_bf16_f32 v99, v70, v71
    s_nop 1
    v_permlane16_swap_b32 v96, v98
    v_permlane16_swap_b32 v97, v99
    buffer_store_dwordx4 v[96:99], v7, s[20:23], s44 offen offset:0 sc1
    v_cvt_pk_bf16_f32 v100, v72, v73
    v_cvt_pk_bf16_f32 v101, v74, v75
    v_cvt_pk_bf16_f32 v102, v76, v77
    v_cvt_pk_bf16_f32 v103, v78, v79
    s_nop 1
    v_permlane16_swap_b32 v100, v102
    v_permlane16_swap_b32 v101, v103
    buffer_store_dwordx4 v[100:103], v7, s[20:23], s44 offen offset:1024 sc1
    v_cvt_pk_bf16_f32 v104, v80, v81
    v_cvt_pk_bf16_f32 v105, v82, v83
    v_cvt_pk_bf16_f32 v106, v84, v85
    v_cvt_pk_bf16_f32 v107, v86, v87
    s_nop 1
    v_permlane16_swap_b32 v104, v106
    v_permlane16_swap_b32 v105, v107
    buffer_store_dwordx4 v[104:107], v7, s[20:23], s45 offen offset:0 sc1
    v_cvt_pk_bf16_f32 v108, v88, v89
    v_cvt_pk_bf16_f32 v109, v90, v91
    v_cvt_pk_bf16_f32 v110, v92, v93
    v_cvt_pk_bf16_f32 v111, v94, v95
    s_nop 1
    v_permlane16_swap_b32 v108, v110
    v_permlane16_swap_b32 v109, v111
    buffer_store_dwordx4 v[108:111], v7, s[20:23], s45 offen offset:1024 sc1
    s_cmp_ge_u32 s42, 2
    s_cbranch_scc1 gma_ne
    s_waitcnt vmcnt(0)
    s_barrier
    s_cmp_lg_u32 s3, 0
    s_cbranch_scc1 gma_ne
    s_lshl_b32 s70, s42, 7
    s_add_u32 s70, s70, s53
    v_mov_b32 v14, 1
    s_mov_b64 exec, 1
    buffer_atomic_add v14, v15, s[20:23], s70 offen sc1
    s_mov_b64 exec, -1
gma_ne:
    s_add_u32 s44, s44, 458752
    s_add_u32 s42, s42, 1
    s_cmp_lt_u32 s42, 64
    s_cbranch_scc1 gma_loop
    s_waitcnt vmcnt(0)
    s_barrier
    s_cmp_lg_u32 s3, 0
    s_cbranch_scc1 gma_nf
    s_add_u32 s70, s53, 7936
    v_mov_b32 v14, 1
    s_mov_b64 exec, 1
    buffer_atomic_add v14, v15, s[20:23], s70 offen sc1
    buffer_atomic_add v14, v15, s[20:23], s70 offen offset:128 sc1
    s_mov_b64 exec, -1
gma_nf:
    s_add_u32 s52, s52, 1
    s_cmp_lt_u32 s52, 2
    s_cbranch_scc1 gma_layer
    s_sub_u32 s2, s2, 28
    s_barrier
    s_endpgm
gm_vo:
    v_lshlrev_b32 v7, 6, v2
    v_lshl_add_u32 v7, v3, 4, v7
    s_sub_u32 s26, s24, 7168
    s_lshl_b32 s26, s26, 6
gmv_layer:
    s_mul_i32 s43, s52, 1835008
    s_add_u32 s43, s43, 31752192
    s_mul_i32 s44, s52, 66060288
    s_add_u32 s44, s44, 64782336
    s_mul_i32 s53, s52, 8192
    s_add_u32 s53, s53, 167632896
    s_mul_i32 s25, s3, 7168
    s_add_u32 s43, s43, s25
    s_add_u32 s44, s44, s26
    s_mov_b32 s42, 0
    s_mov_b32 s47, 0
    s_mov_b32 s51, 29184
    s_mov_b32 s54, 58368
    s_waitcnt vmcnt(0)
    s_barrier
    s_cmp_eq_u32 s52, 0
    s_cbranch_scc1 mega_kernel_nw47
    s_cmp_lg_u32 s3, 0
    s_cbranch_scc1 mega_kernel_wd49
    s_lshl_b32 s70, s42, 7
    s_add_u32 s70, s70, 167567360
mega_kernel_wc48:
    buffer_load_dword v14, v15, s[20:23], s70 offen sc1
    s_waitcnt vmcnt(0)
    v_readfirstlane_b32 s71, v14
    s_cmp_ge_u32 s71, 2
    s_cbranch_scc1 mega_kernel_wd49
    s_sleep 6
    s_branch mega_kernel_wc48
mega_kernel_wd49:
    s_barrier
mega_kernel_nw47:
    s_mov_b64 exec, s[34:35]
    s_add_u32 s48, s46, s47
    s_mov_b32 s49, s43
    s_mov_b32 m0, s48
    s_nop 0
    buffer_load_dwordx4 v6, s[20:23], s49 offen sc1 lds
    s_add_u32 s48, s48, 912
    s_add_u32 s49, s49, 896
    s_mov_b32 m0, s48
    s_nop 0
    buffer_load_dwordx4 v6, s[20:23], s49 offen sc1 lds
    s_add_u32 s48, s48, 912
    s_add_u32 s49, s49, 896
    s_mov_b32 m0, s48
    s_nop 0
    buffer_load_dwordx4 v6, s[20:23], s49 offen sc1 lds
    s_add_u32 s48, s48, 912
    s_add_u32 s49, s49, 896
    s_mov_b32 m0, s48
    s_nop 0
    buffer_load_dwordx4 v6, s[20:23], s49 offen sc1 lds
    s_add_u32 s48, s48, 912
    s_add_u32 s49, s49, 896
    s_mov_b32 m0, s48
    s_nop 0
    buffer_load_dwordx4 v6, s[20:23], s49 offen sc1 lds
    s_add_u32 s48, s48, 912
    s_add_u32 s49, s49, 896
    s_mov_b32 m0, s48
    s_nop 0
    buffer_load_dwordx4 v6, s[20:23], s49 offen sc1 lds
    s_add_u32 s48, s48, 912
    s_add_u32 s49, s49, 896
    s_mov_b32 m0, s48
    s_nop 0
    buffer_load_dwordx4 v6, s[20:23], s49 offen sc1 lds
    s_add_u32 s48, s48, 912
    s_add_u32 s49, s49, 896
    s_mov_b32 m0, s48
    s_nop 0
    buffer_load_dwordx4 v6, s[20:23], s49 offen sc1 lds
    s_mov_b64 exec, -1
    s_add_u32 s43, s43, 28672
    s_mov_b32 s72, 1
    s_cmp_eq_u32 s52, 0
    s_cbranch_scc1 mega_kernel_nw50
    s_cmp_lg_u32 s3, 0
    s_cbranch_scc1 mega_kernel_wd52
    s_lshl_b32 s70, s72, 7
    s_add_u32 s70, s70, 167567360
mega_kernel_wc51:
    buffer_load_dword v14, v15, s[20:23], s70 offen sc1
    s_waitcnt vmcnt(0)
    v_readfirstlane_b32 s71, v14
    s_cmp_ge_u32 s71, 2
    s_cbranch_scc1 mega_kernel_wd52
    s_sleep 6
    s_branch mega_kernel_wc51
mega_kernel_wd52:
    s_barrier
mega_kernel_nw50:
    s_waitcnt vmcnt(0)
    s_mov_b64 exec, s[34:35]
    s_add_u32 s48, s46, s51
    s_mov_b32 s49, s43
    s_mov_b32 m0, s48
    s_nop 0
    buffer_load_dwordx4 v6, s[20:23], s49 offen sc1 lds
    s_add_u32 s48, s48, 912
    s_add_u32 s49, s49, 896
    s_mov_b32 m0, s48
    s_nop 0
    buffer_load_dwordx4 v6, s[20:23], s49 offen sc1 lds
    s_add_u32 s48, s48, 912
    s_add_u32 s49, s49, 896
    s_mov_b32 m0, s48
    s_nop 0
    buffer_load_dwordx4 v6, s[20:23], s49 offen sc1 lds
    s_add_u32 s48, s48, 912
    s_add_u32 s49, s49, 896
    s_mov_b32 m0, s48
    s_nop 0
    buffer_load_dwordx4 v6, s[20:23], s49 offen sc1 lds
    s_add_u32 s48, s48, 912
    s_add_u32 s49, s49, 896
    s_mov_b32 m0, s48
    s_nop 0
    buffer_load_dwordx4 v6, s[20:23], s49 offen sc1 lds
    s_add_u32 s48, s48, 912
    s_add_u32 s49, s49, 896
    s_mov_b32 m0, s48
    s_nop 0
    buffer_load_dwordx4 v6, s[20:23], s49 offen sc1 lds
    s_add_u32 s48, s48, 912
    s_add_u32 s49, s49, 896
    s_mov_b32 m0, s48
    s_nop 0
    buffer_load_dwordx4 v6, s[20:23], s49 offen sc1 lds
    s_add_u32 s48, s48, 912
    s_add_u32 s49, s49, 896
    s_mov_b32 m0, s48
    s_nop 0
    buffer_load_dwordx4 v6, s[20:23], s49 offen sc1 lds
    s_mov_b64 exec, -1
    s_add_u32 s43, s43, 28672
gmv_loop:
    s_waitcnt vmcnt(12)
    s_cmp_lt_u32 s42, 63
    s_cbranch_scc1 gmv_w1
    s_waitcnt vmcnt(0)
gmv_w1:
    s_barrier
    s_cmp_lt_u32 s42, 4
    s_cbranch_scc1 mega_kernel_ns53
    s_cmp_lg_u32 s3, 0
    s_cbranch_scc1 mega_kernel_ns53
    s_sub_u32 s70, s42, 2
    s_lshl_b32 s70, s70, 7
    s_add_u32 s70, s70, s53
    v_mov_b32 v14, 1
    s_mov_b64 exec, 1
    buffer_atomic_add v14, v15, s[20:23], s70 offen sc1
    s_mov_b64 exec, -1
mega_kernel_ns53:
    s_cmp_ge_u32 s42, 62
    s_cbranch_scc1 gmv_nodma
    s_add_u32 s72, s42, 2
    s_cmp_eq_u32 s52, 0
    s_cbranch_scc1 mega_kernel_nw54
    s_cmp_lg_u32 s3, 0
    s_cbranch_scc1 mega_kernel_wd56
    s_lshl_b32 s70, s72, 7
    s_add_u32 s70, s70, 167567360
mega_kernel_wc55:
    buffer_load_dword v14, v15, s[20:23], s70 offen sc1
    s_waitcnt vmcnt(0)
    v_readfirstlane_b32 s71, v14
    s_cmp_ge_u32 s71, 2
    s_cbranch_scc1 mega_kernel_wd56
    s_sleep 6
    s_branch mega_kernel_wc55
mega_kernel_wd56:
    s_barrier
mega_kernel_nw54:
    s_mov_b64 exec, s[34:35]
    s_add_u32 s48, s46, s54
    s_mov_b32 s49, s43
    s_mov_b32 m0, s48
    s_nop 0
    buffer_load_dwordx4 v6, s[20:23], s49 offen sc1 lds
    s_add_u32 s48, s48, 912
    s_add_u32 s49, s49, 896
    s_mov_b32 m0, s48
    s_nop 0
    buffer_load_dwordx4 v6, s[20:23], s49 offen sc1 lds
    s_add_u32 s48, s48, 912
    s_add_u32 s49, s49, 896
    s_mov_b32 m0, s48
    s_nop 0
    buffer_load_dwordx4 v6, s[20:23], s49 offen sc1 lds
    s_add_u32 s48, s48, 912
    s_add_u32 s49, s49, 896
    s_mov_b32 m0, s48
    s_nop 0
    buffer_load_dwordx4 v6, s[20:23], s49 offen sc1 lds
    s_add_u32 s48, s48, 912
    s_add_u32 s49, s49, 896
    s_mov_b32 m0, s48
    s_nop 0
    buffer_load_dwordx4 v6, s[20:23], s49 offen sc1 lds
    s_add_u32 s48, s48, 912
    s_add_u32 s49, s49, 896
    s_mov_b32 m0, s48
    s_nop 0
    buffer_load_dwordx4 v6, s[20:23], s49 offen sc1 lds
    s_add_u32 s48, s48, 912
    s_add_u32 s49, s49, 896
    s_mov_b32 m0, s48
    s_nop 0
    buffer_load_dwordx4 v6, s[20:23], s49 offen sc1 lds
    s_add_u32 s48, s48, 912
    s_add_u32 s49, s49, 896
    s_mov_b32 m0, s48
    s_nop 0
    buffer_load_dwordx4 v6, s[20:23], s49 offen sc1 lds
    s_mov_b64 exec, -1
    s_add_u32 s43, s43, 28672
gmv_nodma:
    v_add_u32 v49, s47, v5
    v_add_u32 v50, 14592, v49
    ds_read_b128 v[16:19], v49 offset:0
    ds_read_b128 v[20:23], v50 offset:0
    ds_read_b128 v[24:27], v49 offset:64
    ds_read_b128 v[28:31], v50 offset:64
    ds_read_b128 v[32:35], v49 offset:128
    ds_read_b128 v[36:39], v50 offset:128
    ds_read_b128 v[40:43], v49 offset:192
    ds_read_b128 v[44:47], v50 offset:192
    s_waitcnt lgkmcnt(6)
    v_mfma_f32_16x16x32_bf16 v[64:67], v[16:19], a[0:3], 0
    v_mfma_f32_16x16x32_bf16 v[68:71], v[16:19], a[56:59], 0
    v_mfma_f32_16x16x32_bf16 v[72:75], v[16:19], a[112:115], 0
    v_mfma_f32_16x16x32_bf16 v[76:79], v[16:19], a[168:171], 0
    v_mfma_f32_16x16x32_bf16 v[80:83], v[20:23], a[0:3], 0
    v_mfma_f32_16x16x32_bf16 v[84:87], v[20:23], a[56:59], 0
    v_mfma_f32_16x16x32_bf16 v[88:91], v[20:23], a[112:115], 0
    v_mfma_f32_16x16x32_bf16 v[92:95], v[20:23], a[168:171], 0
    ds_read_b128 v[16:19], v49 offset:256
    ds_read_b128 v[20:23], v50 offset:256
    s_waitcnt lgkmcnt(6)
    v_mfma_f32_16x16x32_bf16 v[64:67], v[24:27], a[4:7], v[64:67]
    v_mfma_f32_16x16x32_bf16 v[68:71], v[24:27], a[60:63], v[68:71]
    v_mfma_f32_16x16x32_bf16 v[72:75], v[24:27], a[116:119], v[72:75]
    v_mfma_f32_16x16x32_bf16 v[76:79], v[24:27], a[172:175], v[76:79]
    v_mfma_f32_16x16x32_bf16 v[80:83], v[28:31], a[4:7], v[80:83]
    v_mfma_f32_16x16x32_bf16 v[84:87], v[28:31], a[60:63], v[84:87]
    v_mfma_f32_16x16x32_bf16 v[88:91], v[28:31], a[116:119], v[88:91]
    v_mfma_f32_16x16x32_bf16 v[92:95], v[28:31], a[172:175], v[92:95]
    ds_read_b128 v[24:27], v49 offset:320
    ds_read_b128 v[28:31], v50 offset:320
    s_waitcnt lgkmcnt(6)
    v_mfma_f32_16x16x32_bf16 v[64:67], v[32:35], a[8:11], v[64:67]
    v_mfma_f32_16x16x32_bf16 v[68:71], v[32:35], a[64:67], v[68:71]
    v_mfma_f32_16x16x32_bf16 v[72:75], v[32:35], a[120:123], v[72:75]
    v_mfma_f32_16x16x32_bf16 v[76:79], v[32:35], a[176:179], v[76:79]
    v_mfma_f32_16x16x32_bf16 v[80:83], v[36:39], a[8:11], v[80:83]
    v_mfma_f32_16x16x32_bf16 v[84:87], v[36:39], a[64:67], v[84:87]
    v_mfma_f32_16x16x32_bf16 v[88:91], v[36:39], a[120:123], v[88:91]
    v_mfma_f32_16x16x32_bf16 v[92:95], v[36:39], a[176:179], v[92:95]
    ds_read_b128 v[32:35], v49 offset:384
    ds_read_b128 v[36:39], v50 offset:384
    s_waitcnt lgkmcnt(6)
    v_mfma_f32_16x16x32_bf16 v[64:67], v[40:43], a[12:15], v[64:67]
    v_mfma_f32_16x16x32_bf16 v[68:71], v[40:43], a[68:71], v[68:71]
    v_mfma_f32_16x16x32_bf16 v[72:75], v[40:43], a[124:127], v[72:75]
    v_mfma_f32_16x16x32_bf16 v[76:79], v[40:43], a[180:183], v[76:79]
    v_mfma_f32_16x16x32_bf16 v[80:83], v[44:47], a[12:15], v[80:83]
    v_mfma_f32_16x16x32_bf16 v[84:87], v[44:47], a[68:71], v[84:87]
    v_mfma_f32_16x16x32_bf16 v[88:91], v[44:47], a[124:127], v[88:91]
    v_mfma_f32_16x16x32_bf16 v[92:95], v[44:47], a[180:183], v[92:95]
    ds_read_b128 v[40:43], v49 offset:448
    ds_read_b128 v[44:47], v50 offset:448
    s_waitcnt lgkmcnt(6)
    v_mfma_f32_16x16x32_bf16 v[64:67], v[16:19], a[16:19], v[64:67]
    v_mfma_f32_16x16x32_bf16 v[68:71], v[16:19], a[72:75], v[68:71]
    v_mfma_f32_16x16x32_bf16 v[72:75], v[16:19], a[128:131], v[72:75]
    v_mfma_f32_16x16x32_bf16 v[76:79], v[16:19], a[184:187], v[76:79]
    v_mfma_f32_16x16x32_bf16 v[80:83], v[20:23], a[16:19], v[80:83]
    v_mfma_f32_16x16x32_bf16 v[84:87], v[20:23], a[72:75], v[84:87]
    v_mfma_f32_16x16x32_bf16 v[88:91], v[20:23], a[128:131], v[88:91]
    v_mfma_f32_16x16x32_bf16 v[92:95], v[20:23], a[184:187], v[92:95]
    ds_read_b128 v[16:19], v49 offset:512
    ds_read_b128 v[20:23], v50 offset:512
    s_waitcnt lgkmcnt(6)
    v_mfma_f32_16x16x32_bf16 v[64:67], v[24:27], a[20:23], v[64:67]
    v_mfma_f32_16x16x32_bf16 v[68:71], v[24:27], a[76:79], v[68:71]
    v_mfma_f32_16x16x32_bf16 v[72:75], v[24:27], a[132:135], v[72:75]
    v_mfma_f32_16x16x32_bf16 v[76:79], v[24:27], a[188:191], v[76:79]
    v_mfma_f32_16x16x32_bf16 v[80:83], v[28:31], a[20:23], v[80:83]
    v_mfma_f32_16x16x32_bf16 v[84:87], v[28:31], a[76:79], v[84:87]
    v_mfma_f32_16x16x32_bf16 v[88:91], v[28:31], a[132:135], v[88:91]
    v_mfma_f32_16x16x32_bf16 v[92:95], v[28:31], a[188:191], v[92:95]
    ds_read_b128 v[24:27], v49 offset:576
    ds_read_b128 v[28:31], v50 offset:576
    s_waitcnt lgkmcnt(6)
    v_mfma_f32_16x16x32_bf16 v[64:67], v[32:35], a[24:27], v[64:67]
    v_mfma_f32_16x16x32_bf16 v[68:71], v[32:35], a[80:83], v[68:71]
    v_mfma_f32_16x16x32_bf16 v[72:75], v[32:35], a[136:139], v[72:75]
    v_mfma_f32_16x16x32_bf16 v[76:79], v[32:35], a[192:195], v[76:79]
    v_mfma_f32_16x16x32_bf16 v[80:83], v[36:39], a[24:27], v[80:83]
    v_mfma_f32_16x16x32_bf16 v[84:87], v[36:39], a[80:83], v[84:87]
    v_mfma_f32_16x16x32_bf16 v[88:91], v[36:39], a[136:139], v[88:91]
    v_mfma_f32_16x16x32_bf16 v[92:95], v[36:39], a[192:195], v[92:95]
    ds_read_b128 v[32:35], v49 offset:640
    ds_read_b128 v[36:39], v50 offset:640
    s_waitcnt lgkmcnt(6)
    v_mfma_f32_16x16x32_bf16 v[64:67], v[40:43], a[28:31], v[64:67]
    v_mfma_f32_16x16x32_bf16 v[68:71], v[40:43], a[84:87], v[68:71]
    v_mfma_f32_16x16x32_bf16 v[72:75], v[40:43], a[140:143], v[72:75]
    v_mfma_f32_16x16x32_bf16 v[76:79], v[40:43], a[196:199], v[76:79]
    v_mfma_f32_16x16x32_bf16 v[80:83], v[44:47], a[28:31], v[80:83]
    v_mfma_f32_16x16x32_bf16 v[84:87], v[44:47], a[84:87], v[84:87]
    v_mfma_f32_16x16x32_bf16 v[88:91], v[44:47], a[140:143], v[88:91]
    v_mfma_f32_16x16x32_bf16 v[92:95], v[44:47], a[196:199], v[92:95]
    ds_read_b128 v[40:43], v49 offset:704
    ds_read_b128 v[44:47], v50 offset:704
    s_waitcnt lgkmcnt(6)
    v_mfma_f32_16x16x32_bf16 v[64:67], v[16:19], a[32:35], v[64:67]
    v_mfma_f32_16x16x32_bf16 v[68:71], v[16:19], a[88:91], v[68:71]
    v_mfma_f32_16x16x32_bf16 v[72:75], v[16:19], a[144:147], v[72:75]
    v_mfma_f32_16x16x32_bf16 v[76:79], v[16:19], a[200:203], v[76:79]
    v_mfma_f32_16x16x32_bf16 v[80:83], v[20:23], a[32:35], v[80:83]
    v_mfma_f32_16x16x32_bf16 v[84:87], v[20:23], a[88:91], v[84:87]
    v_mfma_f32_16x16x32_bf16 v[88:91], v[20:23], a[144:147], v[88:91]
    v_mfma_f32_16x16x32_bf16 v[92:95], v[20:23], a[200:203], v[92:95]
    ds_read_b128 v[16:19], v49 offset:768
    ds_read_b128 v[20:23], v50 offset:768
    s_waitcnt lgkmcnt(6)
    v_mfma_f32_16x16x32_bf16 v[64:67], v[24:27], a[36:39], v[64:67]
    v_mfma_f32_16x16x32_bf16 v[68:71], v[24:27], a[92:95], v[68:71]
    v_mfma_f32_16x16x32_bf16 v[72:75], v[24:27], a[148:151], v[72:75]
    v_mfma_f32_16x16x32_bf16 v[76:79], v[24:27], a[204:207], v[76:79]
    v_mfma_f32_16x16x32_bf16 v[80:83], v[28:31], a[36:39], v[80:83]
    v_mfma_f32_16x16x32_bf16 v[84:87], v[28:31], a[92:95], v[84:87]
    v_mfma_f32_16x16x32_bf16 v[88:91], v[28:31], a[148:151], v[88:91]
    v_mfma_f32_16x16x32_bf16 v[92:95], v[28:31], a[204:207], v[92:95]
    ds_read_b128 v[24:27], v49 offset:832
    ds_read_b128 v[28:31], v50 offset:832
    s_waitcnt lgkmcnt(6)
    v_mfma_f32_16x16x32_bf16 v[64:67], v[32:35], a[40:43], v[64:67]
    v_mfma_f32_16x16x32_bf16 v[68:71], v[32:35], a[96:99], v[68:71]
    v_mfma_f32_16x16x32_bf16 v[72:75], v[32:35], a[152:155], v[72:75]
    v_mfma_f32_16x16x32_bf16 v[76:79], v[32:35], a[208:211], v[76:79]
    v_mfma_f32_16x16x32_bf16 v[80:83], v[36:39], a[40:43], v[80:83]
    v_mfma_f32_16x16x32_bf16 v[84:87], v[36:39], a[96:99], v[84:87]
    v_mfma_f32_16x16x32_bf16 v[88:91], v[36:39], a[152:155], v[88:91]
    v_mfma_f32_16x16x32_bf16 v[92:95], v[36:39], a[208:211], v[92:95]
    s_waitcnt lgkmcnt(4)
    v_mfma_f32_16x16x32_bf16 v[64:67], v[40:43], a[44:47], v[64:67]
    v_mfma_f32_16x16x32_bf16 v[68:71], v[40:43], a[100:103], v[68:71]
    v_mfma_f32_16x16x32_bf16 v[72:75], v[40:43], a[156:159], v[72:75]
    v_mfma_f32_16x16x32_bf16 v[76:79], v[40:43], a[212:215], v[76:79]
    v_mfma_f32_16x16x32_bf16 v[80:83], v[44:47], a[44:47], v[80:83]
    v_mfma_f32_16x16x32_bf16 v[84:87], v[44:47], a[100:103], v[84:87]
    v_mfma_f32_16x16x32_bf16 v[88:91], v[44:47], a[156:159], v[88:91]
    v_mfma_f32_16x16x32_bf16 v[92:95], v[44:47], a[212:215], v[92:95]
    s_waitcnt lgkmcnt(2)
    v_mfma_f32_16x16x32_bf16 v[64:67], v[16:19], a[48:51], v[64:67]
    v_mfma_f32_16x16x32_bf16 v[68:71], v[16:19], a[104:107], v[68:71]
    v_mfma_f32_16x16x32_bf16 v[72:75], v[16:19], a[160:163], v[72:75]
    v_mfma_f32_16x16x32_bf16 v[76:79], v[16:19], a[216:219], v[76:79]
    v_mfma_f32_16x16x32_bf16 v[80:83], v[20:23], a[48:51], v[80:83]
    v_mfma_f32_16x16x32_bf16 v[84:87], v[20:23], a[104:107], v[84:87]
    v_mfma_f32_16x16x32_bf16 v[88:91], v[20:23], a[160:163], v[88:91]
    v_mfma_f32_16x16x32_bf16 v[92:95], v[20:23], a[216:219], v[92:95]
    s_waitcnt lgkmcnt(0)
    v_mfma_f32_16x16x32_bf16 v[64:67], v[24:27], a[52:55], v[64:67]
    v_mfma_f32_16x16x32_bf16 v[68:71], v[24:27], a[108:111], v[68:71]
    v_mfma_f32_16x16x32_bf16 v[72:75], v[24:27], a[164:167], v[72:75]
    v_mfma_f32_16x16x32_bf16 v[76:79], v[24:27], a[220:223], v[76:79]
    v_mfma_f32_16x16x32_bf16 v[80:83], v[28:31], a[52:55], v[80:83]
    v_mfma_f32_16x16x32_bf16 v[84:87], v[28:31], a[108:111], v[84:87]
    v_mfma_f32_16x16x32_bf16 v[88:91], v[28:31], a[164:167], v[88:91]
    v_mfma_f32_16x16x32_bf16 v[92:95], v[28:31], a[220:223], v[92:95]
    s_mov_b32 s55, s47
    s_mov_b32 s47, s51
    s_mov_b32 s51, s54
    s_mov_b32 s54, s55
    s_nop 7
    v_cvt_pk_bf16_f32 v96, v64, v65
    v_cvt_pk_bf16_f32 v97, v66, v67
    v_cvt_pk_bf16_f32 v98, v80, v81
    v_cvt_pk_bf16_f32 v99, v82, v83
    buffer_store_dwordx4 v[96:99], v7, s[20:23], s44 offen offset:0 sc1
    v_cvt_pk_bf16_f32 v100, v68, v69
    v_cvt_pk_bf16_f32 v101, v70, v71
    v_cvt_pk_bf16_f32 v102, v84, v85
    v_cvt_pk_bf16_f32 v103, v86, v87
    buffer_store_dwordx4 v[100:103], v7, s[20:23], s44 offen offset:1024 sc1
    v_cvt_pk_bf16_f32 v104, v72, v73
    v_cvt_pk_bf16_f32 v105, v74, v75
    v_cvt_pk_bf16_f32 v106, v88, v89
    v_cvt_pk_bf16_f32 v107, v90, v91
    buffer_store_dwordx4 v[104:107], v7, s[20:23], s44 offen offset:2048 sc1
    v_cvt_pk_bf16_f32 v108, v76, v77
    v_cvt_pk_bf16_f32 v109, v78, v79
    v_cvt_pk_bf16_f32 v110, v92, v93
    v_cvt_pk_bf16_f32 v111, v94, v95
    buffer_store_dwordx4 v[108:111], v7, s[20:23], s44 offen offset:3072 sc1
    s_cmp_ge_u32 s42, 2
    s_cbranch_scc1 gmv_ne
    s_waitcnt vmcnt(0)
    s_barrier
    s_cmp_lg_u32 s3, 0
    s_cbranch_scc1 gmv_ne
    s_lshl_b32 s70, s42, 7
    s_add_u32 s70, s70, s53
    v_mov_b32 v14, 1
    s_mov_b64 exec, 1
    buffer_atomic_add v14, v15, s[20:23], s70 offen sc1
    s_mov_b64 exec, -1
gmv_ne:
    s_add_u32 s44, s44, 458752
    s_add_u32 s42, s42, 1
    s_cmp_lt_u32 s42, 64
    s_cbranch_scc1 gmv_loop
    s_waitcnt vmcnt(0)
    s_barrier
    s_cmp_lg_u32 s3, 0
    s_cbranch_scc1 gmv_nf
    s_add_u32 s70, s53, 7936
    v_mov_b32 v14, 1
    s_mov_b64 exec, 1
    buffer_atomic_add v14, v15, s[20:23], s70 offen sc1
    buffer_atomic_add v14, v15, s[20:23], s70 offen offset:128 sc1
    s_mov_b64 exec, -1
gmv_nf:
    s_add_u32 s52, s52, 1
    s_cmp_lt_u32 s52, 1
    s_cbranch_scc1 gmv_layer
    s_sub_u32 s2, s2, 28
    s_barrier
    s_getpc_b64 s[60:61]
mega_kernel_lj57:
    s_add_u32 s60, s60, gh_start-mega_kernel_lj57
    s_addc_u32 s61, s61, 0
    s_setpc_b64 s[60:61]
g2_start:
    v_mul_u32_u24 v5, 896, v2
    v_lshl_add_u32 v5, v3, 4, v5
    s_lshl_b32 s24, s2, 8
    s_lshl_b32 s25, s3, 6
    s_add_u32 s24, s24, s25
    s_add_u32 s25, s24, 7168
    s_mul_i32 s25, s25, 896
    s_add_u32 s25, s25, 5275648
    v_lshlrev_b32 v12, 4, v1
    v_add_u32 v13, 4096, v12
    v_add_u32 v14, 8192, v12
    v_add_u32 v15, 12288, v12
    buffer_load_dwordx4 a[0:3], v12, s[20:23], s25 offen offset:0
    buffer_load_dwordx4 a[4:7], v12, s[20:23], s25 offen offset:1024
    buffer_load_dwordx4 a[8:11], v12, s[20:23], s25 offen offset:2048
    buffer_load_dwordx4 a[12:15], v12, s[20:23], s25 offen offset:3072
    buffer_load_dwordx4 a[16:19], v13, s[20:23], s25 offen offset:0
    buffer_load_dwordx4 a[20:23], v13, s[20:23], s25 offen offset:1024
    buffer_load_dwordx4 a[24:27], v13, s[20:23], s25 offen offset:2048
    buffer_load_dwordx4 a[28:31], v13, s[20:23], s25 offen offset:3072
    buffer_load_dwordx4 a[32:35], v14, s[20:23], s25 offen offset:0
    buffer_load_dwordx4 a[36:39], v14, s[20:23], s25 offen offset:1024
    buffer_load_dwordx4 a[40:43], v14, s[20:23], s25 offen offset:2048
    buffer_load_dwordx4 a[44:47], v14, s[20:23], s25 offen offset:3072
    buffer_load_dwordx4 a[48:51], v15, s[20:23], s25 offen offset:0
    buffer_load_dwordx4 a[52:55], v15, s[20:23], s25 offen offset:1024
    s_add_u32 s25, s25, 14336
    buffer_load_dwordx4 a[56:59], v12, s[20:23], s25 offen offset:0
    buffer_load_dwordx4 a[60:63], v12, s[20:23], s25 offen offset:1024
    buffer_load_dwordx4 a[64:67], v12, s[20:23], s25 offen offset:2048
    buffer_load_dwordx4 a[68:71], v12, s[20:23], s25 offen offset:3072
    buffer_load_dwordx4 a[72:75], v13, s[20:23], s25 offen offset:0
    buffer_load_dwordx4 a[76:79], v13, s[20:23], s25 offen offset:1024
    buffer_load_dwordx4 a[80:83], v13, s[20:23], s25 offen offset:2048
    buffer_load_dwordx4 a[84:87], v13, s[20:23], s25 offen offset:3072
    buffer_load_dwordx4 a[88:91], v14, s[20:23], s25 offen offset:0
    buffer_load_dwordx4 a[92:95], v14, s[20:23], s25 offen offset:1024
    buffer_load_dwordx4 a[96:99], v14, s[20:23], s25 offen offset:2048
    buffer_load_dwordx4 a[100:103], v14, s[20:23], s25 offen offset:3072
    buffer_load_dwordx4 a[104:107], v15, s[20:23], s25 offen offset:0
    buffer_load_dwordx4 a[108:111], v15, s[20:23], s25 offen offset:1024
    s_add_u32 s25, s25, 14336
    buffer_load_dwordx4 a[112:115], v12, s[20:23], s25 offen offset:0
    buffer_load_dwordx4 a[116:119], v12, s[20:23], s25 offen offset:1024
    buffer_load_dwordx4 a[120:123], v12, s[20:23], s25 offen offset:2048
    buffer_load_dwordx4 a[124:127], v12, s[20:23], s25 offen offset:3072
    buffer_load_dwordx4 a[128:131], v13, s[20:23], s25 offen offset:0
    buffer_load_dwordx4 a[132:135], v13, s[20:23], s25 offen offset:1024
    buffer_load_dwordx4 a[136:139], v13, s[20:23], s25 offen offset:2048
    buffer_load_dwordx4 a[140:143], v13, s[20:23], s25 offen offset:3072
    buffer_load_dwordx4 a[144:147], v14, s[20:23], s25 offen offset:0
    buffer_load_dwordx4 a[148:151], v14, s[20:23], s25 offen offset:1024
    buffer_load_dwordx4 a[152:155], v14, s[20:23], s25 offen offset:2048
    buffer_load_dwordx4 a[156:159], v14, s[20:23], s25 offen offset:3072
    buffer_load_dwordx4 a[160:163], v15, s[20:23], s25 offen offset:0
    buffer_load_dwordx4 a[164:167], v15, s[20:23], s25 offen offset:1024
    s_add_u32 s25, s25, 14336
    buffer_load_dwordx4 a[168:171], v12, s[20:23], s25 offen offset:0
    buffer_load_dwordx4 a[172:175], v12, s[20:23], s25 offen offset:1024
    buffer_load_dwordx4 a[176:179], v12, s[20:23], s25 offen offset:2048
    buffer_load_dwordx4 a[180:183], v12, s[20:23], s25 offen offset:3072
    buffer_load_dwordx4 a[184:187], v13, s[20:23], s25 offen offset:0
    buffer_load_dwordx4 a[188:191], v13, s[20:23], s25 offen offset:1024
    buffer_load_dwordx4 a[192:195], v13, s[20:23], s25 offen offset:2048
    buffer_load_dwordx4 a[196:199], v13, s[20:23], s25 offen offset:3072
    buffer_load_dwordx4 a[200:203], v14, s[20:23], s25 offen offset:0
    buffer_load_dwordx4 a[204:207], v14, s[20:23], s25 offen offset:1024
    buffer_load_dwordx4 a[208:211], v14, s[20:23], s25 offen offset:2048
    buffer_load_dwordx4 a[212:215], v14, s[20:23], s25 offen offset:3072
    buffer_load_dwordx4 a[216:219], v15, s[20:23], s25 offen offset:0
    buffer_load_dwordx4 a[220:223], v15, s[20:23], s25 offen offset:1024
    s_mov_b32 s34, -1
    s_mov_b32 s35, 0x00ffffff
    v_lshlrev_b32 v6, 4, v1
    s_mul_i32 s46, s3, 7296
    v_mul_u32_u24 v5, 912, v2
    v_lshl_add_u32 v5, v3, 4, v5
    v_mov_b32 v15, 0
    s_mul_i32 s43, s3, 7168
    s_add_u32 s43, s43, 33587200
    s_mov_b32 s42, 0
    s_mov_b32 s47, 0
    v_lshlrev_b32 v7, 6, v2
    v_lshl_add_u32 v7, v3, 4, v7
    s_lshl_b32 s44, s24, 6
    s_add_u32 s44, s44, 130842624
    s_cmp_lg_u32 s3, 0
    s_cbranch_scc1 mega_kernel_wd59
    s_lshl_b32 s70, s42, 7
    s_add_u32 s70, s70, 167567360
mega_kernel_wc58:
    buffer_load_dword v14, v15, s[20:23], s70 offen sc1
    s_waitcnt vmcnt(0)
    v_readfirstlane_b32 s71, v14
    s_cmp_ge_u32 s71, 2
    s_cbranch_scc1 mega_kernel_wd59
    s_sleep 6
    s_branch mega_kernel_wc58
mega_kernel_wd59:
    s_barrier
    s_mov_b64 exec, s[34:35]
    s_add_u32 s48, s46, s47
    s_mov_b32 s49, s43
    s_mov_b32 m0, s48
    s_nop 0
    buffer_load_dwordx4 v6, s[20:23], s49 offen sc1 lds
    s_add_u32 s48, s48, 912
    s_add_u32 s49, s49, 896
    s_mov_b32 m0, s48
    s_nop 0
    buffer_load_dwordx4 v6, s[20:23], s49 offen sc1 lds
    s_add_u32 s48, s48, 912
    s_add_u32 s49, s49, 896
    s_mov_b32 m0, s48
    s_nop 0
    buffer_load_dwordx4 v6, s[20:23], s49 offen sc1 lds
    s_add_u32 s48, s48, 912
    s_add_u32 s49, s49, 896
    s_mov_b32 m0, s48
    s_nop 0
    buffer_load_dwordx4 v6, s[20:23], s49 offen sc1 lds
    s_add_u32 s48, s48, 912
    s_add_u32 s49, s49, 896
    s_mov_b32 m0, s48
    s_nop 0
    buffer_load_dwordx4 v6, s[20:23], s49 offen sc1 lds
    s_add_u32 s48, s48, 912
    s_add_u32 s49, s49, 896
    s_mov_b32 m0, s48
    s_nop 0
    buffer_load_dwordx4 v6, s[20:23], s49 offen sc1 lds
    s_add_u32 s48, s48, 912
    s_add_u32 s49, s49, 896
    s_mov_b32 m0, s48
    s_nop 0
    buffer_load_dwordx4 v6, s[20:23], s49 offen sc1 lds
    s_add_u32 s48, s48, 912
    s_add_u32 s49, s49, 896
    s_mov_b32 m0, s48
    s_nop 0
    buffer_load_dwordx4 v6, s[20:23], s49 offen sc1 lds
    s_mov_b64 exec, -1
    s_add_u32 s43, s43, 28672
g2_loop:
    s_waitcnt vmcnt(0)
    s_barrier
    v_add_u32 v49, s47, v5
    v_add_u32 v50, 14592, v49
    ds_read_b128 v[16:19], v49 offset:0
    ds_read_b128 v[20:23], v50 offset:0
    ds_read_b128 v[24:27], v49 offset:64
    ds_read_b128 v[28:31], v50 offset:64
    ds_read_b128 v[32:35], v49 offset:128
    ds_read_b128 v[36:39], v50 offset:128
    ds_read_b128 v[40:43], v49 offset:192
    ds_read_b128 v[44:47], v50 offset:192
    s_waitcnt lgkmcnt(6)
    v_mfma_f32_16x16x32_bf16 v[64:67], v[16:19], a[0:3], 0
    v_mfma_f32_16x16x32_bf16 v[68:71], v[16:19], a[56:59], 0
    v_mfma_f32_16x16x32_bf16 v[72:75], v[16:19], a[112:115], 0
    v_mfma_f32_16x16x32_bf16 v[76:79], v[16:19], a[168:171], 0
    v_mfma_f32_16x16x32_bf16 v[80:83], v[20:23], a[0:3], 0
    v_mfma_f32_16x16x32_bf16 v[84:87], v[20:23], a[56:59], 0
    v_mfma_f32_16x16x32_bf16 v[88:91], v[20:23], a[112:115], 0
    v_mfma_f32_16x16x32_bf16 v[92:95], v[20:23], a[168:171], 0
    ds_read_b128 v[16:19], v49 offset:256
    ds_read_b128 v[20:23], v50 offset:256
    s_waitcnt lgkmcnt(6)
    v_mfma_f32_16x16x32_bf16 v[64:67], v[24:27], a[4:7], v[64:67]
    v_mfma_f32_16x16x32_bf16 v[68:71], v[24:27], a[60:63], v[68:71]
    v_mfma_f32_16x16x32_bf16 v[72:75], v[24:27], a[116:119], v[72:75]
    v_mfma_f32_16x16x32_bf16 v[76:79], v[24:27], a[172:175], v[76:79]
    v_mfma_f32_16x16x32_bf16 v[80:83], v[28:31], a[4:7], v[80:83]
    v_mfma_f32_16x16x32_bf16 v[84:87], v[28:31], a[60:63], v[84:87]
    v_mfma_f32_16x16x32_bf16 v[88:91], v[28:31], a[116:119], v[88:91]
    v_mfma_f32_16x16x32_bf16 v[92:95], v[28:31], a[172:175], v[92:95]
    ds_read_b128 v[24:27], v49 offset:320
    ds_read_b128 v[28:31], v50 offset:320
    s_waitcnt lgkmcnt(6)
    v_mfma_f32_16x16x32_bf16 v[64:67], v[32:35], a[8:11], v[64:67]
    v_mfma_f32_16x16x32_bf16 v[68:71], v[32:35], a[64:67], v[68:71]
    v_mfma_f32_16x16x32_bf16 v[72:75], v[32:35], a[120:123], v[72:75]
    v_mfma_f32_16x16x32_bf16 v[76:79], v[32:35], a[176:179], v[76:79]
    v_mfma_f32_16x16x32_bf16 v[80:83], v[36:39], a[8:11], v[80:83]
    v_mfma_f32_16x16x32_bf16 v[84:87], v[36:39], a[64:67], v[84:87]
    v_mfma_f32_16x16x32_bf16 v[88:91], v[36:39], a[120:123], v[88:91]
    v_mfma_f32_16x16x32_bf16 v[92:95], v[36:39], a[176:179], v[92:95]
    ds_read_b128 v[32:35], v49 offset:384
    ds_read_b128 v[36:39], v50 offset:384
    s_waitcnt lgkmcnt(6)
    v_mfma_f32_16x16x32_bf16 v[64:67], v[40:43], a[12:15], v[64:67]
    v_mfma_f32_16x16x32_bf16 v[68:71], v[40:43], a[68:71], v[68:71]
    v_mfma_f32_16x16x32_bf16 v[72:75], v[40:43], a[124:127], v[72:75]
    v_mfma_f32_16x16x32_bf16 v[76:79], v[40:43], a[180:183], v[76:79]
    v_mfma_f32_16x16x32_bf16 v[80:83], v[44:47], a[12:15], v[80:83]
    v_mfma_f32_16x16x32_bf16 v[84:87], v[44:47], a[68:71], v[84:87]
    v_mfma_f32_16x16x32_bf16 v[88:91], v[44:47], a[124:127], v[88:91]
    v_mfma_f32_16x16x32_bf16 v[92:95], v[44:47], a[180:183], v[92:95]
    ds_read_b128 v[40:43], v49 offset:448
    ds_read_b128 v[44:47], v50 offset:448
    s_waitcnt lgkmcnt(6)
    v_mfma_f32_16x16x32_bf16 v[64:67], v[16:19], a[16:19], v[64:67]
    v_mfma_f32_16x16x32_bf16 v[68:71], v[16:19], a[72:75], v[68:71]
    v_mfma_f32_16x16x32_bf16 v[72:75], v[16:19], a[128:131], v[72:75]
    v_mfma_f32_16x16x32_bf16 v[76:79], v[16:19], a[184:187], v[76:79]
    v_mfma_f32_16x16x32_bf16 v[80:83], v[20:23], a[16:19], v[80:83]
    v_mfma_f32_16x16x32_bf16 v[84:87], v[20:23], a[72:75], v[84:87]
    v_mfma_f32_16x16x32_bf16 v[88:91], v[20:23], a[128:131], v[88:91]
    v_mfma_f32_16x16x32_bf16 v[92:95], v[20:23], a[184:187], v[92:95]
    ds_read_b128 v[16:19], v49 offset:512
    ds_read_b128 v[20:23], v50 offset:512
    s_waitcnt lgkmcnt(6)
    v_mfma_f32_16x16x32_bf16 v[64:67], v[24:27], a[20:23], v[64:67]
    v_mfma_f32_16x16x32_bf16 v[68:71], v[24:27], a[76:79], v[68:71]
    v_mfma_f32_16x16x32_bf16 v[72:75], v[24:27], a[132:135], v[72:75]
    v_mfma_f32_16x16x32_bf16 v[76:79], v[24:27], a[188:191], v[76:79]
    v_mfma_f32_16x16x32_bf16 v[80:83], v[28:31], a[20:23], v[80:83]
    v_mfma_f32_16x16x32_bf16 v[84:87], v[28:31], a[76:79], v[84:87]
    v_mfma_f32_16x16x32_bf16 v[88:91], v[28:31], a[132:135], v[88:91]
    v_mfma_f32_16x16x32_bf16 v[92:95], v[28:31], a[188:191], v[92:95]
    ds_read_b128 v[24:27], v49 offset:576
    ds_read_b128 v[28:31], v50 offset:576
    s_waitcnt lgkmcnt(6)
    v_mfma_f32_16x16x32_bf16 v[64:67], v[32:35], a[24:27], v[64:67]
    v_mfma_f32_16x16x32_bf16 v[68:71], v[32:35], a[80:83], v[68:71]
    v_mfma_f32_16x16x32_bf16 v[72:75], v[32:35], a[136:139], v[72:75]
    v_mfma_f32_16x16x32_bf16 v[76:79], v[32:35], a[192:195], v[76:79]
    v_mfma_f32_16x16x32_bf16 v[80:83], v[36:39], a[24:27], v[80:83]
    v_mfma_f32_16x16x32_bf16 v[84:87], v[36:39], a[80:83], v[84:87]
    v_mfma_f32_16x16x32_bf16 v[88:91], v[36:39], a[136:139], v[88:91]
    v_mfma_f32_16x16x32_bf16 v[92:95], v[36:39], a[192:195], v[92:95]
    ds_read_b128 v[32:35], v49 offset:640
    ds_read_b128 v[36:39], v50 offset:640
    s_waitcnt lgkmcnt(6)
    v_mfma_f32_16x16x32_bf16 v[64:67], v[40:43], a[28:31], v[64:67]
    v_mfma_f32_16x16x32_bf16 v[68:71], v[40:43], a[84:87], v[68:71]
    v_mfma_f32_16x16x32_bf16 v[72:75], v[40:43], a[140:143], v[72:75]
    v_mfma_f32_16x16x32_bf16 v[76:79], v[40:43], a[196:199], v[76:79]
    v_mfma_f32_16x16x32_bf16 v[80:83], v[44:47], a[28:31], v[80:83]
    v_mfma_f32_16x16x32_bf16 v[84:87], v[44:47], a[84:87], v[84:87]
    v_mfma_f32_16x16x32_bf16 v[88:91], v[44:47], a[140:143], v[88:91]
    v_mfma_f32_16x16x32_bf16 v[92:95], v[44:47], a[196:199], v[92:95]
    ds_read_b128 v[40:43], v49 offset:704
    ds_read_b128 v[44:47], v50 offset:704
    s_waitcnt lgkmcnt(6)
    v_mfma_f32_16x16x32_bf16 v[64:67], v[16:19], a[32:35], v[64:67]
    v_mfma_f32_16x16x32_bf16 v[68:71], v[16:19], a[88:91], v[68:71]
    v_mfma_f32_16x16x32_bf16 v[72:75], v[16:19], a[144:147], v[72:75]
    v_mfma_f32_16x16x32_bf16 v[76:79], v[16:19], a[200:203], v[76:79]
    v_mfma_f32_16x16x32_bf16 v[80:83], v[20:23], a[32:35], v[80:83]
    v_mfma_f32_16x16x32_bf16 v[84:87], v[20:23], a[88:91], v[84:87]
    v_mfma_f32_16x16x32_bf16 v[88:91], v[20:23], a[144:147], v[88:91]
    v_mfma_f32_16x16x32_bf16 v[92:95], v[20:23], a[200:203], v[92:95]
    ds_read_b128 v[16:19], v49 offset:768
    ds_read_b128 v[20:23], v50 offset:768
    s_waitcnt lgkmcnt(6)
    v_mfma_f32_16x16x32_bf16 v[64:67], v[24:27], a[36:39], v[64:67]
    v_mfma_f32_16x16x32_bf16 v[68:71], v[24:27], a[92:95], v[68:71]
    v_mfma_f32_16x16x32_bf16 v[72:75], v[24:27], a[148:151], v[72:75]
    v_mfma_f32_16x16x32_bf16 v[76:79], v[24:27], a[204:207], v[76:79]
    v_mfma_f32_16x16x32_bf16 v[80:83], v[28:31], a[36:39], v[80:83]
    v_mfma_f32_16x16x32_bf16 v[84:87], v[28:31], a[92:95], v[84:87]
    v_mfma_f32_16x16x32_bf16 v[88:91], v[28:31], a[148:151], v[88:91]
    v_mfma_f32_16x16x32_bf16 v[92:95], v[28:31], a[204:207], v[92:95]
    ds_read_b128 v[24:27], v49 offset:832
    ds_read_b128 v[28:31], v50 offset:832
    s_waitcnt lgkmcnt(6)
    v_mfma_f32_16x16x32_bf16 v[64:67], v[32:35], a[40:43], v[64:67]
    v_mfma_f32_16x16x32_bf16 v[68:71], v[32:35], a[96:99], v[68:71]
    v_mfma_f32_16x16x32_bf16 v[72:75], v[32:35], a[152:155], v[72:75]
    v_mfma_f32_16x16x32_bf16 v[76:79], v[32:35], a[208:211], v[76:79]
    v_mfma_f32_16x16x32_bf16 v[80:83], v[36:39], a[40:43], v[80:83]
    v_mfma_f32_16x16x32_bf16 v[84:87], v[36:39], a[96:99], v[84:87]
    v_mfma_f32_16x16x32_bf16 v[88:91], v[36:39], a[152:155], v[88:91]
    v_mfma_f32_16x16x32_bf16 v[92:95], v[36:39], a[208:211], v[92:95]
    s_waitcnt lgkmcnt(4)
    v_mfma_f32_16x16x32_bf16 v[64:67], v[40:43], a[44:47], v[64:67]
    v_mfma_f32_16x16x32_bf16 v[68:71], v[40:43], a[100:103], v[68:71]
    v_mfma_f32_16x16x32_bf16 v[72:75], v[40:43], a[156:159], v[72:75]
    v_mfma_f32_16x16x32_bf16 v[76:79], v[40:43], a[212:215], v[76:79]
    v_mfma_f32_16x16x32_bf16 v[80:83], v[44:47], a[44:47], v[80:83]
    v_mfma_f32_16x16x32_bf16 v[84:87], v[44:47], a[100:103], v[84:87]
    v_mfma_f32_16x16x32_bf16 v[88:91], v[44:47], a[156:159], v[88:91]
    v_mfma_f32_16x16x32_bf16 v[92:95], v[44:47], a[212:215], v[92:95]
    s_waitcnt lgkmcnt(2)
    v_mfma_f32_16x16x32_bf16 v[64:67], v[16:19], a[48:51], v[64:67]
    v_mfma_f32_16x16x32_bf16 v[68:71], v[16:19], a[104:107], v[68:71]
    v_mfma_f32_16x16x32_bf16 v[72:75], v[16:19], a[160:163], v[72:75]
    v_mfma_f32_16x16x32_bf16 v[76:79], v[16:19], a[216:219], v[76:79]
    v_mfma_f32_16x16x32_bf16 v[80:83], v[20:23], a[48:51], v[80:83]
    v_mfma_f32_16x16x32_bf16 v[84:87], v[20:23], a[104:107], v[84:87]
    v_mfma_f32_16x16x32_bf16 v[88:91], v[20:23], a[160:163], v[88:91]
    v_mfma_f32_16x16x32_bf16 v[92:95], v[20:23], a[216:219], v[92:95]
    s_waitcnt lgkmcnt(0)
    v_mfma_f32_16x16x32_bf16 v[64:67], v[24:27], a[52:55], v[64:67]
    v_mfma_f32_16x16x32_bf16 v[68:71], v[24:27], a[108:111], v[68:71]
    v_mfma_f32_16x16x32_bf16 v[72:75], v[24:27], a[164:167], v[72:75]
    v_mfma_f32_16x16x32_bf16 v[76:79], v[24:27], a[220:223], v[76:79]
    v_mfma_f32_16x16x32_bf16 v[80:83], v[28:31], a[52:55], v[80:83]
    v_mfma_f32_16x16x32_bf16 v[84:87], v[28:31], a[108:111], v[84:87]
    v_mfma_f32_16x16x32_bf16 v[88:91], v[28:31], a[164:167], v[88:91]
    v_mfma_f32_16x16x32_bf16 v[92:95], v[28:31], a[220:223], v[92:95]
    s_xor_b32 s47, s47, 29184
    s_nop 7
    v_cvt_pk_bf16_f32 v96, v64, v65
    v_cvt_pk_bf16_f32 v97, v66, v67
    v_cvt_pk_bf16_f32 v98, v80, v81
    v_cvt_pk_bf16_f32 v99, v82, v83
    buffer_store_dwordx4 v[96:99], v7, s[20:23], s44 offen offset:0 sc1
    v_cvt_pk_bf16_f32 v100, v68, v69
    v_cvt_pk_bf16_f32 v101, v70, v71
    v_cvt_pk_bf16_f32 v102, v84, v85
    v_cvt_pk_bf16_f32 v103, v86, v87
    buffer_store_dwordx4 v[100:103], v7, s[20:23], s44 offen offset:1024 sc1
    v_cvt_pk_bf16_f32 v104, v72, v73
    v_cvt_pk_bf16_f32 v105, v74, v75
    v_cvt_pk_bf16_f32 v106, v88, v89
    v_cvt_pk_bf16_f32 v107, v90, v91
    buffer_store_dwordx4 v[104:107], v7, s[20:23], s44 offen offset:2048 sc1
    v_cvt_pk_bf16_f32 v108, v76, v77
    v_cvt_pk_bf16_f32 v109, v78, v79
    v_cvt_pk_bf16_f32 v110, v92, v93
    v_cvt_pk_bf16_f32 v111, v94, v95
    buffer_store_dwordx4 v[108:111], v7, s[20:23], s44 offen offset:3072 sc1
    s_waitcnt vmcnt(0)
    s_barrier
    s_cmp_lg_u32 s3, 0
    s_cbranch_scc1 mega_kernel_sg60
    s_lshl_b32 s70, s42, 7
    s_add_u32 s70, s70, 167624704
    v_mov_b32 v14, 1
    v_mov_b32 v15, 0
    s_mov_b64 exec, 1
    buffer_atomic_add v14, v15, s[20:23], s70 offen sc1
    s_mov_b64 exec, -1
mega_kernel_sg60:
    s_add_u32 s44, s44, 458752
    s_add_u32 s42, s42, 1
    s_cmp_lt_u32 s42, 64
    s_cbranch_scc0 g2_done
    s_cmp_lg_u32 s3, 0
    s_cbranch_scc1 mega_kernel_wd62
    s_lshl_b32 s70, s42, 7
    s_add_u32 s70, s70, 167567360
mega_kernel_wc61:
    buffer_load_dword v14, v15, s[20:23], s70 offen sc1
    s_waitcnt vmcnt(0)
    v_readfirstlane_b32 s71, v14
    s_cmp_ge_u32 s71, 2
    s_cbranch_scc1 mega_kernel_wd62
    s_sleep 6
    s_branch mega_kernel_wc61
mega_kernel_wd62:
    s_barrier
    s_mov_b64 exec, s[34:35]
    s_add_u32 s48, s46, s47
    s_mov_b32 s49, s43
    s_mov_b32 m0, s48
    s_nop 0
    buffer_load_dwordx4 v6, s[20:23], s49 offen sc1 lds
    s_add_u32 s48, s48, 912
    s_add_u32 s49, s49, 896
    s_mov_b32 m0, s48
    s_nop 0
    buffer_load_dwordx4 v6, s[20:23], s49 offen sc1 lds
    s_add_u32 s48, s48, 912
    s_add_u32 s49, s49, 896
    s_mov_b32 m0, s48
    s_nop 0
    buffer_load_dwordx4 v6, s[20:23], s49 offen sc1 lds
    s_add_u32 s48, s48, 912
    s_add_u32 s49, s49, 896
    s_mov_b32 m0, s48
    s_nop 0
    buffer_load_dwordx4 v6, s[20:23], s49 offen sc1 lds
    s_add_u32 s48, s48, 912
    s_add_u32 s49, s49, 896
    s_mov_b32 m0, s48
    s_nop 0
    buffer_load_dwordx4 v6, s[20:23], s49 offen sc1 lds
    s_add_u32 s48, s48, 912
    s_add_u32 s49, s49, 896
    s_mov_b32 m0, s48
    s_nop 0
    buffer_load_dwordx4 v6, s[20:23], s49 offen sc1 lds
    s_add_u32 s48, s48, 912
    s_add_u32 s49, s49, 896
    s_mov_b32 m0, s48
    s_nop 0
    buffer_load_dwordx4 v6, s[20:23], s49 offen sc1 lds
    s_add_u32 s48, s48, 912
    s_add_u32 s49, s49, 896
    s_mov_b32 m0, s48
    s_nop 0
    buffer_load_dwordx4 v6, s[20:23], s49 offen sc1 lds
    s_mov_b64 exec, -1
    s_add_u32 s43, s43, 28672
    s_branch g2_loop
g2_done:
    s_endpgm
gx_start:
    v_mul_u32_u24 v5, 896, v2
    v_lshl_add_u32 v5, v3, 4, v5
    s_lshl_b32 s24, s2, 8
    s_lshl_b32 s25, s3, 6
    s_add_u32 s24, s24, s25
    s_mul_i32 s25, s24, 896
    s_add_u32 s25, s25, 5275648
    v_lshlrev_b32 v12, 4, v1
    v_add_u32 v13, 4096, v12
    v_add_u32 v14, 8192, v12
    v_add_u32 v15, 12288, v12
    buffer_load_dwordx4 a[0:3], v12, s[20:23], s25 offen offset:0
    buffer_load_dwordx4 a[4:7], v12, s[20:23], s25 offen offset:1024
    buffer_load_dwordx4 a[8:11], v12, s[20:23], s25 offen offset:2048
    buffer_load_dwordx4 a[12:15], v12, s[20:23], s25 offen offset:3072
    buffer_load_dwordx4 a[16:19], v13, s[20:23], s25 offen offset:0
    buffer_load_dwordx4 a[20:23], v13, s[20:23], s25 offen offset:1024
    buffer_load_dwordx4 a[24:27], v13, s[20:23], s25 offen offset:2048
    buffer_load_dwordx4 a[28:31], v13, s[20:23], s25 offen offset:3072
    buffer_load_dwordx4 a[32:35], v14, s[20:23], s25 offen offset:0
    buffer_load_dwordx4 a[36:39], v14, s[20:23], s25 offen offset:1024
    buffer_load_dwordx4 a[40:43], v14, s[20:23], s25 offen offset:2048
    buffer_load_dwordx4 a[44:47], v14, s[20:23], s25 offen offset:3072
    buffer_load_dwordx4 a[48:51], v15, s[20:23], s25 offen offset:0
    buffer_load_dwordx4 a[52:55], v15, s[20:23], s25 offen offset:1024
    s_add_u32 s25, s25, 14336
    buffer_load_dwordx4 a[56:59], v12, s[20:23], s25 offen offset:0
    buffer_load_dwordx4 a[60:63], v12, s[20:23], s25 offen offset:1024
    buffer_load_dwordx4 a[64:67], v12, s[20:23], s25 offen offset:2048
    buffer_load_dwordx4 a[68:71], v12, s[20:23], s25 offen offset:3072
    buffer_load_dwordx4 a[72:75], v13, s[20:23], s25 offen offset:0
    buffer_load_dwordx4 a[76:79], v13, s[20:23], s25 offen offset:1024
    buffer_load_dwordx4 a[80:83], v13, s[20:23], s25 offen offset:2048
    buffer_load_dwordx4 a[84:87], v13, s[20:23], s25 offen offset:3072
    buffer_load_dwordx4 a[88:91], v14, s[20:23], s25 offen offset:0
    buffer_load_dwordx4 a[92:95], v14, s[20:23], s25 offen offset:1024
    buffer_load_dwordx4 a[96:99], v14, s[20:23], s25 offen offset:2048
    buffer_load_dwordx4 a[100:103], v14, s[20:23], s25 offen offset:3072
    buffer_load_dwordx4 a[104:107], v15, s[20:23], s25 offen offset:0
    buffer_load_dwordx4 a[108:111], v15, s[20:23], s25 offen offset:1024
    s_add_u32 s25, s25, 14336
    buffer_load_dwordx4 a[112:115], v12, s[20:23], s25 offen offset:0
    buffer_load_dwordx4 a[116:119], v12, s[20:23], s25 offen offset:1024
    buffer_load_dwordx4 a[120:123], v12, s[20:23], s25 offen offset:2048
    buffer_load_dwordx4 a[124:127], v12, s[20:23], s25 offen offset:3072
    buffer_load_dwordx4 a[128:131], v13, s[20:23], s25 offen offset:0
    buffer_load_dwordx4 a[132:135], v13, s[20:23], s25 offen offset:1024
    buffer_load_dwordx4 a[136:139], v13, s[20:23], s25 offen offset:2048
    buffer_load_dwordx4 a[140:143], v13, s[20:23], s25 offen offset:3072
    buffer_load_dwordx4 a[144:147], v14, s[20:23], s25 offen offset:0
    buffer_load_dwordx4 a[148:151], v14, s[20:23], s25 offen offset:1024
    buffer_load_dwordx4 a[152:155], v14, s[20:23], s25 offen offset:2048
    buffer_load_dwordx4 a[156:159], v14, s[20:23], s25 offen offset:3072
    buffer_load_dwordx4 a[160:163], v15, s[20:23], s25 offen offset:0
    buffer_load_dwordx4 a[164:167], v15, s[20:23], s25 offen offset:1024
    s_add_u32 s25, s25, 14336
    buffer_load_dwordx4 a[168:171], v12, s[20:23], s25 offen offset:0
    buffer_load_dwordx4 a[172:175], v12, s[20:23], s25 offen offset:1024
    buffer_load_dwordx4 a[176:179], v12, s[20:23], s25 offen offset:2048
    buffer_load_dwordx4 a[180:183], v12, s[20:23], s25 offen offset:3072
    buffer_load_dwordx4 a[184:187], v13, s[20:23], s25 offen offset:0
    buffer_load_dwordx4 a[188:191], v13, s[20:23], s25 offen offset:1024
    buffer_load_dwordx4 a[192:195], v13, s[20:23], s25 offen offset:2048
    buffer_load_dwordx4 a[196:199], v13, s[20:23], s25 offen offset:3072
    buffer_load_dwordx4 a[200:203], v14, s[20:23], s25 offen offset:0
    buffer_load_dwordx4 a[204:207], v14, s[20:23], s25 offen offset:1024
    buffer_load_dwordx4 a[208:211], v14, s[20:23], s25 offen offset:2048
    buffer_load_dwordx4 a[212:215], v14, s[20:23], s25 offen offset:3072
    buffer_load_dwordx4 a[216:219], v15, s[20:23], s25 offen offset:0
    buffer_load_dwordx4 a[220:223], v15, s[20:23], s25 offen offset:1024
    s_mov_b32 s34, -1
    s_mov_b32 s35, 0x00ffffff
    v_lshlrev_b32 v6, 4, v1
    s_mul_i32 s46, s3, 7296
    v_mul_u32_u24 v5, 912, v2
    v_lshl_add_u32 v5, v3, 4, v5
    v_mov_b32 v15, 0
    v_lshlrev_b32 v7, 4, v2
    v_and_b32 v8, 1, v3
    v_lshl_add_u32 v7, v8, 9, v7
    v_lshrrev_b32 v8, 1, v3
    v_lshl_add_u32 v7, v8, 8, v7
    s_mul_hi_u32 s26, s24, 9586981
    s_mul_i32 s27, s26, 448
    s_sub_u32 s27, s24, s27
    s_lshl_b32 s27, s27, 5
    s_mul_i32 s26, s26, 28672
    s_add_u32 s26, s26, s27
    s_mul_i32 s27, s3, 7168
    s_mov_b32 s42, 0
    s_mov_b32 s47, 0
    s_mov_b32 s51, 29184
    s_mov_b32 s54, 58368
    s_cmp_ge_u32 s42, 22
    s_cbranch_scc1 mega_kernel_t63
    s_mov_b32 s56, 0
    s_mov_b32 s57, s42
    s_branch mega_kernel_t65
mega_kernel_t63:
    s_cmp_ge_u32 s42, 70
    s_cbranch_scc1 mega_kernel_t64
    s_sub_u32 s57, s42, 22
    s_and_b32 s56, s57, 1
    s_lshr_b32 s57, s57, 1
    s_cmp_eq_u32 s56, 1
    s_cbranch_scc1 mega_kernel_t65
    s_add_u32 s57, s57, 22
    s_branch mega_kernel_t65
mega_kernel_t64:
    s_mov_b32 s56, 0
    s_sub_u32 s57, s42, 24
mega_kernel_t65:
    s_cmp_eq_u32 s56, 0
    s_cbranch_scc1 mega_kernel_nw66
    s_cmp_lg_u32 s3, 0
    s_cbranch_scc1 mega_kernel_wd68
    s_lshl_b32 s70, s57, 7
    s_add_u32 s70, s70, 167567360
mega_kernel_wc67:
    buffer_load_dword v14, v15, s[20:23], s70 offen sc1
    s_waitcnt vmcnt(0)
    v_readfirstlane_b32 s71, v14
    s_cmp_ge_u32 s71, 2
    s_cbranch_scc1 mega_kernel_wd68
    s_sleep 6
    s_branch mega_kernel_wc67
mega_kernel_wd68:
    s_barrier
mega_kernel_nw66:
    s_mul_i32 s49, s56, 1835008
    s_mul_i32 s58, s57, 28672
    s_add_u32 s49, s49, s58
    s_add_u32 s49, s49, s27
    s_add_u32 s49, s49, 31752192
    s_mov_b64 exec, s[34:35]
    s_add_u32 s48, s46, s47
    s_mov_b32 m0, s48
    s_nop 0
    buffer_load_dwordx4 v6, s[20:23], s49 offen sc1 lds
    s_add_u32 s48, s48, 912
    s_add_u32 s49, s49, 896
    s_mov_b32 m0, s48
    s_nop 0
    buffer_load_dwordx4 v6, s[20:23], s49 offen sc1 lds
    s_add_u32 s48, s48, 912
    s_add_u32 s49, s49, 896
    s_mov_b32 m0, s48
    s_nop 0
    buffer_load_dwordx4 v6, s[20:23], s49 offen sc1 lds
    s_add_u32 s48, s48, 912
    s_add_u32 s49, s49, 896
    s_mov_b32 m0, s48
    s_nop 0
    buffer_load_dwordx4 v6, s[20:23], s49 offen sc1 lds
    s_add_u32 s48, s48, 912
    s_add_u32 s49, s49, 896
    s_mov_b32 m0, s48
    s_nop 0
    buffer_load_dwordx4 v6, s[20:23], s49 offen sc1 lds
    s_add_u32 s48, s48, 912
    s_add_u32 s49, s49, 896
    s_mov_b32 m0, s48
    s_nop 0
    buffer_load_dwordx4 v6, s[20:23], s49 offen sc1 lds
    s_add_u32 s48, s48, 912
    s_add_u32 s49, s49, 896
    s_mov_b32 m0, s48
    s_nop 0
    buffer_load_dwordx4 v6, s[20:23], s49 offen sc1 lds
    s_add_u32 s48, s48, 912
    s_add_u32 s49, s49, 896
    s_mov_b32 m0, s48
    s_nop 0
    buffer_load_dwordx4 v6, s[20:23], s49 offen sc1 lds
    s_mov_b64 exec, -1
    s_waitcnt vmcnt(0)
    s_mov_b32 s72, 1
    s_cmp_ge_u32 s72, 22
    s_cbranch_scc1 mega_kernel_t69
    s_mov_b32 s56, 0
    s_mov_b32 s57, s72
    s_branch mega_kernel_t71
mega_kernel_t69:
    s_cmp_ge_u32 s72, 70
    s_cbranch_scc1 mega_kernel_t70
    s_sub_u32 s57, s72, 22
    s_and_b32 s56, s57, 1
    s_lshr_b32 s57, s57, 1
    s_cmp_eq_u32 s56, 1
    s_cbranch_scc1 mega_kernel_t71
    s_add_u32 s57, s57, 22
    s_branch mega_kernel_t71
mega_kernel_t70:
    s_mov_b32 s56, 0
    s_sub_u32 s57, s72, 24
mega_kernel_t71:
    s_cmp_eq_u32 s56, 0
    s_cbranch_scc1 mega_kernel_nw72
    s_cmp_lg_u32 s3, 0
    s_cbranch_scc1 mega_kernel_wd74
    s_lshl_b32 s70, s57, 7
    s_add_u32 s70, s70, 167567360
mega_kernel_wc73:
    buffer_load_dword v14, v15, s[20:23], s70 offen sc1
    s_waitcnt vmcnt(0)
    v_readfirstlane_b32 s71, v14
    s_cmp_ge_u32 s71, 2
    s_cbranch_scc1 mega_kernel_wd74
    s_sleep 6
    s_branch mega_kernel_wc73
mega_kernel_wd74:
    s_barrier
mega_kernel_nw72:
    s_mul_i32 s49, s56, 1835008
    s_mul_i32 s58, s57, 28672
    s_add_u32 s49, s49, s58
    s_add_u32 s49, s49, s27
    s_add_u32 s49, s49, 31752192
    s_mov_b64 exec, s[34:35]
    s_add_u32 s48, s46, s51
    s_mov_b32 m0, s48
    s_nop 0
    buffer_load_dwordx4 v6, s[20:23], s49 offen sc1 lds
    s_add_u32 s48, s48, 912
    s_add_u32 s49, s49, 896
    s_mov_b32 m0, s48
    s_nop 0
    buffer_load_dwordx4 v6, s[20:23], s49 offen sc1 lds
    s_add_u32 s48, s48, 912
    s_add_u32 s49, s49, 896
    s_mov_b32 m0, s48
    s_nop 0
    buffer_load_dwordx4 v6, s[20:23], s49 offen sc1 lds
    s_add_u32 s48, s48, 912
    s_add_u32 s49, s49, 896
    s_mov_b32 m0, s48
    s_nop 0
    buffer_load_dwordx4 v6, s[20:23], s49 offen sc1 lds
    s_add_u32 s48, s48, 912
    s_add_u32 s49, s49, 896
    s_mov_b32 m0, s48
    s_nop 0
    buffer_load_dwordx4 v6, s[20:23], s49 offen sc1 lds
    s_add_u32 s48, s48, 912
    s_add_u32 s49, s49, 896
    s_mov_b32 m0, s48
    s_nop 0
    buffer_load_dwordx4 v6, s[20:23], s49 offen sc1 lds
    s_add_u32 s48, s48, 912
    s_add_u32 s49, s49, 896
    s_mov_b32 m0, s48
    s_nop 0
    buffer_load_dwordx4 v6, s[20:23], s49 offen sc1 lds
    s_add_u32 s48, s48, 912
    s_add_u32 s49, s49, 896
    s_mov_b32 m0, s48
    s_nop 0
    buffer_load_dwordx4 v6, s[20:23], s49 offen sc1 lds
    s_mov_b64 exec, -1
gx_loop:
    s_waitcnt vmcnt(12)
    s_cmp_lt_u32 s42, 87
    s_cbranch_scc1 gx_w1
    s_waitcnt vmcnt(0)
gx_w1:
    s_barrier
    s_cmp_lt_u32 s42, 2
    s_cbranch_scc1 gx_ns
    s_cmp_lg_u32 s3, 0
    s_cbranch_scc1 gx_ns
    s_sub_u32 s72, s42, 2
    s_cmp_ge_u32 s72, 22
    s_cbranch_scc1 mega_kernel_t75
    s_mov_b32 s56, 0
    s_mov_b32 s57, s72
    s_branch mega_kernel_t77
mega_kernel_t75:
    s_cmp_ge_u32 s72, 70
    s_cbranch_scc1 mega_kernel_t76
    s_sub_u32 s57, s72, 22
    s_and_b32 s56, s57, 1
    s_lshr_b32 s57, s57, 1
    s_cmp_eq_u32 s56, 1
    s_cbranch_scc1 mega_kernel_t77
    s_add_u32 s57, s57, 22
    s_branch mega_kernel_t77
mega_kernel_t76:
    s_mov_b32 s56, 0
    s_sub_u32 s57, s72, 24
mega_kernel_t77:
    s_lshl_b32 s56, s56, 13
    s_lshl_b32 s57, s57, 7
    s_add_u32 s70, s56, s57
    s_add_u32 s70, s70, 167575552
    v_mov_b32 v14, 1
    s_mov_b64 exec, 1
    buffer_atomic_add v14, v15, s[20:23], s70 offen sc1
    s_mov_b64 exec, -1
gx_ns:
    s_cmp_ge_u32 s42, 86
    s_cbranch_scc1 gx_nodma
    s_add_u32 s72, s42, 2
    s_cmp_ge_u32 s72, 22
    s_cbranch_scc1 mega_kernel_t78
    s_mov_b32 s56, 0
    s_mov_b32 s57, s72
    s_branch mega_kernel_t80
mega_kernel_t78:
    s_cmp_ge_u32 s72, 70
    s_cbranch_scc1 mega_kernel_t79
    s_sub_u32 s57, s72, 22
    s_and_b32 s56, s57, 1
    s_lshr_b32 s57, s57, 1
    s_cmp_eq_u32 s56, 1
    s_cbranch_scc1 mega_kernel_t80
    s_add_u32 s57, s57, 22
    s_branch mega_kernel_t80
mega_kernel_t79:
    s_mov_b32 s56, 0
    s_sub_u32 s57, s72, 24
mega_kernel_t80:
    s_cmp_eq_u32 s56, 0
    s_cbranch_scc1 mega_kernel_nw81
    s_cmp_lg_u32 s3, 0
    s_cbranch_scc1 mega_kernel_wd83
    s_lshl_b32 s70, s57, 7
    s_add_u32 s70, s70, 167567360
mega_kernel_wc82:
    buffer_load_dword v14, v15, s[20:23], s70 offen sc1
    s_waitcnt vmcnt(0)
    v_readfirstlane_b32 s71, v14
    s_cmp_ge_u32 s71, 2
    s_cbranch_scc1 mega_kernel_wd83
    s_sleep 6
    s_branch mega_kernel_wc82
mega_kernel_wd83:
    s_barrier
mega_kernel_nw81:
    s_mul_i32 s49, s56, 1835008
    s_mul_i32 s58, s57, 28672
    s_add_u32 s49, s49, s58
    s_add_u32 s49, s49, s27
    s_add_u32 s49, s49, 31752192
    s_mov_b64 exec, s[34:35]
    s_add_u32 s48, s46, s54
    s_mov_b32 m0, s48
    s_nop 0
    buffer_load_dwordx4 v6, s[20:23], s49 offen sc1 lds
    s_add_u32 s48, s48, 912
    s_add_u32 s49, s49, 896
    s_mov_b32 m0, s48
    s_nop 0
    buffer_load_dwordx4 v6, s[20:23], s49 offen sc1 lds
    s_add_u32 s48, s48, 912
    s_add_u32 s49, s49, 896
    s_mov_b32 m0, s48
    s_nop 0
    buffer_load_dwordx4 v6, s[20:23], s49 offen sc1 lds
    s_add_u32 s48, s48, 912
    s_add_u32 s49, s49, 896
    s_mov_b32 m0, s48
    s_nop 0
    buffer_load_dwordx4 v6, s[20:23], s49 offen sc1 lds
    s_add_u32 s48, s48, 912
    s_add_u32 s49, s49, 896
    s_mov_b32 m0, s48
    s_nop 0
    buffer_load_dwordx4 v6, s[20:23], s49 offen sc1 lds
    s_add_u32 s48, s48, 912
    s_add_u32 s49, s49, 896
    s_mov_b32 m0, s48
    s_nop 0
    buffer_load_dwordx4 v6, s[20:23], s49 offen sc1 lds
    s_add_u32 s48, s48, 912
    s_add_u32 s49, s49, 896
    s_mov_b32 m0, s48
    s_nop 0
    buffer_load_dwordx4 v6, s[20:23], s49 offen sc1 lds
    s_add_u32 s48, s48, 912
    s_add_u32 s49, s49, 896
    s_mov_b32 m0, s48
    s_nop 0
    buffer_load_dwordx4 v6, s[20:23], s49 offen sc1 lds
    s_mov_b64 exec, -1
gx_nodma:
    v_add_u32 v49, s47, v5
    v_add_u32 v50, 14592, v49
    ds_read_b128 v[16:19], v49 offset:0
    ds_read_b128 v[20:23], v50 offset:0
    ds_read_b128 v[24:27], v49 offset:64
    ds_read_b128 v[28:31], v50 offset:64
    ds_read_b128 v[32:35], v49 offset:128
    ds_read_b128 v[36:39], v50 offset:128
    ds_read_b128 v[40:43], v49 offset:192
    ds_read_b128 v[44:47], v50 offset:192
    s_waitcnt lgkmcnt(6)
    v_mfma_f32_16x16x32_bf16 v[64:67], a[0:3], v[16:19], 0
    v_mfma_f32_16x16x32_bf16 v[68:71], a[56:59], v[16:19], 0
    v_mfma_f32_16x16x32_bf16 v[72:75], a[112:115], v[16:19], 0
    v_mfma_f32_16x16x32_bf16 v[76:79], a[168:171], v[16:19], 0
    v_mfma_f32_16x16x32_bf16 v[80:83], a[0:3], v[20:23], 0
    v_mfma_f32_16x16x32_bf16 v[84:87], a[56:59], v[20:23], 0
    v_mfma_f32_16x16x32_bf16 v[88:91], a[112:115], v[20:23], 0
    v_mfma_f32_16x16x32_bf16 v[92:95], a[168:171], v[20:23], 0
    ds_read_b128 v[16:19], v49 offset:256
    ds_read_b128 v[20:23], v50 offset:256
    s_waitcnt lgkmcnt(6)
    v_mfma_f32_16x16x32_bf16 v[64:67], a[4:7], v[24:27], v[64:67]
    v_mfma_f32_16x16x32_bf16 v[68:71], a[60:63], v[24:27], v[68:71]
    v_mfma_f32_16x16x32_bf16 v[72:75], a[116:119], v[24:27], v[72:75]
    v_mfma_f32_16x16x32_bf16 v[76:79], a[172:175], v[24:27], v[76:79]
    v_mfma_f32_16x16x32_bf16 v[80:83], a[4:7], v[28:31], v[80:83]
    v_mfma_f32_16x16x32_bf16 v[84:87], a[60:63], v[28:31], v[84:87]
    v_mfma_f32_16x16x32_bf16 v[88:91], a[116:119], v[28:31], v[88:91]
    v_mfma_f32_16x16x32_bf16 v[92:95], a[172:175], v[28:31], v[92:95]
    ds_read_b128 v[24:27], v49 offset:320
    ds_read_b128 v[28:31], v50 offset:320
    s_waitcnt lgkmcnt(6)
    v_mfma_f32_16x16x32_bf16 v[64:67], a[8:11], v[32:35], v[64:67]
    v_mfma_f32_16x16x32_bf16 v[68:71], a[64:67], v[32:35], v[68:71]
    v_mfma_f32_16x16x32_bf16 v[72:75], a[120:123], v[32:35], v[72:75]
    v_mfma_f32_16x16x32_bf16 v[76:79], a[176:179], v[32:35], v[76:79]
    v_mfma_f32_16x16x32_bf16 v[80:83], a[8:11], v[36:39], v[80:83]
    v_mfma_f32_16x16x32_bf16 v[84:87], a[64:67], v[36:39], v[84:87]
    v_mfma_f32_16x16x32_bf16 v[88:91], a[120:123], v[36:39], v[88:91]
    v_mfma_f32_16x16x32_bf16 v[92:95], a[176:179], v[36:39], v[92:95]
    ds_read_b128 v[32:35], v49 offset:384
    ds_read_b128 v[36:39], v50 offset:384
    s_waitcnt lgkmcnt(6)
    v_mfma_f32_16x16x32_bf16 v[64:67], a[12:15], v[40:43], v[64:67]
    v_mfma_f32_16x16x32_bf16 v[68:71], a[68:71], v[40:43], v[68:71]
    v_mfma_f32_16x16x32_bf16 v[72:75], a[124:127], v[40:43], v[72:75]
    v_mfma_f32_16x16x32_bf16 v[76:79], a[180:183], v[40:43], v[76:79]
    v_mfma_f32_16x16x32_bf16 v[80:83], a[12:15], v[44:47], v[80:83]
    v_mfma_f32_16x16x32_bf16 v[84:87], a[68:71], v[44:47], v[84:87]
    v_mfma_f32_16x16x32_bf16 v[88:91], a[124:127], v[44:47], v[88:91]
    v_mfma_f32_16x16x32_bf16 v[92:95], a[180:183], v[44:47], v[92:95]
    ds_read_b128 v[40:43], v49 offset:448
    ds_read_b128 v[44:47], v50 offset:448
    s_waitcnt lgkmcnt(6)
    v_mfma_f32_16x16x32_bf16 v[64:67], a[16:19], v[16:19], v[64:67]
    v_mfma_f32_16x16x32_bf16 v[68:71], a[72:75], v[16:19], v[68:71]
    v_mfma_f32_16x16x32_bf16 v[72:75], a[128:131], v[16:19], v[72:75]
    v_mfma_f32_16x16x32_bf16 v[76:79], a[184:187], v[16:19], v[76:79]
    v_mfma_f32_16x16x32_bf16 v[80:83], a[16:19], v[20:23], v[80:83]
    v_mfma_f32_16x16x32_bf16 v[84:87], a[72:75], v[20:23], v[84:87]
    v_mfma_f32_16x16x32_bf16 v[88:91], a[128:131], v[20:23], v[88:91]
    v_mfma_f32_16x16x32_bf16 v[92:95], a[184:187], v[20:23], v[92:95]
    ds_read_b128 v[16:19], v49 offset:512
    ds_read_b128 v[20:23], v50 offset:512
    s_waitcnt lgkmcnt(6)
    v_mfma_f32_16x16x32_bf16 v[64:67], a[20:23], v[24:27], v[64:67]
    v_mfma_f32_16x16x32_bf16 v[68:71], a[76:79], v[24:27], v[68:71]
    v_mfma_f32_16x16x32_bf16 v[72:75], a[132:135], v[24:27], v[72:75]
    v_mfma_f32_16x16x32_bf16 v[76:79], a[188:191], v[24:27], v[76:79]
    v_mfma_f32_16x16x32_bf16 v[80:83], a[20:23], v[28:31], v[80:83]
    v_mfma_f32_16x16x32_bf16 v[84:87], a[76:79], v[28:31], v[84:87]
    v_mfma_f32_16x16x32_bf16 v[88:91], a[132:135], v[28:31], v[88:91]
    v_mfma_f32_16x16x32_bf16 v[92:95], a[188:191], v[28:31], v[92:95]
    ds_read_b128 v[24:27], v49 offset:576
    ds_read_b128 v[28:31], v50 offset:576
    s_waitcnt lgkmcnt(6)
    v_mfma_f32_16x16x32_bf16 v[64:67], a[24:27], v[32:35], v[64:67]
    v_mfma_f32_16x16x32_bf16 v[68:71], a[80:83], v[32:35], v[68:71]
    v_mfma_f32_16x16x32_bf16 v[72:75], a[136:139], v[32:35], v[72:75]
    v_mfma_f32_16x16x32_bf16 v[76:79], a[192:195], v[32:35], v[76:79]
    v_mfma_f32_16x16x32_bf16 v[80:83], a[24:27], v[36:39], v[80:83]
    v_mfma_f32_16x16x32_bf16 v[84:87], a[80:83], v[36:39], v[84:87]
    v_mfma_f32_16x16x32_bf16 v[88:91], a[136:139], v[36:39], v[88:91]
    v_mfma_f32_16x16x32_bf16 v[92:95], a[192:195], v[36:39], v[92:95]
    ds_read_b128 v[32:35], v49 offset:640
    ds_read_b128 v[36:39], v50 offset:640
    s_waitcnt lgkmcnt(6)
    v_mfma_f32_16x16x32_bf16 v[64:67], a[28:31], v[40:43], v[64:67]
    v_mfma_f32_16x16x32_bf16 v[68:71], a[84:87], v[40:43], v[68:71]
    v_mfma_f32_16x16x32_bf16 v[72:75], a[140:143], v[40:43], v[72:75]
    v_mfma_f32_16x16x32_bf16 v[76:79], a[196:199], v[40:43], v[76:79]
    v_mfma_f32_16x16x32_bf16 v[80:83], a[28:31], v[44:47], v[80:83]
    v_mfma_f32_16x16x32_bf16 v[84:87], a[84:87], v[44:47], v[84:87]
    v_mfma_f32_16x16x32_bf16 v[88:91], a[140:143], v[44:47], v[88:91]
    v_mfma_f32_16x16x32_bf16 v[92:95], a[196:199], v[44:47], v[92:95]
    ds_read_b128 v[40:43], v49 offset:704
    ds_read_b128 v[44:47], v50 offset:704
    s_waitcnt lgkmcnt(6)
    v_mfma_f32_16x16x32_bf16 v[64:67], a[32:35], v[16:19], v[64:67]
    v_mfma_f32_16x16x32_bf16 v[68:71], a[88:91], v[16:19], v[68:71]
    v_mfma_f32_16x16x32_bf16 v[72:75], a[144:147], v[16:19], v[72:75]
    v_mfma_f32_16x16x32_bf16 v[76:79], a[200:203], v[16:19], v[76:79]
    v_mfma_f32_16x16x32_bf16 v[80:83], a[32:35], v[20:23], v[80:83]
    v_mfma_f32_16x16x32_bf16 v[84:87], a[88:91], v[20:23], v[84:87]
    v_mfma_f32_16x16x32_bf16 v[88:91], a[144:147], v[20:23], v[88:91]
    v_mfma_f32_16x16x32_bf16 v[92:95], a[200:203], v[20:23], v[92:95]
    ds_read_b128 v[16:19], v49 offset:768
    ds_read_b128 v[20:23], v50 offset:768
    s_waitcnt lgkmcnt(6)
    v_mfma_f32_16x16x32_bf16 v[64:67], a[36:39], v[24:27], v[64:67]
    v_mfma_f32_16x16x32_bf16 v[68:71], a[92:95], v[24:27], v[68:71]
    v_mfma_f32_16x16x32_bf16 v[72:75], a[148:151], v[24:27], v[72:75]
    v_mfma_f32_16x16x32_bf16 v[76:79], a[204:207], v[24:27], v[76:79]
    v_mfma_f32_16x16x32_bf16 v[80:83], a[36:39], v[28:31], v[80:83]
    v_mfma_f32_16x16x32_bf16 v[84:87], a[92:95], v[28:31], v[84:87]
    v_mfma_f32_16x16x32_bf16 v[88:91], a[148:151], v[28:31], v[88:91]
    v_mfma_f32_16x16x32_bf16 v[92:95], a[204:207], v[28:31], v[92:95]
    ds_read_b128 v[24:27], v49 offset:832
    ds_read_b128 v[28:31], v50 offset:832
    s_waitcnt lgkmcnt(6)
    v_mfma_f32_16x16x32_bf16 v[64:67], a[40:43], v[32:35], v[64:67]
    v_mfma_f32_16x16x32_bf16 v[68:71], a[96:99], v[32:35], v[68:71]
    v_mfma_f32_16x16x32_bf16 v[72:75], a[152:155], v[32:35], v[72:75]
    v_mfma_f32_16x16x32_bf16 v[76:79], a[208:211], v[32:35], v[76:79]
    v_mfma_f32_16x16x32_bf16 v[80:83], a[40:43], v[36:39], v[80:83]
    v_mfma_f32_16x16x32_bf16 v[84:87], a[96:99], v[36:39], v[84:87]
    v_mfma_f32_16x16x32_bf16 v[88:91], a[152:155], v[36:39], v[88:91]
    v_mfma_f32_16x16x32_bf16 v[92:95], a[208:211], v[36:39], v[92:95]
    s_waitcnt lgkmcnt(4)
    v_mfma_f32_16x16x32_bf16 v[64:67], a[44:47], v[40:43], v[64:67]
    v_mfma_f32_16x16x32_bf16 v[68:71], a[100:103], v[40:43], v[68:71]
    v_mfma_f32_16x16x32_bf16 v[72:75], a[156:159], v[40:43], v[72:75]
    v_mfma_f32_16x16x32_bf16 v[76:79], a[212:215], v[40:43], v[76:79]
    v_mfma_f32_16x16x32_bf16 v[80:83], a[44:47], v[44:47], v[80:83]
    v_mfma_f32_16x16x32_bf16 v[84:87], a[100:103], v[44:47], v[84:87]
    v_mfma_f32_16x16x32_bf16 v[88:91], a[156:159], v[44:47], v[88:91]
    v_mfma_f32_16x16x32_bf16 v[92:95], a[212:215], v[44:47], v[92:95]
    s_waitcnt lgkmcnt(2)
    v_mfma_f32_16x16x32_bf16 v[64:67], a[48:51], v[16:19], v[64:67]
    v_mfma_f32_16x16x32_bf16 v[68:71], a[104:107], v[16:19], v[68:71]
    v_mfma_f32_16x16x32_bf16 v[72:75], a[160:163], v[16:19], v[72:75]
    v_mfma_f32_16x16x32_bf16 v[76:79], a[216:219], v[16:19], v[76:79]
    v_mfma_f32_16x16x32_bf16 v[80:83], a[48:51], v[20:23], v[80:83]
    v_mfma_f32_16x16x32_bf16 v[84:87], a[104:107], v[20:23], v[84:87]
    v_mfma_f32_16x16x32_bf16 v[88:91], a[160:163], v[20:23], v[88:91]
    v_mfma_f32_16x16x32_bf16 v[92:95], a[216:219], v[20:23], v[92:95]
    s_waitcnt lgkmcnt(0)
    v_mfma_f32_16x16x32_bf16 v[64:67], a[52:55], v[24:27], v[64:67]
    v_mfma_f32_16x16x32_bf16 v[68:71], a[108:111], v[24:27], v[68:71]
    v_mfma_f32_16x16x32_bf16 v[72:75], a[164:167], v[24:27], v[72:75]
    v_mfma_f32_16x16x32_bf16 v[76:79], a[220:223], v[24:27], v[76:79]
    v_mfma_f32_16x16x32_bf16 v[80:83], a[52:55], v[28:31], v[80:83]
    v_mfma_f32_16x16x32_bf16 v[84:87], a[108:111], v[28:31], v[84:87]
    v_mfma_f32_16x16x32_bf16 v[88:91], a[164:167], v[28:31], v[88:91]
    v_mfma_f32_16x16x32_bf16 v[92:95], a[220:223], v[28:31], v[92:95]
    s_mov_b32 s55, s47
    s_mov_b32 s47, s51
    s_mov_b32 s51, s54
    s_mov_b32 s54, s55
    s_cmp_ge_u32 s42, 22
    s_cbranch_scc1 mega_kernel_t84
    s_mov_b32 s56, 0
    s_mov_b32 s57, s42
    s_branch mega_kernel_t86
mega_kernel_t84:
    s_cmp_ge_u32 s42, 70
    s_cbranch_scc1 mega_kernel_t85
    s_sub_u32 s57, s42, 22
    s_and_b32 s56, s57, 1
    s_lshr_b32 s57, s57, 1
    s_cmp_eq_u32 s56, 1
    s_cbranch_scc1 mega_kernel_t86
    s_add_u32 s57, s57, 22
    s_branch mega_kernel_t86
mega_kernel_t85:
    s_mov_b32 s56, 0
    s_sub_u32 s57, s42, 24
mega_kernel_t86:
    s_mul_i32 s44, s56, 66060288
    s_mul_i32 s58, s57, 458752
    s_add_u32 s44, s44, s58
    s_add_u32 s44, s44, s26
    s_add_u32 s44, s44, 35422208
    s_add_u32 s45, s44, 14336
    v_cvt_pk_bf16_f32 v96, v64, v65
    v_cvt_pk_bf16_f32 v97, v66, v67
    v_cvt_pk_bf16_f32 v98, v68, v69
    v_cvt_pk_bf16_f32 v99, v70, v71
    s_nop 1
    v_permlane16_swap_b32 v96, v98
    v_permlane16_swap_b32 v97, v99
    buffer_store_dwordx4 v[96:99], v7, s[20:23], s44 offen offset:0 sc1
    v_cvt_pk_bf16_f32 v100, v72, v73
    v_cvt_pk_bf16_f32 v101, v74, v75
    v_cvt_pk_bf16_f32 v102, v76, v77
    v_cvt_pk_bf16_f32 v103, v78, v79
    s_nop 1
    v_permlane16_swap_b32 v100, v102
    v_permlane16_swap_b32 v101, v103
    buffer_store_dwordx4 v[100:103], v7, s[20:23], s44 offen offset:1024 sc1
    v_cvt_pk_bf16_f32 v104, v80, v81
    v_cvt_pk_bf16_f32 v105, v82, v83
    v_cvt_pk_bf16_f32 v106, v84, v85
    v_cvt_pk_bf16_f32 v107, v86, v87
    s_nop 1
    v_permlane16_swap_b32 v104, v106
    v_permlane16_swap_b32 v105, v107
    buffer_store_dwordx4 v[104:107], v7, s[20:23], s45 offen offset:0 sc1
    v_cvt_pk_bf16_f32 v108, v88, v89
    v_cvt_pk_bf16_f32 v109, v90, v91
    v_cvt_pk_bf16_f32 v110, v92, v93
    v_cvt_pk_bf16_f32 v111, v94, v95
    s_nop 1
    v_permlane16_swap_b32 v108, v110
    v_permlane16_swap_b32 v109, v111
    buffer_store_dwordx4 v[108:111], v7, s[20:23], s45 offen offset:1024 sc1
    s_add_u32 s42, s42, 1
    s_cmp_lt_u32 s42, 88
    s_cbranch_scc1 gx_loop
    s_waitcnt vmcnt(0)
    s_barrier
    s_cmp_lg_u32 s3, 0
    s_cbranch_scc1 gx_end
    s_mov_b32 s72, 86
    s_cmp_ge_u32 s72, 22
    s_cbranch_scc1 mega_kernel_t87
    s_mov_b32 s56, 0
    s_mov_b32 s57, s72
    s_branch mega_kernel_t89
mega_kernel_t87:
    s_cmp_ge_u32 s72, 70
    s_cbranch_scc1 mega_kernel_t88
    s_sub_u32 s57, s72, 22
    s_and_b32 s56, s57, 1
    s_lshr_b32 s57, s57, 1
    s_cmp_eq_u32 s56, 1
    s_cbranch_scc1 mega_kernel_t89
    s_add_u32 s57, s57, 22
    s_branch mega_kernel_t89
mega_kernel_t88:
    s_mov_b32 s56, 0
    s_sub_u32 s57, s72, 24
mega_kernel_t89:
    s_lshl_b32 s56, s56, 13
    s_lshl_b32 s57, s57, 7
    s_add_u32 s70, s56, s57
    s_add_u32 s70, s70, 167575552
    v_mov_b32 v14, 1
    s_mov_b64 exec, 1
    buffer_atomic_add v14, v15, s[20:23], s70 offen sc1
    s_mov_b64 exec, -1
    s_mov_b32 s72, 87
    s_cmp_ge_u32 s72, 22
    s_cbranch_scc1 mega_kernel_t90
    s_mov_b32 s56, 0
    s_mov_b32 s57, s72
    s_branch mega_kernel_t92
mega_kernel_t90:
    s_cmp_ge_u32 s72, 70
    s_cbranch_scc1 mega_kernel_t91
    s_sub_u32 s57, s72, 22
    s_and_b32 s56, s57, 1
    s_lshr_b32 s57, s57, 1
    s_cmp_eq_u32 s56, 1
    s_cbranch_scc1 mega_kernel_t92
    s_add_u32 s57, s57, 22
    s_branch mega_kernel_t92
mega_kernel_t91:
    s_mov_b32 s56, 0
    s_sub_u32 s57, s72, 24
mega_kernel_t92:
    s_lshl_b32 s56, s56, 13
    s_lshl_b32 s57, s57, 7
    s_add_u32 s70, s56, s57
    s_add_u32 s70, s70, 167575552
    v_mov_b32 v14, 1
    s_mov_b64 exec, 1
    buffer_atomic_add v14, v15, s[20:23], s70 offen sc1
    s_mov_b64 exec, -1
gx_end:
    s_endpgm
gh_start:
    v_mul_u32_u24 v5, 896, v2
    v_lshl_add_u32 v5, v3, 4, v5
    s_lshl_b32 s24, s2, 8
    s_lshl_b32 s25, s3, 6
    s_add_u32 s24, s24, s25
    s_add_u32 s25, s24, 0
    s_mul_i32 s25, s25, 896
    s_add_u32 s25, s25, 5275648
    v_lshlrev_b32 v12, 4, v1
    v_add_u32 v13, 4096, v12
    v_add_u32 v14, 8192, v12
    v_add_u32 v15, 12288, v12
    buffer_load_dwordx4 a[0:3], v12, s[20:23], s25 offen offset:0
    buffer_load_dwordx4 a[4:7], v12, s[20:23], s25 offen offset:1024
    buffer_load_dwordx4 a[8:11], v12, s[20:23], s25 offen offset:2048
    buffer_load_dwordx4 a[12:15], v12, s[20:23], s25 offen offset:3072
    buffer_load_dwordx4 a[16:19], v13, s[20:23], s25 offen offset:0
    buffer_load_dwordx4 a[20:23], v13, s[20:23], s25 offen offset:1024
    buffer_load_dwordx4 a[24:27], v13, s[20:23], s25 offen offset:2048
    buffer_load_dwordx4 a[28:31], v13, s[20:23], s25 offen offset:3072
    buffer_load_dwordx4 a[32:35], v14, s[20:23], s25 offen offset:0
    buffer_load_dwordx4 a[36:39], v14, s[20:23], s25 offen offset:1024
    buffer_load_dwordx4 a[40:43], v14, s[20:23], s25 offen offset:2048
    buffer_load_dwordx4 a[44:47], v14, s[20:23], s25 offen offset:3072
    buffer_load_dwordx4 a[48:51], v15, s[20:23], s25 offen offset:0
    buffer_load_dwordx4 a[52:55], v15, s[20:23], s25 offen offset:1024
    s_add_u32 s25, s25, 14336
    buffer_load_dwordx4 a[56:59], v12, s[20:23], s25 offen offset:0
    buffer_load_dwordx4 a[60:63], v12, s[20:23], s25 offen offset:1024
    buffer_load_dwordx4 a[64:67], v12, s[20:23], s25 offen offset:2048
    buffer_load_dwordx4 a[68:71], v12, s[20:23], s25 offen offset:3072
    buffer_load_dwordx4 a[72:75], v13, s[20:23], s25 offen offset:0
    buffer_load_dwordx4 a[76:79], v13, s[20:23], s25 offen offset:1024
    buffer_load_dwordx4 a[80:83], v13, s[20:23], s25 offen offset:2048
    buffer_load_dwordx4 a[84:87], v13, s[20:23], s25 offen offset:3072
    buffer_load_dwordx4 a[88:91], v14, s[20:23], s25 offen offset:0
    buffer_load_dwordx4 a[92:95], v14, s[20:23], s25 offen offset:1024
    buffer_load_dwordx4 a[96:99], v14, s[20:23], s25 offen offset:2048
    buffer_load_dwordx4 a[100:103], v14, s[20:23], s25 offen offset:3072
    buffer_load_dwordx4 a[104:107], v15, s[20:23], s25 offen offset:0
    buffer_load_dwordx4 a[108:111], v15, s[20:23], s25 offen offset:1024
    s_add_u32 s25, s25, 14336
    buffer_load_dwordx4 a[112:115], v12, s[20:23], s25 offen offset:0
    buffer_load_dwordx4 a[116:119], v12, s[20:23], s25 offen offset:1024
    buffer_load_dwordx4 a[120:123], v12, s[20:23], s25 offen offset:2048
    buffer_load_dwordx4 a[124:127], v12, s[20:23], s25 offen offset:3072
    buffer_load_dwordx4 a[128:131], v13, s[20:23], s25 offen offset:0
    buffer_load_dwordx4 a[132:135], v13, s[20:23], s25 offen offset:1024
    buffer_load_dwordx4 a[136:139], v13, s[20:23], s25 offen offset:2048
    buffer_load_dwordx4 a[140:143], v13, s[20:23], s25 offen offset:3072
    buffer_load_dwordx4 a[144:147], v14, s[20:23], s25 offen offset:0
    buffer_load_dwordx4 a[148:151], v14, s[20:23], s25 offen offset:1024
    buffer_load_dwordx4 a[152:155], v14, s[20:23], s25 offen offset:2048
    buffer_load_dwordx4 a[156:159], v14, s[20:23], s25 offen offset:3072
    buffer_load_dwordx4 a[160:163], v15, s[20:23], s25 offen offset:0
    buffer_load_dwordx4 a[164:167], v15, s[20:23], s25 offen offset:1024
    s_add_u32 s25, s25, 14336
    buffer_load_dwordx4 a[168:171], v12, s[20:23], s25 offen offset:0
    buffer_load_dwordx4 a[172:175], v12, s[20:23], s25 offen offset:1024
    buffer_load_dwordx4 a[176:179], v12, s[20:23], s25 offen offset:2048
    buffer_load_dwordx4 a[180:183], v12, s[20:23], s25 offen offset:3072
    buffer_load_dwordx4 a[184:187], v13, s[20:23], s25 offen offset:0
    buffer_load_dwordx4 a[188:191], v13, s[20:23], s25 offen offset:1024
    buffer_load_dwordx4 a[192:195], v13, s[20:23], s25 offen offset:2048
    buffer_load_dwordx4 a[196:199], v13, s[20:23], s25 offen offset:3072
    buffer_load_dwordx4 a[200:203], v14, s[20:23], s25 offen offset:0
    buffer_load_dwordx4 a[204:207], v14, s[20:23], s25 offen offset:1024
    buffer_load_dwordx4 a[208:211], v14, s[20:23], s25 offen offset:2048
    buffer_load_dwordx4 a[212:215], v14, s[20:23], s25 offen offset:3072
    buffer_load_dwordx4 a[216:219], v15, s[20:23], s25 offen offset:0
    buffer_load_dwordx4 a[220:223], v15, s[20:23], s25 offen offset:1024
    s_mov_b32 s34, -1
    s_mov_b32 s35, 0x00ffffff
    v_lshlrev_b32 v6, 4, v1
    s_mul_i32 s46, s3, 7296
    v_mul_u32_u24 v5, 912, v2
    v_lshl_add_u32 v5, v3, 4, v5
    v_mov_b32 v15, 0
    s_mul_i32 s43, s3, 7168
    s_add_u32 s43, s43, 34275328
    s_mov_b32 s42, 24
    s_mov_b32 s47, 0
    v_lshlrev_b32 v7, 4, v2
    v_and_b32 v8, 1, v3
    v_lshl_add_u32 v7, v8, 9, v7
    v_lshrrev_b32 v8, 1, v3
    v_lshl_add_u32 v7, v8, 8, v7
    s_mul_hi_u32 s26, s24, 9586981
    s_mul_i32 s27, s26, 448
    s_sub_u32 s27, s24, s27
    s_lshl_b32 s27, s27, 5
    s_mul_i32 s44, s26, 28672
    s_add_u32 s44, s44, s27
    s_add_u32 s44, s44, 112492544
    s_cmp_lg_u32 s3, 0
    s_cbranch_scc1 mega_kernel_wd94
    s_lshl_b32 s70, s42, 7
    s_add_u32 s70, s70, 167567360
mega_kernel_wc93:
    buffer_load_dword v14, v15, s[20:23], s70 offen sc1
    s_waitcnt vmcnt(0)
    v_readfirstlane_b32 s71, v14
    s_cmp_ge_u32 s71, 2
    s_cbranch_scc1 mega_kernel_wd94
    s_sleep 6
    s_branch mega_kernel_wc93
mega_kernel_wd94:
    s_barrier
    s_mov_b64 exec, s[34:35]
    s_add_u32 s48, s46, s47
    s_mov_b32 s49, s43
    s_mov_b32 m0, s48
    s_nop 0
    buffer_load_dwordx4 v6, s[20:23], s49 offen sc1 lds
    s_add_u32 s48, s48, 912
    s_add_u32 s49, s49, 896
    s_mov_b32 m0, s48
    s_nop 0
    buffer_load_dwordx4 v6, s[20:23], s49 offen sc1 lds
    s_add_u32 s48, s48, 912
    s_add_u32 s49, s49, 896
    s_mov_b32 m0, s48
    s_nop 0
    buffer_load_dwordx4 v6, s[20:23], s49 offen sc1 lds
    s_add_u32 s48, s48, 912
    s_add_u32 s49, s49, 896
    s_mov_b32 m0, s48
    s_nop 0
    buffer_load_dwordx4 v6, s[20:23], s49 offen sc1 lds
    s_add_u32 s48, s48, 912
    s_add_u32 s49, s49, 896
    s_mov_b32 m0, s48
    s_nop 0
    buffer_load_dwordx4 v6, s[20:23], s49 offen sc1 lds
    s_add_u32 s48, s48, 912
    s_add_u32 s49, s49, 896
    s_mov_b32 m0, s48
    s_nop 0
    buffer_load_dwordx4 v6, s[20:23], s49 offen sc1 lds
    s_add_u32 s48, s48, 912
    s_add_u32 s49, s49, 896
    s_mov_b32 m0, s48
    s_nop 0
    buffer_load_dwordx4 v6, s[20:23], s49 offen sc1 lds
    s_add_u32 s48, s48, 912
    s_add_u32 s49, s49, 896
    s_mov_b32 m0, s48
    s_nop 0
    buffer_load_dwordx4 v6, s[20:23], s49 offen sc1 lds
    s_mov_b64 exec, -1
    s_add_u32 s43, s43, 28672
gh_loop:
    s_waitcnt vmcnt(0)
    s_barrier
    v_add_u32 v49, s47, v5
    v_add_u32 v50, 14592, v49
    ds_read_b128 v[16:19], v49 offset:0
    ds_read_b128 v[20:23], v50 offset:0
    ds_read_b128 v[24:27], v49 offset:64
    ds_read_b128 v[28:31], v50 offset:64
    ds_read_b128 v[32:35], v49 offset:128
    ds_read_b128 v[36:39], v50 offset:128
    ds_read_b128 v[40:43], v49 offset:192
    ds_read_b128 v[44:47], v50 offset:192
    s_waitcnt lgkmcnt(6)
    v_mfma_f32_16x16x32_bf16 v[64:67], a[0:3], v[16:19], 0
    v_mfma_f32_16x16x32_bf16 v[68:71], a[56:59], v[16:19], 0
    v_mfma_f32_16x16x32_bf16 v[72:75], a[112:115], v[16:19], 0
    v_mfma_f32_16x16x32_bf16 v[76:79], a[168:171], v[16:19], 0
    v_mfma_f32_16x16x32_bf16 v[80:83], a[0:3], v[20:23], 0
    v_mfma_f32_16x16x32_bf16 v[84:87], a[56:59], v[20:23], 0
    v_mfma_f32_16x16x32_bf16 v[88:91], a[112:115], v[20:23], 0
    v_mfma_f32_16x16x32_bf16 v[92:95], a[168:171], v[20:23], 0
    ds_read_b128 v[16:19], v49 offset:256
    ds_read_b128 v[20:23], v50 offset:256
    s_waitcnt lgkmcnt(6)
    v_mfma_f32_16x16x32_bf16 v[64:67], a[4:7], v[24:27], v[64:67]
    v_mfma_f32_16x16x32_bf16 v[68:71], a[60:63], v[24:27], v[68:71]
    v_mfma_f32_16x16x32_bf16 v[72:75], a[116:119], v[24:27], v[72:75]
    v_mfma_f32_16x16x32_bf16 v[76:79], a[172:175], v[24:27], v[76:79]
    v_mfma_f32_16x16x32_bf16 v[80:83], a[4:7], v[28:31], v[80:83]
    v_mfma_f32_16x16x32_bf16 v[84:87], a[60:63], v[28:31], v[84:87]
    v_mfma_f32_16x16x32_bf16 v[88:91], a[116:119], v[28:31], v[88:91]
    v_mfma_f32_16x16x32_bf16 v[92:95], a[172:175], v[28:31], v[92:95]
    ds_read_b128 v[24:27], v49 offset:320
    ds_read_b128 v[28:31], v50 offset:320
    s_waitcnt lgkmcnt(6)
    v_mfma_f32_16x16x32_bf16 v[64:67], a[8:11], v[32:35], v[64:67]
    v_mfma_f32_16x16x32_bf16 v[68:71], a[64:67], v[32:35], v[68:71]
    v_mfma_f32_16x16x32_bf16 v[72:75], a[120:123], v[32:35], v[72:75]
    v_mfma_f32_16x16x32_bf16 v[76:79], a[176:179], v[32:35], v[76:79]
    v_mfma_f32_16x16x32_bf16 v[80:83], a[8:11], v[36:39], v[80:83]
    v_mfma_f32_16x16x32_bf16 v[84:87], a[64:67], v[36:39], v[84:87]
    v_mfma_f32_16x16x32_bf16 v[88:91], a[120:123], v[36:39], v[88:91]
    v_mfma_f32_16x16x32_bf16 v[92:95], a[176:179], v[36:39], v[92:95]
    ds_read_b128 v[32:35], v49 offset:384
    ds_read_b128 v[36:39], v50 offset:384
    s_waitcnt lgkmcnt(6)
    v_mfma_f32_16x16x32_bf16 v[64:67], a[12:15], v[40:43], v[64:67]
    v_mfma_f32_16x16x32_bf16 v[68:71], a[68:71], v[40:43], v[68:71]
    v_mfma_f32_16x16x32_bf16 v[72:75], a[124:127], v[40:43], v[72:75]
    v_mfma_f32_16x16x32_bf16 v[76:79], a[180:183], v[40:43], v[76:79]
    v_mfma_f32_16x16x32_bf16 v[80:83], a[12:15], v[44:47], v[80:83]
    v_mfma_f32_16x16x32_bf16 v[84:87], a[68:71], v[44:47], v[84:87]
    v_mfma_f32_16x16x32_bf16 v[88:91], a[124:127], v[44:47], v[88:91]
    v_mfma_f32_16x16x32_bf16 v[92:95], a[180:183], v[44:47], v[92:95]
    ds_read_b128 v[40:43], v49 offset:448
    ds_read_b128 v[44:47], v50 offset:448
    s_waitcnt lgkmcnt(6)
    v_mfma_f32_16x16x32_bf16 v[64:67], a[16:19], v[16:19], v[64:67]
    v_mfma_f32_16x16x32_bf16 v[68:71], a[72:75], v[16:19], v[68:71]
    v_mfma_f32_16x16x32_bf16 v[72:75], a[128:131], v[16:19], v[72:75]
    v_mfma_f32_16x16x32_bf16 v[76:79], a[184:187], v[16:19], v[76:79]
    v_mfma_f32_16x16x32_bf16 v[80:83], a[16:19], v[20:23], v[80:83]
    v_mfma_f32_16x16x32_bf16 v[84:87], a[72:75], v[20:23], v[84:87]
    v_mfma_f32_16x16x32_bf16 v[88:91], a[128:131], v[20:23], v[88:91]
    v_mfma_f32_16x16x32_bf16 v[92:95], a[184:187], v[20:23], v[92:95]
    ds_read_b128 v[16:19], v49 offset:512
    ds_read_b128 v[20:23], v50 offset:512
    s_waitcnt lgkmcnt(6)
    v_mfma_f32_16x16x32_bf16 v[64:67], a[20:23], v[24:27], v[64:67]
    v_mfma_f32_16x16x32_bf16 v[68:71], a[76:79], v[24:27], v[68:71]
    v_mfma_f32_16x16x32_bf16 v[72:75], a[132:135], v[24:27], v[72:75]
    v_mfma_f32_16x16x32_bf16 v[76:79], a[188:191], v[24:27], v[76:79]
    v_mfma_f32_16x16x32_bf16 v[80:83], a[20:23], v[28:31], v[80:83]
    v_mfma_f32_16x16x32_bf16 v[84:87], a[76:79], v[28:31], v[84:87]
    v_mfma_f32_16x16x32_bf16 v[88:91], a[132:135], v[28:31], v[88:91]
    v_mfma_f32_16x16x32_bf16 v[92:95], a[188:191], v[28:31], v[92:95]
    ds_read_b128 v[24:27], v49 offset:576
    ds_read_b128 v[28:31], v50 offset:576
    s_waitcnt lgkmcnt(6)
    v_mfma_f32_16x16x32_bf16 v[64:67], a[24:27], v[32:35], v[64:67]
    v_mfma_f32_16x16x32_bf16 v[68:71], a[80:83], v[32:35], v[68:71]
    v_mfma_f32_16x16x32_bf16 v[72:75], a[136:139], v[32:35], v[72:75]
    v_mfma_f32_16x16x32_bf16 v[76:79], a[192:195], v[32:35], v[76:79]
    v_mfma_f32_16x16x32_bf16 v[80:83], a[24:27], v[36:39], v[80:83]
    v_mfma_f32_16x16x32_bf16 v[84:87], a[80:83], v[36:39], v[84:87]
    v_mfma_f32_16x16x32_bf16 v[88:91], a[136:139], v[36:39], v[88:91]
    v_mfma_f32_16x16x32_bf16 v[92:95], a[192:195], v[36:39], v[92:95]
    ds_read_b128 v[32:35], v49 offset:640
    ds_read_b128 v[36:39], v50 offset:640
    s_waitcnt lgkmcnt(6)
    v_mfma_f32_16x16x32_bf16 v[64:67], a[28:31], v[40:43], v[64:67]
    v_mfma_f32_16x16x32_bf16 v[68:71], a[84:87], v[40:43], v[68:71]
    v_mfma_f32_16x16x32_bf16 v[72:75], a[140:143], v[40:43], v[72:75]
    v_mfma_f32_16x16x32_bf16 v[76:79], a[196:199], v[40:43], v[76:79]
    v_mfma_f32_16x16x32_bf16 v[80:83], a[28:31], v[44:47], v[80:83]
    v_mfma_f32_16x16x32_bf16 v[84:87], a[84:87], v[44:47], v[84:87]
    v_mfma_f32_16x16x32_bf16 v[88:91], a[140:143], v[44:47], v[88:91]
    v_mfma_f32_16x16x32_bf16 v[92:95], a[196:199], v[44:47], v[92:95]
    ds_read_b128 v[40:43], v49 offset:704
    ds_read_b128 v[44:47], v50 offset:704
    s_waitcnt lgkmcnt(6)
    v_mfma_f32_16x16x32_bf16 v[64:67], a[32:35], v[16:19], v[64:67]
    v_mfma_f32_16x16x32_bf16 v[68:71], a[88:91], v[16:19], v[68:71]
    v_mfma_f32_16x16x32_bf16 v[72:75], a[144:147], v[16:19], v[72:75]
    v_mfma_f32_16x16x32_bf16 v[76:79], a[200:203], v[16:19], v[76:79]
    v_mfma_f32_16x16x32_bf16 v[80:83], a[32:35], v[20:23], v[80:83]
    v_mfma_f32_16x16x32_bf16 v[84:87], a[88:91], v[20:23], v[84:87]
    v_mfma_f32_16x16x32_bf16 v[88:91], a[144:147], v[20:23], v[88:91]
    v_mfma_f32_16x16x32_bf16 v[92:95], a[200:203], v[20:23], v[92:95]
    ds_read_b128 v[16:19], v49 offset:768
    ds_read_b128 v[20:23], v50 offset:768
    s_waitcnt lgkmcnt(6)
    v_mfma_f32_16x16x32_bf16 v[64:67], a[36:39], v[24:27], v[64:67]
    v_mfma_f32_16x16x32_bf16 v[68:71], a[92:95], v[24:27], v[68:71]
    v_mfma_f32_16x16x32_bf16 v[72:75], a[148:151], v[24:27], v[72:75]
    v_mfma_f32_16x16x32_bf16 v[76:79], a[204:207], v[24:27], v[76:79]
    v_mfma_f32_16x16x32_bf16 v[80:83], a[36:39], v[28:31], v[80:83]
    v_mfma_f32_16x16x32_bf16 v[84:87], a[92:95], v[28:31], v[84:87]
    v_mfma_f32_16x16x32_bf16 v[88:91], a[148:151], v[28:31], v[88:91]
    v_mfma_f32_16x16x32_bf16 v[92:95], a[204:207], v[28:31], v[92:95]
    ds_read_b128 v[24:27], v49 offset:832
    ds_read_b128 v[28:31], v50 offset:832
    s_waitcnt lgkmcnt(6)
    v_mfma_f32_16x16x32_bf16 v[64:67], a[40:43], v[32:35], v[64:67]
    v_mfma_f32_16x16x32_bf16 v[68:71], a[96:99], v[32:35], v[68:71]
    v_mfma_f32_16x16x32_bf16 v[72:75], a[152:155], v[32:35], v[72:75]
    v_mfma_f32_16x16x32_bf16 v[76:79], a[208:211], v[32:35], v[76:79]
    v_mfma_f32_16x16x32_bf16 v[80:83], a[40:43], v[36:39], v[80:83]
    v_mfma_f32_16x16x32_bf16 v[84:87], a[96:99], v[36:39], v[84:87]
    v_mfma_f32_16x16x32_bf16 v[88:91], a[152:155], v[36:39], v[88:91]
    v_mfma_f32_16x16x32_bf16 v[92:95], a[208:211], v[36:39], v[92:95]
    s_waitcnt lgkmcnt(4)
    v_mfma_f32_16x16x32_bf16 v[64:67], a[44:47], v[40:43], v[64:67]
    v_mfma_f32_16x16x32_bf16 v[68:71], a[100:103], v[40:43], v[68:71]
    v_mfma_f32_16x16x32_bf16 v[72:75], a[156:159], v[40:43], v[72:75]
    v_mfma_f32_16x16x32_bf16 v[76:79], a[212:215], v[40:43], v[76:79]
    v_mfma_f32_16x16x32_bf16 v[80:83], a[44:47], v[44:47], v[80:83]
    v_mfma_f32_16x16x32_bf16 v[84:87], a[100:103], v[44:47], v[84:87]
    v_mfma_f32_16x16x32_bf16 v[88:91], a[156:159], v[44:47], v[88:91]
    v_mfma_f32_16x16x32_bf16 v[92:95], a[212:215], v[44:47], v[92:95]
    s_waitcnt lgkmcnt(2)
    v_mfma_f32_16x16x32_bf16 v[64:67], a[48:51], v[16:19], v[64:67]
    v_mfma_f32_16x16x32_bf16 v[68:71], a[104:107], v[16:19], v[68:71]
    v_mfma_f32_16x16x32_bf16 v[72:75], a[160:163], v[16:19], v[72:75]
    v_mfma_f32_16x16x32_bf16 v[76:79], a[216:219], v[16:19], v[76:79]
    v_mfma_f32_16x16x32_bf16 v[80:83], a[48:51], v[20:23], v[80:83]
    v_mfma_f32_16x16x32_bf16 v[84:87], a[104:107], v[20:23], v[84:87]
    v_mfma_f32_16x16x32_bf16 v[88:91], a[160:163], v[20:23], v[88:91]
    v_mfma_f32_16x16x32_bf16 v[92:95], a[216:219], v[20:23], v[92:95]
    s_waitcnt lgkmcnt(0)
    v_mfma_f32_16x16x32_bf16 v[64:67], a[52:55], v[24:27], v[64:67]
    v_mfma_f32_16x16x32_bf16 v[68:71], a[108:111], v[24:27], v[68:71]
    v_mfma_f32_16x16x32_bf16 v[72:75], a[164:167], v[24:27], v[72:75]
    v_mfma_f32_16x16x32_bf16 v[76:79], a[220:223], v[24:27], v[76:79]
    v_mfma_f32_16x16x32_bf16 v[80:83], a[52:55], v[28:31], v[80:83]
    v_mfma_f32_16x16x32_bf16 v[84:87], a[108:111], v[28:31], v[84:87]
    v_mfma_f32_16x16x32_bf16 v[88:91], a[164:167], v[28:31], v[88:91]
    v_mfma_f32_16x16x32_bf16 v[92:95], a[220:223], v[28:31], v[92:95]
    s_xor_b32 s47, s47, 29184
    s_nop 7
    s_add_u32 s45, s44, 14336
    v_cvt_pk_bf16_f32 v96, v64, v65
    v_cvt_pk_bf16_f32 v97, v66, v67
    v_cvt_pk_bf16_f32 v98, v68, v69
    v_cvt_pk_bf16_f32 v99, v70, v71
    s_nop 1
    v_permlane16_swap_b32 v96, v98
    v_permlane16_swap_b32 v97, v99
    buffer_store_dwordx4 v[96:99], v7, s[20:23], s44 offen offset:0 sc1
    v_cvt_pk_bf16_f32 v100, v72, v73
    v_cvt_pk_bf16_f32 v101, v74, v75
    v_cvt_pk_bf16_f32 v102, v76, v77
    v_cvt_pk_bf16_f32 v103, v78, v79
    s_nop 1
    v_permlane16_swap_b32 v100, v102
    v_permlane16_swap_b32 v101, v103
    buffer_store_dwordx4 v[100:103], v7, s[20:23], s44 offen offset:1024 sc1
    v_cvt_pk_bf16_f32 v104, v80, v81
    v_cvt_pk_bf16_f32 v105, v82, v83
    v_cvt_pk_bf16_f32 v106, v84, v85
    v_cvt_pk_bf16_f32 v107, v86, v87
    s_nop 1
    v_permlane16_swap_b32 v104, v106
    v_permlane16_swap_b32 v105, v107
    buffer_store_dwordx4 v[104:107], v7, s[20:23], s45 offen offset:0 sc1
    v_cvt_pk_bf16_f32 v108, v88, v89
    v_cvt_pk_bf16_f32 v109, v90, v91
    v_cvt_pk_bf16_f32 v110, v92, v93
    v_cvt_pk_bf16_f32 v111, v94, v95
    s_nop 1
    v_permlane16_swap_b32 v108, v110
    v_permlane16_swap_b32 v109, v111
    buffer_store_dwordx4 v[108:111], v7, s[20:23], s45 offen offset:1024 sc1
    s_waitcnt vmcnt(0)
    s_barrier
    s_cmp_lg_u32 s3, 0
    s_cbranch_scc1 mega_kernel_sg95
    s_lshl_b32 s70, s42, 7
    s_add_u32 s70, s70, 167583744
    v_mov_b32 v14, 1
    v_mov_b32 v15, 0
    s_mov_b64 exec, 1
    buffer_atomic_add v14, v15, s[20:23], s70 offen sc1
    s_mov_b64 exec, -1
mega_kernel_sg95:
    s_add_u32 s44, s44, 458752
    s_add_u32 s42, s42, 1
    s_cmp_lt_u32 s42, 64
    s_cbranch_scc0 gh_done
    s_cmp_lg_u32 s3, 0
    s_cbranch_scc1 mega_kernel_wd97
    s_lshl_b32 s70, s42, 7
    s_add_u32 s70, s70, 167567360
mega_kernel_wc96:
    buffer_load_dword v14, v15, s[20:23], s70 offen sc1
    s_waitcnt vmcnt(0)
    v_readfirstlane_b32 s71, v14
    s_cmp_ge_u32 s71, 2
    s_cbranch_scc1 mega_kernel_wd97
    s_sleep 6
    s_branch mega_kernel_wc96
mega_kernel_wd97:
    s_barrier
    s_mov_b64 exec, s[34:35]
    s_add_u32 s48, s46, s47
    s_mov_b32 s49, s43
    s_mov_b32 m0, s48
    s_nop 0
    buffer_load_dwordx4 v6, s[20:23], s49 offen sc1 lds
    s_add_u32 s48, s48, 912
    s_add_u32 s49, s49, 896
    s_mov_b32 m0, s48
    s_nop 0
    buffer_load_dwordx4 v6, s[20:23], s49 offen sc1 lds
    s_add_u32 s48, s48, 912
    s_add_u32 s49, s49, 896
    s_mov_b32 m0, s48
    s_nop 0
    buffer_load_dwordx4 v6, s[20:23], s49 offen sc1 lds
    s_add_u32 s48, s48, 912
    s_add_u32 s49, s49, 896
    s_mov_b32 m0, s48
    s_nop 0
    buffer_load_dwordx4 v6, s[20:23], s49 offen sc1 lds
    s_add_u32 s48, s48, 912
    s_add_u32 s49, s49, 896
    s_mov_b32 m0, s48
    s_nop 0
    buffer_load_dwordx4 v6, s[20:23], s49 offen sc1 lds
    s_add_u32 s48, s48, 912
    s_add_u32 s49, s49, 896
    s_mov_b32 m0, s48
    s_nop 0
    buffer_load_dwordx4 v6, s[20:23], s49 offen sc1 lds
    s_add_u32 s48, s48, 912
    s_add_u32 s49, s49, 896
    s_mov_b32 m0, s48
    s_nop 0
    buffer_load_dwordx4 v6, s[20:23], s49 offen sc1 lds
    s_add_u32 s48, s48, 912
    s_add_u32 s49, s49, 896
    s_mov_b32 m0, s48
    s_nop 0
    buffer_load_dwordx4 v6, s[20:23], s49 offen sc1 lds
    s_mov_b64 exec, -1
    s_add_u32 s43, s43, 28672
    s_branch gh_loop
gh_done:
    s_endpgm
bs0_start:
    v_lshrrev_b32 v5, 1, v3
    v_lshlrev_b32 v5, 8, v5
    v_lshl_add_u32 v5, v4, 5, v5
    v_and_b32 v6, 1, v3
    v_lshl_add_u32 v5, v6, 4, v5
    v_mul_u32_u24 v6, 896, v2
    v_lshl_add_u32 v6, v3, 4, v6
    v_lshlrev_b32 v7, 4, v1
    v_add_u32 v178, 4096, v7
    v_add_u32 v179, 8192, v7
    v_add_u32 v196, 12288, v7
    v_lshlrev_b32 v245, 2, v3
    v_cmp_gt_u32 s[32:33], 2, v3
    v_mov_b32 v246, 0xff800000
    v_lshlrev_b32 v247, 4, v1
    v_lshlrev_b32 v248, 3, v1
    v_mov_b32 v177, 0
    s_mov_b32 s50, 0x3fb8aa3b
bs0_loop:
    s_lshr_b32 s24, s2, 2
    s_and_b32 s25, s2, 3
    s_lshl_b32 s25, s25, 2
    s_add_u32 s25, s25, s3
    s_cmp_lg_u32 s3, 0
    s_cbranch_scc1 mega_kernel_wd99
    s_lshl_b32 s70, s24, 7
    s_add_u32 s70, s70, 167575552
mega_kernel_wc98:
    buffer_load_dword v176, v177, s[20:23], s70 offen sc1
    s_waitcnt vmcnt(0)
    v_readfirstlane_b32 s71, v176
    s_cmp_ge_u32 s71, 28
    s_cbranch_scc1 mega_kernel_wd99
    s_sleep 6
    s_branch mega_kernel_wc98
mega_kernel_wd99:
    s_barrier
    s_mul_i32 s26, s24, 7168
    s_add_u32 s26, s26, 174897152
    s_add_u32 s31, s26, 4096
    s_mul_i32 s27, s24, 28672
    s_add_u32 s28, s27, 31752192
    s_add_u32 s29, s28, 14336
    s_mul_i32 s30, s24, 458752
    s_mul_i32 s27, s25, 28672
    s_add_u32 s30, s30, s27
    s_add_u32 s30, s30, 35422208
    s_add_u32 s34, s30, 14336
    s_mul_i32 s35, s24, 49152
    s_mul_i32 s27, s25, 3072
    s_add_u32 s35, s35, s27
    s_add_u32 s35, s35, 167673856
    buffer_load_dwordx4 v[64:67], v6, s[20:23], s28 offen offset:0
    buffer_load_dwordx4 v[68:71], v6, s[20:23], s28 offen offset:64
    buffer_load_dwordx4 v[72:75], v6, s[20:23], s28 offen offset:128
    buffer_load_dwordx4 v[76:79], v6, s[20:23], s28 offen offset:192
    buffer_load_dwordx4 v[80:83], v6, s[20:23], s28 offen offset:256
    buffer_load_dwordx4 v[84:87], v6, s[20:23], s28 offen offset:320
    buffer_load_dwordx4 v[88:91], v6, s[20:23], s28 offen offset:384
    buffer_load_dwordx4 v[92:95], v6, s[20:23], s28 offen offset:448
    buffer_load_dwordx4 v[96:99], v6, s[20:23], s28 offen offset:512
    buffer_load_dwordx4 v[100:103], v6, s[20:23], s28 offen offset:576
    buffer_load_dwordx4 v[104:107], v6, s[20:23], s28 offen offset:640
    buffer_load_dwordx4 v[108:111], v6, s[20:23], s28 offen offset:704
    buffer_load_dwordx4 v[112:115], v6, s[20:23], s28 offen offset:768
    buffer_load_dwordx4 v[116:119], v6, s[20:23], s28 offen offset:832
    buffer_load_dwordx4 v[120:123], v6, s[20:23], s29 offen offset:0
    buffer_load_dwordx4 v[124:127], v6, s[20:23], s29 offen offset:64
    buffer_load_dwordx4 v[128:131], v6, s[20:23], s29 offen offset:128
    buffer_load_dwordx4 v[132:135], v6, s[20:23], s29 offen offset:192
    buffer_load_dwordx4 v[136:139], v6, s[20:23], s29 offen offset:256
    buffer_load_dwordx4 v[140:143], v6, s[20:23], s29 offen offset:320
    buffer_load_dwordx4 v[144:147], v6, s[20:23], s29 offen offset:384
    buffer_load_dwordx4 v[148:151], v6, s[20:23], s29 offen offset:448
    buffer_load_dwordx4 v[152:155], v6, s[20:23], s29 offen offset:512
    buffer_load_dwordx4 v[156:159], v6, s[20:23], s29 offen offset:576
    buffer_load_dwordx4 v[160:163], v6, s[20:23], s29 offen offset:640
    buffer_load_dwordx4 v[164:167], v6, s[20:23], s29 offen offset:704
    buffer_load_dwordx4 v[168:171], v6, s[20:23], s29 offen offset:768
    buffer_load_dwordx4 v[172:175], v6, s[20:23], s29 offen offset:832
    buffer_load_dwordx4 a[0:3], v7, s[20:23], s30 offen offset:0 sc1
    buffer_load_dwordx4 a[4:7], v7, s[20:23], s30 offen offset:1024 sc1
    buffer_load_dwordx4 a[8:11], v7, s[20:23], s30 offen offset:2048 sc1
    buffer_load_dwordx4 a[12:15], v7, s[20:23], s30 offen offset:3072 sc1
    buffer_load_dwordx4 a[16:19], v178, s[20:23], s30 offen offset:0 sc1
    buffer_load_dwordx4 a[20:23], v178, s[20:23], s30 offen offset:1024 sc1
    buffer_load_dwordx4 a[24:27], v178, s[20:23], s30 offen offset:2048 sc1
    buffer_load_dwordx4 a[28:31], v178, s[20:23], s30 offen offset:3072 sc1
    buffer_load_dwordx4 a[32:35], v179, s[20:23], s30 offen offset:0 sc1
    buffer_load_dwordx4 a[36:39], v179, s[20:23], s30 offen offset:1024 sc1
    buffer_load_dwordx4 a[40:43], v179, s[20:23], s30 offen offset:2048 sc1
    buffer_load_dwordx4 a[44:47], v179, s[20:23], s30 offen offset:3072 sc1
    buffer_load_dwordx4 a[48:51], v196, s[20:23], s30 offen offset:0 sc1
    buffer_load_dwordx4 a[52:55], v196, s[20:23], s30 offen offset:1024 sc1
    buffer_load_dwordx4 a[56:59], v7, s[20:23], s34 offen offset:0 sc1
    buffer_load_dwordx4 a[60:63], v7, s[20:23], s34 offen offset:1024 sc1
    buffer_load_dwordx4 a[64:67], v7, s[20:23], s34 offen offset:2048 sc1
    buffer_load_dwordx4 a[68:71], v7, s[20:23], s34 offen offset:3072 sc1
    buffer_load_dwordx4 a[72:75], v178, s[20:23], s34 offen offset:0 sc1
    buffer_load_dwordx4 a[76:79], v178, s[20:23], s34 offen offset:1024 sc1
    buffer_load_dwordx4 a[80:83], v178, s[20:23], s34 offen offset:2048 sc1
    buffer_load_dwordx4 a[84:87], v178, s[20:23], s34 offen offset:3072 sc1
    buffer_load_dwordx4 a[88:91], v179, s[20:23], s34 offen offset:0 sc1
    buffer_load_dwordx4 a[92:95], v179, s[20:23], s34 offen offset:1024 sc1
    buffer_load_dwordx4 a[96:99], v179, s[20:23], s34 offen offset:2048 sc1
    buffer_load_dwordx4 a[100:103], v179, s[20:23], s34 offen offset:3072 sc1
    buffer_load_dwordx4 a[104:107], v196, s[20:23], s34 offen offset:0 sc1
    buffer_load_dwordx4 a[108:111], v196, s[20:23], s34 offen offset:1024 sc1
    s_cmp_lt_u32 s24, 2
    s_cbranch_scc1 mega_kernel_z100
    s_sub_u32 s73, s24, 2
    s_cmp_lg_u32 s3, 0
    s_cbranch_scc1 mega_kernel_wd102
    s_lshl_b32 s70, s73, 7
    s_add_u32 s70, s70, 167591936
mega_kernel_wc101:
    buffer_load_dword v176, v177, s[20:23], s70 offen sc1
    s_waitcnt vmcnt(0)
    v_readfirstlane_b32 s71, v176
    s_cmp_ge_u32 s71, 14
    s_cbranch_scc1 mega_kernel_wd102
    s_sleep 6
    s_branch mega_kernel_wc101
mega_kernel_wd102:
    s_barrier
mega_kernel_z100:
bs0_mp:
    buffer_load_dwordx4 v[8:11], v5, s[20:23], s26 offen offset:0 sc1
    buffer_load_dwordx4 v[12:15], v5, s[20:23], s26 offen offset:512 sc1
    buffer_load_dwordx4 v[16:19], v5, s[20:23], s26 offen offset:1024 sc1
    buffer_load_dwordx4 v[20:23], v5, s[20:23], s26 offen offset:1536 sc1
    buffer_load_dwordx4 v[24:27], v5, s[20:23], s26 offen offset:2048 sc1
    buffer_load_dwordx4 v[28:31], v5, s[20:23], s26 offen offset:2560 sc1
    buffer_load_dwordx4 v[32:35], v5, s[20:23], s26 offen offset:3072 sc1
    buffer_load_dwordx4 v[36:39], v5, s[20:23], s26 offen offset:3584 sc1
    buffer_load_dwordx4 v[40:43], v5, s[20:23], s31 offen offset:0 sc1
    buffer_load_dwordx4 v[44:47], v5, s[20:23], s31 offen offset:512 sc1
    buffer_load_dwordx4 v[48:51], v5, s[20:23], s31 offen offset:1024 sc1
    buffer_load_dwordx4 v[52:55], v5, s[20:23], s31 offen offset:1536 sc1
    buffer_load_dwordx4 v[56:59], v5, s[20:23], s31 offen offset:2048 sc1
    buffer_load_dwordx4 v[60:63], v5, s[20:23], s31 offen offset:2560 sc1
    s_waitcnt vmcnt(0)
    v_max3_u32 v176, v8, v10, v12
    v_max3_u32 v176, v176, v14, v16
    v_max3_u32 v176, v176, v18, v20
    v_max3_u32 v176, v176, v22, v24
    v_max3_u32 v176, v176, v26, v28
    v_max3_u32 v176, v176, v30, v32
    v_max3_u32 v176, v176, v34, v36
    v_max3_u32 v176, v176, v38, v40
    v_max3_u32 v176, v176, v42, v44
    v_max3_u32 v176, v176, v46, v48
    v_max3_u32 v176, v176, v50, v52
    v_max3_u32 v176, v176, v54, v56
    v_max3_u32 v176, v176, v58, v60
    v_max_u32 v176, v176, v62
    v_cmp_eq_u32 vcc, -1, v176
    s_cbranch_vccz mega_kernel_mo103
    s_sleep 4
    s_branch bs0_mp
mega_kernel_mo103:
    v_mfma_f32_16x16x32_bf16 v[232:235], v[8:11], a[0:3], 0
    v_mfma_f32_16x16x32_bf16 v[236:239], v[64:67], a[0:3], 0
    v_mfma_f32_16x16x32_bf16 v[240:243], v[120:123], a[0:3], 0
    v_mfma_f32_16x16x32_bf16 v[232:235], v[12:15], a[4:7], v[232:235]
    v_mfma_f32_16x16x32_bf16 v[236:239], v[68:71], a[4:7], v[236:239]
    v_mfma_f32_16x16x32_bf16 v[240:243], v[124:127], a[4:7], v[240:243]
    v_mfma_f32_16x16x32_bf16 v[232:235], v[16:19], a[8:11], v[232:235]
    v_mfma_f32_16x16x32_bf16 v[236:239], v[72:75], a[8:11], v[236:239]
    v_mfma_f32_16x16x32_bf16 v[240:243], v[128:131], a[8:11], v[240:243]
    v_mfma_f32_16x16x32_bf16 v[232:235], v[20:23], a[12:15], v[232:235]
    v_mfma_f32_16x16x32_bf16 v[236:239], v[76:79], a[12:15], v[236:239]
    v_mfma_f32_16x16x32_bf16 v[240:243], v[132:135], a[12:15], v[240:243]
    v_mfma_f32_16x16x32_bf16 v[232:235], v[24:27], a[16:19], v[232:235]
    v_mfma_f32_16x16x32_bf16 v[236:239], v[80:83], a[16:19], v[236:239]
    v_mfma_f32_16x16x32_bf16 v[240:243], v[136:139], a[16:19], v[240:243]
    v_mfma_f32_16x16x32_bf16 v[232:235], v[28:31], a[20:23], v[232:235]
    v_mfma_f32_16x16x32_bf16 v[236:239], v[84:87], a[20:23], v[236:239]
    v_mfma_f32_16x16x32_bf16 v[240:243], v[140:143], a[20:23], v[240:243]
    v_mfma_f32_16x16x32_bf16 v[232:235], v[32:35], a[24:27], v[232:235]
    v_mfma_f32_16x16x32_bf16 v[236:239], v[88:91], a[24:27], v[236:239]
    v_mfma_f32_16x16x32_bf16 v[240:243], v[144:147], a[24:27], v[240:243]
    v_mfma_f32_16x16x32_bf16 v[232:235], v[36:39], a[28:31], v[232:235]
    v_mfma_f32_16x16x32_bf16 v[236:239], v[92:95], a[28:31], v[236:239]
    v_mfma_f32_16x16x32_bf16 v[240:243], v[148:151], a[28:31], v[240:243]
    v_mfma_f32_16x16x32_bf16 v[232:235], v[40:43], a[32:35], v[232:235]
    v_mfma_f32_16x16x32_bf16 v[236:239], v[96:99], a[32:35], v[236:239]
    v_mfma_f32_16x16x32_bf16 v[240:243], v[152:155], a[32:35], v[240:243]
    v_mfma_f32_16x16x32_bf16 v[232:235], v[44:47], a[36:39], v[232:235]
    v_mfma_f32_16x16x32_bf16 v[236:239], v[100:103], a[36:39], v[236:239]
    v_mfma_f32_16x16x32_bf16 v[240:243], v[156:159], a[36:39], v[240:243]
    v_mfma_f32_16x16x32_bf16 v[232:235], v[48:51], a[40:43], v[232:235]
    v_mfma_f32_16x16x32_bf16 v[236:239], v[104:107], a[40:43], v[236:239]
    v_mfma_f32_16x16x32_bf16 v[240:243], v[160:163], a[40:43], v[240:243]
    v_mfma_f32_16x16x32_bf16 v[232:235], v[52:55], a[44:47], v[232:235]
    v_mfma_f32_16x16x32_bf16 v[236:239], v[108:111], a[44:47], v[236:239]
    v_mfma_f32_16x16x32_bf16 v[240:243], v[164:167], a[44:47], v[240:243]
    v_mfma_f32_16x16x32_bf16 v[232:235], v[56:59], a[48:51], v[232:235]
    v_mfma_f32_16x16x32_bf16 v[236:239], v[112:115], a[48:51], v[236:239]
    v_mfma_f32_16x16x32_bf16 v[240:243], v[168:171], a[48:51], v[240:243]
    v_mfma_f32_16x16x32_bf16 v[232:235], v[60:63], a[52:55], v[232:235]
    v_mfma_f32_16x16x32_bf16 v[236:239], v[116:119], a[52:55], v[236:239]
    v_mfma_f32_16x16x32_bf16 v[240:243], v[172:175], a[52:55], v[240:243]
    v_add_u32 v244, 0, v2
    s_nop 7
    v_cndmask_b32 v232, v246, v232, s[32:33]
    v_add_u32 v249, 0, v245
    v_cmp_le_u32 vcc, v249, v244
    v_add_u32 v249, 16, v249
    v_cmp_le_u32 s[36:37], v249, v244
    s_nop 0
    v_cndmask_b32 v236, v246, v236, vcc
    v_cndmask_b32 v240, v246, v240, s[36:37]
    v_cndmask_b32 v233, v246, v233, s[32:33]
    v_add_u32 v249, 1, v245
    v_cmp_le_u32 vcc, v249, v244
    v_add_u32 v249, 16, v249
    v_cmp_le_u32 s[36:37], v249, v244
    s_nop 0
    v_cndmask_b32 v237, v246, v237, vcc
    v_cndmask_b32 v241, v246, v241, s[36:37]
    v_cndmask_b32 v234, v246, v234, s[32:33]
    v_add_u32 v249, 2, v245
    v_cmp_le_u32 vcc, v249, v244
    v_add_u32 v249, 16, v249
    v_cmp_le_u32 s[36:37], v249, v244
    s_nop 0
    v_cndmask_b32 v238, v246, v238, vcc
    v_cndmask_b32 v242, v246, v242, s[36:37]
    v_cndmask_b32 v235, v246, v235, s[32:33]
    v_add_u32 v249, 3, v245
    v_cmp_le_u32 vcc, v249, v244
    v_add_u32 v249, 16, v249
    v_cmp_le_u32 s[36:37], v249, v244
    s_nop 0
    v_cndmask_b32 v239, v246, v239, vcc
    v_cndmask_b32 v243, v246, v243, s[36:37]
    v_max3_f32 v250, v232, v233, v234
    v_max3_f32 v250, v250, v235, v236
    v_max3_f32 v250, v250, v237, v238
    v_max3_f32 v250, v250, v239, v240
    v_max3_f32 v250, v250, v241, v242
    v_max_f32 v250, v250, v243
    v_mov_b32 v251, v250
    s_nop 1
    v_permlane16_swap_b32 v250, v251
    v_max_f32 v250, v250, v251
    v_mov_b32 v251, v250
    s_nop 1
    v_permlane32_swap_b32 v250, v251
    v_max_f32 v250, v250, v251
    v_mul_f32 v250, 0xbfb8aa3b, v250
    v_fma_f32 v232, v232, s50, v250
    v_fma_f32 v233, v233, s50, v250
    v_fma_f32 v234, v234, s50, v250
    v_fma_f32 v235, v235, s50, v250
    v_fma_f32 v236, v236, s50, v250
    v_fma_f32 v237, v237, s50, v250
    v_fma_f32 v238, v238, s50, v250
    v_fma_f32 v239, v239, s50, v250
    v_fma_f32 v240, v240, s50, v250
    v_fma_f32 v241, v241, s50, v250
    v_fma_f32 v242, v242, s50, v250
    v_fma_f32 v243, v243, s50, v250
    v_exp_f32 v232, v232
    v_exp_f32 v233, v233
    v_exp_f32 v234, v234
    v_exp_f32 v235, v235
    v_exp_f32 v236, v236
    v_exp_f32 v237, v237
    v_exp_f32 v238, v238
    v_exp_f32 v239, v239
    v_exp_f32 v240, v240
    v_exp_f32 v241, v241
    v_exp_f32 v242, v242
    v_exp_f32 v243, v243
    s_nop 0
    v_add_f32 v250, v232, v233
    v_add_f32 v250, v250, v234
    v_add_f32 v250, v250, v235
    v_add_f32 v250, v250, v236
    v_add_f32 v250, v250, v237
    v_add_f32 v250, v250, v238
    v_add_f32 v250, v250, v239
    v_add_f32 v250, v250, v240
    v_add_f32 v250, v250, v241
    v_add_f32 v250, v250, v242
    v_add_f32 v250, v250, v243
    v_mov_b32 v251, v250
    s_nop 1
    v_permlane16_swap_b32 v250, v251
    v_add_f32 v250, v250, v251
    v_mov_b32 v251, v250
    s_nop 1
    v_permlane32_swap_b32 v250, v251
    v_add_f32 v250, v250, v251
    v_rcp_f32 v250, v250
    s_nop 0
    v_mul_f32 v232, v232, v250
    v_mul_f32 v233, v233, v250
    v_mul_f32 v234, v234, v250
    v_mul_f32 v235, v235, v250
    v_mul_f32 v236, v236, v250
    v_mul_f32 v237, v237, v250
    v_mul_f32 v238, v238, v250
    v_mul_f32 v239, v239, v250
    v_mul_f32 v240, v240, v250
    v_mul_f32 v241, v241, v250
    v_mul_f32 v242, v242, v250
    v_mul_f32 v243, v243, v250
    v_cvt_pk_bf16_f32 v180, v236, v237
    v_cvt_pk_bf16_f32 v181, v238, v239
    v_cvt_pk_bf16_f32 v182, v240, v241
    v_cvt_pk_bf16_f32 v183, v242, v243
    v_cvt_pk_bf16_f32 v184, v232, v233
    v_cvt_pk_bf16_f32 v185, v234, v235
    buffer_store_dwordx4 v[180:183], v247, s[20:23], s35 offen offset:0 sc1
    buffer_store_dwordx2 v[184:185], v248, s[20:23], s35 offen offset:1024 sc1
    v_mfma_f32_16x16x32_bf16 v[232:235], v[8:11], a[56:59], 0
    v_mfma_f32_16x16x32_bf16 v[236:239], v[64:67], a[56:59], 0
    v_mfma_f32_16x16x32_bf16 v[240:243], v[120:123], a[56:59], 0
    v_mfma_f32_16x16x32_bf16 v[232:235], v[12:15], a[60:63], v[232:235]
    v_mfma_f32_16x16x32_bf16 v[236:239], v[68:71], a[60:63], v[236:239]
    v_mfma_f32_16x16x32_bf16 v[240:243], v[124:127], a[60:63], v[240:243]
    v_mfma_f32_16x16x32_bf16 v[232:235], v[16:19], a[64:67], v[232:235]
    v_mfma_f32_16x16x32_bf16 v[236:239], v[72:75], a[64:67], v[236:239]
    v_mfma_f32_16x16x32_bf16 v[240:243], v[128:131], a[64:67], v[240:243]
    v_mfma_f32_16x16x32_bf16 v[232:235], v[20:23], a[68:71], v[232:235]
    v_mfma_f32_16x16x32_bf16 v[236:239], v[76:79], a[68:71], v[236:239]
    v_mfma_f32_16x16x32_bf16 v[240:243], v[132:135], a[68:71], v[240:243]
    v_mfma_f32_16x16x32_bf16 v[232:235], v[24:27], a[72:75], v[232:235]
    v_mfma_f32_16x16x32_bf16 v[236:239], v[80:83], a[72:75], v[236:239]
    v_mfma_f32_16x16x32_bf16 v[240:243], v[136:139], a[72:75], v[240:243]
    v_mfma_f32_16x16x32_bf16 v[232:235], v[28:31], a[76:79], v[232:235]
    v_mfma_f32_16x16x32_bf16 v[236:239], v[84:87], a[76:79], v[236:239]
    v_mfma_f32_16x16x32_bf16 v[240:243], v[140:143], a[76:79], v[240:243]
    v_mfma_f32_16x16x32_bf16 v[232:235], v[32:35], a[80:83], v[232:235]
    v_mfma_f32_16x16x32_bf16 v[236:239], v[88:91], a[80:83], v[236:239]
    v_mfma_f32_16x16x32_bf16 v[240:243], v[144:147], a[80:83], v[240:243]
    v_mfma_f32_16x16x32_bf16 v[232:235], v[36:39], a[84:87], v[232:235]
    v_mfma_f32_16x16x32_bf16 v[236:239], v[92:95], a[84:87], v[236:239]
    v_mfma_f32_16x16x32_bf16 v[240:243], v[148:151], a[84:87], v[240:243]
    v_mfma_f32_16x16x32_bf16 v[232:235], v[40:43], a[88:91], v[232:235]
    v_mfma_f32_16x16x32_bf16 v[236:239], v[96:99], a[88:91], v[236:239]
    v_mfma_f32_16x16x32_bf16 v[240:243], v[152:155], a[88:91], v[240:243]
    v_mfma_f32_16x16x32_bf16 v[232:235], v[44:47], a[92:95], v[232:235]
    v_mfma_f32_16x16x32_bf16 v[236:239], v[100:103], a[92:95], v[236:239]
    v_mfma_f32_16x16x32_bf16 v[240:243], v[156:159], a[92:95], v[240:243]
    v_mfma_f32_16x16x32_bf16 v[232:235], v[48:51], a[96:99], v[232:235]
    v_mfma_f32_16x16x32_bf16 v[236:239], v[104:107], a[96:99], v[236:239]
    v_mfma_f32_16x16x32_bf16 v[240:243], v[160:163], a[96:99], v[240:243]
    v_mfma_f32_16x16x32_bf16 v[232:235], v[52:55], a[100:103], v[232:235]
    v_mfma_f32_16x16x32_bf16 v[236:239], v[108:111], a[100:103], v[236:239]
    v_mfma_f32_16x16x32_bf16 v[240:243], v[164:167], a[100:103], v[240:243]
    v_mfma_f32_16x16x32_bf16 v[232:235], v[56:59], a[104:107], v[232:235]
    v_mfma_f32_16x16x32_bf16 v[236:239], v[112:115], a[104:107], v[236:239]
    v_mfma_f32_16x16x32_bf16 v[240:243], v[168:171], a[104:107], v[240:243]
    v_mfma_f32_16x16x32_bf16 v[232:235], v[60:63], a[108:111], v[232:235]
    v_mfma_f32_16x16x32_bf16 v[236:239], v[116:119], a[108:111], v[236:239]
    v_mfma_f32_16x16x32_bf16 v[240:243], v[172:175], a[108:111], v[240:243]
    v_add_u32 v244, 16, v2
    s_nop 7
    v_cndmask_b32 v232, v246, v232, s[32:33]
    v_add_u32 v249, 0, v245
    v_cmp_le_u32 vcc, v249, v244
    v_add_u32 v249, 16, v249
    v_cmp_le_u32 s[36:37], v249, v244
    s_nop 0
    v_cndmask_b32 v236, v246, v236, vcc
    v_cndmask_b32 v240, v246, v240, s[36:37]
    v_cndmask_b32 v233, v246, v233, s[32:33]
    v_add_u32 v249, 1, v245
    v_cmp_le_u32 vcc, v249, v244
    v_add_u32 v249, 16, v249
    v_cmp_le_u32 s[36:37], v249, v244
    s_nop 0
    v_cndmask_b32 v237, v246, v237, vcc
    v_cndmask_b32 v241, v246, v241, s[36:37]
    v_cndmask_b32 v234, v246, v234, s[32:33]
    v_add_u32 v249, 2, v245
    v_cmp_le_u32 vcc, v249, v244
    v_add_u32 v249, 16, v249
    v_cmp_le_u32 s[36:37], v249, v244
    s_nop 0
    v_cndmask_b32 v238, v246, v238, vcc
    v_cndmask_b32 v242, v246, v242, s[36:37]
    v_cndmask_b32 v235, v246, v235, s[32:33]
    v_add_u32 v249, 3, v245
    v_cmp_le_u32 vcc, v249, v244
    v_add_u32 v249, 16, v249
    v_cmp_le_u32 s[36:37], v249, v244
    s_nop 0
    v_cndmask_b32 v239, v246, v239, vcc
    v_cndmask_b32 v243, v246, v243, s[36:37]
    v_max3_f32 v250, v232, v233, v234
    v_max3_f32 v250, v250, v235, v236
    v_max3_f32 v250, v250, v237, v238
    v_max3_f32 v250, v250, v239, v240
    v_max3_f32 v250, v250, v241, v242
    v_max_f32 v250, v250, v243
    v_mov_b32 v251, v250
    s_nop 1
    v_permlane16_swap_b32 v250, v251
    v_max_f32 v250, v250, v251
    v_mov_b32 v251, v250
    s_nop 1
    v_permlane32_swap_b32 v250, v251
    v_max_f32 v250, v250, v251
    v_mul_f32 v250, 0xbfb8aa3b, v250
    v_fma_f32 v232, v232, s50, v250
    v_fma_f32 v233, v233, s50, v250
    v_fma_f32 v234, v234, s50, v250
    v_fma_f32 v235, v235, s50, v250
    v_fma_f32 v236, v236, s50, v250
    v_fma_f32 v237, v237, s50, v250
    v_fma_f32 v238, v238, s50, v250
    v_fma_f32 v239, v239, s50, v250
    v_fma_f32 v240, v240, s50, v250
    v_fma_f32 v241, v241, s50, v250
    v_fma_f32 v242, v242, s50, v250
    v_fma_f32 v243, v243, s50, v250
    v_exp_f32 v232, v232
    v_exp_f32 v233, v233
    v_exp_f32 v234, v234
    v_exp_f32 v235, v235
    v_exp_f32 v236, v236
    v_exp_f32 v237, v237
    v_exp_f32 v238, v238
    v_exp_f32 v239, v239
    v_exp_f32 v240, v240
    v_exp_f32 v241, v241
    v_exp_f32 v242, v242
    v_exp_f32 v243, v243
    s_nop 0
    v_add_f32 v250, v232, v233
    v_add_f32 v250, v250, v234
    v_add_f32 v250, v250, v235
    v_add_f32 v250, v250, v236
    v_add_f32 v250, v250, v237
    v_add_f32 v250, v250, v238
    v_add_f32 v250, v250, v239
    v_add_f32 v250, v250, v240
    v_add_f32 v250, v250, v241
    v_add_f32 v250, v250, v242
    v_add_f32 v250, v250, v243
    v_mov_b32 v251, v250
    s_nop 1
    v_permlane16_swap_b32 v250, v251
    v_add_f32 v250, v250, v251
    v_mov_b32 v251, v250
    s_nop 1
    v_permlane32_swap_b32 v250, v251
    v_add_f32 v250, v250, v251
    v_rcp_f32 v250, v250
    s_nop 0
    v_mul_f32 v232, v232, v250
    v_mul_f32 v233, v233, v250
    v_mul_f32 v234, v234, v250
    v_mul_f32 v235, v235, v250
    v_mul_f32 v236, v236, v250
    v_mul_f32 v237, v237, v250
    v_mul_f32 v238, v238, v250
    v_mul_f32 v239, v239, v250
    v_mul_f32 v240, v240, v250
    v_mul_f32 v241, v241, v250
    v_mul_f32 v242, v242, v250
    v_mul_f32 v243, v243, v250
    v_cvt_pk_bf16_f32 v188, v236, v237
    v_cvt_pk_bf16_f32 v189, v238, v239
    v_cvt_pk_bf16_f32 v190, v240, v241
    v_cvt_pk_bf16_f32 v191, v242, v243
    v_cvt_pk_bf16_f32 v192, v232, v233
    v_cvt_pk_bf16_f32 v193, v234, v235
    buffer_store_dwordx4 v[188:191], v247, s[20:23], s35 offen offset:1536 sc1
    buffer_store_dwordx2 v[192:193], v248, s[20:23], s35 offen offset:2560 sc1
    s_waitcnt vmcnt(0)
    s_barrier
    s_cmp_lg_u32 s3, 0
    s_cbranch_scc1 mega_kernel_sg104
    s_lshl_b32 s70, s24, 7
    s_add_u32 s70, s70, 167608320
    v_mov_b32 v176, 1
    v_mov_b32 v177, 0
    s_mov_b64 exec, 1
    buffer_atomic_add v176, v177, s[20:23], s70 offen sc1
    s_mov_b64 exec, -1
mega_kernel_sg104:
    s_add_u32 s2, s2, 16
    s_cmp_lt_u32 s2, 256
    s_cbranch_scc1 bs0_loop
    s_endpgm
bs1_start:
    v_lshrrev_b32 v5, 1, v3
    v_lshlrev_b32 v5, 8, v5
    v_lshl_add_u32 v5, v4, 5, v5
    v_and_b32 v6, 1, v3
    v_lshl_add_u32 v5, v6, 4, v5
    v_mul_u32_u24 v6, 896, v2
    v_lshl_add_u32 v6, v3, 4, v6
    v_lshlrev_b32 v7, 4, v1
    v_add_u32 v178, 4096, v7
    v_add_u32 v179, 8192, v7
    v_add_u32 v196, 12288, v7
    v_lshlrev_b32 v245, 2, v3
    v_cmp_gt_u32 s[32:33], 2, v3
    v_mov_b32 v246, 0xff800000
    v_lshlrev_b32 v247, 4, v1
    v_lshlrev_b32 v248, 3, v1
    v_mov_b32 v177, 0
    s_mov_b32 s50, 0x3fb8aa3b
bs1_loop:
    s_lshr_b32 s24, s2, 2
    s_and_b32 s25, s2, 3
    s_lshl_b32 s25, s25, 2
    s_add_u32 s25, s25, s3
    s_cmp_lg_u32 s3, 0
    s_cbranch_scc1 mega_kernel_wd106
    s_lshl_b32 s70, s24, 7
    s_add_u32 s70, s70, 167583744
mega_kernel_wc105:
    buffer_load_dword v176, v177, s[20:23], s70 offen sc1
    s_waitcnt vmcnt(0)
    v_readfirstlane_b32 s71, v176
    s_cmp_ge_u32 s71, 28
    s_cbranch_scc1 mega_kernel_wd106
    s_sleep 6
    s_branch mega_kernel_wc105
mega_kernel_wd106:
    s_barrier
    s_mul_i32 s26, s24, 7168
    s_add_u32 s26, s26, 175363072
    s_add_u32 s31, s26, 4096
    s_mul_i32 s27, s24, 28672
    s_add_u32 s28, s27, 33587200
    s_add_u32 s29, s28, 14336
    s_mul_i32 s30, s24, 458752
    s_mul_i32 s27, s25, 28672
    s_add_u32 s30, s30, s27
    s_add_u32 s30, s30, 101482496
    s_add_u32 s34, s30, 14336
    s_mul_i32 s35, s24, 49152
    s_mul_i32 s27, s25, 3072
    s_add_u32 s35, s35, s27
    s_add_u32 s35, s35, 170819584
    buffer_load_dwordx4 v[64:67], v6, s[20:23], s28 offen offset:0 sc1
    buffer_load_dwordx4 v[68:71], v6, s[20:23], s28 offen offset:64 sc1
    buffer_load_dwordx4 v[72:75], v6, s[20:23], s28 offen offset:128 sc1
    buffer_load_dwordx4 v[76:79], v6, s[20:23], s28 offen offset:192 sc1
    buffer_load_dwordx4 v[80:83], v6, s[20:23], s28 offen offset:256 sc1
    buffer_load_dwordx4 v[84:87], v6, s[20:23], s28 offen offset:320 sc1
    buffer_load_dwordx4 v[88:91], v6, s[20:23], s28 offen offset:384 sc1
    buffer_load_dwordx4 v[92:95], v6, s[20:23], s28 offen offset:448 sc1
    buffer_load_dwordx4 v[96:99], v6, s[20:23], s28 offen offset:512 sc1
    buffer_load_dwordx4 v[100:103], v6, s[20:23], s28 offen offset:576 sc1
    buffer_load_dwordx4 v[104:107], v6, s[20:23], s28 offen offset:640 sc1
    buffer_load_dwordx4 v[108:111], v6, s[20:23], s28 offen offset:704 sc1
    buffer_load_dwordx4 v[112:115], v6, s[20:23], s28 offen offset:768 sc1
    buffer_load_dwordx4 v[116:119], v6, s[20:23], s28 offen offset:832 sc1
    buffer_load_dwordx4 v[120:123], v6, s[20:23], s29 offen offset:0 sc1
    buffer_load_dwordx4 v[124:127], v6, s[20:23], s29 offen offset:64 sc1
    buffer_load_dwordx4 v[128:131], v6, s[20:23], s29 offen offset:128 sc1
    buffer_load_dwordx4 v[132:135], v6, s[20:23], s29 offen offset:192 sc1
    buffer_load_dwordx4 v[136:139], v6, s[20:23], s29 offen offset:256 sc1
    buffer_load_dwordx4 v[140:143], v6, s[20:23], s29 offen offset:320 sc1
    buffer_load_dwordx4 v[144:147], v6, s[20:23], s29 offen offset:384 sc1
    buffer_load_dwordx4 v[148:151], v6, s[20:23], s29 offen offset:448 sc1
    buffer_load_dwordx4 v[152:155], v6, s[20:23], s29 offen offset:512 sc1
    buffer_load_dwordx4 v[156:159], v6, s[20:23], s29 offen offset:576 sc1
    buffer_load_dwordx4 v[160:163], v6, s[20:23], s29 offen offset:640 sc1
    buffer_load_dwordx4 v[164:167], v6, s[20:23], s29 offen offset:704 sc1
    buffer_load_dwordx4 v[168:171], v6, s[20:23], s29 offen offset:768 sc1
    buffer_load_dwordx4 v[172:175], v6, s[20:23], s29 offen offset:832 sc1
    buffer_load_dwordx4 a[0:3], v7, s[20:23], s30 offen offset:0 sc1
    buffer_load_dwordx4 a[4:7], v7, s[20:23], s30 offen offset:1024 sc1
    buffer_load_dwordx4 a[8:11], v7, s[20:23], s30 offen offset:2048 sc1
    buffer_load_dwordx4 a[12:15], v7, s[20:23], s30 offen offset:3072 sc1
    buffer_load_dwordx4 a[16:19], v178, s[20:23], s30 offen offset:0 sc1
    buffer_load_dwordx4 a[20:23], v178, s[20:23], s30 offen offset:1024 sc1
    buffer_load_dwordx4 a[24:27], v178, s[20:23], s30 offen offset:2048 sc1
    buffer_load_dwordx4 a[28:31], v178, s[20:23], s30 offen offset:3072 sc1
    buffer_load_dwordx4 a[32:35], v179, s[20:23], s30 offen offset:0 sc1
    buffer_load_dwordx4 a[36:39], v179, s[20:23], s30 offen offset:1024 sc1
    buffer_load_dwordx4 a[40:43], v179, s[20:23], s30 offen offset:2048 sc1
    buffer_load_dwordx4 a[44:47], v179, s[20:23], s30 offen offset:3072 sc1
    buffer_load_dwordx4 a[48:51], v196, s[20:23], s30 offen offset:0 sc1
    buffer_load_dwordx4 a[52:55], v196, s[20:23], s30 offen offset:1024 sc1
    buffer_load_dwordx4 a[56:59], v7, s[20:23], s34 offen offset:0 sc1
    buffer_load_dwordx4 a[60:63], v7, s[20:23], s34 offen offset:1024 sc1
    buffer_load_dwordx4 a[64:67], v7, s[20:23], s34 offen offset:2048 sc1
    buffer_load_dwordx4 a[68:71], v7, s[20:23], s34 offen offset:3072 sc1
    buffer_load_dwordx4 a[72:75], v178, s[20:23], s34 offen offset:0 sc1
    buffer_load_dwordx4 a[76:79], v178, s[20:23], s34 offen offset:1024 sc1
    buffer_load_dwordx4 a[80:83], v178, s[20:23], s34 offen offset:2048 sc1
    buffer_load_dwordx4 a[84:87], v178, s[20:23], s34 offen offset:3072 sc1
    buffer_load_dwordx4 a[88:91], v179, s[20:23], s34 offen offset:0 sc1
    buffer_load_dwordx4 a[92:95], v179, s[20:23], s34 offen offset:1024 sc1
    buffer_load_dwordx4 a[96:99], v179, s[20:23], s34 offen offset:2048 sc1
    buffer_load_dwordx4 a[100:103], v179, s[20:23], s34 offen offset:3072 sc1
    buffer_load_dwordx4 a[104:107], v196, s[20:23], s34 offen offset:0 sc1
    buffer_load_dwordx4 a[108:111], v196, s[20:23], s34 offen offset:1024 sc1
    s_cmp_lt_u32 s24, 2
    s_cbranch_scc1 mega_kernel_z107
    s_sub_u32 s73, s24, 2
    s_cmp_lg_u32 s3, 0
    s_cbranch_scc1 mega_kernel_wd109
    s_lshl_b32 s70, s73, 7
    s_add_u32 s70, s70, 167600128
mega_kernel_wc108:
    buffer_load_dword v176, v177, s[20:23], s70 offen sc1
    s_waitcnt vmcnt(0)
    v_readfirstlane_b32 s71, v176
    s_cmp_ge_u32 s71, 14
    s_cbranch_scc1 mega_kernel_wd109
    s_sleep 6
    s_branch mega_kernel_wc108
mega_kernel_wd109:
    s_barrier
mega_kernel_z107:
bs1_mp:
    buffer_load_dwordx4 v[8:11], v5, s[20:23], s26 offen offset:0 sc1
    buffer_load_dwordx4 v[12:15], v5, s[20:23], s26 offen offset:512 sc1
    buffer_load_dwordx4 v[16:19], v5, s[20:23], s26 offen offset:1024 sc1
    buffer_load_dwordx4 v[20:23], v5, s[20:23], s26 offen offset:1536 sc1
    buffer_load_dwordx4 v[24:27], v5, s[20:23], s26 offen offset:2048 sc1
    buffer_load_dwordx4 v[28:31], v5, s[20:23], s26 offen offset:2560 sc1
    buffer_load_dwordx4 v[32:35], v5, s[20:23], s26 offen offset:3072 sc1
    buffer_load_dwordx4 v[36:39], v5, s[20:23], s26 offen offset:3584 sc1
    buffer_load_dwordx4 v[40:43], v5, s[20:23], s31 offen offset:0 sc1
    buffer_load_dwordx4 v[44:47], v5, s[20:23], s31 offen offset:512 sc1
    buffer_load_dwordx4 v[48:51], v5, s[20:23], s31 offen offset:1024 sc1
    buffer_load_dwordx4 v[52:55], v5, s[20:23], s31 offen offset:1536 sc1
    buffer_load_dwordx4 v[56:59], v5, s[20:23], s31 offen offset:2048 sc1
    buffer_load_dwordx4 v[60:63], v5, s[20:23], s31 offen offset:2560 sc1
    s_waitcnt vmcnt(0)
    v_max3_u32 v176, v8, v10, v12
    v_max3_u32 v176, v176, v14, v16
    v_max3_u32 v176, v176, v18, v20
    v_max3_u32 v176, v176, v22, v24
    v_max3_u32 v176, v176, v26, v28
    v_max3_u32 v176, v176, v30, v32
    v_max3_u32 v176, v176, v34, v36
    v_max3_u32 v176, v176, v38, v40
    v_max3_u32 v176, v176, v42, v44
    v_max3_u32 v176, v176, v46, v48
    v_max3_u32 v176, v176, v50, v52
    v_max3_u32 v176, v176, v54, v56
    v_max3_u32 v176, v176, v58, v60
    v_max_u32 v176, v176, v62
    v_cmp_eq_u32 vcc, -1, v176
    s_cbranch_vccz mega_kernel_mo110
    s_sleep 4
    s_branch bs1_mp
mega_kernel_mo110:
    v_mfma_f32_16x16x32_bf16 v[232:235], v[8:11], a[0:3], 0
    v_mfma_f32_16x16x32_bf16 v[236:239], v[64:67], a[0:3], 0
    v_mfma_f32_16x16x32_bf16 v[240:243], v[120:123], a[0:3], 0
    v_mfma_f32_16x16x32_bf16 v[232:235], v[12:15], a[4:7], v[232:235]
    v_mfma_f32_16x16x32_bf16 v[236:239], v[68:71], a[4:7], v[236:239]
    v_mfma_f32_16x16x32_bf16 v[240:243], v[124:127], a[4:7], v[240:243]
    v_mfma_f32_16x16x32_bf16 v[232:235], v[16:19], a[8:11], v[232:235]
    v_mfma_f32_16x16x32_bf16 v[236:239], v[72:75], a[8:11], v[236:239]
    v_mfma_f32_16x16x32_bf16 v[240:243], v[128:131], a[8:11], v[240:243]
    v_mfma_f32_16x16x32_bf16 v[232:235], v[20:23], a[12:15], v[232:235]
    v_mfma_f32_16x16x32_bf16 v[236:239], v[76:79], a[12:15], v[236:239]
    v_mfma_f32_16x16x32_bf16 v[240:243], v[132:135], a[12:15], v[240:243]
    v_mfma_f32_16x16x32_bf16 v[232:235], v[24:27], a[16:19], v[232:235]
    v_mfma_f32_16x16x32_bf16 v[236:239], v[80:83], a[16:19], v[236:239]
    v_mfma_f32_16x16x32_bf16 v[240:243], v[136:139], a[16:19], v[240:243]
    v_mfma_f32_16x16x32_bf16 v[232:235], v[28:31], a[20:23], v[232:235]
    v_mfma_f32_16x16x32_bf16 v[236:239], v[84:87], a[20:23], v[236:239]
    v_mfma_f32_16x16x32_bf16 v[240:243], v[140:143], a[20:23], v[240:243]
    v_mfma_f32_16x16x32_bf16 v[232:235], v[32:35], a[24:27], v[232:235]
    v_mfma_f32_16x16x32_bf16 v[236:239], v[88:91], a[24:27], v[236:239]
    v_mfma_f32_16x16x32_bf16 v[240:243], v[144:147], a[24:27], v[240:243]
    v_mfma_f32_16x16x32_bf16 v[232:235], v[36:39], a[28:31], v[232:235]
    v_mfma_f32_16x16x32_bf16 v[236:239], v[92:95], a[28:31], v[236:239]
    v_mfma_f32_16x16x32_bf16 v[240:243], v[148:151], a[28:31], v[240:243]
    v_mfma_f32_16x16x32_bf16 v[232:235], v[40:43], a[32:35], v[232:235]
    v_mfma_f32_16x16x32_bf16 v[236:239], v[96:99], a[32:35], v[236:239]
    v_mfma_f32_16x16x32_bf16 v[240:243], v[152:155], a[32:35], v[240:243]
    v_mfma_f32_16x16x32_bf16 v[232:235], v[44:47], a[36:39], v[232:235]
    v_mfma_f32_16x16x32_bf16 v[236:239], v[100:103], a[36:39], v[236:239]
    v_mfma_f32_16x16x32_bf16 v[240:243], v[156:159], a[36:39], v[240:243]
    v_mfma_f32_16x16x32_bf16 v[232:235], v[48:51], a[40:43], v[232:235]
    v_mfma_f32_16x16x32_bf16 v[236:239], v[104:107], a[40:43], v[236:239]
    v_mfma_f32_16x16x32_bf16 v[240:243], v[160:163], a[40:43], v[240:243]
    v_mfma_f32_16x16x32_bf16 v[232:235], v[52:55], a[44:47], v[232:235]
    v_mfma_f32_16x16x32_bf16 v[236:239], v[108:111], a[44:47], v[236:239]
    v_mfma_f32_16x16x32_bf16 v[240:243], v[164:167], a[44:47], v[240:243]
    v_mfma_f32_16x16x32_bf16 v[232:235], v[56:59], a[48:51], v[232:235]
    v_mfma_f32_16x16x32_bf16 v[236:239], v[112:115], a[48:51], v[236:239]
    v_mfma_f32_16x16x32_bf16 v[240:243], v[168:171], a[48:51], v[240:243]
    v_mfma_f32_16x16x32_bf16 v[232:235], v[60:63], a[52:55], v[232:235]
    v_mfma_f32_16x16x32_bf16 v[236:239], v[116:119], a[52:55], v[236:239]
    v_mfma_f32_16x16x32_bf16 v[240:243], v[172:175], a[52:55], v[240:243]
    v_add_u32 v244, 0, v2
    s_nop 7
    v_cndmask_b32 v232, v246, v232, s[32:33]
    v_add_u32 v249, 0, v245
    v_cmp_le_u32 vcc, v249, v244
    v_add_u32 v249, 16, v249
    v_cmp_le_u32 s[36:37], v249, v244
    s_nop 0
    v_cndmask_b32 v236, v246, v236, vcc
    v_cndmask_b32 v240, v246, v240, s[36:37]
    v_cndmask_b32 v233, v246, v233, s[32:33]
    v_add_u32 v249, 1, v245
    v_cmp_le_u32 vcc, v249, v244
    v_add_u32 v249, 16, v249
    v_cmp_le_u32 s[36:37], v249, v244
    s_nop 0
    v_cndmask_b32 v237, v246, v237, vcc
    v_cndmask_b32 v241, v246, v241, s[36:37]
    v_cndmask_b32 v234, v246, v234, s[32:33]
    v_add_u32 v249, 2, v245
    v_cmp_le_u32 vcc, v249, v244
    v_add_u32 v249, 16, v249
    v_cmp_le_u32 s[36:37], v249, v244
    s_nop 0
    v_cndmask_b32 v238, v246, v238, vcc
    v_cndmask_b32 v242, v246, v242, s[36:37]
    v_cndmask_b32 v235, v246, v235, s[32:33]
    v_add_u32 v249, 3, v245
    v_cmp_le_u32 vcc, v249, v244
    v_add_u32 v249, 16, v249
    v_cmp_le_u32 s[36:37], v249, v244
    s_nop 0
    v_cndmask_b32 v239, v246, v239, vcc
    v_cndmask_b32 v243, v246, v243, s[36:37]
    v_max3_f32 v250, v232, v233, v234
    v_max3_f32 v250, v250, v235, v236
    v_max3_f32 v250, v250, v237, v238
    v_max3_f32 v250, v250, v239, v240
    v_max3_f32 v250, v250, v241, v242
    v_max_f32 v250, v250, v243
    v_mov_b32 v251, v250
    s_nop 1
    v_permlane16_swap_b32 v250, v251
    v_max_f32 v250, v250, v251
    v_mov_b32 v251, v250
    s_nop 1
    v_permlane32_swap_b32 v250, v251
    v_max_f32 v250, v250, v251
    v_mul_f32 v250, 0xbfb8aa3b, v250
    v_fma_f32 v232, v232, s50, v250
    v_fma_f32 v233, v233, s50, v250
    v_fma_f32 v234, v234, s50, v250
    v_fma_f32 v235, v235, s50, v250
    v_fma_f32 v236, v236, s50, v250
    v_fma_f32 v237, v237, s50, v250
    v_fma_f32 v238, v238, s50, v250
    v_fma_f32 v239, v239, s50, v250
    v_fma_f32 v240, v240, s50, v250
    v_fma_f32 v241, v241, s50, v250
    v_fma_f32 v242, v242, s50, v250
    v_fma_f32 v243, v243, s50, v250
    v_exp_f32 v232, v232
    v_exp_f32 v233, v233
    v_exp_f32 v234, v234
    v_exp_f32 v235, v235
    v_exp_f32 v236, v236
    v_exp_f32 v237, v237
    v_exp_f32 v238, v238
    v_exp_f32 v239, v239
    v_exp_f32 v240, v240
    v_exp_f32 v241, v241
    v_exp_f32 v242, v242
    v_exp_f32 v243, v243
    s_nop 0
    v_add_f32 v250, v232, v233
    v_add_f32 v250, v250, v234
    v_add_f32 v250, v250, v235
    v_add_f32 v250, v250, v236
    v_add_f32 v250, v250, v237
    v_add_f32 v250, v250, v238
    v_add_f32 v250, v250, v239
    v_add_f32 v250, v250, v240
    v_add_f32 v250, v250, v241
    v_add_f32 v250, v250, v242
    v_add_f32 v250, v250, v243
    v_mov_b32 v251, v250
    s_nop 1
    v_permlane16_swap_b32 v250, v251
    v_add_f32 v250, v250, v251
    v_mov_b32 v251, v250
    s_nop 1
    v_permlane32_swap_b32 v250, v251
    v_add_f32 v250, v250, v251
    v_rcp_f32 v250, v250
    s_nop 0
    v_mul_f32 v232, v232, v250
    v_mul_f32 v233, v233, v250
    v_mul_f32 v234, v234, v250
    v_mul_f32 v235, v235, v250
    v_mul_f32 v236, v236, v250
    v_mul_f32 v237, v237, v250
    v_mul_f32 v238, v238, v250
    v_mul_f32 v239, v239, v250
    v_mul_f32 v240, v240, v250
    v_mul_f32 v241, v241, v250
    v_mul_f32 v242, v242, v250
    v_mul_f32 v243, v243, v250
    v_cvt_pk_bf16_f32 v180, v236, v237
    v_cvt_pk_bf16_f32 v181, v238, v239
    v_cvt_pk_bf16_f32 v182, v240, v241
    v_cvt_pk_bf16_f32 v183, v242, v243
    v_cvt_pk_bf16_f32 v184, v232, v233
    v_cvt_pk_bf16_f32 v185, v234, v235
    buffer_store_dwordx4 v[180:183], v247, s[20:23], s35 offen offset:0 sc1
    buffer_store_dwordx2 v[184:185], v248, s[20:23], s35 offen offset:1024 sc1
    v_mfma_f32_16x16x32_bf16 v[232:235], v[8:11], a[56:59], 0
    v_mfma_f32_16x16x32_bf16 v[236:239], v[64:67], a[56:59], 0
    v_mfma_f32_16x16x32_bf16 v[240:243], v[120:123], a[56:59], 0
    v_mfma_f32_16x16x32_bf16 v[232:235], v[12:15], a[60:63], v[232:235]
    v_mfma_f32_16x16x32_bf16 v[236:239], v[68:71], a[60:63], v[236:239]
    v_mfma_f32_16x16x32_bf16 v[240:243], v[124:127], a[60:63], v[240:243]
    v_mfma_f32_16x16x32_bf16 v[232:235], v[16:19], a[64:67], v[232:235]
    v_mfma_f32_16x16x32_bf16 v[236:239], v[72:75], a[64:67], v[236:239]
    v_mfma_f32_16x16x32_bf16 v[240:243], v[128:131], a[64:67], v[240:243]
    v_mfma_f32_16x16x32_bf16 v[232:235], v[20:23], a[68:71], v[232:235]
    v_mfma_f32_16x16x32_bf16 v[236:239], v[76:79], a[68:71], v[236:239]
    v_mfma_f32_16x16x32_bf16 v[240:243], v[132:135], a[68:71], v[240:243]
    v_mfma_f32_16x16x32_bf16 v[232:235], v[24:27], a[72:75], v[232:235]
    v_mfma_f32_16x16x32_bf16 v[236:239], v[80:83], a[72:75], v[236:239]
    v_mfma_f32_16x16x32_bf16 v[240:243], v[136:139], a[72:75], v[240:243]
    v_mfma_f32_16x16x32_bf16 v[232:235], v[28:31], a[76:79], v[232:235]
    v_mfma_f32_16x16x32_bf16 v[236:239], v[84:87], a[76:79], v[236:239]
    v_mfma_f32_16x16x32_bf16 v[240:243], v[140:143], a[76:79], v[240:243]
    v_mfma_f32_16x16x32_bf16 v[232:235], v[32:35], a[80:83], v[232:235]
    v_mfma_f32_16x16x32_bf16 v[236:239], v[88:91], a[80:83], v[236:239]
    v_mfma_f32_16x16x32_bf16 v[240:243], v[144:147], a[80:83], v[240:243]
    v_mfma_f32_16x16x32_bf16 v[232:235], v[36:39], a[84:87], v[232:235]
    v_mfma_f32_16x16x32_bf16 v[236:239], v[92:95], a[84:87], v[236:239]
    v_mfma_f32_16x16x32_bf16 v[240:243], v[148:151], a[84:87], v[240:243]
    v_mfma_f32_16x16x32_bf16 v[232:235], v[40:43], a[88:91], v[232:235]
    v_mfma_f32_16x16x32_bf16 v[236:239], v[96:99], a[88:91], v[236:239]
    v_mfma_f32_16x16x32_bf16 v[240:243], v[152:155], a[88:91], v[240:243]
    v_mfma_f32_16x16x32_bf16 v[232:235], v[44:47], a[92:95], v[232:235]
    v_mfma_f32_16x16x32_bf16 v[236:239], v[100:103], a[92:95], v[236:239]
    v_mfma_f32_16x16x32_bf16 v[240:243], v[156:159], a[92:95], v[240:243]
    v_mfma_f32_16x16x32_bf16 v[232:235], v[48:51], a[96:99], v[232:235]
    v_mfma_f32_16x16x32_bf16 v[236:239], v[104:107], a[96:99], v[236:239]
    v_mfma_f32_16x16x32_bf16 v[240:243], v[160:163], a[96:99], v[240:243]
    v_mfma_f32_16x16x32_bf16 v[232:235], v[52:55], a[100:103], v[232:235]
    v_mfma_f32_16x16x32_bf16 v[236:239], v[108:111], a[100:103], v[236:239]
    v_mfma_f32_16x16x32_bf16 v[240:243], v[164:167], a[100:103], v[240:243]
    v_mfma_f32_16x16x32_bf16 v[232:235], v[56:59], a[104:107], v[232:235]
    v_mfma_f32_16x16x32_bf16 v[236:239], v[112:115], a[104:107], v[236:239]
    v_mfma_f32_16x16x32_bf16 v[240:243], v[168:171], a[104:107], v[240:243]
    v_mfma_f32_16x16x32_bf16 v[232:235], v[60:63], a[108:111], v[232:235]
    v_mfma_f32_16x16x32_bf16 v[236:239], v[116:119], a[108:111], v[236:239]
    v_mfma_f32_16x16x32_bf16 v[240:243], v[172:175], a[108:111], v[240:243]
    v_add_u32 v244, 16, v2
    s_nop 7
    v_cndmask_b32 v232, v246, v232, s[32:33]
    v_add_u32 v249, 0, v245
    v_cmp_le_u32 vcc, v249, v244
    v_add_u32 v249, 16, v249
    v_cmp_le_u32 s[36:37], v249, v244
    s_nop 0
    v_cndmask_b32 v236, v246, v236, vcc
    v_cndmask_b32 v240, v246, v240, s[36:37]
    v_cndmask_b32 v233, v246, v233, s[32:33]
    v_add_u32 v249, 1, v245
    v_cmp_le_u32 vcc, v249, v244
    v_add_u32 v249, 16, v249
    v_cmp_le_u32 s[36:37], v249, v244
    s_nop 0
    v_cndmask_b32 v237, v246, v237, vcc
    v_cndmask_b32 v241, v246, v241, s[36:37]
    v_cndmask_b32 v234, v246, v234, s[32:33]
    v_add_u32 v249, 2, v245
    v_cmp_le_u32 vcc, v249, v244
    v_add_u32 v249, 16, v249
    v_cmp_le_u32 s[36:37], v249, v244
    s_nop 0
    v_cndmask_b32 v238, v246, v238, vcc
    v_cndmask_b32 v242, v246, v242, s[36:37]
    v_cndmask_b32 v235, v246, v235, s[32:33]
    v_add_u32 v249, 3, v245
    v_cmp_le_u32 vcc, v249, v244
    v_add_u32 v249, 16, v249
    v_cmp_le_u32 s[36:37], v249, v244
    s_nop 0
    v_cndmask_b32 v239, v246, v239, vcc
    v_cndmask_b32 v243, v246, v243, s[36:37]
    v_max3_f32 v250, v232, v233, v234
    v_max3_f32 v250, v250, v235, v236
    v_max3_f32 v250, v250, v237, v238
    v_max3_f32 v250, v250, v239, v240
    v_max3_f32 v250, v250, v241, v242
    v_max_f32 v250, v250, v243
    v_mov_b32 v251, v250
    s_nop 1
    v_permlane16_swap_b32 v250, v251
    v_max_f32 v250, v250, v251
    v_mov_b32 v251, v250
    s_nop 1
    v_permlane32_swap_b32 v250, v251
    v_max_f32 v250, v250, v251
    v_mul_f32 v250, 0xbfb8aa3b, v250
    v_fma_f32 v232, v232, s50, v250
    v_fma_f32 v233, v233, s50, v250
    v_fma_f32 v234, v234, s50, v250
    v_fma_f32 v235, v235, s50, v250
    v_fma_f32 v236, v236, s50, v250
    v_fma_f32 v237, v237, s50, v250
    v_fma_f32 v238, v238, s50, v250
    v_fma_f32 v239, v239, s50, v250
    v_fma_f32 v240, v240, s50, v250
    v_fma_f32 v241, v241, s50, v250
    v_fma_f32 v242, v242, s50, v250
    v_fma_f32 v243, v243, s50, v250
    v_exp_f32 v232, v232
    v_exp_f32 v233, v233
    v_exp_f32 v234, v234
    v_exp_f32 v235, v235
    v_exp_f32 v236, v236
    v_exp_f32 v237, v237
    v_exp_f32 v238, v238
    v_exp_f32 v239, v239
    v_exp_f32 v240, v240
    v_exp_f32 v241, v241
    v_exp_f32 v242, v242
    v_exp_f32 v243, v243
    s_nop 0
    v_add_f32 v250, v232, v233
    v_add_f32 v250, v250, v234
    v_add_f32 v250, v250, v235
    v_add_f32 v250, v250, v236
    v_add_f32 v250, v250, v237
    v_add_f32 v250, v250, v238
    v_add_f32 v250, v250, v239
    v_add_f32 v250, v250, v240
    v_add_f32 v250, v250, v241
    v_add_f32 v250, v250, v242
    v_add_f32 v250, v250, v243
    v_mov_b32 v251, v250
    s_nop 1
    v_permlane16_swap_b32 v250, v251
    v_add_f32 v250, v250, v251
    v_mov_b32 v251, v250
    s_nop 1
    v_permlane32_swap_b32 v250, v251
    v_add_f32 v250, v250, v251
    v_rcp_f32 v250, v250
    s_nop 0
    v_mul_f32 v232, v232, v250
    v_mul_f32 v233, v233, v250
    v_mul_f32 v234, v234, v250
    v_mul_f32 v235, v235, v250
    v_mul_f32 v236, v236, v250
    v_mul_f32 v237, v237, v250
    v_mul_f32 v238, v238, v250
    v_mul_f32 v239, v239, v250
    v_mul_f32 v240, v240, v250
    v_mul_f32 v241, v241, v250
    v_mul_f32 v242, v242, v250
    v_mul_f32 v243, v243, v250
    v_cvt_pk_bf16_f32 v188, v236, v237
    v_cvt_pk_bf16_f32 v189, v238, v239
    v_cvt_pk_bf16_f32 v190, v240, v241
    v_cvt_pk_bf16_f32 v191, v242, v243
    v_cvt_pk_bf16_f32 v192, v232, v233
    v_cvt_pk_bf16_f32 v193, v234, v235
    buffer_store_dwordx4 v[188:191], v247, s[20:23], s35 offen offset:1536 sc1
    buffer_store_dwordx2 v[192:193], v248, s[20:23], s35 offen offset:2560 sc1
    s_waitcnt vmcnt(0)
    s_barrier
    s_cmp_lg_u32 s3, 0
    s_cbranch_scc1 mega_kernel_sg111
    s_lshl_b32 s70, s24, 7
    s_add_u32 s70, s70, 167616512
    v_mov_b32 v176, 1
    v_mov_b32 v177, 0
    s_mov_b64 exec, 1
    buffer_atomic_add v176, v177, s[20:23], s70 offen sc1
    s_mov_b64 exec, -1
mega_kernel_sg111:
    s_add_u32 s2, s2, 24
    s_cmp_lt_u32 s2, 256
    s_cbranch_scc1 bs1_loop
    s_endpgm
bv0_start:
    v_lshlrev_b32 v5, 6, v2
    v_lshl_add_u32 v5, v3, 4, v5
    v_and_b32 v6, 1, v3
    v_lshlrev_b32 v6, 3, v6
    v_lshl_add_u32 v6, v2, 4, v6
    v_mul_u32_u24 v7, 896, v2
    v_lshl_add_u32 v7, v3, 3, v7
    v_lshlrev_b32 v8, 4, v1
    v_lshlrev_b32 v9, 3, v1
    v_add_u32 v9, 1024, v9
    v_mov_b32 v11, 0
bv0_loop:
    s_mul_hi_u32 s24, s2, 613566757
    s_mul_i32 s25, s24, 7
    s_sub_u32 s25, s2, s25
    s_lshl_b32 s25, s25, 2
    s_add_u32 s25, s25, s3
    s_cmp_lg_u32 s3, 0
    s_cbranch_scc1 mega_kernel_wd113
    s_lshl_b32 s70, s24, 7
    s_add_u32 s70, s70, 167632896
mega_kernel_wc112:
    buffer_load_dword v10, v11, s[20:23], s70 offen sc1
    s_waitcnt vmcnt(0)
    v_readfirstlane_b32 s71, v10
    s_cmp_ge_u32 s71, 28
    s_cbranch_scc1 mega_kernel_wd113
    s_sleep 6
    s_branch mega_kernel_wc112
mega_kernel_wd113:
    s_barrier
    s_mul_i32 s26, s24, 458752
    s_lshl_b32 s27, s25, 10
    s_add_u32 s26, s26, s27
    s_add_u32 s26, s26, 64782336
    s_mul_i32 s28, s24, 114688
    s_lshl_b32 s27, s25, 8
    s_add_u32 s28, s28, s27
    s_add_u32 s28, s28, 94142464
    s_mul_i32 s29, s24, 28672
    s_lshl_b32 s27, s25, 5
    s_add_u32 s29, s29, s27
    s_add_u32 s30, s29, 26247168
    s_add_u32 s31, s30, 14336
    buffer_load_dwordx4 a[0:3], v5, s[20:23], s26 offen sc1
    s_add_u32 s26, s26, 28672
    buffer_load_dwordx4 a[4:7], v5, s[20:23], s26 offen sc1
    s_add_u32 s26, s26, 28672
    buffer_load_dwordx4 a[8:11], v5, s[20:23], s26 offen sc1
    s_add_u32 s26, s26, 28672
    buffer_load_dwordx4 a[12:15], v5, s[20:23], s26 offen sc1
    s_add_u32 s26, s26, 28672
    buffer_load_dwordx4 a[16:19], v5, s[20:23], s26 offen sc1
    s_add_u32 s26, s26, 28672
    buffer_load_dwordx4 a[20:23], v5, s[20:23], s26 offen sc1
    s_add_u32 s26, s26, 28672
    buffer_load_dwordx4 a[24:27], v5, s[20:23], s26 offen sc1
    s_add_u32 s26, s26, 28672
    buffer_load_dwordx4 a[28:31], v5, s[20:23], s26 offen sc1
    s_add_u32 s26, s26, 28672
    buffer_load_dwordx4 a[32:35], v5, s[20:23], s26 offen sc1
    s_add_u32 s26, s26, 28672
    buffer_load_dwordx4 a[36:39], v5, s[20:23], s26 offen sc1
    s_add_u32 s26, s26, 28672
    buffer_load_dwordx4 a[40:43], v5, s[20:23], s26 offen sc1
    s_add_u32 s26, s26, 28672
    buffer_load_dwordx4 a[44:47], v5, s[20:23], s26 offen sc1
    s_add_u32 s26, s26, 28672
    buffer_load_dwordx4 a[48:51], v5, s[20:23], s26 offen sc1
    s_add_u32 s26, s26, 28672
    buffer_load_dwordx4 a[52:55], v5, s[20:23], s26 offen sc1
    s_add_u32 s26, s26, 28672
    buffer_load_dwordx4 a[56:59], v5, s[20:23], s26 offen sc1
    s_add_u32 s26, s26, 28672
    buffer_load_dwordx4 a[60:63], v5, s[20:23], s26 offen sc1
    buffer_load_dwordx2 v[12:13], v7, s[20:23], s30 offen
    buffer_load_dwordx2 v[14:15], v7, s[20:23], s31 offen
    s_cmp_lg_u32 s3, 0
    s_cbranch_scc1 mega_kernel_wd115
    s_lshl_b32 s70, s24, 7
    s_add_u32 s70, s70, 167591936
mega_kernel_wc114:
    buffer_load_dword v10, v11, s[20:23], s70 offen sc1
    s_waitcnt vmcnt(0)
    v_readfirstlane_b32 s71, v10
    s_cmp_ge_u32 s71, 14
    s_cbranch_scc1 mega_kernel_wd115
    s_sleep 6
    s_branch mega_kernel_wc114
mega_kernel_wd115:
    s_barrier
    buffer_load_dwordx2 a[64:65], v6, s[20:23], s28 offen sc1
    s_add_u32 s28, s28, 7168
    buffer_load_dwordx2 a[66:67], v6, s[20:23], s28 offen sc1
    s_add_u32 s28, s28, 7168
    buffer_load_dwordx2 a[68:69], v6, s[20:23], s28 offen sc1
    s_add_u32 s28, s28, 7168
    buffer_load_dwordx2 a[70:71], v6, s[20:23], s28 offen sc1
    s_add_u32 s28, s28, 7168
    buffer_load_dwordx2 a[72:73], v6, s[20:23], s28 offen sc1
    s_add_u32 s28, s28, 7168
    buffer_load_dwordx2 a[74:75], v6, s[20:23], s28 offen sc1
    s_add_u32 s28, s28, 7168
    buffer_load_dwordx2 a[76:77], v6, s[20:23], s28 offen sc1
    s_add_u32 s28, s28, 7168
    buffer_load_dwordx2 a[78:79], v6, s[20:23], s28 offen sc1
    s_add_u32 s28, s28, 7168
    buffer_load_dwordx2 a[80:81], v6, s[20:23], s28 offen sc1
    s_add_u32 s28, s28, 7168
    buffer_load_dwordx2 a[82:83], v6, s[20:23], s28 offen sc1
    s_add_u32 s28, s28, 7168
    buffer_load_dwordx2 a[84:85], v6, s[20:23], s28 offen sc1
    s_add_u32 s28, s28, 7168
    buffer_load_dwordx2 a[86:87], v6, s[20:23], s28 offen sc1
    s_add_u32 s28, s28, 7168
    buffer_load_dwordx2 a[88:89], v6, s[20:23], s28 offen sc1
    s_add_u32 s28, s28, 7168
    buffer_load_dwordx2 a[90:91], v6, s[20:23], s28 offen sc1
    s_add_u32 s28, s28, 7168
    buffer_load_dwordx2 a[92:93], v6, s[20:23], s28 offen sc1
    s_add_u32 s28, s28, 7168
    buffer_load_dwordx2 a[94:95], v6, s[20:23], s28 offen sc1
    s_cmp_lg_u32 s3, 0
    s_cbranch_scc1 mega_kernel_wd117
    s_lshl_b32 s70, s24, 7
    s_add_u32 s70, s70, 167608320
mega_kernel_wc116:
    buffer_load_dword v10, v11, s[20:23], s70 offen sc1
    s_waitcnt vmcnt(0)
    v_readfirstlane_b32 s71, v10
    s_cmp_ge_u32 s71, 4
    s_cbranch_scc1 mega_kernel_wd117
    s_sleep 6
    s_branch mega_kernel_wc116
mega_kernel_wd117:
    s_barrier
    s_mul_i32 s26, s24, 49152
    s_mul_i32 s27, s3, 12288
    s_add_u32 s26, s26, s27
    s_add_u32 s26, s26, 167673856
    s_add_u32 s34, s27, 0
    s_mov_b32 m0, s34
    s_nop 0
    buffer_load_dwordx4 v8, s[20:23], s26 offen sc1 lds
    s_add_u32 s26, s26, 1024
    s_add_u32 s34, s27, 1024
    s_mov_b32 m0, s34
    s_nop 0
    buffer_load_dwordx4 v8, s[20:23], s26 offen sc1 lds
    s_add_u32 s26, s26, 1024
    s_add_u32 s34, s27, 2048
    s_mov_b32 m0, s34
    s_nop 0
    buffer_load_dwordx4 v8, s[20:23], s26 offen sc1 lds
    s_add_u32 s26, s26, 1024
    s_add_u32 s34, s27, 3072
    s_mov_b32 m0, s34
    s_nop 0
    buffer_load_dwordx4 v8, s[20:23], s26 offen sc1 lds
    s_add_u32 s26, s26, 1024
    s_add_u32 s34, s27, 4096
    s_mov_b32 m0, s34
    s_nop 0
    buffer_load_dwordx4 v8, s[20:23], s26 offen sc1 lds
    s_add_u32 s26, s26, 1024
    s_add_u32 s34, s27, 5120
    s_mov_b32 m0, s34
    s_nop 0
    buffer_load_dwordx4 v8, s[20:23], s26 offen sc1 lds
    s_add_u32 s26, s26, 1024
    s_add_u32 s34, s27, 6144
    s_mov_b32 m0, s34
    s_nop 0
    buffer_load_dwordx4 v8, s[20:23], s26 offen sc1 lds
    s_add_u32 s26, s26, 1024
    s_add_u32 s34, s27, 7168
    s_mov_b32 m0, s34
    s_nop 0
    buffer_load_dwordx4 v8, s[20:23], s26 offen sc1 lds
    s_add_u32 s26, s26, 1024
    s_add_u32 s34, s27, 8192
    s_mov_b32 m0, s34
    s_nop 0
    buffer_load_dwordx4 v8, s[20:23], s26 offen sc1 lds
    s_add_u32 s26, s26, 1024
    s_add_u32 s34, s27, 9216
    s_mov_b32 m0, s34
    s_nop 0
    buffer_load_dwordx4 v8, s[20:23], s26 offen sc1 lds
    s_add_u32 s26, s26, 1024
    s_add_u32 s34, s27, 10240
    s_mov_b32 m0, s34
    s_nop 0
    buffer_load_dwordx4 v8, s[20:23], s26 offen sc1 lds
    s_add_u32 s26, s26, 1024
    s_add_u32 s34, s27, 11264
    s_mov_b32 m0, s34
    s_nop 0
    buffer_load_dwordx4 v8, s[20:23], s26 offen sc1 lds
    s_waitcnt vmcnt(0)
    s_barrier
    ds_read_b128 v[32:35], v8 offset:0
    ds_read_b64 v[36:37], v9 offset:0
    ds_read_b128 v[38:41], v8 offset:1536
    ds_read_b64 v[42:43], v9 offset:1536
    ds_read_b128 v[44:47], v8 offset:3072
    ds_read_b64 v[48:49], v9 offset:3072
    ds_read_b128 v[50:53], v8 offset:4608
    ds_read_b64 v[54:55], v9 offset:4608
    ds_read_b128 v[56:59], v8 offset:6144
    ds_read_b64 v[60:61], v9 offset:6144
    ds_read_b128 v[62:65], v8 offset:7680
    ds_read_b64 v[66:67], v9 offset:7680
    ds_read_b128 v[68:71], v8 offset:9216
    ds_read_b64 v[72:73], v9 offset:9216
    ds_read_b128 v[74:77], v8 offset:10752
    ds_read_b64 v[78:79], v9 offset:10752
    ds_read_b128 v[80:83], v8 offset:12288
    ds_read_b64 v[84:85], v9 offset:12288
    ds_read_b128 v[86:89], v8 offset:13824
    ds_read_b64 v[90:91], v9 offset:13824
    ds_read_b128 v[92:95], v8 offset:15360
    ds_read_b64 v[96:97], v9 offset:15360
    ds_read_b128 v[98:101], v8 offset:16896
    ds_read_b64 v[102:103], v9 offset:16896
    ds_read_b128 v[104:107], v8 offset:18432
    ds_read_b64 v[108:109], v9 offset:18432
    ds_read_b128 v[110:113], v8 offset:19968
    ds_read_b64 v[114:115], v9 offset:19968
    ds_read_b128 v[116:119], v8 offset:21504
    ds_read_b64 v[120:121], v9 offset:21504
    ds_read_b128 v[122:125], v8 offset:23040
    ds_read_b64 v[126:127], v9 offset:23040
    ds_read_b128 v[128:131], v8 offset:24576
    ds_read_b64 v[132:133], v9 offset:24576
    ds_read_b128 v[134:137], v8 offset:26112
    ds_read_b64 v[138:139], v9 offset:26112
    ds_read_b128 v[140:143], v8 offset:27648
    ds_read_b64 v[144:145], v9 offset:27648
    ds_read_b128 v[146:149], v8 offset:29184
    ds_read_b64 v[150:151], v9 offset:29184
    ds_read_b128 v[152:155], v8 offset:30720
    ds_read_b64 v[156:157], v9 offset:30720
    ds_read_b128 v[158:161], v8 offset:32256
    ds_read_b64 v[162:163], v9 offset:32256
    ds_read_b128 v[164:167], v8 offset:33792
    ds_read_b64 v[168:169], v9 offset:33792
    ds_read_b128 v[170:173], v8 offset:35328
    ds_read_b64 v[174:175], v9 offset:35328
    ds_read_b128 v[176:179], v8 offset:36864
    ds_read_b64 v[180:181], v9 offset:36864
    ds_read_b128 v[182:185], v8 offset:38400
    ds_read_b64 v[186:187], v9 offset:38400
    ds_read_b128 v[188:191], v8 offset:39936
    ds_read_b64 v[192:193], v9 offset:39936
    ds_read_b128 v[194:197], v8 offset:41472
    ds_read_b64 v[198:199], v9 offset:41472
    ds_read_b128 v[200:203], v8 offset:43008
    ds_read_b64 v[204:205], v9 offset:43008
    ds_read_b128 v[206:209], v8 offset:44544
    ds_read_b64 v[210:211], v9 offset:44544
    ds_read_b128 v[212:215], v8 offset:46080
    ds_read_b64 v[216:217], v9 offset:46080
    ds_read_b128 v[218:221], v8 offset:47616
    ds_read_b64 v[222:223], v9 offset:47616
    s_waitcnt lgkmcnt(0)
    v_mfma_f32_16x16x32_bf16 v[16:19], a[0:3], v[32:35], 0
    v_mfma_f32_16x16x32_bf16 v[20:23], a[0:3], v[38:41], 0
    v_mfma_f32_16x16x16_bf16 v[24:27], a[64:65], v[36:37], 0
    v_mfma_f32_16x16x16_bf16 v[28:31], a[64:65], v[42:43], 0
    v_mfma_f32_16x16x32_bf16 v[16:19], a[4:7], v[44:47], v[16:19]
    v_mfma_f32_16x16x32_bf16 v[20:23], a[4:7], v[50:53], v[20:23]
    v_mfma_f32_16x16x16_bf16 v[24:27], a[66:67], v[48:49], v[24:27]
    v_mfma_f32_16x16x16_bf16 v[28:31], a[66:67], v[54:55], v[28:31]
    v_mfma_f32_16x16x32_bf16 v[16:19], a[8:11], v[56:59], v[16:19]
    v_mfma_f32_16x16x32_bf16 v[20:23], a[8:11], v[62:65], v[20:23]
    v_mfma_f32_16x16x16_bf16 v[24:27], a[68:69], v[60:61], v[24:27]
    v_mfma_f32_16x16x16_bf16 v[28:31], a[68:69], v[66:67], v[28:31]
    v_mfma_f32_16x16x32_bf16 v[16:19], a[12:15], v[68:71], v[16:19]
    v_mfma_f32_16x16x32_bf16 v[20:23], a[12:15], v[74:77], v[20:23]
    v_mfma_f32_16x16x16_bf16 v[24:27], a[70:71], v[72:73], v[24:27]
    v_mfma_f32_16x16x16_bf16 v[28:31], a[70:71], v[78:79], v[28:31]
    v_mfma_f32_16x16x32_bf16 v[16:19], a[16:19], v[80:83], v[16:19]
    v_mfma_f32_16x16x32_bf16 v[20:23], a[16:19], v[86:89], v[20:23]
    v_mfma_f32_16x16x16_bf16 v[24:27], a[72:73], v[84:85], v[24:27]
    v_mfma_f32_16x16x16_bf16 v[28:31], a[72:73], v[90:91], v[28:31]
    v_mfma_f32_16x16x32_bf16 v[16:19], a[20:23], v[92:95], v[16:19]
    v_mfma_f32_16x16x32_bf16 v[20:23], a[20:23], v[98:101], v[20:23]
    v_mfma_f32_16x16x16_bf16 v[24:27], a[74:75], v[96:97], v[24:27]
    v_mfma_f32_16x16x16_bf16 v[28:31], a[74:75], v[102:103], v[28:31]
    v_mfma_f32_16x16x32_bf16 v[16:19], a[24:27], v[104:107], v[16:19]
    v_mfma_f32_16x16x32_bf16 v[20:23], a[24:27], v[110:113], v[20:23]
    v_mfma_f32_16x16x16_bf16 v[24:27], a[76:77], v[108:109], v[24:27]
    v_mfma_f32_16x16x16_bf16 v[28:31], a[76:77], v[114:115], v[28:31]
    v_mfma_f32_16x16x32_bf16 v[16:19], a[28:31], v[116:119], v[16:19]
    v_mfma_f32_16x16x32_bf16 v[20:23], a[28:31], v[122:125], v[20:23]
    v_mfma_f32_16x16x16_bf16 v[24:27], a[78:79], v[120:121], v[24:27]
    v_mfma_f32_16x16x16_bf16 v[28:31], a[78:79], v[126:127], v[28:31]
    v_mfma_f32_16x16x32_bf16 v[16:19], a[32:35], v[128:131], v[16:19]
    v_mfma_f32_16x16x32_bf16 v[20:23], a[32:35], v[134:137], v[20:23]
    v_mfma_f32_16x16x16_bf16 v[24:27], a[80:81], v[132:133], v[24:27]
    v_mfma_f32_16x16x16_bf16 v[28:31], a[80:81], v[138:139], v[28:31]
    v_mfma_f32_16x16x32_bf16 v[16:19], a[36:39], v[140:143], v[16:19]
    v_mfma_f32_16x16x32_bf16 v[20:23], a[36:39], v[146:149], v[20:23]
    v_mfma_f32_16x16x16_bf16 v[24:27], a[82:83], v[144:145], v[24:27]
    v_mfma_f32_16x16x16_bf16 v[28:31], a[82:83], v[150:151], v[28:31]
    v_mfma_f32_16x16x32_bf16 v[16:19], a[40:43], v[152:155], v[16:19]
    v_mfma_f32_16x16x32_bf16 v[20:23], a[40:43], v[158:161], v[20:23]
    v_mfma_f32_16x16x16_bf16 v[24:27], a[84:85], v[156:157], v[24:27]
    v_mfma_f32_16x16x16_bf16 v[28:31], a[84:85], v[162:163], v[28:31]
    v_mfma_f32_16x16x32_bf16 v[16:19], a[44:47], v[164:167], v[16:19]
    v_mfma_f32_16x16x32_bf16 v[20:23], a[44:47], v[170:173], v[20:23]
    v_mfma_f32_16x16x16_bf16 v[24:27], a[86:87], v[168:169], v[24:27]
    v_mfma_f32_16x16x16_bf16 v[28:31], a[86:87], v[174:175], v[28:31]
    v_mfma_f32_16x16x32_bf16 v[16:19], a[48:51], v[176:179], v[16:19]
    v_mfma_f32_16x16x32_bf16 v[20:23], a[48:51], v[182:185], v[20:23]
    v_mfma_f32_16x16x16_bf16 v[24:27], a[88:89], v[180:181], v[24:27]
    v_mfma_f32_16x16x16_bf16 v[28:31], a[88:89], v[186:187], v[28:31]
    v_mfma_f32_16x16x32_bf16 v[16:19], a[52:55], v[188:191], v[16:19]
    v_mfma_f32_16x16x32_bf16 v[20:23], a[52:55], v[194:197], v[20:23]
    v_mfma_f32_16x16x16_bf16 v[24:27], a[90:91], v[192:193], v[24:27]
    v_mfma_f32_16x16x16_bf16 v[28:31], a[90:91], v[198:199], v[28:31]
    v_mfma_f32_16x16x32_bf16 v[16:19], a[56:59], v[200:203], v[16:19]
    v_mfma_f32_16x16x32_bf16 v[20:23], a[56:59], v[206:209], v[20:23]
    v_mfma_f32_16x16x16_bf16 v[24:27], a[92:93], v[204:205], v[24:27]
    v_mfma_f32_16x16x16_bf16 v[28:31], a[92:93], v[210:211], v[28:31]
    v_mfma_f32_16x16x32_bf16 v[16:19], a[60:63], v[212:215], v[16:19]
    v_mfma_f32_16x16x32_bf16 v[20:23], a[60:63], v[218:221], v[20:23]
    v_mfma_f32_16x16x16_bf16 v[24:27], a[94:95], v[216:217], v[24:27]
    v_mfma_f32_16x16x16_bf16 v[28:31], a[94:95], v[222:223], v[28:31]
    s_nop 7
    s_nop 1
    v_add_f32 v16, v16, v24
    v_add_f32 v17, v17, v25
    v_add_f32 v18, v18, v26
    v_add_f32 v19, v19, v27
    v_add_f32 v20, v20, v28
    v_add_f32 v21, v21, v29
    v_add_f32 v22, v22, v30
    v_add_f32 v23, v23, v31
    s_add_u32 s30, s29, 28082176
    s_add_u32 s31, s30, 14336
    s_add_u32 s34, s29, 14336
    v_cvt_pk_bf16_f32 v16, v16, v17
    v_cvt_pk_bf16_f32 v17, v18, v19
    v_lshlrev_b32 v24, 16, v16
    v_and_b32 v25, 0xffff0000, v16
    v_lshlrev_b32 v26, 16, v12
    v_and_b32 v27, 0xffff0000, v12
    v_add_f32 v24, v24, v26
    v_add_f32 v25, v25, v27
    v_cvt_pk_bf16_f32 v16, v24, v25
    v_lshlrev_b32 v24, 16, v17
    v_and_b32 v25, 0xffff0000, v17
    v_lshlrev_b32 v26, 16, v13
    v_and_b32 v27, 0xffff0000, v13
    v_add_f32 v24, v24, v26
    v_add_f32 v25, v25, v27
    v_cvt_pk_bf16_f32 v17, v24, v25
    buffer_store_dwordx2 v[16:17], v7, s[20:23], s30 offen sc1
    v_cvt_pk_bf16_f32 v20, v20, v21
    v_cvt_pk_bf16_f32 v21, v22, v23
    v_lshlrev_b32 v24, 16, v20
    v_and_b32 v25, 0xffff0000, v20
    v_lshlrev_b32 v26, 16, v14
    v_and_b32 v27, 0xffff0000, v14
    v_add_f32 v24, v24, v26
    v_add_f32 v25, v25, v27
    v_cvt_pk_bf16_f32 v20, v24, v25
    v_lshlrev_b32 v24, 16, v21
    v_and_b32 v25, 0xffff0000, v21
    v_lshlrev_b32 v26, 16, v15
    v_and_b32 v27, 0xffff0000, v15
    v_add_f32 v24, v24, v26
    v_add_f32 v25, v25, v27
    v_cvt_pk_bf16_f32 v21, v24, v25
    buffer_store_dwordx2 v[20:21], v7, s[20:23], s31 offen sc1
    s_waitcnt vmcnt(0)
    s_barrier
    s_cmp_lg_u32 s3, 0
    s_cbranch_scc1 mega_kernel_sg118
    s_lshl_b32 s70, s24, 7
    s_add_u32 s70, s70, 167542784
    v_mov_b32 v10, 1
    v_mov_b32 v11, 0
    s_mov_b64 exec, 1
    buffer_atomic_add v10, v11, s[20:23], s70 offen sc1
    s_mov_b64 exec, -1
mega_kernel_sg118:
    s_add_u32 s2, s2, 14
    s_cmp_lt_u32 s2, 448
    s_cbranch_scc1 bv0_loop
    s_endpgm
bv1_start:
    v_lshlrev_b32 v5, 6, v2
    v_lshl_add_u32 v5, v3, 4, v5
    v_and_b32 v6, 1, v3
    v_lshlrev_b32 v6, 3, v6
    v_lshl_add_u32 v6, v2, 4, v6
    v_mul_u32_u24 v7, 896, v2
    v_lshl_add_u32 v7, v3, 3, v7
    v_lshlrev_b32 v8, 4, v1
    v_lshlrev_b32 v9, 3, v1
    v_add_u32 v9, 1024, v9
    v_mov_b32 v11, 0
bv1_loop:
    s_mul_hi_u32 s24, s2, 613566757
    s_mul_i32 s25, s24, 7
    s_sub_u32 s25, s2, s25
    s_lshl_b32 s25, s25, 2
    s_add_u32 s25, s25, s3
    s_cmp_lg_u32 s3, 0
    s_cbranch_scc1 mega_kernel_wd120
    s_lshl_b32 s70, s24, 7
    s_add_u32 s70, s70, 167624704
mega_kernel_wc119:
    buffer_load_dword v10, v11, s[20:23], s70 offen sc1
    s_waitcnt vmcnt(0)
    v_readfirstlane_b32 s71, v10
    s_cmp_ge_u32 s71, 28
    s_cbranch_scc1 mega_kernel_wd120
    s_sleep 6
    s_branch mega_kernel_wc119
mega_kernel_wd120:
    s_barrier
    s_mul_i32 s26, s24, 458752
    s_lshl_b32 s27, s25, 10
    s_add_u32 s26, s26, s27
    s_add_u32 s26, s26, 130842624
    s_mul_i32 s28, s24, 114688
    s_lshl_b32 s27, s25, 8
    s_add_u32 s28, s28, s27
    s_add_u32 s28, s28, 160202752
    s_mul_i32 s29, s24, 28672
    s_lshl_b32 s27, s25, 5
    s_add_u32 s29, s29, s27
    s_add_u32 s30, s29, 29917184
    s_add_u32 s31, s30, 14336
    buffer_load_dwordx4 a[0:3], v5, s[20:23], s26 offen sc1
    s_add_u32 s26, s26, 28672
    buffer_load_dwordx4 a[4:7], v5, s[20:23], s26 offen sc1
    s_add_u32 s26, s26, 28672
    buffer_load_dwordx4 a[8:11], v5, s[20:23], s26 offen sc1
    s_add_u32 s26, s26, 28672
    buffer_load_dwordx4 a[12:15], v5, s[20:23], s26 offen sc1
    s_add_u32 s26, s26, 28672
    buffer_load_dwordx4 a[16:19], v5, s[20:23], s26 offen sc1
    s_add_u32 s26, s26, 28672
    buffer_load_dwordx4 a[20:23], v5, s[20:23], s26 offen sc1
    s_add_u32 s26, s26, 28672
    buffer_load_dwordx4 a[24:27], v5, s[20:23], s26 offen sc1
    s_add_u32 s26, s26, 28672
    buffer_load_dwordx4 a[28:31], v5, s[20:23], s26 offen sc1
    s_add_u32 s26, s26, 28672
    buffer_load_dwordx4 a[32:35], v5, s[20:23], s26 offen sc1
    s_add_u32 s26, s26, 28672
    buffer_load_dwordx4 a[36:39], v5, s[20:23], s26 offen sc1
    s_add_u32 s26, s26, 28672
    buffer_load_dwordx4 a[40:43], v5, s[20:23], s26 offen sc1
    s_add_u32 s26, s26, 28672
    buffer_load_dwordx4 a[44:47], v5, s[20:23], s26 offen sc1
    s_add_u32 s26, s26, 28672
    buffer_load_dwordx4 a[48:51], v5, s[20:23], s26 offen sc1
    s_add_u32 s26, s26, 28672
    buffer_load_dwordx4 a[52:55], v5, s[20:23], s26 offen sc1
    s_add_u32 s26, s26, 28672
    buffer_load_dwordx4 a[56:59], v5, s[20:23], s26 offen sc1
    s_add_u32 s26, s26, 28672
    buffer_load_dwordx4 a[60:63], v5, s[20:23], s26 offen sc1
    buffer_load_dwordx2 v[12:13], v7, s[20:23], s30 offen sc1
    buffer_load_dwordx2 v[14:15], v7, s[20:23], s31 offen sc1
    s_cmp_lg_u32 s3, 0
    s_cbranch_scc1 mega_kernel_wd122
    s_lshl_b32 s70, s24, 7
    s_add_u32 s70, s70, 167600128
mega_kernel_wc121:
    buffer_load_dword v10, v11, s[20:23], s70 offen sc1
    s_waitcnt vmcnt(0)
    v_readfirstlane_b32 s71, v10
    s_cmp_ge_u32 s71, 14
    s_cbranch_scc1 mega_kernel_wd122
    s_sleep 6
    s_branch mega_kernel_wc121
mega_kernel_wd122:
    s_barrier
    buffer_load_dwordx2 a[64:65], v6, s[20:23], s28 offen sc1
    s_add_u32 s28, s28, 7168
    buffer_load_dwordx2 a[66:67], v6, s[20:23], s28 offen sc1
    s_add_u32 s28, s28, 7168
    buffer_load_dwordx2 a[68:69], v6, s[20:23], s28 offen sc1
    s_add_u32 s28, s28, 7168
    buffer_load_dwordx2 a[70:71], v6, s[20:23], s28 offen sc1
    s_add_u32 s28, s28, 7168
    buffer_load_dwordx2 a[72:73], v6, s[20:23], s28 offen sc1
    s_add_u32 s28, s28, 7168
    buffer_load_dwordx2 a[74:75], v6, s[20:23], s28 offen sc1
    s_add_u32 s28, s28, 7168
    buffer_load_dwordx2 a[76:77], v6, s[20:23], s28 offen sc1
    s_add_u32 s28, s28, 7168
    buffer_load_dwordx2 a[78:79], v6, s[20:23], s28 offen sc1
    s_add_u32 s28, s28, 7168
    buffer_load_dwordx2 a[80:81], v6, s[20:23], s28 offen sc1
    s_add_u32 s28, s28, 7168
    buffer_load_dwordx2 a[82:83], v6, s[20:23], s28 offen sc1
    s_add_u32 s28, s28, 7168
    buffer_load_dwordx2 a[84:85], v6, s[20:23], s28 offen sc1
    s_add_u32 s28, s28, 7168
    buffer_load_dwordx2 a[86:87], v6, s[20:23], s28 offen sc1
    s_add_u32 s28, s28, 7168
    buffer_load_dwordx2 a[88:89], v6, s[20:23], s28 offen sc1
    s_add_u32 s28, s28, 7168
    buffer_load_dwordx2 a[90:91], v6, s[20:23], s28 offen sc1
    s_add_u32 s28, s28, 7168
    buffer_load_dwordx2 a[92:93], v6, s[20:23], s28 offen sc1
    s_add_u32 s28, s28, 7168
    buffer_load_dwordx2 a[94:95], v6, s[20:23], s28 offen sc1
    s_cmp_lg_u32 s3, 0
    s_cbranch_scc1 mega_kernel_wd124
    s_lshl_b32 s70, s24, 7
    s_add_u32 s70, s70, 167616512
mega_kernel_wc123:
    buffer_load_dword v10, v11, s[20:23], s70 offen sc1
    s_waitcnt vmcnt(0)
    v_readfirstlane_b32 s71, v10
    s_cmp_ge_u32 s71, 4
    s_cbranch_scc1 mega_kernel_wd124
    s_sleep 6
    s_branch mega_kernel_wc123
mega_kernel_wd124:
    s_barrier
    s_mul_i32 s26, s24, 49152
    s_mul_i32 s27, s3, 12288
    s_add_u32 s26, s26, s27
    s_add_u32 s26, s26, 170819584
    s_add_u32 s34, s27, 0
    s_mov_b32 m0, s34
    s_nop 0
    buffer_load_dwordx4 v8, s[20:23], s26 offen sc1 lds
    s_add_u32 s26, s26, 1024
    s_add_u32 s34, s27, 1024
    s_mov_b32 m0, s34
    s_nop 0
    buffer_load_dwordx4 v8, s[20:23], s26 offen sc1 lds
    s_add_u32 s26, s26, 1024
    s_add_u32 s34, s27, 2048
    s_mov_b32 m0, s34
    s_nop 0
    buffer_load_dwordx4 v8, s[20:23], s26 offen sc1 lds
    s_add_u32 s26, s26, 1024
    s_add_u32 s34, s27, 3072
    s_mov_b32 m0, s34
    s_nop 0
    buffer_load_dwordx4 v8, s[20:23], s26 offen sc1 lds
    s_add_u32 s26, s26, 1024
    s_add_u32 s34, s27, 4096
    s_mov_b32 m0, s34
    s_nop 0
    buffer_load_dwordx4 v8, s[20:23], s26 offen sc1 lds
    s_add_u32 s26, s26, 1024
    s_add_u32 s34, s27, 5120
    s_mov_b32 m0, s34
    s_nop 0
    buffer_load_dwordx4 v8, s[20:23], s26 offen sc1 lds
    s_add_u32 s26, s26, 1024
    s_add_u32 s34, s27, 6144
    s_mov_b32 m0, s34
    s_nop 0
    buffer_load_dwordx4 v8, s[20:23], s26 offen sc1 lds
    s_add_u32 s26, s26, 1024
    s_add_u32 s34, s27, 7168
    s_mov_b32 m0, s34
    s_nop 0
    buffer_load_dwordx4 v8, s[20:23], s26 offen sc1 lds
    s_add_u32 s26, s26, 1024
    s_add_u32 s34, s27, 8192
    s_mov_b32 m0, s34
    s_nop 0
    buffer_load_dwordx4 v8, s[20:23], s26 offen sc1 lds
    s_add_u32 s26, s26, 1024
    s_add_u32 s34, s27, 9216
    s_mov_b32 m0, s34
    s_nop 0
    buffer_load_dwordx4 v8, s[20:23], s26 offen sc1 lds
    s_add_u32 s26, s26, 1024
    s_add_u32 s34, s27, 10240
    s_mov_b32 m0, s34
    s_nop 0
    buffer_load_dwordx4 v8, s[20:23], s26 offen sc1 lds
    s_add_u32 s26, s26, 1024
    s_add_u32 s34, s27, 11264
    s_mov_b32 m0, s34
    s_nop 0
    buffer_load_dwordx4 v8, s[20:23], s26 offen sc1 lds
    s_waitcnt vmcnt(0)
    s_barrier
    ds_read_b128 v[32:35], v8 offset:0
    ds_read_b64 v[36:37], v9 offset:0
    ds_read_b128 v[38:41], v8 offset:1536
    ds_read_b64 v[42:43], v9 offset:1536
    ds_read_b128 v[44:47], v8 offset:3072
    ds_read_b64 v[48:49], v9 offset:3072
    ds_read_b128 v[50:53], v8 offset:4608
    ds_read_b64 v[54:55], v9 offset:4608
    ds_read_b128 v[56:59], v8 offset:6144
    ds_read_b64 v[60:61], v9 offset:6144
    ds_read_b128 v[62:65], v8 offset:7680
    ds_read_b64 v[66:67], v9 offset:7680
    ds_read_b128 v[68:71], v8 offset:9216
    ds_read_b64 v[72:73], v9 offset:9216
    ds_read_b128 v[74:77], v8 offset:10752
    ds_read_b64 v[78:79], v9 offset:10752
    ds_read_b128 v[80:83], v8 offset:12288
    ds_read_b64 v[84:85], v9 offset:12288
    ds_read_b128 v[86:89], v8 offset:13824
    ds_read_b64 v[90:91], v9 offset:13824
    ds_read_b128 v[92:95], v8 offset:15360
    ds_read_b64 v[96:97], v9 offset:15360
    ds_read_b128 v[98:101], v8 offset:16896
    ds_read_b64 v[102:103], v9 offset:16896
    ds_read_b128 v[104:107], v8 offset:18432
    ds_read_b64 v[108:109], v9 offset:18432
    ds_read_b128 v[110:113], v8 offset:19968
    ds_read_b64 v[114:115], v9 offset:19968
    ds_read_b128 v[116:119], v8 offset:21504
    ds_read_b64 v[120:121], v9 offset:21504
    ds_read_b128 v[122:125], v8 offset:23040
    ds_read_b64 v[126:127], v9 offset:23040
    ds_read_b128 v[128:131], v8 offset:24576
    ds_read_b64 v[132:133], v9 offset:24576
    ds_read_b128 v[134:137], v8 offset:26112
    ds_read_b64 v[138:139], v9 offset:26112
    ds_read_b128 v[140:143], v8 offset:27648
    ds_read_b64 v[144:145], v9 offset:27648
    ds_read_b128 v[146:149], v8 offset:29184
    ds_read_b64 v[150:151], v9 offset:29184
    ds_read_b128 v[152:155], v8 offset:30720
    ds_read_b64 v[156:157], v9 offset:30720
    ds_read_b128 v[158:161], v8 offset:32256
    ds_read_b64 v[162:163], v9 offset:32256
    ds_read_b128 v[164:167], v8 offset:33792
    ds_read_b64 v[168:169], v9 offset:33792
    ds_read_b128 v[170:173], v8 offset:35328
    ds_read_b64 v[174:175], v9 offset:35328
    ds_read_b128 v[176:179], v8 offset:36864
    ds_read_b64 v[180:181], v9 offset:36864
    ds_read_b128 v[182:185], v8 offset:38400
    ds_read_b64 v[186:187], v9 offset:38400
    ds_read_b128 v[188:191], v8 offset:39936
    ds_read_b64 v[192:193], v9 offset:39936
    ds_read_b128 v[194:197], v8 offset:41472
    ds_read_b64 v[198:199], v9 offset:41472
    ds_read_b128 v[200:203], v8 offset:43008
    ds_read_b64 v[204:205], v9 offset:43008
    ds_read_b128 v[206:209], v8 offset:44544
    ds_read_b64 v[210:211], v9 offset:44544
    ds_read_b128 v[212:215], v8 offset:46080
    ds_read_b64 v[216:217], v9 offset:46080
    ds_read_b128 v[218:221], v8 offset:47616
    ds_read_b64 v[222:223], v9 offset:47616
    s_waitcnt lgkmcnt(0)
    v_mfma_f32_16x16x32_bf16 v[16:19], a[0:3], v[32:35], 0
    v_mfma_f32_16x16x32_bf16 v[20:23], a[0:3], v[38:41], 0
    v_mfma_f32_16x16x16_bf16 v[24:27], a[64:65], v[36:37], 0
    v_mfma_f32_16x16x16_bf16 v[28:31], a[64:65], v[42:43], 0
    v_mfma_f32_16x16x32_bf16 v[16:19], a[4:7], v[44:47], v[16:19]
    v_mfma_f32_16x16x32_bf16 v[20:23], a[4:7], v[50:53], v[20:23]
    v_mfma_f32_16x16x16_bf16 v[24:27], a[66:67], v[48:49], v[24:27]
    v_mfma_f32_16x16x16_bf16 v[28:31], a[66:67], v[54:55], v[28:31]
    v_mfma_f32_16x16x32_bf16 v[16:19], a[8:11], v[56:59], v[16:19]
    v_mfma_f32_16x16x32_bf16 v[20:23], a[8:11], v[62:65], v[20:23]
    v_mfma_f32_16x16x16_bf16 v[24:27], a[68:69], v[60:61], v[24:27]
    v_mfma_f32_16x16x16_bf16 v[28:31], a[68:69], v[66:67], v[28:31]
    v_mfma_f32_16x16x32_bf16 v[16:19], a[12:15], v[68:71], v[16:19]
    v_mfma_f32_16x16x32_bf16 v[20:23], a[12:15], v[74:77], v[20:23]
    v_mfma_f32_16x16x16_bf16 v[24:27], a[70:71], v[72:73], v[24:27]
    v_mfma_f32_16x16x16_bf16 v[28:31], a[70:71], v[78:79], v[28:31]
    v_mfma_f32_16x16x32_bf16 v[16:19], a[16:19], v[80:83], v[16:19]
    v_mfma_f32_16x16x32_bf16 v[20:23], a[16:19], v[86:89], v[20:23]
    v_mfma_f32_16x16x16_bf16 v[24:27], a[72:73], v[84:85], v[24:27]
    v_mfma_f32_16x16x16_bf16 v[28:31], a[72:73], v[90:91], v[28:31]
    v_mfma_f32_16x16x32_bf16 v[16:19], a[20:23], v[92:95], v[16:19]
    v_mfma_f32_16x16x32_bf16 v[20:23], a[20:23], v[98:101], v[20:23]
    v_mfma_f32_16x16x16_bf16 v[24:27], a[74:75], v[96:97], v[24:27]
    v_mfma_f32_16x16x16_bf16 v[28:31], a[74:75], v[102:103], v[28:31]
    v_mfma_f32_16x16x32_bf16 v[16:19], a[24:27], v[104:107], v[16:19]
    v_mfma_f32_16x16x32_bf16 v[20:23], a[24:27], v[110:113], v[20:23]
    v_mfma_f32_16x16x16_bf16 v[24:27], a[76:77], v[108:109], v[24:27]
    v_mfma_f32_16x16x16_bf16 v[28:31], a[76:77], v[114:115], v[28:31]
    v_mfma_f32_16x16x32_bf16 v[16:19], a[28:31], v[116:119], v[16:19]
    v_mfma_f32_16x16x32_bf16 v[20:23], a[28:31], v[122:125], v[20:23]
    v_mfma_f32_16x16x16_bf16 v[24:27], a[78:79], v[120:121], v[24:27]
    v_mfma_f32_16x16x16_bf16 v[28:31], a[78:79], v[126:127], v[28:31]
    v_mfma_f32_16x16x32_bf16 v[16:19], a[32:35], v[128:131], v[16:19]
    v_mfma_f32_16x16x32_bf16 v[20:23], a[32:35], v[134:137], v[20:23]
    v_mfma_f32_16x16x16_bf16 v[24:27], a[80:81], v[132:133], v[24:27]
    v_mfma_f32_16x16x16_bf16 v[28:31], a[80:81], v[138:139], v[28:31]
    v_mfma_f32_16x16x32_bf16 v[16:19], a[36:39], v[140:143], v[16:19]
    v_mfma_f32_16x16x32_bf16 v[20:23], a[36:39], v[146:149], v[20:23]
    v_mfma_f32_16x16x16_bf16 v[24:27], a[82:83], v[144:145], v[24:27]
    v_mfma_f32_16x16x16_bf16 v[28:31], a[82:83], v[150:151], v[28:31]
    v_mfma_f32_16x16x32_bf16 v[16:19], a[40:43], v[152:155], v[16:19]
    v_mfma_f32_16x16x32_bf16 v[20:23], a[40:43], v[158:161], v[20:23]
    v_mfma_f32_16x16x16_bf16 v[24:27], a[84:85], v[156:157], v[24:27]
    v_mfma_f32_16x16x16_bf16 v[28:31], a[84:85], v[162:163], v[28:31]
    v_mfma_f32_16x16x32_bf16 v[16:19], a[44:47], v[164:167], v[16:19]
    v_mfma_f32_16x16x32_bf16 v[20:23], a[44:47], v[170:173], v[20:23]
    v_mfma_f32_16x16x16_bf16 v[24:27], a[86:87], v[168:169], v[24:27]
    v_mfma_f32_16x16x16_bf16 v[28:31], a[86:87], v[174:175], v[28:31]
    v_mfma_f32_16x16x32_bf16 v[16:19], a[48:51], v[176:179], v[16:19]
    v_mfma_f32_16x16x32_bf16 v[20:23], a[48:51], v[182:185], v[20:23]
    v_mfma_f32_16x16x16_bf16 v[24:27], a[88:89], v[180:181], v[24:27]
    v_mfma_f32_16x16x16_bf16 v[28:31], a[88:89], v[186:187], v[28:31]
    v_mfma_f32_16x16x32_bf16 v[16:19], a[52:55], v[188:191], v[16:19]
    v_mfma_f32_16x16x32_bf16 v[20:23], a[52:55], v[194:197], v[20:23]
    v_mfma_f32_16x16x16_bf16 v[24:27], a[90:91], v[192:193], v[24:27]
    v_mfma_f32_16x16x16_bf16 v[28:31], a[90:91], v[198:199], v[28:31]
    v_mfma_f32_16x16x32_bf16 v[16:19], a[56:59], v[200:203], v[16:19]
    v_mfma_f32_16x16x32_bf16 v[20:23], a[56:59], v[206:209], v[20:23]
    v_mfma_f32_16x16x16_bf16 v[24:27], a[92:93], v[204:205], v[24:27]
    v_mfma_f32_16x16x16_bf16 v[28:31], a[92:93], v[210:211], v[28:31]
    v_mfma_f32_16x16x32_bf16 v[16:19], a[60:63], v[212:215], v[16:19]
    v_mfma_f32_16x16x32_bf16 v[20:23], a[60:63], v[218:221], v[20:23]
    v_mfma_f32_16x16x16_bf16 v[24:27], a[94:95], v[216:217], v[24:27]
    v_mfma_f32_16x16x16_bf16 v[28:31], a[94:95], v[222:223], v[28:31]
    s_nop 7
    s_nop 1
    v_add_f32 v16, v16, v24
    v_add_f32 v17, v17, v25
    v_add_f32 v18, v18, v26
    v_add_f32 v19, v19, v27
    v_add_f32 v20, v20, v28
    v_add_f32 v21, v21, v29
    v_add_f32 v22, v22, v30
    v_add_f32 v23, v23, v31
    s_add_u32 s30, s29, 28082176
    s_add_u32 s31, s30, 14336
    s_add_u32 s34, s29, 14336
    v_cvt_pk_bf16_f32 v16, v16, v17
    v_cvt_pk_bf16_f32 v17, v18, v19
    v_lshlrev_b32 v24, 16, v16
    v_and_b32 v25, 0xffff0000, v16
    v_lshlrev_b32 v26, 16, v12
    v_and_b32 v27, 0xffff0000, v12
    v_add_f32 v24, v24, v26
    v_add_f32 v25, v25, v27
    v_cvt_pk_bf16_f32 v16, v24, v25
    v_lshlrev_b32 v24, 16, v17
    v_and_b32 v25, 0xffff0000, v17
    v_lshlrev_b32 v26, 16, v13
    v_and_b32 v27, 0xffff0000, v13
    v_add_f32 v24, v24, v26
    v_add_f32 v25, v25, v27
    v_cvt_pk_bf16_f32 v17, v24, v25
    buffer_store_dwordx2 v[16:17], v7, s[16:19], s29 offen
    v_cvt_pk_bf16_f32 v20, v20, v21
    v_cvt_pk_bf16_f32 v21, v22, v23
    v_lshlrev_b32 v24, 16, v20
    v_and_b32 v25, 0xffff0000, v20
    v_lshlrev_b32 v26, 16, v14
    v_and_b32 v27, 0xffff0000, v14
    v_add_f32 v24, v24, v26
    v_add_f32 v25, v25, v27
    v_cvt_pk_bf16_f32 v20, v24, v25
    v_lshlrev_b32 v24, 16, v21
    v_and_b32 v25, 0xffff0000, v21
    v_lshlrev_b32 v26, 16, v15
    v_and_b32 v27, 0xffff0000, v15
    v_add_f32 v24, v24, v26
    v_add_f32 v25, v25, v27
    v_cvt_pk_bf16_f32 v21, v24, v25
    buffer_store_dwordx2 v[20:21], v7, s[16:19], s34 offen
    s_barrier
    s_add_u32 s2, s2, 14
    s_cmp_lt_u32 s2, 448
    s_cbranch_scc1 bv1_loop
    s_endpgm
a1_start:
    s_mul_hi_u32 s25, s2, 1431655766
    s_mul_i32 s24, s25, 3
    s_sub_u32 s24, s2, s24
    v_mul_u32_u24 v7, 896, v2
    v_lshl_add_u32 v7, v3, 4, v7
    s_mul_i32 s28, s24, 448
    s_mul_i32 s29, s3, 112
    s_add_u32 s28, s28, s29
    s_mul_i32 s28, s28, 896
    s_add_u32 s28, s28, 0
    v_lshlrev_b32 v12, 4, v1
    v_add_u32 v13, 4096, v12
    v_add_u32 v14, 8192, v12
    v_add_u32 v15, 12288, v12
    buffer_load_dwordx4 a[0:3], v12, s[20:23], s28 offen offset:0
    buffer_load_dwordx4 a[4:7], v12, s[20:23], s28 offen offset:1024
    buffer_load_dwordx4 a[8:11], v12, s[20:23], s28 offen offset:2048
    buffer_load_dwordx4 a[12:15], v12, s[20:23], s28 offen offset:3072
    buffer_load_dwordx4 a[16:19], v13, s[20:23], s28 offen offset:0
    buffer_load_dwordx4 a[20:23], v13, s[20:23], s28 offen offset:1024
    buffer_load_dwordx4 a[24:27], v13, s[20:23], s28 offen offset:2048
    buffer_load_dwordx4 a[28:31], v13, s[20:23], s28 offen offset:3072
    buffer_load_dwordx4 a[32:35], v14, s[20:23], s28 offen offset:0
    buffer_load_dwordx4 a[36:39], v14, s[20:23], s28 offen offset:1024
    buffer_load_dwordx4 a[40:43], v14, s[20:23], s28 offen offset:2048
    buffer_load_dwordx4 a[44:47], v14, s[20:23], s28 offen offset:3072
    buffer_load_dwordx4 a[48:51], v15, s[20:23], s28 offen offset:0
    buffer_load_dwordx4 a[52:55], v15, s[20:23], s28 offen offset:1024
    s_add_u32 s28, s28, 14336
    buffer_load_dwordx4 a[56:59], v12, s[20:23], s28 offen offset:0
    buffer_load_dwordx4 a[60:63], v12, s[20:23], s28 offen offset:1024
    buffer_load_dwordx4 a[64:67], v12, s[20:23], s28 offen offset:2048
    buffer_load_dwordx4 a[68:71], v12, s[20:23], s28 offen offset:3072
    buffer_load_dwordx4 a[72:75], v13, s[20:23], s28 offen offset:0
    buffer_load_dwordx4 a[76:79], v13, s[20:23], s28 offen offset:1024
    buffer_load_dwordx4 a[80:83], v13, s[20:23], s28 offen offset:2048
    buffer_load_dwordx4 a[84:87], v13, s[20:23], s28 offen offset:3072
    buffer_load_dwordx4 a[88:91], v14, s[20:23], s28 offen offset:0
    buffer_load_dwordx4 a[92:95], v14, s[20:23], s28 offen offset:1024
    buffer_load_dwordx4 a[96:99], v14, s[20:23], s28 offen offset:2048
    buffer_load_dwordx4 a[100:103], v14, s[20:23], s28 offen offset:3072
    buffer_load_dwordx4 a[104:107], v15, s[20:23], s28 offen offset:0
    buffer_load_dwordx4 a[108:111], v15, s[20:23], s28 offen offset:1024
    s_add_u32 s28, s28, 14336
    buffer_load_dwordx4 a[112:115], v12, s[20:23], s28 offen offset:0
    buffer_load_dwordx4 a[116:119], v12, s[20:23], s28 offen offset:1024
    buffer_load_dwordx4 a[120:123], v12, s[20:23], s28 offen offset:2048
    buffer_load_dwordx4 a[124:127], v12, s[20:23], s28 offen offset:3072
    buffer_load_dwordx4 a[128:131], v13, s[20:23], s28 offen offset:0
    buffer_load_dwordx4 a[132:135], v13, s[20:23], s28 offen offset:1024
    buffer_load_dwordx4 a[136:139], v13, s[20:23], s28 offen offset:2048
    buffer_load_dwordx4 a[140:143], v13, s[20:23], s28 offen offset:3072
    buffer_load_dwordx4 a[144:147], v14, s[20:23], s28 offen offset:0
    buffer_load_dwordx4 a[148:151], v14, s[20:23], s28 offen offset:1024
    buffer_load_dwordx4 a[152:155], v14, s[20:23], s28 offen offset:2048
    buffer_load_dwordx4 a[156:159], v14, s[20:23], s28 offen offset:3072
    buffer_load_dwordx4 a[160:163], v15, s[20:23], s28 offen offset:0
    buffer_load_dwordx4 a[164:167], v15, s[20:23], s28 offen offset:1024
    s_add_u32 s28, s28, 14336
    buffer_load_dwordx4 a[168:171], v12, s[20:23], s28 offen offset:0
    buffer_load_dwordx4 a[172:175], v12, s[20:23], s28 offen offset:1024
    buffer_load_dwordx4 a[176:179], v12, s[20:23], s28 offen offset:2048
    buffer_load_dwordx4 a[180:183], v12, s[20:23], s28 offen offset:3072
    buffer_load_dwordx4 a[184:187], v13, s[20:23], s28 offen offset:0
    buffer_load_dwordx4 a[188:191], v13, s[20:23], s28 offen offset:1024
    buffer_load_dwordx4 a[192:195], v13, s[20:23], s28 offen offset:2048
    buffer_load_dwordx4 a[196:199], v13, s[20:23], s28 offen offset:3072
    buffer_load_dwordx4 a[200:203], v14, s[20:23], s28 offen offset:0
    buffer_load_dwordx4 a[204:207], v14, s[20:23], s28 offen offset:1024
    buffer_load_dwordx4 a[208:211], v14, s[20:23], s28 offen offset:2048
    buffer_load_dwordx4 a[212:215], v14, s[20:23], s28 offen offset:3072
    buffer_load_dwordx4 a[216:219], v15, s[20:23], s28 offen offset:0
    buffer_load_dwordx4 a[220:223], v15, s[20:23], s28 offen offset:1024
    s_add_u32 s28, s28, 14336
    buffer_load_dwordx4 a[224:227], v12, s[20:23], s28 offen offset:0
    buffer_load_dwordx4 a[228:231], v12, s[20:23], s28 offen offset:1024
    buffer_load_dwordx4 a[232:235], v12, s[20:23], s28 offen offset:2048
    buffer_load_dwordx4 a[236:239], v12, s[20:23], s28 offen offset:3072
    buffer_load_dwordx4 a[240:243], v13, s[20:23], s28 offen offset:0
    buffer_load_dwordx4 a[244:247], v13, s[20:23], s28 offen offset:1024
    buffer_load_dwordx4 a[248:251], v13, s[20:23], s28 offen offset:2048
    buffer_load_dwordx4 a[252:255], v13, s[20:23], s28 offen offset:3072
    buffer_load_dwordx4 v[110:113], v14, s[20:23], s28 offen offset:0
    buffer_load_dwordx4 v[114:117], v14, s[20:23], s28 offen offset:1024
    buffer_load_dwordx4 v[118:121], v14, s[20:23], s28 offen offset:2048
    buffer_load_dwordx4 v[122:125], v14, s[20:23], s28 offen offset:3072
    buffer_load_dwordx4 v[126:129], v15, s[20:23], s28 offen offset:0
    buffer_load_dwordx4 v[130:133], v15, s[20:23], s28 offen offset:1024
    s_add_u32 s28, s28, 14336
    buffer_load_dwordx4 v[134:137], v12, s[20:23], s28 offen offset:0
    buffer_load_dwordx4 v[138:141], v12, s[20:23], s28 offen offset:1024
    buffer_load_dwordx4 v[142:145], v12, s[20:23], s28 offen offset:2048
    buffer_load_dwordx4 v[146:149], v12, s[20:23], s28 offen offset:3072
    buffer_load_dwordx4 v[150:153], v13, s[20:23], s28 offen offset:0
    buffer_load_dwordx4 v[154:157], v13, s[20:23], s28 offen offset:1024
    buffer_load_dwordx4 v[158:161], v13, s[20:23], s28 offen offset:2048
    buffer_load_dwordx4 v[162:165], v13, s[20:23], s28 offen offset:3072
    buffer_load_dwordx4 v[166:169], v14, s[20:23], s28 offen offset:0
    buffer_load_dwordx4 v[170:173], v14, s[20:23], s28 offen offset:1024
    buffer_load_dwordx4 v[174:177], v14, s[20:23], s28 offen offset:2048
    buffer_load_dwordx4 v[178:181], v14, s[20:23], s28 offen offset:3072
    buffer_load_dwordx4 v[182:185], v15, s[20:23], s28 offen offset:0
    buffer_load_dwordx4 v[186:189], v15, s[20:23], s28 offen offset:1024
    s_add_u32 s28, s28, 14336
    buffer_load_dwordx4 v[190:193], v12, s[20:23], s28 offen offset:0
    buffer_load_dwordx4 v[194:197], v12, s[20:23], s28 offen offset:1024
    buffer_load_dwordx4 v[198:201], v12, s[20:23], s28 offen offset:2048
    buffer_load_dwordx4 v[202:205], v12, s[20:23], s28 offen offset:3072
    buffer_load_dwordx4 v[206:209], v13, s[20:23], s28 offen offset:0
    buffer_load_dwordx4 v[210:213], v13, s[20:23], s28 offen offset:1024
    buffer_load_dwordx4 v[214:217], v13, s[20:23], s28 offen offset:2048
    buffer_load_dwordx4 v[218:221], v13, s[20:23], s28 offen offset:3072
    buffer_load_dwordx4 v[222:225], v14, s[20:23], s28 offen offset:0
    buffer_load_dwordx4 v[226:229], v14, s[20:23], s28 offen offset:1024
    buffer_load_dwordx4 v[230:233], v14, s[20:23], s28 offen offset:2048
    buffer_load_dwordx4 v[234:237], v14, s[20:23], s28 offen offset:3072
    buffer_load_dwordx4 v[238:241], v15, s[20:23], s28 offen offset:0
    buffer_load_dwordx4 v[242:245], v15, s[20:23], s28 offen offset:1024
a1_loop:
    v_mov_b32 v7, 0
    s_cmp_lg_u32 s3, 0
    s_cbranch_scc1 mega_kernel_wd126
    s_lshl_b32 s70, s25, 7
    s_add_u32 s70, s70, 167542784
mega_kernel_wc125:
    buffer_load_dword v6, v7, s[20:23], s70 offen sc1
    s_waitcnt vmcnt(0)
    v_readfirstlane_b32 s71, v6
    s_cmp_ge_u32 s71, 7
    s_cbranch_scc1 mega_kernel_wd126
    s_sleep 6
    s_branch mega_kernel_wc125
mega_kernel_wd126:
    s_barrier
    v_lshrrev_b32 v4, 3, v1
    v_and_b32 v5, 7, v1
    v_mul_u32_u24 v6, 896, v4
    v_lshl_add_u32 v6, v5, 4, v6
    s_lshl_b32 s26, s25, 5
    s_lshl_b32 s27, s3, 3
    s_add_u32 s26, s26, s27
    s_mul_i32 s26, s26, 896
    s_add_u32 s26, s26, 28082176
    buffer_load_dwordx4 v[8:11], v6, s[20:23], s26 offen offset:0 sc1
    buffer_load_dwordx4 v[12:15], v6, s[20:23], s26 offen offset:128 sc1
    buffer_load_dwordx4 v[16:19], v6, s[20:23], s26 offen offset:256 sc1
    buffer_load_dwordx4 v[20:23], v6, s[20:23], s26 offen offset:384 sc1
    buffer_load_dwordx4 v[24:27], v6, s[20:23], s26 offen offset:512 sc1
    buffer_load_dwordx4 v[28:31], v6, s[20:23], s26 offen offset:640 sc1
    buffer_load_dwordx4 v[32:35], v6, s[20:23], s26 offen offset:768 sc1
    s_waitcnt vmcnt(0)
    v_lshlrev_b32 v40, 16, v8
    v_and_b32 v41, 0xffff0000, v8
    v_lshlrev_b32 v42, 16, v9
    v_and_b32 v43, 0xffff0000, v9
    v_lshlrev_b32 v44, 16, v10
    v_and_b32 v45, 0xffff0000, v10
    v_lshlrev_b32 v46, 16, v11
    v_and_b32 v47, 0xffff0000, v11
    v_lshlrev_b32 v48, 16, v12
    v_and_b32 v49, 0xffff0000, v12
    v_lshlrev_b32 v50, 16, v13
    v_and_b32 v51, 0xffff0000, v13
    v_lshlrev_b32 v52, 16, v14
    v_and_b32 v53, 0xffff0000, v14
    v_lshlrev_b32 v54, 16, v15
    v_and_b32 v55, 0xffff0000, v15
    v_lshlrev_b32 v56, 16, v16
    v_and_b32 v57, 0xffff0000, v16
    v_lshlrev_b32 v58, 16, v17
    v_and_b32 v59, 0xffff0000, v17
    v_lshlrev_b32 v60, 16, v18
    v_and_b32 v61, 0xffff0000, v18
    v_lshlrev_b32 v62, 16, v19
    v_and_b32 v63, 0xffff0000, v19
    v_lshlrev_b32 v64, 16, v20
    v_and_b32 v65, 0xffff0000, v20
    v_lshlrev_b32 v66, 16, v21
    v_and_b32 v67, 0xffff0000, v21
    v_lshlrev_b32 v68, 16, v22
    v_and_b32 v69, 0xffff0000, v22
    v_lshlrev_b32 v70, 16, v23
    v_and_b32 v71, 0xffff0000, v23
    v_lshlrev_b32 v72, 16, v24
    v_and_b32 v73, 0xffff0000, v24
    v_lshlrev_b32 v74, 16, v25
    v_and_b32 v75, 0xffff0000, v25
    v_lshlrev_b32 v76, 16, v26
    v_and_b32 v77, 0xffff0000, v26
    v_lshlrev_b32 v78, 16, v27
    v_and_b32 v79, 0xffff0000, v27
    v_lshlrev_b32 v80, 16, v28
    v_and_b32 v81, 0xffff0000, v28
    v_lshlrev_b32 v82, 16, v29
    v_and_b32 v83, 0xffff0000, v29
    v_lshlrev_b32 v84, 16, v30
    v_and_b32 v85, 0xffff0000, v30
    v_lshlrev_b32 v86, 16, v31
    v_and_b32 v87, 0xffff0000, v31
    v_lshlrev_b32 v88, 16, v32
    v_and_b32 v89, 0xffff0000, v32
    v_lshlrev_b32 v90, 16, v33
    v_and_b32 v91, 0xffff0000, v33
    v_lshlrev_b32 v92, 16, v34
    v_and_b32 v93, 0xffff0000, v34
    v_lshlrev_b32 v94, 16, v35
    v_and_b32 v95, 0xffff0000, v35
    v_add_f32 v36, v40, v41
    v_add_f32 v36, v36, v42
    v_add_f32 v36, v36, v43
    v_add_f32 v36, v36, v44
    v_add_f32 v36, v36, v45
    v_add_f32 v36, v36, v46
    v_add_f32 v36, v36, v47
    v_add_f32 v36, v36, v48
    v_add_f32 v36, v36, v49
    v_add_f32 v36, v36, v50
    v_add_f32 v36, v36, v51
    v_add_f32 v36, v36, v52
    v_add_f32 v36, v36, v53
    v_add_f32 v36, v36, v54
    v_add_f32 v36, v36, v55
    v_add_f32 v36, v36, v56
    v_add_f32 v36, v36, v57
    v_add_f32 v36, v36, v58
    v_add_f32 v36, v36, v59
    v_add_f32 v36, v36, v60
    v_add_f32 v36, v36, v61
    v_add_f32 v36, v36, v62
    v_add_f32 v36, v36, v63
    v_add_f32 v36, v36, v64
    v_add_f32 v36, v36, v65
    v_add_f32 v36, v36, v66
    v_add_f32 v36, v36, v67
    v_add_f32 v36, v36, v68
    v_add_f32 v36, v36, v69
    v_add_f32 v36, v36, v70
    v_add_f32 v36, v36, v71
    v_add_f32 v36, v36, v72
    v_add_f32 v36, v36, v73
    v_add_f32 v36, v36, v74
    v_add_f32 v36, v36, v75
    v_add_f32 v36, v36, v76
    v_add_f32 v36, v36, v77
    v_add_f32 v36, v36, v78
    v_add_f32 v36, v36, v79
    v_add_f32 v36, v36, v80
    v_add_f32 v36, v36, v81
    v_add_f32 v36, v36, v82
    v_add_f32 v36, v36, v83
    v_add_f32 v36, v36, v84
    v_add_f32 v36, v36, v85
    v_add_f32 v36, v36, v86
    v_add_f32 v36, v36, v87
    v_add_f32 v36, v36, v88
    v_add_f32 v36, v36, v89
    v_add_f32 v36, v36, v90
    v_add_f32 v36, v36, v91
    v_add_f32 v36, v36, v92
    v_add_f32 v36, v36, v93
    v_add_f32 v36, v36, v94
    v_add_f32 v36, v36, v95
    s_nop 1
    v_add_f32_dpp v36, v36, v36 quad_perm:[1,0,3,2] row_mask:0xf bank_mask:0xf
    s_nop 1
    v_add_f32_dpp v36, v36, v36 quad_perm:[2,3,0,1] row_mask:0xf bank_mask:0xf
    s_nop 1
    v_add_f32_dpp v36, v36, v36 row_half_mirror row_mask:0xf bank_mask:0xf
    v_mul_f32 v36, 0x3b124925, v36
    v_mov_b32 v37, 0
    v_sub_f32 v38, v40, v36
    v_fmac_f32 v37, v38, v38
    v_sub_f32 v38, v41, v36
    v_fmac_f32 v37, v38, v38
    v_sub_f32 v38, v42, v36
    v_fmac_f32 v37, v38, v38
    v_sub_f32 v38, v43, v36
    v_fmac_f32 v37, v38, v38
    v_sub_f32 v38, v44, v36
    v_fmac_f32 v37, v38, v38
    v_sub_f32 v38, v45, v36
    v_fmac_f32 v37, v38, v38
    v_sub_f32 v38, v46, v36
    v_fmac_f32 v37, v38, v38
    v_sub_f32 v38, v47, v36
    v_fmac_f32 v37, v38, v38
    v_sub_f32 v38, v48, v36
    v_fmac_f32 v37, v38, v38
    v_sub_f32 v38, v49, v36
    v_fmac_f32 v37, v38, v38
    v_sub_f32 v38, v50, v36
    v_fmac_f32 v37, v38, v38
    v_sub_f32 v38, v51, v36
    v_fmac_f32 v37, v38, v38
    v_sub_f32 v38, v52, v36
    v_fmac_f32 v37, v38, v38
    v_sub_f32 v38, v53, v36
    v_fmac_f32 v37, v38, v38
    v_sub_f32 v38, v54, v36
    v_fmac_f32 v37, v38, v38
    v_sub_f32 v38, v55, v36
    v_fmac_f32 v37, v38, v38
    v_sub_f32 v38, v56, v36
    v_fmac_f32 v37, v38, v38
    v_sub_f32 v38, v57, v36
    v_fmac_f32 v37, v38, v38
    v_sub_f32 v38, v58, v36
    v_fmac_f32 v37, v38, v38
    v_sub_f32 v38, v59, v36
    v_fmac_f32 v37, v38, v38
    v_sub_f32 v38, v60, v36
    v_fmac_f32 v37, v38, v38
    v_sub_f32 v38, v61, v36
    v_fmac_f32 v37, v38, v38
    v_sub_f32 v38, v62, v36
    v_fmac_f32 v37, v38, v38
    v_sub_f32 v38, v63, v36
    v_fmac_f32 v37, v38, v38
    v_sub_f32 v38, v64, v36
    v_fmac_f32 v37, v38, v38
    v_sub_f32 v38, v65, v36
    v_fmac_f32 v37, v38, v38
    v_sub_f32 v38, v66, v36
    v_fmac_f32 v37, v38, v38
    v_sub_f32 v38, v67, v36
    v_fmac_f32 v37, v38, v38
    v_sub_f32 v38, v68, v36
    v_fmac_f32 v37, v38, v38
    v_sub_f32 v38, v69, v36
    v_fmac_f32 v37, v38, v38
    v_sub_f32 v38, v70, v36
    v_fmac_f32 v37, v38, v38
    v_sub_f32 v38, v71, v36
    v_fmac_f32 v37, v38, v38
    v_sub_f32 v38, v72, v36
    v_fmac_f32 v37, v38, v38
    v_sub_f32 v38, v73, v36
    v_fmac_f32 v37, v38, v38
    v_sub_f32 v38, v74, v36
    v_fmac_f32 v37, v38, v38
    v_sub_f32 v38, v75, v36
    v_fmac_f32 v37, v38, v38
    v_sub_f32 v38, v76, v36
    v_fmac_f32 v37, v38, v38
    v_sub_f32 v38, v77, v36
    v_fmac_f32 v37, v38, v38
    v_sub_f32 v38, v78, v36
    v_fmac_f32 v37, v38, v38
    v_sub_f32 v38, v79, v36
    v_fmac_f32 v37, v38, v38
    v_sub_f32 v38, v80, v36
    v_fmac_f32 v37, v38, v38
    v_sub_f32 v38, v81, v36
    v_fmac_f32 v37, v38, v38
    v_sub_f32 v38, v82, v36
    v_fmac_f32 v37, v38, v38
    v_sub_f32 v38, v83, v36
    v_fmac_f32 v37, v38, v38
    v_sub_f32 v38, v84, v36
    v_fmac_f32 v37, v38, v38
    v_sub_f32 v38, v85, v36
    v_fmac_f32 v37, v38, v38
    v_sub_f32 v38, v86, v36
    v_fmac_f32 v37, v38, v38
    v_sub_f32 v38, v87, v36
    v_fmac_f32 v37, v38, v38
    v_sub_f32 v38, v88, v36
    v_fmac_f32 v37, v38, v38
    v_sub_f32 v38, v89, v36
    v_fmac_f32 v37, v38, v38
    v_sub_f32 v38, v90, v36
    v_fmac_f32 v37, v38, v38
    v_sub_f32 v38, v91, v36
    v_fmac_f32 v37, v38, v38
    v_sub_f32 v38, v92, v36
    v_fmac_f32 v37, v38, v38
    v_sub_f32 v38, v93, v36
    v_fmac_f32 v37, v38, v38
    v_sub_f32 v38, v94, v36
    v_fmac_f32 v37, v38, v38
    v_sub_f32 v38, v95, v36
    v_fmac_f32 v37, v38, v38
    s_nop 1
    v_add_f32_dpp v37, v37, v37 quad_perm:[1,0,3,2] row_mask:0xf bank_mask:0xf
    s_nop 1
    v_add_f32_dpp v37, v37, v37 quad_perm:[2,3,0,1] row_mask:0xf bank_mask:0xf
    s_nop 1
    v_add_f32_dpp v37, v37, v37 row_half_mirror row_mask:0xf bank_mask:0xf
    v_mul_f32 v37, 0x3b124925, v37
    v_cvt_pk_bf16_f32 v36, v36, v36
    v_and_b32 v36, 0xffff0000, v36
    v_cvt_pk_bf16_f32 v37, v37, v37
    v_and_b32 v37, 0xffff0000, v37
    v_add_f32 v37, 0x3727c5ac, v37
    v_cvt_pk_bf16_f32 v37, v37, v37
    v_and_b32 v37, 0xffff0000, v37
    v_sqrt_f32 v37, v37
    s_nop 0
    v_cvt_pk_bf16_f32 v37, v37, v37
    v_and_b32 v37, 0xffff0000, v37
    v_rcp_f32 v37, v37
    s_nop 0
    v_sub_f32 v40, v40, v36
    v_sub_f32 v41, v41, v36
    v_sub_f32 v42, v42, v36
    v_sub_f32 v43, v43, v36
    v_sub_f32 v44, v44, v36
    v_sub_f32 v45, v45, v36
    v_sub_f32 v46, v46, v36
    v_sub_f32 v47, v47, v36
    v_sub_f32 v48, v48, v36
    v_sub_f32 v49, v49, v36
    v_sub_f32 v50, v50, v36
    v_sub_f32 v51, v51, v36
    v_sub_f32 v52, v52, v36
    v_sub_f32 v53, v53, v36
    v_sub_f32 v54, v54, v36
    v_sub_f32 v55, v55, v36
    v_sub_f32 v56, v56, v36
    v_sub_f32 v57, v57, v36
    v_sub_f32 v58, v58, v36
    v_sub_f32 v59, v59, v36
    v_sub_f32 v60, v60, v36
    v_sub_f32 v61, v61, v36
    v_sub_f32 v62, v62, v36
    v_sub_f32 v63, v63, v36
    v_sub_f32 v64, v64, v36
    v_sub_f32 v65, v65, v36
    v_sub_f32 v66, v66, v36
    v_sub_f32 v67, v67, v36
    v_sub_f32 v68, v68, v36
    v_sub_f32 v69, v69, v36
    v_sub_f32 v70, v70, v36
    v_sub_f32 v71, v71, v36
    v_sub_f32 v72, v72, v36
    v_sub_f32 v73, v73, v36
    v_sub_f32 v74, v74, v36
    v_sub_f32 v75, v75, v36
    v_sub_f32 v76, v76, v36
    v_sub_f32 v77, v77, v36
    v_sub_f32 v78, v78, v36
    v_sub_f32 v79, v79, v36
    v_sub_f32 v80, v80, v36
    v_sub_f32 v81, v81, v36
    v_sub_f32 v82, v82, v36
    v_sub_f32 v83, v83, v36
    v_sub_f32 v84, v84, v36
    v_sub_f32 v85, v85, v36
    v_sub_f32 v86, v86, v36
    v_sub_f32 v87, v87, v36
    v_sub_f32 v88, v88, v36
    v_sub_f32 v89, v89, v36
    v_sub_f32 v90, v90, v36
    v_sub_f32 v91, v91, v36
    v_sub_f32 v92, v92, v36
    v_sub_f32 v93, v93, v36
    v_sub_f32 v94, v94, v36
    v_sub_f32 v95, v95, v36
    v_cvt_pk_bf16_f32 v8, v40, v41
    v_cvt_pk_bf16_f32 v9, v42, v43
    v_cvt_pk_bf16_f32 v10, v44, v45
    v_cvt_pk_bf16_f32 v11, v46, v47
    v_cvt_pk_bf16_f32 v12, v48, v49
    v_cvt_pk_bf16_f32 v13, v50, v51
    v_cvt_pk_bf16_f32 v14, v52, v53
    v_cvt_pk_bf16_f32 v15, v54, v55
    v_cvt_pk_bf16_f32 v16, v56, v57
    v_cvt_pk_bf16_f32 v17, v58, v59
    v_cvt_pk_bf16_f32 v18, v60, v61
    v_cvt_pk_bf16_f32 v19, v62, v63
    v_cvt_pk_bf16_f32 v20, v64, v65
    v_cvt_pk_bf16_f32 v21, v66, v67
    v_cvt_pk_bf16_f32 v22, v68, v69
    v_cvt_pk_bf16_f32 v23, v70, v71
    v_cvt_pk_bf16_f32 v24, v72, v73
    v_cvt_pk_bf16_f32 v25, v74, v75
    v_cvt_pk_bf16_f32 v26, v76, v77
    v_cvt_pk_bf16_f32 v27, v78, v79
    v_cvt_pk_bf16_f32 v28, v80, v81
    v_cvt_pk_bf16_f32 v29, v82, v83
    v_cvt_pk_bf16_f32 v30, v84, v85
    v_cvt_pk_bf16_f32 v31, v86, v87
    v_cvt_pk_bf16_f32 v32, v88, v89
    v_cvt_pk_bf16_f32 v33, v90, v91
    v_cvt_pk_bf16_f32 v34, v92, v93
    v_cvt_pk_bf16_f32 v35, v94, v95
    v_lshlrev_b32 v40, 16, v8
    v_and_b32 v41, 0xffff0000, v8
    v_lshlrev_b32 v42, 16, v9
    v_and_b32 v43, 0xffff0000, v9
    v_lshlrev_b32 v44, 16, v10
    v_and_b32 v45, 0xffff0000, v10
    v_lshlrev_b32 v46, 16, v11
    v_and_b32 v47, 0xffff0000, v11
    v_lshlrev_b32 v48, 16, v12
    v_and_b32 v49, 0xffff0000, v12
    v_lshlrev_b32 v50, 16, v13
    v_and_b32 v51, 0xffff0000, v13
    v_lshlrev_b32 v52, 16, v14
    v_and_b32 v53, 0xffff0000, v14
    v_lshlrev_b32 v54, 16, v15
    v_and_b32 v55, 0xffff0000, v15
    v_lshlrev_b32 v56, 16, v16
    v_and_b32 v57, 0xffff0000, v16
    v_lshlrev_b32 v58, 16, v17
    v_and_b32 v59, 0xffff0000, v17
    v_lshlrev_b32 v60, 16, v18
    v_and_b32 v61, 0xffff0000, v18
    v_lshlrev_b32 v62, 16, v19
    v_and_b32 v63, 0xffff0000, v19
    v_lshlrev_b32 v64, 16, v20
    v_and_b32 v65, 0xffff0000, v20
    v_lshlrev_b32 v66, 16, v21
    v_and_b32 v67, 0xffff0000, v21
    v_lshlrev_b32 v68, 16, v22
    v_and_b32 v69, 0xffff0000, v22
    v_lshlrev_b32 v70, 16, v23
    v_and_b32 v71, 0xffff0000, v23
    v_lshlrev_b32 v72, 16, v24
    v_and_b32 v73, 0xffff0000, v24
    v_lshlrev_b32 v74, 16, v25
    v_and_b32 v75, 0xffff0000, v25
    v_lshlrev_b32 v76, 16, v26
    v_and_b32 v77, 0xffff0000, v26
    v_lshlrev_b32 v78, 16, v27
    v_and_b32 v79, 0xffff0000, v27
    v_lshlrev_b32 v80, 16, v28
    v_and_b32 v81, 0xffff0000, v28
    v_lshlrev_b32 v82, 16, v29
    v_and_b32 v83, 0xffff0000, v29
    v_lshlrev_b32 v84, 16, v30
    v_and_b32 v85, 0xffff0000, v30
    v_lshlrev_b32 v86, 16, v31
    v_and_b32 v87, 0xffff0000, v31
    v_lshlrev_b32 v88, 16, v32
    v_and_b32 v89, 0xffff0000, v32
    v_lshlrev_b32 v90, 16, v33
    v_and_b32 v91, 0xffff0000, v33
    v_lshlrev_b32 v92, 16, v34
    v_and_b32 v93, 0xffff0000, v34
    v_lshlrev_b32 v94, 16, v35
    v_and_b32 v95, 0xffff0000, v35
    v_mul_f32 v40, v40, v37
    v_mul_f32 v41, v41, v37
    v_mul_f32 v42, v42, v37
    v_mul_f32 v43, v43, v37
    v_mul_f32 v44, v44, v37
    v_mul_f32 v45, v45, v37
    v_mul_f32 v46, v46, v37
    v_mul_f32 v47, v47, v37
    v_mul_f32 v48, v48, v37
    v_mul_f32 v49, v49, v37
    v_mul_f32 v50, v50, v37
    v_mul_f32 v51, v51, v37
    v_mul_f32 v52, v52, v37
    v_mul_f32 v53, v53, v37
    v_mul_f32 v54, v54, v37
    v_mul_f32 v55, v55, v37
    v_mul_f32 v56, v56, v37
    v_mul_f32 v57, v57, v37
    v_mul_f32 v58, v58, v37
    v_mul_f32 v59, v59, v37
    v_mul_f32 v60, v60, v37
    v_mul_f32 v61, v61, v37
    v_mul_f32 v62, v62, v37
    v_mul_f32 v63, v63, v37
    v_mul_f32 v64, v64, v37
    v_mul_f32 v65, v65, v37
    v_mul_f32 v66, v66, v37
    v_mul_f32 v67, v67, v37
    v_mul_f32 v68, v68, v37
    v_mul_f32 v69, v69, v37
    v_mul_f32 v70, v70, v37
    v_mul_f32 v71, v71, v37
    v_mul_f32 v72, v72, v37
    v_mul_f32 v73, v73, v37
    v_mul_f32 v74, v74, v37
    v_mul_f32 v75, v75, v37
    v_mul_f32 v76, v76, v37
    v_mul_f32 v77, v77, v37
    v_mul_f32 v78, v78, v37
    v_mul_f32 v79, v79, v37
    v_mul_f32 v80, v80, v37
    v_mul_f32 v81, v81, v37
    v_mul_f32 v82, v82, v37
    v_mul_f32 v83, v83, v37
    v_mul_f32 v84, v84, v37
    v_mul_f32 v85, v85, v37
    v_mul_f32 v86, v86, v37
    v_mul_f32 v87, v87, v37
    v_mul_f32 v88, v88, v37
    v_mul_f32 v89, v89, v37
    v_mul_f32 v90, v90, v37
    v_mul_f32 v91, v91, v37
    v_mul_f32 v92, v92, v37
    v_mul_f32 v93, v93, v37
    v_mul_f32 v94, v94, v37
    v_mul_f32 v95, v95, v37
    v_cvt_pk_bf16_f32 v8, v40, v41
    v_cvt_pk_bf16_f32 v9, v42, v43
    v_cvt_pk_bf16_f32 v10, v44, v45
    v_cvt_pk_bf16_f32 v11, v46, v47
    v_cvt_pk_bf16_f32 v12, v48, v49
    v_cvt_pk_bf16_f32 v13, v50, v51
    v_cvt_pk_bf16_f32 v14, v52, v53
    v_cvt_pk_bf16_f32 v15, v54, v55
    v_cvt_pk_bf16_f32 v16, v56, v57
    v_cvt_pk_bf16_f32 v17, v58, v59
    v_cvt_pk_bf16_f32 v18, v60, v61
    v_cvt_pk_bf16_f32 v19, v62, v63
    v_cvt_pk_bf16_f32 v20, v64, v65
    v_cvt_pk_bf16_f32 v21, v66, v67
    v_cvt_pk_bf16_f32 v22, v68, v69
    v_cvt_pk_bf16_f32 v23, v70, v71
    v_cvt_pk_bf16_f32 v24, v72, v73
    v_cvt_pk_bf16_f32 v25, v74, v75
    v_cvt_pk_bf16_f32 v26, v76, v77
    v_cvt_pk_bf16_f32 v27, v78, v79
    v_cvt_pk_bf16_f32 v28, v80, v81
    v_cvt_pk_bf16_f32 v29, v82, v83
    v_cvt_pk_bf16_f32 v30, v84, v85
    v_cvt_pk_bf16_f32 v31, v86, v87
    v_cvt_pk_bf16_f32 v32, v88, v89
    v_cvt_pk_bf16_f32 v33, v90, v91
    v_cvt_pk_bf16_f32 v34, v92, v93
    v_cvt_pk_bf16_f32 v35, v94, v95
    s_mul_i32 s27, s3, 7296
    v_mul_u32_u24 v6, 912, v4
    v_lshl_add_u32 v6, v5, 4, v6
    v_add_u32 v6, s27, v6
    ds_write_b128 v6, v[8:11] offset:0
    ds_write_b128 v6, v[12:15] offset:128
    ds_write_b128 v6, v[16:19] offset:256
    ds_write_b128 v6, v[20:23] offset:384
    ds_write_b128 v6, v[24:27] offset:512
    ds_write_b128 v6, v[28:31] offset:640
    ds_write_b128 v6, v[32:35] offset:768
    v_mul_u32_u24 v6, 912, v2
    v_lshl_add_u32 v6, v3, 4, v6
    v_add_u32 v5, 14592, v6
    s_waitcnt lgkmcnt(0)
    s_barrier
    s_cmp_eq_u32 s24, 2
    s_cbranch_scc1 a1_v
    ds_read_b128 v[64:67], v6 offset:0
    ds_read_b128 v[68:71], v5 offset:0
    ds_read_b128 v[72:75], v6 offset:64
    ds_read_b128 v[76:79], v5 offset:64
    ds_read_b128 v[80:83], v6 offset:128
    ds_read_b128 v[84:87], v5 offset:128
    ds_read_b128 v[88:91], v6 offset:192
    ds_read_b128 v[92:95], v5 offset:192
    s_waitcnt lgkmcnt(6)
    v_mfma_f32_16x16x32_bf16 v[8:11], a[0:3], v[64:67], 0
    v_mfma_f32_16x16x32_bf16 v[12:15], a[0:3], v[68:71], 0
    v_mfma_f32_16x16x32_bf16 v[16:19], a[56:59], v[64:67], 0
    v_mfma_f32_16x16x32_bf16 v[20:23], a[56:59], v[68:71], 0
    v_mfma_f32_16x16x32_bf16 v[24:27], a[112:115], v[64:67], 0
    v_mfma_f32_16x16x32_bf16 v[28:31], a[112:115], v[68:71], 0
    v_mfma_f32_16x16x32_bf16 v[32:35], a[168:171], v[64:67], 0
    v_mfma_f32_16x16x32_bf16 v[36:39], a[168:171], v[68:71], 0
    v_mfma_f32_16x16x32_bf16 v[40:43], a[224:227], v[64:67], 0
    v_mfma_f32_16x16x32_bf16 v[44:47], a[224:227], v[68:71], 0
    v_mfma_f32_16x16x32_bf16 v[48:51], v[134:137], v[64:67], 0
    v_mfma_f32_16x16x32_bf16 v[52:55], v[134:137], v[68:71], 0
    v_mfma_f32_16x16x32_bf16 v[56:59], v[190:193], v[64:67], 0
    v_mfma_f32_16x16x32_bf16 v[60:63], v[190:193], v[68:71], 0
    ds_read_b128 v[64:67], v6 offset:256
    ds_read_b128 v[68:71], v5 offset:256
    s_waitcnt lgkmcnt(6)
    v_mfma_f32_16x16x32_bf16 v[8:11], a[4:7], v[72:75], v[8:11]
    v_mfma_f32_16x16x32_bf16 v[12:15], a[4:7], v[76:79], v[12:15]
    v_mfma_f32_16x16x32_bf16 v[16:19], a[60:63], v[72:75], v[16:19]
    v_mfma_f32_16x16x32_bf16 v[20:23], a[60:63], v[76:79], v[20:23]
    v_mfma_f32_16x16x32_bf16 v[24:27], a[116:119], v[72:75], v[24:27]
    v_mfma_f32_16x16x32_bf16 v[28:31], a[116:119], v[76:79], v[28:31]
    v_mfma_f32_16x16x32_bf16 v[32:35], a[172:175], v[72:75], v[32:35]
    v_mfma_f32_16x16x32_bf16 v[36:39], a[172:175], v[76:79], v[36:39]
    v_mfma_f32_16x16x32_bf16 v[40:43], a[228:231], v[72:75], v[40:43]
    v_mfma_f32_16x16x32_bf16 v[44:47], a[228:231], v[76:79], v[44:47]
    v_mfma_f32_16x16x32_bf16 v[48:51], v[138:141], v[72:75], v[48:51]
    v_mfma_f32_16x16x32_bf16 v[52:55], v[138:141], v[76:79], v[52:55]
    v_mfma_f32_16x16x32_bf16 v[56:59], v[194:197], v[72:75], v[56:59]
    v_mfma_f32_16x16x32_bf16 v[60:63], v[194:197], v[76:79], v[60:63]
    ds_read_b128 v[72:75], v6 offset:320
    ds_read_b128 v[76:79], v5 offset:320
    s_waitcnt lgkmcnt(6)
    v_mfma_f32_16x16x32_bf16 v[8:11], a[8:11], v[80:83], v[8:11]
    v_mfma_f32_16x16x32_bf16 v[12:15], a[8:11], v[84:87], v[12:15]
    v_mfma_f32_16x16x32_bf16 v[16:19], a[64:67], v[80:83], v[16:19]
    v_mfma_f32_16x16x32_bf16 v[20:23], a[64:67], v[84:87], v[20:23]
    v_mfma_f32_16x16x32_bf16 v[24:27], a[120:123], v[80:83], v[24:27]
    v_mfma_f32_16x16x32_bf16 v[28:31], a[120:123], v[84:87], v[28:31]
    v_mfma_f32_16x16x32_bf16 v[32:35], a[176:179], v[80:83], v[32:35]
    v_mfma_f32_16x16x32_bf16 v[36:39], a[176:179], v[84:87], v[36:39]
    v_mfma_f32_16x16x32_bf16 v[40:43], a[232:235], v[80:83], v[40:43]
    v_mfma_f32_16x16x32_bf16 v[44:47], a[232:235], v[84:87], v[44:47]
    v_mfma_f32_16x16x32_bf16 v[48:51], v[142:145], v[80:83], v[48:51]
    v_mfma_f32_16x16x32_bf16 v[52:55], v[142:145], v[84:87], v[52:55]
    v_mfma_f32_16x16x32_bf16 v[56:59], v[198:201], v[80:83], v[56:59]
    v_mfma_f32_16x16x32_bf16 v[60:63], v[198:201], v[84:87], v[60:63]
    ds_read_b128 v[80:83], v6 offset:384
    ds_read_b128 v[84:87], v5 offset:384
    s_waitcnt lgkmcnt(6)
    v_mfma_f32_16x16x32_bf16 v[8:11], a[12:15], v[88:91], v[8:11]
    v_mfma_f32_16x16x32_bf16 v[12:15], a[12:15], v[92:95], v[12:15]
    v_mfma_f32_16x16x32_bf16 v[16:19], a[68:71], v[88:91], v[16:19]
    v_mfma_f32_16x16x32_bf16 v[20:23], a[68:71], v[92:95], v[20:23]
    v_mfma_f32_16x16x32_bf16 v[24:27], a[124:127], v[88:91], v[24:27]
    v_mfma_f32_16x16x32_bf16 v[28:31], a[124:127], v[92:95], v[28:31]
    v_mfma_f32_16x16x32_bf16 v[32:35], a[180:183], v[88:91], v[32:35]
    v_mfma_f32_16x16x32_bf16 v[36:39], a[180:183], v[92:95], v[36:39]
    v_mfma_f32_16x16x32_bf16 v[40:43], a[236:239], v[88:91], v[40:43]
    v_mfma_f32_16x16x32_bf16 v[44:47], a[236:239], v[92:95], v[44:47]
    v_mfma_f32_16x16x32_bf16 v[48:51], v[146:149], v[88:91], v[48:51]
    v_mfma_f32_16x16x32_bf16 v[52:55], v[146:149], v[92:95], v[52:55]
    v_mfma_f32_16x16x32_bf16 v[56:59], v[202:205], v[88:91], v[56:59]
    v_mfma_f32_16x16x32_bf16 v[60:63], v[202:205], v[92:95], v[60:63]
    ds_read_b128 v[88:91], v6 offset:448
    ds_read_b128 v[92:95], v5 offset:448
    s_waitcnt lgkmcnt(6)
    v_mfma_f32_16x16x32_bf16 v[8:11], a[16:19], v[64:67], v[8:11]
    v_mfma_f32_16x16x32_bf16 v[12:15], a[16:19], v[68:71], v[12:15]
    v_mfma_f32_16x16x32_bf16 v[16:19], a[72:75], v[64:67], v[16:19]
    v_mfma_f32_16x16x32_bf16 v[20:23], a[72:75], v[68:71], v[20:23]
    v_mfma_f32_16x16x32_bf16 v[24:27], a[128:131], v[64:67], v[24:27]
    v_mfma_f32_16x16x32_bf16 v[28:31], a[128:131], v[68:71], v[28:31]
    v_mfma_f32_16x16x32_bf16 v[32:35], a[184:187], v[64:67], v[32:35]
    v_mfma_f32_16x16x32_bf16 v[36:39], a[184:187], v[68:71], v[36:39]
    v_mfma_f32_16x16x32_bf16 v[40:43], a[240:243], v[64:67], v[40:43]
    v_mfma_f32_16x16x32_bf16 v[44:47], a[240:243], v[68:71], v[44:47]
    v_mfma_f32_16x16x32_bf16 v[48:51], v[150:153], v[64:67], v[48:51]
    v_mfma_f32_16x16x32_bf16 v[52:55], v[150:153], v[68:71], v[52:55]
    v_mfma_f32_16x16x32_bf16 v[56:59], v[206:209], v[64:67], v[56:59]
    v_mfma_f32_16x16x32_bf16 v[60:63], v[206:209], v[68:71], v[60:63]
    ds_read_b128 v[64:67], v6 offset:512
    ds_read_b128 v[68:71], v5 offset:512
    s_waitcnt lgkmcnt(6)
    v_mfma_f32_16x16x32_bf16 v[8:11], a[20:23], v[72:75], v[8:11]
    v_mfma_f32_16x16x32_bf16 v[12:15], a[20:23], v[76:79], v[12:15]
    v_mfma_f32_16x16x32_bf16 v[16:19], a[76:79], v[72:75], v[16:19]
    v_mfma_f32_16x16x32_bf16 v[20:23], a[76:79], v[76:79], v[20:23]
    v_mfma_f32_16x16x32_bf16 v[24:27], a[132:135], v[72:75], v[24:27]
    v_mfma_f32_16x16x32_bf16 v[28:31], a[132:135], v[76:79], v[28:31]
    v_mfma_f32_16x16x32_bf16 v[32:35], a[188:191], v[72:75], v[32:35]
    v_mfma_f32_16x16x32_bf16 v[36:39], a[188:191], v[76:79], v[36:39]
    v_mfma_f32_16x16x32_bf16 v[40:43], a[244:247], v[72:75], v[40:43]
    v_mfma_f32_16x16x32_bf16 v[44:47], a[244:247], v[76:79], v[44:47]
    v_mfma_f32_16x16x32_bf16 v[48:51], v[154:157], v[72:75], v[48:51]
    v_mfma_f32_16x16x32_bf16 v[52:55], v[154:157], v[76:79], v[52:55]
    v_mfma_f32_16x16x32_bf16 v[56:59], v[210:213], v[72:75], v[56:59]
    v_mfma_f32_16x16x32_bf16 v[60:63], v[210:213], v[76:79], v[60:63]
    ds_read_b128 v[72:75], v6 offset:576
    ds_read_b128 v[76:79], v5 offset:576
    s_waitcnt lgkmcnt(6)
    v_mfma_f32_16x16x32_bf16 v[8:11], a[24:27], v[80:83], v[8:11]
    v_mfma_f32_16x16x32_bf16 v[12:15], a[24:27], v[84:87], v[12:15]
    v_mfma_f32_16x16x32_bf16 v[16:19], a[80:83], v[80:83], v[16:19]
    v_mfma_f32_16x16x32_bf16 v[20:23], a[80:83], v[84:87], v[20:23]
    v_mfma_f32_16x16x32_bf16 v[24:27], a[136:139], v[80:83], v[24:27]
    v_mfma_f32_16x16x32_bf16 v[28:31], a[136:139], v[84:87], v[28:31]
    v_mfma_f32_16x16x32_bf16 v[32:35], a[192:195], v[80:83], v[32:35]
    v_mfma_f32_16x16x32_bf16 v[36:39], a[192:195], v[84:87], v[36:39]
    v_mfma_f32_16x16x32_bf16 v[40:43], a[248:251], v[80:83], v[40:43]
    v_mfma_f32_16x16x32_bf16 v[44:47], a[248:251], v[84:87], v[44:47]
    v_mfma_f32_16x16x32_bf16 v[48:51], v[158:161], v[80:83], v[48:51]
    v_mfma_f32_16x16x32_bf16 v[52:55], v[158:161], v[84:87], v[52:55]
    v_mfma_f32_16x16x32_bf16 v[56:59], v[214:217], v[80:83], v[56:59]
    v_mfma_f32_16x16x32_bf16 v[60:63], v[214:217], v[84:87], v[60:63]
    ds_read_b128 v[80:83], v6 offset:640
    ds_read_b128 v[84:87], v5 offset:640
    s_waitcnt lgkmcnt(6)
    v_mfma_f32_16x16x32_bf16 v[8:11], a[28:31], v[88:91], v[8:11]
    v_mfma_f32_16x16x32_bf16 v[12:15], a[28:31], v[92:95], v[12:15]
    v_mfma_f32_16x16x32_bf16 v[16:19], a[84:87], v[88:91], v[16:19]
    v_mfma_f32_16x16x32_bf16 v[20:23], a[84:87], v[92:95], v[20:23]
    v_mfma_f32_16x16x32_bf16 v[24:27], a[140:143], v[88:91], v[24:27]
    v_mfma_f32_16x16x32_bf16 v[28:31], a[140:143], v[92:95], v[28:31]
    v_mfma_f32_16x16x32_bf16 v[32:35], a[196:199], v[88:91], v[32:35]
    v_mfma_f32_16x16x32_bf16 v[36:39], a[196:199], v[92:95], v[36:39]
    v_mfma_f32_16x16x32_bf16 v[40:43], a[252:255], v[88:91], v[40:43]
    v_mfma_f32_16x16x32_bf16 v[44:47], a[252:255], v[92:95], v[44:47]
    v_mfma_f32_16x16x32_bf16 v[48:51], v[162:165], v[88:91], v[48:51]
    v_mfma_f32_16x16x32_bf16 v[52:55], v[162:165], v[92:95], v[52:55]
    v_mfma_f32_16x16x32_bf16 v[56:59], v[218:221], v[88:91], v[56:59]
    v_mfma_f32_16x16x32_bf16 v[60:63], v[218:221], v[92:95], v[60:63]
    ds_read_b128 v[88:91], v6 offset:704
    ds_read_b128 v[92:95], v5 offset:704
    s_waitcnt lgkmcnt(6)
    v_mfma_f32_16x16x32_bf16 v[8:11], a[32:35], v[64:67], v[8:11]
    v_mfma_f32_16x16x32_bf16 v[12:15], a[32:35], v[68:71], v[12:15]
    v_mfma_f32_16x16x32_bf16 v[16:19], a[88:91], v[64:67], v[16:19]
    v_mfma_f32_16x16x32_bf16 v[20:23], a[88:91], v[68:71], v[20:23]
    v_mfma_f32_16x16x32_bf16 v[24:27], a[144:147], v[64:67], v[24:27]
    v_mfma_f32_16x16x32_bf16 v[28:31], a[144:147], v[68:71], v[28:31]
    v_mfma_f32_16x16x32_bf16 v[32:35], a[200:203], v[64:67], v[32:35]
    v_mfma_f32_16x16x32_bf16 v[36:39], a[200:203], v[68:71], v[36:39]
    v_mfma_f32_16x16x32_bf16 v[40:43], v[110:113], v[64:67], v[40:43]
    v_mfma_f32_16x16x32_bf16 v[44:47], v[110:113], v[68:71], v[44:47]
    v_mfma_f32_16x16x32_bf16 v[48:51], v[166:169], v[64:67], v[48:51]
    v_mfma_f32_16x16x32_bf16 v[52:55], v[166:169], v[68:71], v[52:55]
    v_mfma_f32_16x16x32_bf16 v[56:59], v[222:225], v[64:67], v[56:59]
    v_mfma_f32_16x16x32_bf16 v[60:63], v[222:225], v[68:71], v[60:63]
    ds_read_b128 v[64:67], v6 offset:768
    ds_read_b128 v[68:71], v5 offset:768
    s_waitcnt lgkmcnt(6)
    v_mfma_f32_16x16x32_bf16 v[8:11], a[36:39], v[72:75], v[8:11]
    v_mfma_f32_16x16x32_bf16 v[12:15], a[36:39], v[76:79], v[12:15]
    v_mfma_f32_16x16x32_bf16 v[16:19], a[92:95], v[72:75], v[16:19]
    v_mfma_f32_16x16x32_bf16 v[20:23], a[92:95], v[76:79], v[20:23]
    v_mfma_f32_16x16x32_bf16 v[24:27], a[148:151], v[72:75], v[24:27]
    v_mfma_f32_16x16x32_bf16 v[28:31], a[148:151], v[76:79], v[28:31]
    v_mfma_f32_16x16x32_bf16 v[32:35], a[204:207], v[72:75], v[32:35]
    v_mfma_f32_16x16x32_bf16 v[36:39], a[204:207], v[76:79], v[36:39]
    v_mfma_f32_16x16x32_bf16 v[40:43], v[114:117], v[72:75], v[40:43]
    v_mfma_f32_16x16x32_bf16 v[44:47], v[114:117], v[76:79], v[44:47]
    v_mfma_f32_16x16x32_bf16 v[48:51], v[170:173], v[72:75], v[48:51]
    v_mfma_f32_16x16x32_bf16 v[52:55], v[170:173], v[76:79], v[52:55]
    v_mfma_f32_16x16x32_bf16 v[56:59], v[226:229], v[72:75], v[56:59]
    v_mfma_f32_16x16x32_bf16 v[60:63], v[226:229], v[76:79], v[60:63]
    ds_read_b128 v[72:75], v6 offset:832
    ds_read_b128 v[76:79], v5 offset:832
    s_waitcnt lgkmcnt(6)
    v_mfma_f32_16x16x32_bf16 v[8:11], a[40:43], v[80:83], v[8:11]
    v_mfma_f32_16x16x32_bf16 v[12:15], a[40:43], v[84:87], v[12:15]
    v_mfma_f32_16x16x32_bf16 v[16:19], a[96:99], v[80:83], v[16:19]
    v_mfma_f32_16x16x32_bf16 v[20:23], a[96:99], v[84:87], v[20:23]
    v_mfma_f32_16x16x32_bf16 v[24:27], a[152:155], v[80:83], v[24:27]
    v_mfma_f32_16x16x32_bf16 v[28:31], a[152:155], v[84:87], v[28:31]
    v_mfma_f32_16x16x32_bf16 v[32:35], a[208:211], v[80:83], v[32:35]
    v_mfma_f32_16x16x32_bf16 v[36:39], a[208:211], v[84:87], v[36:39]
    v_mfma_f32_16x16x32_bf16 v[40:43], v[118:121], v[80:83], v[40:43]
    v_mfma_f32_16x16x32_bf16 v[44:47], v[118:121], v[84:87], v[44:47]
    v_mfma_f32_16x16x32_bf16 v[48:51], v[174:177], v[80:83], v[48:51]
    v_mfma_f32_16x16x32_bf16 v[52:55], v[174:177], v[84:87], v[52:55]
    v_mfma_f32_16x16x32_bf16 v[56:59], v[230:233], v[80:83], v[56:59]
    v_mfma_f32_16x16x32_bf16 v[60:63], v[230:233], v[84:87], v[60:63]
    s_waitcnt lgkmcnt(4)
    v_mfma_f32_16x16x32_bf16 v[8:11], a[44:47], v[88:91], v[8:11]
    v_mfma_f32_16x16x32_bf16 v[12:15], a[44:47], v[92:95], v[12:15]
    v_mfma_f32_16x16x32_bf16 v[16:19], a[100:103], v[88:91], v[16:19]
    v_mfma_f32_16x16x32_bf16 v[20:23], a[100:103], v[92:95], v[20:23]
    v_mfma_f32_16x16x32_bf16 v[24:27], a[156:159], v[88:91], v[24:27]
    v_mfma_f32_16x16x32_bf16 v[28:31], a[156:159], v[92:95], v[28:31]
    v_mfma_f32_16x16x32_bf16 v[32:35], a[212:215], v[88:91], v[32:35]
    v_mfma_f32_16x16x32_bf16 v[36:39], a[212:215], v[92:95], v[36:39]
    v_mfma_f32_16x16x32_bf16 v[40:43], v[122:125], v[88:91], v[40:43]
    v_mfma_f32_16x16x32_bf16 v[44:47], v[122:125], v[92:95], v[44:47]
    v_mfma_f32_16x16x32_bf16 v[48:51], v[178:181], v[88:91], v[48:51]
    v_mfma_f32_16x16x32_bf16 v[52:55], v[178:181], v[92:95], v[52:55]
    v_mfma_f32_16x16x32_bf16 v[56:59], v[234:237], v[88:91], v[56:59]
    v_mfma_f32_16x16x32_bf16 v[60:63], v[234:237], v[92:95], v[60:63]
    s_waitcnt lgkmcnt(2)
    v_mfma_f32_16x16x32_bf16 v[8:11], a[48:51], v[64:67], v[8:11]
    v_mfma_f32_16x16x32_bf16 v[12:15], a[48:51], v[68:71], v[12:15]
    v_mfma_f32_16x16x32_bf16 v[16:19], a[104:107], v[64:67], v[16:19]
    v_mfma_f32_16x16x32_bf16 v[20:23], a[104:107], v[68:71], v[20:23]
    v_mfma_f32_16x16x32_bf16 v[24:27], a[160:163], v[64:67], v[24:27]
    v_mfma_f32_16x16x32_bf16 v[28:31], a[160:163], v[68:71], v[28:31]
    v_mfma_f32_16x16x32_bf16 v[32:35], a[216:219], v[64:67], v[32:35]
    v_mfma_f32_16x16x32_bf16 v[36:39], a[216:219], v[68:71], v[36:39]
    v_mfma_f32_16x16x32_bf16 v[40:43], v[126:129], v[64:67], v[40:43]
    v_mfma_f32_16x16x32_bf16 v[44:47], v[126:129], v[68:71], v[44:47]
    v_mfma_f32_16x16x32_bf16 v[48:51], v[182:185], v[64:67], v[48:51]
    v_mfma_f32_16x16x32_bf16 v[52:55], v[182:185], v[68:71], v[52:55]
    v_mfma_f32_16x16x32_bf16 v[56:59], v[238:241], v[64:67], v[56:59]
    v_mfma_f32_16x16x32_bf16 v[60:63], v[238:241], v[68:71], v[60:63]
    s_waitcnt lgkmcnt(0)
    v_mfma_f32_16x16x32_bf16 v[8:11], a[52:55], v[72:75], v[8:11]
    v_mfma_f32_16x16x32_bf16 v[12:15], a[52:55], v[76:79], v[12:15]
    v_mfma_f32_16x16x32_bf16 v[16:19], a[108:111], v[72:75], v[16:19]
    v_mfma_f32_16x16x32_bf16 v[20:23], a[108:111], v[76:79], v[20:23]
    v_mfma_f32_16x16x32_bf16 v[24:27], a[164:167], v[72:75], v[24:27]
    v_mfma_f32_16x16x32_bf16 v[28:31], a[164:167], v[76:79], v[28:31]
    v_mfma_f32_16x16x32_bf16 v[32:35], a[220:223], v[72:75], v[32:35]
    v_mfma_f32_16x16x32_bf16 v[36:39], a[220:223], v[76:79], v[36:39]
    v_mfma_f32_16x16x32_bf16 v[40:43], v[130:133], v[72:75], v[40:43]
    v_mfma_f32_16x16x32_bf16 v[44:47], v[130:133], v[76:79], v[44:47]
    v_mfma_f32_16x16x32_bf16 v[48:51], v[186:189], v[72:75], v[48:51]
    v_mfma_f32_16x16x32_bf16 v[52:55], v[186:189], v[76:79], v[52:55]
    v_mfma_f32_16x16x32_bf16 v[56:59], v[242:245], v[72:75], v[56:59]
    v_mfma_f32_16x16x32_bf16 v[60:63], v[242:245], v[76:79], v[60:63]
    s_nop 7
    s_lshl_b32 s26, s24, 21
    s_add_u32 s26, s26, 18120704
    s_lshl_b32 s27, s3, 19
    s_add_u32 s26, s26, s27
    s_lshl_b32 s27, s25, 11
    s_add_u32 s26, s26, s27
    v_lshlrev_b32 v64, 6, v2
    v_lshlrev_b32 v65, 2, v3
    v_add_u32 v65, 0, v65
    v_mul_u32_u24 v66, 37, v65
    v_lshrrev_b32 v66, 10, v66
    v_mul_u32_u24 v67, 28, v66
    v_sub_u32 v65, v65, v67
    v_lshl_add_u32 v65, v65, 1, v64
    v_lshl_add_u32 v65, v66, 17, v65
    v_cvt_pk_bf16_f32 v8, v8, v9
    v_cvt_pk_bf16_f32 v9, v10, v11
    buffer_store_dwordx2 v[8:9], v65, s[20:23], s26 offen offset:0 sc1
    v_cvt_pk_bf16_f32 v12, v12, v13
    v_cvt_pk_bf16_f32 v13, v14, v15
    buffer_store_dwordx2 v[12:13], v65, s[20:23], s26 offen offset:1024 sc1
    v_lshlrev_b32 v65, 2, v3
    v_add_u32 v65, 16, v65
    v_mul_u32_u24 v66, 37, v65
    v_lshrrev_b32 v66, 10, v66
    v_mul_u32_u24 v67, 28, v66
    v_sub_u32 v65, v65, v67
    v_lshl_add_u32 v65, v65, 1, v64
    v_lshl_add_u32 v65, v66, 17, v65
    v_cvt_pk_bf16_f32 v16, v16, v17
    v_cvt_pk_bf16_f32 v17, v18, v19
    buffer_store_dwordx2 v[16:17], v65, s[20:23], s26 offen offset:0 sc1
    v_cvt_pk_bf16_f32 v20, v20, v21
    v_cvt_pk_bf16_f32 v21, v22, v23
    buffer_store_dwordx2 v[20:21], v65, s[20:23], s26 offen offset:1024 sc1
    v_lshlrev_b32 v65, 2, v3
    v_add_u32 v65, 32, v65
    v_mul_u32_u24 v66, 37, v65
    v_lshrrev_b32 v66, 10, v66
    v_mul_u32_u24 v67, 28, v66
    v_sub_u32 v65, v65, v67
    v_lshl_add_u32 v65, v65, 1, v64
    v_lshl_add_u32 v65, v66, 17, v65
    v_cvt_pk_bf16_f32 v24, v24, v25
    v_cvt_pk_bf16_f32 v25, v26, v27
    buffer_store_dwordx2 v[24:25], v65, s[20:23], s26 offen offset:0 sc1
    v_cvt_pk_bf16_f32 v28, v28, v29
    v_cvt_pk_bf16_f32 v29, v30, v31
    buffer_store_dwordx2 v[28:29], v65, s[20:23], s26 offen offset:1024 sc1
    v_lshlrev_b32 v65, 2, v3
    v_add_u32 v65, 48, v65
    v_mul_u32_u24 v66, 37, v65
    v_lshrrev_b32 v66, 10, v66
    v_mul_u32_u24 v67, 28, v66
    v_sub_u32 v65, v65, v67
    v_lshl_add_u32 v65, v65, 1, v64
    v_lshl_add_u32 v65, v66, 17, v65
    v_cvt_pk_bf16_f32 v32, v32, v33
    v_cvt_pk_bf16_f32 v33, v34, v35
    buffer_store_dwordx2 v[32:33], v65, s[20:23], s26 offen offset:0 sc1
    v_cvt_pk_bf16_f32 v36, v36, v37
    v_cvt_pk_bf16_f32 v37, v38, v39
    buffer_store_dwordx2 v[36:37], v65, s[20:23], s26 offen offset:1024 sc1
    v_lshlrev_b32 v65, 2, v3
    v_add_u32 v65, 64, v65
    v_mul_u32_u24 v66, 37, v65
    v_lshrrev_b32 v66, 10, v66
    v_mul_u32_u24 v67, 28, v66
    v_sub_u32 v65, v65, v67
    v_lshl_add_u32 v65, v65, 1, v64
    v_lshl_add_u32 v65, v66, 17, v65
    v_cvt_pk_bf16_f32 v40, v40, v41
    v_cvt_pk_bf16_f32 v41, v42, v43
    buffer_store_dwordx2 v[40:41], v65, s[20:23], s26 offen offset:0 sc1
    v_cvt_pk_bf16_f32 v44, v44, v45
    v_cvt_pk_bf16_f32 v45, v46, v47
    buffer_store_dwordx2 v[44:45], v65, s[20:23], s26 offen offset:1024 sc1
    v_lshlrev_b32 v65, 2, v3
    v_add_u32 v65, 80, v65
    v_mul_u32_u24 v66, 37, v65
    v_lshrrev_b32 v66, 10, v66
    v_mul_u32_u24 v67, 28, v66
    v_sub_u32 v65, v65, v67
    v_lshl_add_u32 v65, v65, 1, v64
    v_lshl_add_u32 v65, v66, 17, v65
    v_cvt_pk_bf16_f32 v48, v48, v49
    v_cvt_pk_bf16_f32 v49, v50, v51
    buffer_store_dwordx2 v[48:49], v65, s[20:23], s26 offen offset:0 sc1
    v_cvt_pk_bf16_f32 v52, v52, v53
    v_cvt_pk_bf16_f32 v53, v54, v55
    buffer_store_dwordx2 v[52:53], v65, s[20:23], s26 offen offset:1024 sc1
    v_lshlrev_b32 v65, 2, v3
    v_add_u32 v65, 96, v65
    v_mul_u32_u24 v66, 37, v65
    v_lshrrev_b32 v66, 10, v66
    v_mul_u32_u24 v67, 28, v66
    v_sub_u32 v65, v65, v67
    v_lshl_add_u32 v65, v65, 1, v64
    v_lshl_add_u32 v65, v66, 17, v65
    v_cvt_pk_bf16_f32 v56, v56, v57
    v_cvt_pk_bf16_f32 v57, v58, v59
    buffer_store_dwordx2 v[56:57], v65, s[20:23], s26 offen offset:0 sc1
    v_cvt_pk_bf16_f32 v60, v60, v61
    v_cvt_pk_bf16_f32 v61, v62, v63
    buffer_store_dwordx2 v[60:61], v65, s[20:23], s26 offen offset:1024 sc1
    s_branch a1_fin
a1_v:
    ds_read_b128 v[64:67], v6 offset:0
    ds_read_b128 v[68:71], v5 offset:0
    ds_read_b128 v[72:75], v6 offset:64
    ds_read_b128 v[76:79], v5 offset:64
    ds_read_b128 v[80:83], v6 offset:128
    ds_read_b128 v[84:87], v5 offset:128
    ds_read_b128 v[88:91], v6 offset:192
    ds_read_b128 v[92:95], v5 offset:192
    s_waitcnt lgkmcnt(6)
    v_mfma_f32_16x16x32_bf16 v[8:11], v[64:67], a[0:3], 0
    v_mfma_f32_16x16x32_bf16 v[12:15], v[68:71], a[0:3], 0
    v_mfma_f32_16x16x32_bf16 v[16:19], v[64:67], a[56:59], 0
    v_mfma_f32_16x16x32_bf16 v[20:23], v[68:71], a[56:59], 0
    v_mfma_f32_16x16x32_bf16 v[24:27], v[64:67], a[112:115], 0
    v_mfma_f32_16x16x32_bf16 v[28:31], v[68:71], a[112:115], 0
    v_mfma_f32_16x16x32_bf16 v[32:35], v[64:67], a[168:171], 0
    v_mfma_f32_16x16x32_bf16 v[36:39], v[68:71], a[168:171], 0
    v_mfma_f32_16x16x32_bf16 v[40:43], v[64:67], a[224:227], 0
    v_mfma_f32_16x16x32_bf16 v[44:47], v[68:71], a[224:227], 0
    v_mfma_f32_16x16x32_bf16 v[48:51], v[64:67], v[134:137], 0
    v_mfma_f32_16x16x32_bf16 v[52:55], v[68:71], v[134:137], 0
    v_mfma_f32_16x16x32_bf16 v[56:59], v[64:67], v[190:193], 0
    v_mfma_f32_16x16x32_bf16 v[60:63], v[68:71], v[190:193], 0
    ds_read_b128 v[64:67], v6 offset:256
    ds_read_b128 v[68:71], v5 offset:256
    s_waitcnt lgkmcnt(6)
    v_mfma_f32_16x16x32_bf16 v[8:11], v[72:75], a[4:7], v[8:11]
    v_mfma_f32_16x16x32_bf16 v[12:15], v[76:79], a[4:7], v[12:15]
    v_mfma_f32_16x16x32_bf16 v[16:19], v[72:75], a[60:63], v[16:19]
    v_mfma_f32_16x16x32_bf16 v[20:23], v[76:79], a[60:63], v[20:23]
    v_mfma_f32_16x16x32_bf16 v[24:27], v[72:75], a[116:119], v[24:27]
    v_mfma_f32_16x16x32_bf16 v[28:31], v[76:79], a[116:119], v[28:31]
    v_mfma_f32_16x16x32_bf16 v[32:35], v[72:75], a[172:175], v[32:35]
    v_mfma_f32_16x16x32_bf16 v[36:39], v[76:79], a[172:175], v[36:39]
    v_mfma_f32_16x16x32_bf16 v[40:43], v[72:75], a[228:231], v[40:43]
    v_mfma_f32_16x16x32_bf16 v[44:47], v[76:79], a[228:231], v[44:47]
    v_mfma_f32_16x16x32_bf16 v[48:51], v[72:75], v[138:141], v[48:51]
    v_mfma_f32_16x16x32_bf16 v[52:55], v[76:79], v[138:141], v[52:55]
    v_mfma_f32_16x16x32_bf16 v[56:59], v[72:75], v[194:197], v[56:59]
    v_mfma_f32_16x16x32_bf16 v[60:63], v[76:79], v[194:197], v[60:63]
    ds_read_b128 v[72:75], v6 offset:320
    ds_read_b128 v[76:79], v5 offset:320
    s_waitcnt lgkmcnt(6)
    v_mfma_f32_16x16x32_bf16 v[8:11], v[80:83], a[8:11], v[8:11]
    v_mfma_f32_16x16x32_bf16 v[12:15], v[84:87], a[8:11], v[12:15]
    v_mfma_f32_16x16x32_bf16 v[16:19], v[80:83], a[64:67], v[16:19]
    v_mfma_f32_16x16x32_bf16 v[20:23], v[84:87], a[64:67], v[20:23]
    v_mfma_f32_16x16x32_bf16 v[24:27], v[80:83], a[120:123], v[24:27]
    v_mfma_f32_16x16x32_bf16 v[28:31], v[84:87], a[120:123], v[28:31]
    v_mfma_f32_16x16x32_bf16 v[32:35], v[80:83], a[176:179], v[32:35]
    v_mfma_f32_16x16x32_bf16 v[36:39], v[84:87], a[176:179], v[36:39]
    v_mfma_f32_16x16x32_bf16 v[40:43], v[80:83], a[232:235], v[40:43]
    v_mfma_f32_16x16x32_bf16 v[44:47], v[84:87], a[232:235], v[44:47]
    v_mfma_f32_16x16x32_bf16 v[48:51], v[80:83], v[142:145], v[48:51]
    v_mfma_f32_16x16x32_bf16 v[52:55], v[84:87], v[142:145], v[52:55]
    v_mfma_f32_16x16x32_bf16 v[56:59], v[80:83], v[198:201], v[56:59]
    v_mfma_f32_16x16x32_bf16 v[60:63], v[84:87], v[198:201], v[60:63]
    ds_read_b128 v[80:83], v6 offset:384
    ds_read_b128 v[84:87], v5 offset:384
    s_waitcnt lgkmcnt(6)
    v_mfma_f32_16x16x32_bf16 v[8:11], v[88:91], a[12:15], v[8:11]
    v_mfma_f32_16x16x32_bf16 v[12:15], v[92:95], a[12:15], v[12:15]
    v_mfma_f32_16x16x32_bf16 v[16:19], v[88:91], a[68:71], v[16:19]
    v_mfma_f32_16x16x32_bf16 v[20:23], v[92:95], a[68:71], v[20:23]
    v_mfma_f32_16x16x32_bf16 v[24:27], v[88:91], a[124:127], v[24:27]
    v_mfma_f32_16x16x32_bf16 v[28:31], v[92:95], a[124:127], v[28:31]
    v_mfma_f32_16x16x32_bf16 v[32:35], v[88:91], a[180:183], v[32:35]
    v_mfma_f32_16x16x32_bf16 v[36:39], v[92:95], a[180:183], v[36:39]
    v_mfma_f32_16x16x32_bf16 v[40:43], v[88:91], a[236:239], v[40:43]
    v_mfma_f32_16x16x32_bf16 v[44:47], v[92:95], a[236:239], v[44:47]
    v_mfma_f32_16x16x32_bf16 v[48:51], v[88:91], v[146:149], v[48:51]
    v_mfma_f32_16x16x32_bf16 v[52:55], v[92:95], v[146:149], v[52:55]
    v_mfma_f32_16x16x32_bf16 v[56:59], v[88:91], v[202:205], v[56:59]
    v_mfma_f32_16x16x32_bf16 v[60:63], v[92:95], v[202:205], v[60:63]
    ds_read_b128 v[88:91], v6 offset:448
    ds_read_b128 v[92:95], v5 offset:448
    s_waitcnt lgkmcnt(6)
    v_mfma_f32_16x16x32_bf16 v[8:11], v[64:67], a[16:19], v[8:11]
    v_mfma_f32_16x16x32_bf16 v[12:15], v[68:71], a[16:19], v[12:15]
    v_mfma_f32_16x16x32_bf16 v[16:19], v[64:67], a[72:75], v[16:19]
    v_mfma_f32_16x16x32_bf16 v[20:23], v[68:71], a[72:75], v[20:23]
    v_mfma_f32_16x16x32_bf16 v[24:27], v[64:67], a[128:131], v[24:27]
    v_mfma_f32_16x16x32_bf16 v[28:31], v[68:71], a[128:131], v[28:31]
    v_mfma_f32_16x16x32_bf16 v[32:35], v[64:67], a[184:187], v[32:35]
    v_mfma_f32_16x16x32_bf16 v[36:39], v[68:71], a[184:187], v[36:39]
    v_mfma_f32_16x16x32_bf16 v[40:43], v[64:67], a[240:243], v[40:43]
    v_mfma_f32_16x16x32_bf16 v[44:47], v[68:71], a[240:243], v[44:47]
    v_mfma_f32_16x16x32_bf16 v[48:51], v[64:67], v[150:153], v[48:51]
    v_mfma_f32_16x16x32_bf16 v[52:55], v[68:71], v[150:153], v[52:55]
    v_mfma_f32_16x16x32_bf16 v[56:59], v[64:67], v[206:209], v[56:59]
    v_mfma_f32_16x16x32_bf16 v[60:63], v[68:71], v[206:209], v[60:63]
    ds_read_b128 v[64:67], v6 offset:512
    ds_read_b128 v[68:71], v5 offset:512
    s_waitcnt lgkmcnt(6)
    v_mfma_f32_16x16x32_bf16 v[8:11], v[72:75], a[20:23], v[8:11]
    v_mfma_f32_16x16x32_bf16 v[12:15], v[76:79], a[20:23], v[12:15]
    v_mfma_f32_16x16x32_bf16 v[16:19], v[72:75], a[76:79], v[16:19]
    v_mfma_f32_16x16x32_bf16 v[20:23], v[76:79], a[76:79], v[20:23]
    v_mfma_f32_16x16x32_bf16 v[24:27], v[72:75], a[132:135], v[24:27]
    v_mfma_f32_16x16x32_bf16 v[28:31], v[76:79], a[132:135], v[28:31]
    v_mfma_f32_16x16x32_bf16 v[32:35], v[72:75], a[188:191], v[32:35]
    v_mfma_f32_16x16x32_bf16 v[36:39], v[76:79], a[188:191], v[36:39]
    v_mfma_f32_16x16x32_bf16 v[40:43], v[72:75], a[244:247], v[40:43]
    v_mfma_f32_16x16x32_bf16 v[44:47], v[76:79], a[244:247], v[44:47]
    v_mfma_f32_16x16x32_bf16 v[48:51], v[72:75], v[154:157], v[48:51]
    v_mfma_f32_16x16x32_bf16 v[52:55], v[76:79], v[154:157], v[52:55]
    v_mfma_f32_16x16x32_bf16 v[56:59], v[72:75], v[210:213], v[56:59]
    v_mfma_f32_16x16x32_bf16 v[60:63], v[76:79], v[210:213], v[60:63]
    ds_read_b128 v[72:75], v6 offset:576
    ds_read_b128 v[76:79], v5 offset:576
    s_waitcnt lgkmcnt(6)
    v_mfma_f32_16x16x32_bf16 v[8:11], v[80:83], a[24:27], v[8:11]
    v_mfma_f32_16x16x32_bf16 v[12:15], v[84:87], a[24:27], v[12:15]
    v_mfma_f32_16x16x32_bf16 v[16:19], v[80:83], a[80:83], v[16:19]
    v_mfma_f32_16x16x32_bf16 v[20:23], v[84:87], a[80:83], v[20:23]
    v_mfma_f32_16x16x32_bf16 v[24:27], v[80:83], a[136:139], v[24:27]
    v_mfma_f32_16x16x32_bf16 v[28:31], v[84:87], a[136:139], v[28:31]
    v_mfma_f32_16x16x32_bf16 v[32:35], v[80:83], a[192:195], v[32:35]
    v_mfma_f32_16x16x32_bf16 v[36:39], v[84:87], a[192:195], v[36:39]
    v_mfma_f32_16x16x32_bf16 v[40:43], v[80:83], a[248:251], v[40:43]
    v_mfma_f32_16x16x32_bf16 v[44:47], v[84:87], a[248:251], v[44:47]
    v_mfma_f32_16x16x32_bf16 v[48:51], v[80:83], v[158:161], v[48:51]
    v_mfma_f32_16x16x32_bf16 v[52:55], v[84:87], v[158:161], v[52:55]
    v_mfma_f32_16x16x32_bf16 v[56:59], v[80:83], v[214:217], v[56:59]
    v_mfma_f32_16x16x32_bf16 v[60:63], v[84:87], v[214:217], v[60:63]
    ds_read_b128 v[80:83], v6 offset:640
    ds_read_b128 v[84:87], v5 offset:640
    s_waitcnt lgkmcnt(6)
    v_mfma_f32_16x16x32_bf16 v[8:11], v[88:91], a[28:31], v[8:11]
    v_mfma_f32_16x16x32_bf16 v[12:15], v[92:95], a[28:31], v[12:15]
    v_mfma_f32_16x16x32_bf16 v[16:19], v[88:91], a[84:87], v[16:19]
    v_mfma_f32_16x16x32_bf16 v[20:23], v[92:95], a[84:87], v[20:23]
    v_mfma_f32_16x16x32_bf16 v[24:27], v[88:91], a[140:143], v[24:27]
    v_mfma_f32_16x16x32_bf16 v[28:31], v[92:95], a[140:143], v[28:31]
    v_mfma_f32_16x16x32_bf16 v[32:35], v[88:91], a[196:199], v[32:35]
    v_mfma_f32_16x16x32_bf16 v[36:39], v[92:95], a[196:199], v[36:39]
    v_mfma_f32_16x16x32_bf16 v[40:43], v[88:91], a[252:255], v[40:43]
    v_mfma_f32_16x16x32_bf16 v[44:47], v[92:95], a[252:255], v[44:47]
    v_mfma_f32_16x16x32_bf16 v[48:51], v[88:91], v[162:165], v[48:51]
    v_mfma_f32_16x16x32_bf16 v[52:55], v[92:95], v[162:165], v[52:55]
    v_mfma_f32_16x16x32_bf16 v[56:59], v[88:91], v[218:221], v[56:59]
    v_mfma_f32_16x16x32_bf16 v[60:63], v[92:95], v[218:221], v[60:63]
    ds_read_b128 v[88:91], v6 offset:704
    ds_read_b128 v[92:95], v5 offset:704
    s_waitcnt lgkmcnt(6)
    v_mfma_f32_16x16x32_bf16 v[8:11], v[64:67], a[32:35], v[8:11]
    v_mfma_f32_16x16x32_bf16 v[12:15], v[68:71], a[32:35], v[12:15]
    v_mfma_f32_16x16x32_bf16 v[16:19], v[64:67], a[88:91], v[16:19]
    v_mfma_f32_16x16x32_bf16 v[20:23], v[68:71], a[88:91], v[20:23]
    v_mfma_f32_16x16x32_bf16 v[24:27], v[64:67], a[144:147], v[24:27]
    v_mfma_f32_16x16x32_bf16 v[28:31], v[68:71], a[144:147], v[28:31]
    v_mfma_f32_16x16x32_bf16 v[32:35], v[64:67], a[200:203], v[32:35]
    v_mfma_f32_16x16x32_bf16 v[36:39], v[68:71], a[200:203], v[36:39]
    v_mfma_f32_16x16x32_bf16 v[40:43], v[64:67], v[110:113], v[40:43]
    v_mfma_f32_16x16x32_bf16 v[44:47], v[68:71], v[110:113], v[44:47]
    v_mfma_f32_16x16x32_bf16 v[48:51], v[64:67], v[166:169], v[48:51]
    v_mfma_f32_16x16x32_bf16 v[52:55], v[68:71], v[166:169], v[52:55]
    v_mfma_f32_16x16x32_bf16 v[56:59], v[64:67], v[222:225], v[56:59]
    v_mfma_f32_16x16x32_bf16 v[60:63], v[68:71], v[222:225], v[60:63]
    ds_read_b128 v[64:67], v6 offset:768
    ds_read_b128 v[68:71], v5 offset:768
    s_waitcnt lgkmcnt(6)
    v_mfma_f32_16x16x32_bf16 v[8:11], v[72:75], a[36:39], v[8:11]
    v_mfma_f32_16x16x32_bf16 v[12:15], v[76:79], a[36:39], v[12:15]
    v_mfma_f32_16x16x32_bf16 v[16:19], v[72:75], a[92:95], v[16:19]
    v_mfma_f32_16x16x32_bf16 v[20:23], v[76:79], a[92:95], v[20:23]
    v_mfma_f32_16x16x32_bf16 v[24:27], v[72:75], a[148:151], v[24:27]
    v_mfma_f32_16x16x32_bf16 v[28:31], v[76:79], a[148:151], v[28:31]
    v_mfma_f32_16x16x32_bf16 v[32:35], v[72:75], a[204:207], v[32:35]
    v_mfma_f32_16x16x32_bf16 v[36:39], v[76:79], a[204:207], v[36:39]
    v_mfma_f32_16x16x32_bf16 v[40:43], v[72:75], v[114:117], v[40:43]
    v_mfma_f32_16x16x32_bf16 v[44:47], v[76:79], v[114:117], v[44:47]
    v_mfma_f32_16x16x32_bf16 v[48:51], v[72:75], v[170:173], v[48:51]
    v_mfma_f32_16x16x32_bf16 v[52:55], v[76:79], v[170:173], v[52:55]
    v_mfma_f32_16x16x32_bf16 v[56:59], v[72:75], v[226:229], v[56:59]
    v_mfma_f32_16x16x32_bf16 v[60:63], v[76:79], v[226:229], v[60:63]
    ds_read_b128 v[72:75], v6 offset:832
    ds_read_b128 v[76:79], v5 offset:832
    s_waitcnt lgkmcnt(6)
    v_mfma_f32_16x16x32_bf16 v[8:11], v[80:83], a[40:43], v[8:11]
    v_mfma_f32_16x16x32_bf16 v[12:15], v[84:87], a[40:43], v[12:15]
    v_mfma_f32_16x16x32_bf16 v[16:19], v[80:83], a[96:99], v[16:19]
    v_mfma_f32_16x16x32_bf16 v[20:23], v[84:87], a[96:99], v[20:23]
    v_mfma_f32_16x16x32_bf16 v[24:27], v[80:83], a[152:155], v[24:27]
    v_mfma_f32_16x16x32_bf16 v[28:31], v[84:87], a[152:155], v[28:31]
    v_mfma_f32_16x16x32_bf16 v[32:35], v[80:83], a[208:211], v[32:35]
    v_mfma_f32_16x16x32_bf16 v[36:39], v[84:87], a[208:211], v[36:39]
    v_mfma_f32_16x16x32_bf16 v[40:43], v[80:83], v[118:121], v[40:43]
    v_mfma_f32_16x16x32_bf16 v[44:47], v[84:87], v[118:121], v[44:47]
    v_mfma_f32_16x16x32_bf16 v[48:51], v[80:83], v[174:177], v[48:51]
    v_mfma_f32_16x16x32_bf16 v[52:55], v[84:87], v[174:177], v[52:55]
    v_mfma_f32_16x16x32_bf16 v[56:59], v[80:83], v[230:233], v[56:59]
    v_mfma_f32_16x16x32_bf16 v[60:63], v[84:87], v[230:233], v[60:63]
    s_waitcnt lgkmcnt(4)
    v_mfma_f32_16x16x32_bf16 v[8:11], v[88:91], a[44:47], v[8:11]
    v_mfma_f32_16x16x32_bf16 v[12:15], v[92:95], a[44:47], v[12:15]
    v_mfma_f32_16x16x32_bf16 v[16:19], v[88:91], a[100:103], v[16:19]
    v_mfma_f32_16x16x32_bf16 v[20:23], v[92:95], a[100:103], v[20:23]
    v_mfma_f32_16x16x32_bf16 v[24:27], v[88:91], a[156:159], v[24:27]
    v_mfma_f32_16x16x32_bf16 v[28:31], v[92:95], a[156:159], v[28:31]
    v_mfma_f32_16x16x32_bf16 v[32:35], v[88:91], a[212:215], v[32:35]
    v_mfma_f32_16x16x32_bf16 v[36:39], v[92:95], a[212:215], v[36:39]
    v_mfma_f32_16x16x32_bf16 v[40:43], v[88:91], v[122:125], v[40:43]
    v_mfma_f32_16x16x32_bf16 v[44:47], v[92:95], v[122:125], v[44:47]
    v_mfma_f32_16x16x32_bf16 v[48:51], v[88:91], v[178:181], v[48:51]
    v_mfma_f32_16x16x32_bf16 v[52:55], v[92:95], v[178:181], v[52:55]
    v_mfma_f32_16x16x32_bf16 v[56:59], v[88:91], v[234:237], v[56:59]
    v_mfma_f32_16x16x32_bf16 v[60:63], v[92:95], v[234:237], v[60:63]
    s_waitcnt lgkmcnt(2)
    v_mfma_f32_16x16x32_bf16 v[8:11], v[64:67], a[48:51], v[8:11]
    v_mfma_f32_16x16x32_bf16 v[12:15], v[68:71], a[48:51], v[12:15]
    v_mfma_f32_16x16x32_bf16 v[16:19], v[64:67], a[104:107], v[16:19]
    v_mfma_f32_16x16x32_bf16 v[20:23], v[68:71], a[104:107], v[20:23]
    v_mfma_f32_16x16x32_bf16 v[24:27], v[64:67], a[160:163], v[24:27]
    v_mfma_f32_16x16x32_bf16 v[28:31], v[68:71], a[160:163], v[28:31]
    v_mfma_f32_16x16x32_bf16 v[32:35], v[64:67], a[216:219], v[32:35]
    v_mfma_f32_16x16x32_bf16 v[36:39], v[68:71], a[216:219], v[36:39]
    v_mfma_f32_16x16x32_bf16 v[40:43], v[64:67], v[126:129], v[40:43]
    v_mfma_f32_16x16x32_bf16 v[44:47], v[68:71], v[126:129], v[44:47]
    v_mfma_f32_16x16x32_bf16 v[48:51], v[64:67], v[182:185], v[48:51]
    v_mfma_f32_16x16x32_bf16 v[52:55], v[68:71], v[182:185], v[52:55]
    v_mfma_f32_16x16x32_bf16 v[56:59], v[64:67], v[238:241], v[56:59]
    v_mfma_f32_16x16x32_bf16 v[60:63], v[68:71], v[238:241], v[60:63]
    s_waitcnt lgkmcnt(0)
    v_mfma_f32_16x16x32_bf16 v[8:11], v[72:75], a[52:55], v[8:11]
    v_mfma_f32_16x16x32_bf16 v[12:15], v[76:79], a[52:55], v[12:15]
    v_mfma_f32_16x16x32_bf16 v[16:19], v[72:75], a[108:111], v[16:19]
    v_mfma_f32_16x16x32_bf16 v[20:23], v[76:79], a[108:111], v[20:23]
    v_mfma_f32_16x16x32_bf16 v[24:27], v[72:75], a[164:167], v[24:27]
    v_mfma_f32_16x16x32_bf16 v[28:31], v[76:79], a[164:167], v[28:31]
    v_mfma_f32_16x16x32_bf16 v[32:35], v[72:75], a[220:223], v[32:35]
    v_mfma_f32_16x16x32_bf16 v[36:39], v[76:79], a[220:223], v[36:39]
    v_mfma_f32_16x16x32_bf16 v[40:43], v[72:75], v[130:133], v[40:43]
    v_mfma_f32_16x16x32_bf16 v[44:47], v[76:79], v[130:133], v[44:47]
    v_mfma_f32_16x16x32_bf16 v[48:51], v[72:75], v[186:189], v[48:51]
    v_mfma_f32_16x16x32_bf16 v[52:55], v[76:79], v[186:189], v[52:55]
    v_mfma_f32_16x16x32_bf16 v[56:59], v[72:75], v[242:245], v[56:59]
    v_mfma_f32_16x16x32_bf16 v[60:63], v[76:79], v[242:245], v[60:63]
    s_nop 7
    s_lshl_b32 s27, s3, 19
    s_add_u32 s26, s27, 22315008
    s_lshl_b32 s27, s25, 11
    s_add_u32 s26, s26, s27
    v_lshlrev_b32 v64, 8, v3
    v_add_u32 v65, 0, v2
    v_mul_u32_u24 v66, 2341, v65
    v_lshrrev_b32 v66, 16, v66
    v_mul_u32_u24 v67, 28, v66
    v_sub_u32 v65, v65, v67
    v_lshrrev_b32 v67, 4, v65
    v_and_b32 v65, 15, v65
    v_lshl_add_u32 v65, v65, 4, v64
    v_lshl_add_u32 v65, v67, 10, v65
    v_lshl_add_u32 v65, v66, 17, v65
    v_cvt_pk_bf16_f32 v8, v8, v9
    v_cvt_pk_bf16_f32 v9, v10, v11
    v_cvt_pk_bf16_f32 v10, v12, v13
    v_cvt_pk_bf16_f32 v11, v14, v15
    buffer_store_dwordx4 v[8:11], v65, s[20:23], s26 offen sc1
    v_add_u32 v65, 16, v2
    v_mul_u32_u24 v66, 2341, v65
    v_lshrrev_b32 v66, 16, v66
    v_mul_u32_u24 v67, 28, v66
    v_sub_u32 v65, v65, v67
    v_lshrrev_b32 v67, 4, v65
    v_and_b32 v65, 15, v65
    v_lshl_add_u32 v65, v65, 4, v64
    v_lshl_add_u32 v65, v67, 10, v65
    v_lshl_add_u32 v65, v66, 17, v65
    v_cvt_pk_bf16_f32 v16, v16, v17
    v_cvt_pk_bf16_f32 v17, v18, v19
    v_cvt_pk_bf16_f32 v18, v20, v21
    v_cvt_pk_bf16_f32 v19, v22, v23
    buffer_store_dwordx4 v[16:19], v65, s[20:23], s26 offen sc1
    v_add_u32 v65, 32, v2
    v_mul_u32_u24 v66, 2341, v65
    v_lshrrev_b32 v66, 16, v66
    v_mul_u32_u24 v67, 28, v66
    v_sub_u32 v65, v65, v67
    v_lshrrev_b32 v67, 4, v65
    v_and_b32 v65, 15, v65
    v_lshl_add_u32 v65, v65, 4, v64
    v_lshl_add_u32 v65, v67, 10, v65
    v_lshl_add_u32 v65, v66, 17, v65
    v_cvt_pk_bf16_f32 v24, v24, v25
    v_cvt_pk_bf16_f32 v25, v26, v27
    v_cvt_pk_bf16_f32 v26, v28, v29
    v_cvt_pk_bf16_f32 v27, v30, v31
    buffer_store_dwordx4 v[24:27], v65, s[20:23], s26 offen sc1
    v_add_u32 v65, 48, v2
    v_mul_u32_u24 v66, 2341, v65
    v_lshrrev_b32 v66, 16, v66
    v_mul_u32_u24 v67, 28, v66
    v_sub_u32 v65, v65, v67
    v_lshrrev_b32 v67, 4, v65
    v_and_b32 v65, 15, v65
    v_lshl_add_u32 v65, v65, 4, v64
    v_lshl_add_u32 v65, v67, 10, v65
    v_lshl_add_u32 v65, v66, 17, v65
    v_cvt_pk_bf16_f32 v32, v32, v33
    v_cvt_pk_bf16_f32 v33, v34, v35
    v_cvt_pk_bf16_f32 v34, v36, v37
    v_cvt_pk_bf16_f32 v35, v38, v39
    buffer_store_dwordx4 v[32:35], v65, s[20:23], s26 offen sc1
    v_add_u32 v65, 64, v2
    v_mul_u32_u24 v66, 2341, v65
    v_lshrrev_b32 v66, 16, v66
    v_mul_u32_u24 v67, 28, v66
    v_sub_u32 v65, v65, v67
    v_lshrrev_b32 v67, 4, v65
    v_and_b32 v65, 15, v65
    v_lshl_add_u32 v65, v65, 4, v64
    v_lshl_add_u32 v65, v67, 10, v65
    v_lshl_add_u32 v65, v66, 17, v65
    v_cvt_pk_bf16_f32 v40, v40, v41
    v_cvt_pk_bf16_f32 v41, v42, v43
    v_cvt_pk_bf16_f32 v42, v44, v45
    v_cvt_pk_bf16_f32 v43, v46, v47
    buffer_store_dwordx4 v[40:43], v65, s[20:23], s26 offen sc1
    v_add_u32 v65, 80, v2
    v_mul_u32_u24 v66, 2341, v65
    v_lshrrev_b32 v66, 16, v66
    v_mul_u32_u24 v67, 28, v66
    v_sub_u32 v65, v65, v67
    v_lshrrev_b32 v67, 4, v65
    v_and_b32 v65, 15, v65
    v_lshl_add_u32 v65, v65, 4, v64
    v_lshl_add_u32 v65, v67, 10, v65
    v_lshl_add_u32 v65, v66, 17, v65
    v_cvt_pk_bf16_f32 v48, v48, v49
    v_cvt_pk_bf16_f32 v49, v50, v51
    v_cvt_pk_bf16_f32 v50, v52, v53
    v_cvt_pk_bf16_f32 v51, v54, v55
    buffer_store_dwordx4 v[48:51], v65, s[20:23], s26 offen sc1
    v_add_u32 v65, 96, v2
    v_mul_u32_u24 v66, 2341, v65
    v_lshrrev_b32 v66, 16, v66
    v_mul_u32_u24 v67, 28, v66
    v_sub_u32 v65, v65, v67
    v_lshrrev_b32 v67, 4, v65
    v_and_b32 v65, 15, v65
    v_lshl_add_u32 v65, v65, 4, v64
    v_lshl_add_u32 v65, v67, 10, v65
    v_lshl_add_u32 v65, v66, 17, v65
    v_cvt_pk_bf16_f32 v56, v56, v57
    v_cvt_pk_bf16_f32 v57, v58, v59
    v_cvt_pk_bf16_f32 v58, v60, v61
    v_cvt_pk_bf16_f32 v59, v62, v63
    buffer_store_dwordx4 v[56:59], v65, s[20:23], s26 offen sc1
a1_fin:
    s_waitcnt vmcnt(0)
    s_barrier
    s_cmp_lg_u32 s3, 0
    s_cbranch_scc1 mega_kernel_sg127
    s_lshl_b32 s70, s25, 7
    s_add_u32 s70, s70, 167550976
    v_mov_b32 v6, 1
    v_mov_b32 v7, 0
    s_mov_b64 exec, 1
    buffer_atomic_add v6, v7, s[20:23], s70 offen sc1
    s_mov_b64 exec, -1
mega_kernel_sg127:
    s_add_u32 s25, s25, 4
    s_cmp_lt_u32 s25, 64
    s_cbranch_scc0 a1_done
    s_getpc_b64 s[60:61]
mega_kernel_lj128:
    s_sub_u32 s60, s60, mega_kernel_lj128-a1_loop
    s_subb_u32 s61, s61, 0
    s_setpc_b64 s[60:61]
a1_done:
    s_endpgm
a2_start:
    s_and_b32 s25, s2, 7
    s_lshl_b32 s25, s25, 1
    s_lshr_b32 s26, s3, 1
    s_add_u32 s25, s25, s26
    s_lshr_b32 s55, s2, 3
a2_loop:
    s_lshl_b32 s24, s55, 1
    s_and_b32 s26, s3, 1
    s_add_u32 s24, s24, s26
    v_min_u32 v4, 8, v1
    v_add_u32 v4, s55, v4
    v_subrev_u32 v4, 8, v4
    v_max_i32 v4, 0, v4
    v_lshlrev_b32 v4, 7, v4
    s_mov_b32 s70, 167550976
    s_cmp_lg_u32 s3, 0
    s_cbranch_scc1 a2_wqd
a2_wq:
    buffer_load_dword v5, v4, s[20:23], s70 offen sc1
    s_waitcnt vmcnt(0)
    v_cmp_gt_u32 vcc, 3, v5
    s_cbranch_vccz a2_wqd
    s_sleep 6
    s_branch a2_wq
a2_wqd:
    s_barrier
    v_lshlrev_b32 v4, 6, v2
    v_lshl_add_u32 v4, v3, 4, v4
    s_lshl_b32 s26, s25, 17
    s_lshl_b32 s27, s24, 10
    s_add_u32 s28, s26, s27
    s_add_u32 s28, s28, 18120704
    buffer_load_dwordx4 v[8:11], v4, s[20:23], s28 offen sc1
    v_lshlrev_b32 v5, 4, v1
    s_lshr_b32 s34, s24, 1
    s_sub_i32 s29, s34, 8
    s_max_i32 s29, s29, 0
    s_lshl_b32 s30, s29, 11
    s_add_u32 s30, s30, s26
    s_add_u32 s31, s30, 20217856
    s_add_u32 s30, s30, 22315008
    buffer_load_dwordx4 v[12:15], v4, s[20:23], s31 offen sc1
    buffer_load_dwordx4 v[16:19], v4, s[20:23], s31 offen offset:1024 sc1
    buffer_load_dwordx4 v[84:87], v5, s[20:23], s30 offen sc1
    buffer_load_dwordx4 v[88:91], v5, s[20:23], s30 offen offset:1024 sc1
    s_sub_i32 s29, s34, 7
    s_max_i32 s29, s29, 0
    s_lshl_b32 s30, s29, 11
    s_add_u32 s30, s30, s26
    s_add_u32 s31, s30, 20217856
    s_add_u32 s30, s30, 22315008
    buffer_load_dwordx4 v[20:23], v4, s[20:23], s31 offen sc1
    buffer_load_dwordx4 v[24:27], v4, s[20:23], s31 offen offset:1024 sc1
    buffer_load_dwordx4 v[92:95], v5, s[20:23], s30 offen sc1
    buffer_load_dwordx4 v[96:99], v5, s[20:23], s30 offen offset:1024 sc1
    s_sub_i32 s29, s34, 6
    s_max_i32 s29, s29, 0
    s_lshl_b32 s30, s29, 11
    s_add_u32 s30, s30, s26
    s_add_u32 s31, s30, 20217856
    s_add_u32 s30, s30, 22315008
    buffer_load_dwordx4 v[28:31], v4, s[20:23], s31 offen sc1
    buffer_load_dwordx4 v[32:35], v4, s[20:23], s31 offen offset:1024 sc1
    buffer_load_dwordx4 v[100:103], v5, s[20:23], s30 offen sc1
    buffer_load_dwordx4 v[104:107], v5, s[20:23], s30 offen offset:1024 sc1
    s_sub_i32 s29, s34, 5
    s_max_i32 s29, s29, 0
    s_lshl_b32 s30, s29, 11
    s_add_u32 s30, s30, s26
    s_add_u32 s31, s30, 20217856
    s_add_u32 s30, s30, 22315008
    buffer_load_dwordx4 v[36:39], v4, s[20:23], s31 offen sc1
    buffer_load_dwordx4 v[40:43], v4, s[20:23], s31 offen offset:1024 sc1
    buffer_load_dwordx4 v[108:111], v5, s[20:23], s30 offen sc1
    buffer_load_dwordx4 v[112:115], v5, s[20:23], s30 offen offset:1024 sc1
    s_sub_i32 s29, s34, 4
    s_max_i32 s29, s29, 0
    s_lshl_b32 s30, s29, 11
    s_add_u32 s30, s30, s26
    s_add_u32 s31, s30, 20217856
    s_add_u32 s30, s30, 22315008
    buffer_load_dwordx4 v[44:47], v4, s[20:23], s31 offen sc1
    buffer_load_dwordx4 v[48:51], v4, s[20:23], s31 offen offset:1024 sc1
    buffer_load_dwordx4 v[116:119], v5, s[20:23], s30 offen sc1
    buffer_load_dwordx4 v[120:123], v5, s[20:23], s30 offen offset:1024 sc1
    s_sub_i32 s29, s34, 3
    s_max_i32 s29, s29, 0
    s_lshl_b32 s30, s29, 11
    s_add_u32 s30, s30, s26
    s_add_u32 s31, s30, 20217856
    s_add_u32 s30, s30, 22315008
    buffer_load_dwordx4 v[52:55], v4, s[20:23], s31 offen sc1
    buffer_load_dwordx4 v[56:59], v4, s[20:23], s31 offen offset:1024 sc1
    buffer_load_dwordx4 v[124:127], v5, s[20:23], s30 offen sc1
    buffer_load_dwordx4 v[128:131], v5, s[20:23], s30 offen offset:1024 sc1
    s_sub_i32 s29, s34, 2
    s_max_i32 s29, s29, 0
    s_lshl_b32 s30, s29, 11
    s_add_u32 s30, s30, s26
    s_add_u32 s31, s30, 20217856
    s_add_u32 s30, s30, 22315008
    buffer_load_dwordx4 v[60:63], v4, s[20:23], s31 offen sc1
    buffer_load_dwordx4 v[64:67], v4, s[20:23], s31 offen offset:1024 sc1
    buffer_load_dwordx4 v[132:135], v5, s[20:23], s30 offen sc1
    buffer_load_dwordx4 v[136:139], v5, s[20:23], s30 offen offset:1024 sc1
    s_sub_i32 s29, s34, 1
    s_max_i32 s29, s29, 0
    s_lshl_b32 s30, s29, 11
    s_add_u32 s30, s30, s26
    s_add_u32 s31, s30, 20217856
    s_add_u32 s30, s30, 22315008
    buffer_load_dwordx4 v[68:71], v4, s[20:23], s31 offen sc1
    buffer_load_dwordx4 v[72:75], v4, s[20:23], s31 offen offset:1024 sc1
    buffer_load_dwordx4 v[140:143], v5, s[20:23], s30 offen sc1
    buffer_load_dwordx4 v[144:147], v5, s[20:23], s30 offen offset:1024 sc1
    s_sub_i32 s29, s34, 0
    s_max_i32 s29, s29, 0
    s_lshl_b32 s30, s29, 11
    s_add_u32 s30, s30, s26
    s_add_u32 s31, s30, 20217856
    s_add_u32 s30, s30, 22315008
    buffer_load_dwordx4 v[76:79], v4, s[20:23], s31 offen sc1
    buffer_load_dwordx4 v[80:83], v4, s[20:23], s31 offen offset:1024 sc1
    buffer_load_dwordx4 v[148:151], v5, s[20:23], s30 offen sc1
    buffer_load_dwordx4 v[152:155], v5, s[20:23], s30 offen offset:1024 sc1
    s_waitcnt vmcnt(0)
    v_mfma_f32_16x16x32_bf16 v[156:159], v[12:15], v[8:11], 0
    v_mfma_f32_16x16x32_bf16 v[160:163], v[16:19], v[8:11], 0
    v_mfma_f32_16x16x32_bf16 v[164:167], v[20:23], v[8:11], 0
    v_mfma_f32_16x16x32_bf16 v[168:171], v[24:27], v[8:11], 0
    v_mfma_f32_16x16x32_bf16 v[172:175], v[28:31], v[8:11], 0
    v_mfma_f32_16x16x32_bf16 v[176:179], v[32:35], v[8:11], 0
    v_mfma_f32_16x16x32_bf16 v[180:183], v[36:39], v[8:11], 0
    v_mfma_f32_16x16x32_bf16 v[184:187], v[40:43], v[8:11], 0
    v_mfma_f32_16x16x32_bf16 v[188:191], v[44:47], v[8:11], 0
    v_mfma_f32_16x16x32_bf16 v[192:195], v[48:51], v[8:11], 0
    v_mfma_f32_16x16x32_bf16 v[196:199], v[52:55], v[8:11], 0
    v_mfma_f32_16x16x32_bf16 v[200:203], v[56:59], v[8:11], 0
    v_mfma_f32_16x16x32_bf16 v[204:207], v[60:63], v[8:11], 0
    v_mfma_f32_16x16x32_bf16 v[208:211], v[64:67], v[8:11], 0
    v_mfma_f32_16x16x32_bf16 v[212:215], v[68:71], v[8:11], 0
    v_mfma_f32_16x16x32_bf16 v[216:219], v[72:75], v[8:11], 0
    v_mfma_f32_16x16x32_bf16 v[220:223], v[76:79], v[8:11], 0
    v_mfma_f32_16x16x32_bf16 v[224:227], v[80:83], v[8:11], 0
    s_and_b32 s35, s24, 1
    s_lshl_b32 s35, s35, 4
    v_lshlrev_b32 v7, 2, v3
    v_sub_u32 v7, v2, v7
    v_add_u32 v7, s35, v7
    v_mov_b32 v6, 0xff800000
    s_movk_i32 s36, 256
    s_nop 4
    v_add_u32 v229, 256, v7
    v_cmp_gt_u32 vcc, s36, v229
    s_nop 1
    v_cndmask_b32 v156, v6, v156, vcc
    v_add_u32 v229, 255, v7
    v_cmp_gt_u32 vcc, s36, v229
    s_nop 1
    v_cndmask_b32 v157, v6, v157, vcc
    v_add_u32 v229, 254, v7
    v_cmp_gt_u32 vcc, s36, v229
    s_nop 1
    v_cndmask_b32 v158, v6, v158, vcc
    v_add_u32 v229, 253, v7
    v_cmp_gt_u32 vcc, s36, v229
    s_nop 1
    v_cndmask_b32 v159, v6, v159, vcc
    v_add_u32 v229, 240, v7
    v_cmp_gt_u32 vcc, s36, v229
    s_nop 1
    v_cndmask_b32 v160, v6, v160, vcc
    v_add_u32 v229, 239, v7
    v_cmp_gt_u32 vcc, s36, v229
    s_nop 1
    v_cndmask_b32 v161, v6, v161, vcc
    v_add_u32 v229, 238, v7
    v_cmp_gt_u32 vcc, s36, v229
    s_nop 1
    v_cndmask_b32 v162, v6, v162, vcc
    v_add_u32 v229, 237, v7
    v_cmp_gt_u32 vcc, s36, v229
    s_nop 1
    v_cndmask_b32 v163, v6, v163, vcc
    v_add_u32 v229, 0, v7
    v_cmp_gt_u32 vcc, s36, v229
    s_nop 1
    v_cndmask_b32 v220, v6, v220, vcc
    v_add_u32 v229, -1, v7
    v_cmp_gt_u32 vcc, s36, v229
    s_nop 1
    v_cndmask_b32 v221, v6, v221, vcc
    v_add_u32 v229, -2, v7
    v_cmp_gt_u32 vcc, s36, v229
    s_nop 1
    v_cndmask_b32 v222, v6, v222, vcc
    v_add_u32 v229, -3, v7
    v_cmp_gt_u32 vcc, s36, v229
    s_nop 1
    v_cndmask_b32 v223, v6, v223, vcc
    v_add_u32 v229, -16, v7
    v_cmp_gt_u32 vcc, s36, v229
    s_nop 1
    v_cndmask_b32 v224, v6, v224, vcc
    v_add_u32 v229, -17, v7
    v_cmp_gt_u32 vcc, s36, v229
    s_nop 1
    v_cndmask_b32 v225, v6, v225, vcc
    v_add_u32 v229, -18, v7
    v_cmp_gt_u32 vcc, s36, v229
    s_nop 1
    v_cndmask_b32 v226, v6, v226, vcc
    v_add_u32 v229, -19, v7
    v_cmp_gt_u32 vcc, s36, v229
    s_nop 1
    v_cndmask_b32 v227, v6, v227, vcc
    s_cmp_ge_u32 s34, 8
    s_cbranch_scc1 mega_kernel_m129
    v_mov_b32 v156, v6
    v_mov_b32 v157, v6
    v_mov_b32 v158, v6
    v_mov_b32 v159, v6
    v_mov_b32 v160, v6
    v_mov_b32 v161, v6
    v_mov_b32 v162, v6
    v_mov_b32 v163, v6
mega_kernel_m129:
    s_cmp_ge_u32 s34, 7
    s_cbranch_scc1 mega_kernel_m130
    v_mov_b32 v164, v6
    v_mov_b32 v165, v6
    v_mov_b32 v166, v6
    v_mov_b32 v167, v6
    v_mov_b32 v168, v6
    v_mov_b32 v169, v6
    v_mov_b32 v170, v6
    v_mov_b32 v171, v6
mega_kernel_m130:
    s_cmp_ge_u32 s34, 6
    s_cbranch_scc1 mega_kernel_m131
    v_mov_b32 v172, v6
    v_mov_b32 v173, v6
    v_mov_b32 v174, v6
    v_mov_b32 v175, v6
    v_mov_b32 v176, v6
    v_mov_b32 v177, v6
    v_mov_b32 v178, v6
    v_mov_b32 v179, v6
mega_kernel_m131:
    s_cmp_ge_u32 s34, 5
    s_cbranch_scc1 mega_kernel_m132
    v_mov_b32 v180, v6
    v_mov_b32 v181, v6
    v_mov_b32 v182, v6
    v_mov_b32 v183, v6
    v_mov_b32 v184, v6
    v_mov_b32 v185, v6
    v_mov_b32 v186, v6
    v_mov_b32 v187, v6
mega_kernel_m132:
    s_cmp_ge_u32 s34, 4
    s_cbranch_scc1 mega_kernel_m133
    v_mov_b32 v188, v6
    v_mov_b32 v189, v6
    v_mov_b32 v190, v6
    v_mov_b32 v191, v6
    v_mov_b32 v192, v6
    v_mov_b32 v193, v6
    v_mov_b32 v194, v6
    v_mov_b32 v195, v6
mega_kernel_m133:
    s_cmp_ge_u32 s34, 3
    s_cbranch_scc1 mega_kernel_m134
    v_mov_b32 v196, v6
    v_mov_b32 v197, v6
    v_mov_b32 v198, v6
    v_mov_b32 v199, v6
    v_mov_b32 v200, v6
    v_mov_b32 v201, v6
    v_mov_b32 v202, v6
    v_mov_b32 v203, v6
mega_kernel_m134:
    s_cmp_ge_u32 s34, 2
    s_cbranch_scc1 mega_kernel_m135
    v_mov_b32 v204, v6
    v_mov_b32 v205, v6
    v_mov_b32 v206, v6
    v_mov_b32 v207, v6
    v_mov_b32 v208, v6
    v_mov_b32 v209, v6
    v_mov_b32 v210, v6
    v_mov_b32 v211, v6
mega_kernel_m135:
    s_cmp_ge_u32 s34, 1
    s_cbranch_scc1 mega_kernel_m136
    v_mov_b32 v212, v6
    v_mov_b32 v213, v6
    v_mov_b32 v214, v6
    v_mov_b32 v215, v6
    v_mov_b32 v216, v6
    v_mov_b32 v217, v6
    v_mov_b32 v218, v6
    v_mov_b32 v219, v6
mega_kernel_m136:
    v_max3_f32 v228, v156, v157, v158
    v_max3_f32 v228, v228, v159, v160
    v_max3_f32 v228, v228, v161, v162
    v_max3_f32 v228, v228, v163, v164
    v_max3_f32 v228, v228, v165, v166
    v_max3_f32 v228, v228, v167, v168
    v_max3_f32 v228, v228, v169, v170
    v_max3_f32 v228, v228, v171, v172
    v_max3_f32 v228, v228, v173, v174
    v_max3_f32 v228, v228, v175, v176
    v_max3_f32 v228, v228, v177, v178
    v_max3_f32 v228, v228, v179, v180
    v_max3_f32 v228, v228, v181, v182
    v_max3_f32 v228, v228, v183, v184
    v_max3_f32 v228, v228, v185, v186
    v_max3_f32 v228, v228, v187, v188
    v_max3_f32 v228, v228, v189, v190
    v_max3_f32 v228, v228, v191, v192
    v_max3_f32 v228, v228, v193, v194
    v_max3_f32 v228, v228, v195, v196
    v_max3_f32 v228, v228, v197, v198
    v_max3_f32 v228, v228, v199, v200
    v_max3_f32 v228, v228, v201, v202
    v_max3_f32 v228, v228, v203, v204
    v_max3_f32 v228, v228, v205, v206
    v_max3_f32 v228, v228, v207, v208
    v_max3_f32 v228, v228, v209, v210
    v_max3_f32 v228, v228, v211, v212
    v_max3_f32 v228, v228, v213, v214
    v_max3_f32 v228, v228, v215, v216
    v_max3_f32 v228, v228, v217, v218
    v_max3_f32 v228, v228, v219, v220
    v_max3_f32 v228, v228, v221, v222
    v_max3_f32 v228, v228, v223, v224
    v_max3_f32 v228, v228, v225, v226
    v_max_f32 v228, v228, v227
    v_mov_b32 v229, v228
    s_nop 1
    v_permlane16_swap_b32 v228, v229
    v_max_f32 v228, v228, v229
    v_mov_b32 v229, v228
    s_nop 1
    v_permlane32_swap_b32 v228, v229
    v_max_f32 v228, v228, v229
    s_mov_b32 s40, 1049335798
    v_mul_f32 v228, s40, v228
    v_sub_f32 v228, 0, v228
    v_fma_f32 v156, v156, s40, v228
    v_fma_f32 v157, v157, s40, v228
    v_fma_f32 v158, v158, s40, v228
    v_fma_f32 v159, v159, s40, v228
    v_fma_f32 v160, v160, s40, v228
    v_fma_f32 v161, v161, s40, v228
    v_fma_f32 v162, v162, s40, v228
    v_fma_f32 v163, v163, s40, v228
    v_fma_f32 v164, v164, s40, v228
    v_fma_f32 v165, v165, s40, v228
    v_fma_f32 v166, v166, s40, v228
    v_fma_f32 v167, v167, s40, v228
    v_fma_f32 v168, v168, s40, v228
    v_fma_f32 v169, v169, s40, v228
    v_fma_f32 v170, v170, s40, v228
    v_fma_f32 v171, v171, s40, v228
    v_fma_f32 v172, v172, s40, v228
    v_fma_f32 v173, v173, s40, v228
    v_fma_f32 v174, v174, s40, v228
    v_fma_f32 v175, v175, s40, v228
    v_fma_f32 v176, v176, s40, v228
    v_fma_f32 v177, v177, s40, v228
    v_fma_f32 v178, v178, s40, v228
    v_fma_f32 v179, v179, s40, v228
    v_fma_f32 v180, v180, s40, v228
    v_fma_f32 v181, v181, s40, v228
    v_fma_f32 v182, v182, s40, v228
    v_fma_f32 v183, v183, s40, v228
    v_fma_f32 v184, v184, s40, v228
    v_fma_f32 v185, v185, s40, v228
    v_fma_f32 v186, v186, s40, v228
    v_fma_f32 v187, v187, s40, v228
    v_fma_f32 v188, v188, s40, v228
    v_fma_f32 v189, v189, s40, v228
    v_fma_f32 v190, v190, s40, v228
    v_fma_f32 v191, v191, s40, v228
    v_fma_f32 v192, v192, s40, v228
    v_fma_f32 v193, v193, s40, v228
    v_fma_f32 v194, v194, s40, v228
    v_fma_f32 v195, v195, s40, v228
    v_fma_f32 v196, v196, s40, v228
    v_fma_f32 v197, v197, s40, v228
    v_fma_f32 v198, v198, s40, v228
    v_fma_f32 v199, v199, s40, v228
    v_fma_f32 v200, v200, s40, v228
    v_fma_f32 v201, v201, s40, v228
    v_fma_f32 v202, v202, s40, v228
    v_fma_f32 v203, v203, s40, v228
    v_fma_f32 v204, v204, s40, v228
    v_fma_f32 v205, v205, s40, v228
    v_fma_f32 v206, v206, s40, v228
    v_fma_f32 v207, v207, s40, v228
    v_fma_f32 v208, v208, s40, v228
    v_fma_f32 v209, v209, s40, v228
    v_fma_f32 v210, v210, s40, v228
    v_fma_f32 v211, v211, s40, v228
    v_fma_f32 v212, v212, s40, v228
    v_fma_f32 v213, v213, s40, v228
    v_fma_f32 v214, v214, s40, v228
    v_fma_f32 v215, v215, s40, v228
    v_fma_f32 v216, v216, s40, v228
    v_fma_f32 v217, v217, s40, v228
    v_fma_f32 v218, v218, s40, v228
    v_fma_f32 v219, v219, s40, v228
    v_fma_f32 v220, v220, s40, v228
    v_fma_f32 v221, v221, s40, v228
    v_fma_f32 v222, v222, s40, v228
    v_fma_f32 v223, v223, s40, v228
    v_fma_f32 v224, v224, s40, v228
    v_fma_f32 v225, v225, s40, v228
    v_fma_f32 v226, v226, s40, v228
    v_fma_f32 v227, v227, s40, v228
    v_exp_f32 v156, v156
    v_exp_f32 v157, v157
    v_exp_f32 v158, v158
    v_exp_f32 v159, v159
    v_exp_f32 v160, v160
    v_exp_f32 v161, v161
    v_exp_f32 v162, v162
    v_exp_f32 v163, v163
    v_exp_f32 v164, v164
    v_exp_f32 v165, v165
    v_exp_f32 v166, v166
    v_exp_f32 v167, v167
    v_exp_f32 v168, v168
    v_exp_f32 v169, v169
    v_exp_f32 v170, v170
    v_exp_f32 v171, v171
    v_exp_f32 v172, v172
    v_exp_f32 v173, v173
    v_exp_f32 v174, v174
    v_exp_f32 v175, v175
    v_exp_f32 v176, v176
    v_exp_f32 v177, v177
    v_exp_f32 v178, v178
    v_exp_f32 v179, v179
    v_exp_f32 v180, v180
    v_exp_f32 v181, v181
    v_exp_f32 v182, v182
    v_exp_f32 v183, v183
    v_exp_f32 v184, v184
    v_exp_f32 v185, v185
    v_exp_f32 v186, v186
    v_exp_f32 v187, v187
    v_exp_f32 v188, v188
    v_exp_f32 v189, v189
    v_exp_f32 v190, v190
    v_exp_f32 v191, v191
    v_exp_f32 v192, v192
    v_exp_f32 v193, v193
    v_exp_f32 v194, v194
    v_exp_f32 v195, v195
    v_exp_f32 v196, v196
    v_exp_f32 v197, v197
    v_exp_f32 v198, v198
    v_exp_f32 v199, v199
    v_exp_f32 v200, v200
    v_exp_f32 v201, v201
    v_exp_f32 v202, v202
    v_exp_f32 v203, v203
    v_exp_f32 v204, v204
    v_exp_f32 v205, v205
    v_exp_f32 v206, v206
    v_exp_f32 v207, v207
    v_exp_f32 v208, v208
    v_exp_f32 v209, v209
    v_exp_f32 v210, v210
    v_exp_f32 v211, v211
    v_exp_f32 v212, v212
    v_exp_f32 v213, v213
    v_exp_f32 v214, v214
    v_exp_f32 v215, v215
    v_exp_f32 v216, v216
    v_exp_f32 v217, v217
    v_exp_f32 v218, v218
    v_exp_f32 v219, v219
    v_exp_f32 v220, v220
    v_exp_f32 v221, v221
    v_exp_f32 v222, v222
    v_exp_f32 v223, v223
    v_exp_f32 v224, v224
    v_exp_f32 v225, v225
    v_exp_f32 v226, v226
    v_exp_f32 v227, v227
    s_nop 0
    v_cvt_pk_bf16_f32 v12, v156, v157
    v_cvt_pk_bf16_f32 v13, v158, v159
    v_cvt_pk_bf16_f32 v14, v160, v161
    v_cvt_pk_bf16_f32 v15, v162, v163
    v_cvt_pk_bf16_f32 v16, v164, v165
    v_cvt_pk_bf16_f32 v17, v166, v167
    v_cvt_pk_bf16_f32 v18, v168, v169
    v_cvt_pk_bf16_f32 v19, v170, v171
    v_cvt_pk_bf16_f32 v20, v172, v173
    v_cvt_pk_bf16_f32 v21, v174, v175
    v_cvt_pk_bf16_f32 v22, v176, v177
    v_cvt_pk_bf16_f32 v23, v178, v179
    v_cvt_pk_bf16_f32 v24, v180, v181
    v_cvt_pk_bf16_f32 v25, v182, v183
    v_cvt_pk_bf16_f32 v26, v184, v185
    v_cvt_pk_bf16_f32 v27, v186, v187
    v_cvt_pk_bf16_f32 v28, v188, v189
    v_cvt_pk_bf16_f32 v29, v190, v191
    v_cvt_pk_bf16_f32 v30, v192, v193
    v_cvt_pk_bf16_f32 v31, v194, v195
    v_cvt_pk_bf16_f32 v32, v196, v197
    v_cvt_pk_bf16_f32 v33, v198, v199
    v_cvt_pk_bf16_f32 v34, v200, v201
    v_cvt_pk_bf16_f32 v35, v202, v203
    v_cvt_pk_bf16_f32 v36, v204, v205
    v_cvt_pk_bf16_f32 v37, v206, v207
    v_cvt_pk_bf16_f32 v38, v208, v209
    v_cvt_pk_bf16_f32 v39, v210, v211
    v_cvt_pk_bf16_f32 v40, v212, v213
    v_cvt_pk_bf16_f32 v41, v214, v215
    v_cvt_pk_bf16_f32 v42, v216, v217
    v_cvt_pk_bf16_f32 v43, v218, v219
    v_cvt_pk_bf16_f32 v44, v220, v221
    v_cvt_pk_bf16_f32 v45, v222, v223
    v_cvt_pk_bf16_f32 v46, v224, v225
    v_cvt_pk_bf16_f32 v47, v226, v227
    v_add_f32 v230, v156, v157
    v_add_f32 v230, v230, v158
    v_add_f32 v230, v230, v159
    v_add_f32 v230, v230, v160
    v_add_f32 v230, v230, v161
    v_add_f32 v230, v230, v162
    v_add_f32 v230, v230, v163
    v_add_f32 v230, v230, v164
    v_add_f32 v230, v230, v165
    v_add_f32 v230, v230, v166
    v_add_f32 v230, v230, v167
    v_add_f32 v230, v230, v168
    v_add_f32 v230, v230, v169
    v_add_f32 v230, v230, v170
    v_add_f32 v230, v230, v171
    v_add_f32 v230, v230, v172
    v_add_f32 v230, v230, v173
    v_add_f32 v230, v230, v174
    v_add_f32 v230, v230, v175
    v_add_f32 v230, v230, v176
    v_add_f32 v230, v230, v177
    v_add_f32 v230, v230, v178
    v_add_f32 v230, v230, v179
    v_add_f32 v230, v230, v180
    v_add_f32 v230, v230, v181
    v_add_f32 v230, v230, v182
    v_add_f32 v230, v230, v183
    v_add_f32 v230, v230, v184
    v_add_f32 v230, v230, v185
    v_add_f32 v230, v230, v186
    v_add_f32 v230, v230, v187
    v_add_f32 v230, v230, v188
    v_add_f32 v230, v230, v189
    v_add_f32 v230, v230, v190
    v_add_f32 v230, v230, v191
    v_add_f32 v230, v230, v192
    v_add_f32 v230, v230, v193
    v_add_f32 v230, v230, v194
    v_add_f32 v230, v230, v195
    v_add_f32 v230, v230, v196
    v_add_f32 v230, v230, v197
    v_add_f32 v230, v230, v198
    v_add_f32 v230, v230, v199
    v_add_f32 v230, v230, v200
    v_add_f32 v230, v230, v201
    v_add_f32 v230, v230, v202
    v_add_f32 v230, v230, v203
    v_add_f32 v230, v230, v204
    v_add_f32 v230, v230, v205
    v_add_f32 v230, v230, v206
    v_add_f32 v230, v230, v207
    v_add_f32 v230, v230, v208
    v_add_f32 v230, v230, v209
    v_add_f32 v230, v230, v210
    v_add_f32 v230, v230, v211
    v_add_f32 v230, v230, v212
    v_add_f32 v230, v230, v213
    v_add_f32 v230, v230, v214
    v_add_f32 v230, v230, v215
    v_add_f32 v230, v230, v216
    v_add_f32 v230, v230, v217
    v_add_f32 v230, v230, v218
    v_add_f32 v230, v230, v219
    v_add_f32 v230, v230, v220
    v_add_f32 v230, v230, v221
    v_add_f32 v230, v230, v222
    v_add_f32 v230, v230, v223
    v_add_f32 v230, v230, v224
    v_add_f32 v230, v230, v225
    v_add_f32 v230, v230, v226
    v_add_f32 v230, v230, v227
    v_mfma_f32_16x16x32_bf16 v[232:235], v[84:87], v[12:15], 0
    v_mfma_f32_16x16x32_bf16 v[236:239], v[88:91], v[12:15], 0
    v_mfma_f32_16x16x32_bf16 v[232:235], v[92:95], v[16:19], v[232:235]
    v_mfma_f32_16x16x32_bf16 v[236:239], v[96:99], v[16:19], v[236:239]
    v_mfma_f32_16x16x32_bf16 v[232:235], v[100:103], v[20:23], v[232:235]
    v_mfma_f32_16x16x32_bf16 v[236:239], v[104:107], v[20:23], v[236:239]
    v_mfma_f32_16x16x32_bf16 v[232:235], v[108:111], v[24:27], v[232:235]
    v_mfma_f32_16x16x32_bf16 v[236:239], v[112:115], v[24:27], v[236:239]
    v_mfma_f32_16x16x32_bf16 v[232:235], v[116:119], v[28:31], v[232:235]
    v_mfma_f32_16x16x32_bf16 v[236:239], v[120:123], v[28:31], v[236:239]
    v_mfma_f32_16x16x32_bf16 v[232:235], v[124:127], v[32:35], v[232:235]
    v_mfma_f32_16x16x32_bf16 v[236:239], v[128:131], v[32:35], v[236:239]
    v_mfma_f32_16x16x32_bf16 v[232:235], v[132:135], v[36:39], v[232:235]
    v_mfma_f32_16x16x32_bf16 v[236:239], v[136:139], v[36:39], v[236:239]
    v_mfma_f32_16x16x32_bf16 v[232:235], v[140:143], v[40:43], v[232:235]
    v_mfma_f32_16x16x32_bf16 v[236:239], v[144:147], v[40:43], v[236:239]
    v_mfma_f32_16x16x32_bf16 v[232:235], v[148:151], v[44:47], v[232:235]
    v_mfma_f32_16x16x32_bf16 v[236:239], v[152:155], v[44:47], v[236:239]
    v_mov_b32 v229, v230
    s_nop 1
    v_permlane16_swap_b32 v230, v229
    v_add_f32 v230, v230, v229
    v_mov_b32 v229, v230
    s_nop 1
    v_permlane32_swap_b32 v230, v229
    v_add_f32 v230, v230, v229
    v_rcp_f32 v230, v230
    s_mul_i32 s29, s25, 28
    v_lshlrev_b32 v4, 2, v3
    v_add_u32 v4, s29, v4
    v_add_u32 v5, 16, v4
    v_lshrrev_b32 v6, 3, v4
    v_lshlrev_b32 v6, 8, v6
    v_bfe_u32 v7, v4, 2, 1
    v_lshl_add_u32 v6, v7, 3, v6
    v_lshl_add_u32 v6, v2, 4, v6
    v_lshrrev_b32 v7, 3, v5
    v_lshlrev_b32 v7, 8, v7
    v_bfe_u32 v4, v5, 2, 1
    v_lshl_add_u32 v7, v4, 3, v7
    v_lshl_add_u32 v7, v2, 4, v7
    s_mul_i32 s29, s24, 14336
    s_add_u32 s29, s29, 24412160
    v_mul_f32 v232, v232, v230
    v_mul_f32 v233, v233, v230
    v_mul_f32 v234, v234, v230
    v_mul_f32 v235, v235, v230
    v_mul_f32 v236, v236, v230
    v_mul_f32 v237, v237, v230
    v_mul_f32 v238, v238, v230
    v_mul_f32 v239, v239, v230
    v_cvt_pk_bf16_f32 v232, v232, v233
    v_cvt_pk_bf16_f32 v233, v234, v235
    v_cvt_pk_bf16_f32 v234, v236, v237
    v_cvt_pk_bf16_f32 v235, v238, v239
    buffer_store_dwordx2 v[232:233], v6, s[20:23], s29 offen sc1
    v_cmp_gt_u32 vcc, 3, v3
    s_and_saveexec_b64 s[32:33], vcc
    buffer_store_dwordx2 v[234:235], v7, s[20:23], s29 offen sc1
    s_mov_b64 exec, -1
    s_waitcnt vmcnt(0)
    s_barrier
    s_cmp_lg_u32 s3, 0
    s_cbranch_scc1 mega_kernel_sg137
    s_lshl_b32 s70, s55, 7
    s_add_u32 s70, s70, 167559168
    v_mov_b32 v6, 1
    v_mov_b32 v7, 0
    s_mov_b64 exec, 1
    buffer_atomic_add v6, v7, s[20:23], s70 offen sc1
    s_mov_b64 exec, -1
mega_kernel_sg137:
    s_add_u32 s55, s55, 3
    s_cmp_lt_u32 s55, 64
    s_cbranch_scc1 a2_loop
    s_endpgm
a3_start:
    v_mul_u32_u24 v7, 896, v2
    v_lshl_add_u32 v7, v3, 4, v7
    s_mul_i32 s28, s3, 100352
    s_add_u32 s28, s28, 1204224
    v_lshlrev_b32 v12, 4, v1
    v_add_u32 v13, 4096, v12
    v_add_u32 v14, 8192, v12
    v_add_u32 v15, 12288, v12
    buffer_load_dwordx4 a[0:3], v12, s[20:23], s28 offen offset:0
    buffer_load_dwordx4 a[4:7], v12, s[20:23], s28 offen offset:1024
    buffer_load_dwordx4 a[8:11], v12, s[20:23], s28 offen offset:2048
    buffer_load_dwordx4 a[12:15], v12, s[20:23], s28 offen offset:3072
    buffer_load_dwordx4 a[16:19], v13, s[20:23], s28 offen offset:0
    buffer_load_dwordx4 a[20:23], v13, s[20:23], s28 offen offset:1024
    buffer_load_dwordx4 a[24:27], v13, s[20:23], s28 offen offset:2048
    buffer_load_dwordx4 a[28:31], v13, s[20:23], s28 offen offset:3072
    buffer_load_dwordx4 a[32:35], v14, s[20:23], s28 offen offset:0
    buffer_load_dwordx4 a[36:39], v14, s[20:23], s28 offen offset:1024
    buffer_load_dwordx4 a[40:43], v14, s[20:23], s28 offen offset:2048
    buffer_load_dwordx4 a[44:47], v14, s[20:23], s28 offen offset:3072
    buffer_load_dwordx4 a[48:51], v15, s[20:23], s28 offen offset:0
    buffer_load_dwordx4 a[52:55], v15, s[20:23], s28 offen offset:1024
    s_add_u32 s28, s28, 14336
    buffer_load_dwordx4 a[56:59], v12, s[20:23], s28 offen offset:0
    buffer_load_dwordx4 a[60:63], v12, s[20:23], s28 offen offset:1024
    buffer_load_dwordx4 a[64:67], v12, s[20:23], s28 offen offset:2048
    buffer_load_dwordx4 a[68:71], v12, s[20:23], s28 offen offset:3072
    buffer_load_dwordx4 a[72:75], v13, s[20:23], s28 offen offset:0
    buffer_load_dwordx4 a[76:79], v13, s[20:23], s28 offen offset:1024
    buffer_load_dwordx4 a[80:83], v13, s[20:23], s28 offen offset:2048
    buffer_load_dwordx4 a[84:87], v13, s[20:23], s28 offen offset:3072
    buffer_load_dwordx4 a[88:91], v14, s[20:23], s28 offen offset:0
    buffer_load_dwordx4 a[92:95], v14, s[20:23], s28 offen offset:1024
    buffer_load_dwordx4 a[96:99], v14, s[20:23], s28 offen offset:2048
    buffer_load_dwordx4 a[100:103], v14, s[20:23], s28 offen offset:3072
    buffer_load_dwordx4 a[104:107], v15, s[20:23], s28 offen offset:0
    buffer_load_dwordx4 a[108:111], v15, s[20:23], s28 offen offset:1024
    s_add_u32 s28, s28, 14336
    buffer_load_dwordx4 a[112:115], v12, s[20:23], s28 offen offset:0
    buffer_load_dwordx4 a[116:119], v12, s[20:23], s28 offen offset:1024
    buffer_load_dwordx4 a[120:123], v12, s[20:23], s28 offen offset:2048
    buffer_load_dwordx4 a[124:127], v12, s[20:23], s28 offen offset:3072
    buffer_load_dwordx4 a[128:131], v13, s[20:23], s28 offen offset:0
    buffer_load_dwordx4 a[132:135], v13, s[20:23], s28 offen offset:1024
    buffer_load_dwordx4 a[136:139], v13, s[20:23], s28 offen offset:2048
    buffer_load_dwordx4 a[140:143], v13, s[20:23], s28 offen offset:3072
    buffer_load_dwordx4 a[144:147], v14, s[20:23], s28 offen offset:0
    buffer_load_dwordx4 a[148:151], v14, s[20:23], s28 offen offset:1024
    buffer_load_dwordx4 a[152:155], v14, s[20:23], s28 offen offset:2048
    buffer_load_dwordx4 a[156:159], v14, s[20:23], s28 offen offset:3072
    buffer_load_dwordx4 a[160:163], v15, s[20:23], s28 offen offset:0
    buffer_load_dwordx4 a[164:167], v15, s[20:23], s28 offen offset:1024
    s_add_u32 s28, s28, 14336
    buffer_load_dwordx4 a[168:171], v12, s[20:23], s28 offen offset:0
    buffer_load_dwordx4 a[172:175], v12, s[20:23], s28 offen offset:1024
    buffer_load_dwordx4 a[176:179], v12, s[20:23], s28 offen offset:2048
    buffer_load_dwordx4 a[180:183], v12, s[20:23], s28 offen offset:3072
    buffer_load_dwordx4 a[184:187], v13, s[20:23], s28 offen offset:0
    buffer_load_dwordx4 a[188:191], v13, s[20:23], s28 offen offset:1024
    buffer_load_dwordx4 a[192:195], v13, s[20:23], s28 offen offset:2048
    buffer_load_dwordx4 a[196:199], v13, s[20:23], s28 offen offset:3072
    buffer_load_dwordx4 a[200:203], v14, s[20:23], s28 offen offset:0
    buffer_load_dwordx4 a[204:207], v14, s[20:23], s28 offen offset:1024
    buffer_load_dwordx4 a[208:211], v14, s[20:23], s28 offen offset:2048
    buffer_load_dwordx4 a[212:215], v14, s[20:23], s28 offen offset:3072
    buffer_load_dwordx4 a[216:219], v15, s[20:23], s28 offen offset:0
    buffer_load_dwordx4 a[220:223], v15, s[20:23], s28 offen offset:1024
    s_add_u32 s28, s28, 14336
    buffer_load_dwordx4 a[224:227], v12, s[20:23], s28 offen offset:0
    buffer_load_dwordx4 a[228:231], v12, s[20:23], s28 offen offset:1024
    buffer_load_dwordx4 a[232:235], v12, s[20:23], s28 offen offset:2048
    buffer_load_dwordx4 a[236:239], v12, s[20:23], s28 offen offset:3072
    buffer_load_dwordx4 a[240:243], v13, s[20:23], s28 offen offset:0
    buffer_load_dwordx4 a[244:247], v13, s[20:23], s28 offen offset:1024
    buffer_load_dwordx4 a[248:251], v13, s[20:23], s28 offen offset:2048
    buffer_load_dwordx4 a[252:255], v13, s[20:23], s28 offen offset:3072
    buffer_load_dwordx4 v[110:113], v14, s[20:23], s28 offen offset:0
    buffer_load_dwordx4 v[114:117], v14, s[20:23], s28 offen offset:1024
    buffer_load_dwordx4 v[118:121], v14, s[20:23], s28 offen offset:2048
    buffer_load_dwordx4 v[122:125], v14, s[20:23], s28 offen offset:3072
    buffer_load_dwordx4 v[126:129], v15, s[20:23], s28 offen offset:0
    buffer_load_dwordx4 v[130:133], v15, s[20:23], s28 offen offset:1024
    s_add_u32 s28, s28, 14336
    buffer_load_dwordx4 v[134:137], v12, s[20:23], s28 offen offset:0
    buffer_load_dwordx4 v[138:141], v12, s[20:23], s28 offen offset:1024
    buffer_load_dwordx4 v[142:145], v12, s[20:23], s28 offen offset:2048
    buffer_load_dwordx4 v[146:149], v12, s[20:23], s28 offen offset:3072
    buffer_load_dwordx4 v[150:153], v13, s[20:23], s28 offen offset:0
    buffer_load_dwordx4 v[154:157], v13, s[20:23], s28 offen offset:1024
    buffer_load_dwordx4 v[158:161], v13, s[20:23], s28 offen offset:2048
    buffer_load_dwordx4 v[162:165], v13, s[20:23], s28 offen offset:3072
    buffer_load_dwordx4 v[166:169], v14, s[20:23], s28 offen offset:0
    buffer_load_dwordx4 v[170:173], v14, s[20:23], s28 offen offset:1024
    buffer_load_dwordx4 v[174:177], v14, s[20:23], s28 offen offset:2048
    buffer_load_dwordx4 v[178:181], v14, s[20:23], s28 offen offset:3072
    buffer_load_dwordx4 v[182:185], v15, s[20:23], s28 offen offset:0
    buffer_load_dwordx4 v[186:189], v15, s[20:23], s28 offen offset:1024
    s_add_u32 s28, s28, 14336
    buffer_load_dwordx4 v[190:193], v12, s[20:23], s28 offen offset:0
    buffer_load_dwordx4 v[194:197], v12, s[20:23], s28 offen offset:1024
    buffer_load_dwordx4 v[198:201], v12, s[20:23], s28 offen offset:2048
    buffer_load_dwordx4 v[202:205], v12, s[20:23], s28 offen offset:3072
    buffer_load_dwordx4 v[206:209], v13, s[20:23], s28 offen offset:0
    buffer_load_dwordx4 v[210:213], v13, s[20:23], s28 offen offset:1024
    buffer_load_dwordx4 v[214:217], v13, s[20:23], s28 offen offset:2048
    buffer_load_dwordx4 v[218:221], v13, s[20:23], s28 offen offset:3072
    buffer_load_dwordx4 v[222:225], v14, s[20:23], s28 offen offset:0
    buffer_load_dwordx4 v[226:229], v14, s[20:23], s28 offen offset:1024
    buffer_load_dwordx4 v[230:233], v14, s[20:23], s28 offen offset:2048
    buffer_load_dwordx4 v[234:237], v14, s[20:23], s28 offen offset:3072
    buffer_load_dwordx4 v[238:241], v15, s[20:23], s28 offen offset:0
    buffer_load_dwordx4 v[242:245], v15, s[20:23], s28 offen offset:1024
a3_loop:
    s_lshr_b32 s24, s2, 1
    v_mov_b32 v7, 0
    s_cmp_lg_u32 s3, 0
    s_cbranch_scc1 mega_kernel_wd139
    s_lshl_b32 s70, s24, 7
    s_add_u32 s70, s70, 167559168
mega_kernel_wc138:
    buffer_load_dword v6, v7, s[20:23], s70 offen sc1
    s_waitcnt vmcnt(0)
    v_readfirstlane_b32 s71, v6
    s_cmp_ge_u32 s71, 8
    s_cbranch_scc1 mega_kernel_wd139
    s_sleep 6
    s_branch mega_kernel_wc138
mega_kernel_wd139:
    s_barrier
    v_mul_u32_u24 v7, 896, v2
    v_lshl_add_u32 v7, v3, 4, v7
    s_mul_i32 s26, s2, 14336
    s_add_u32 s27, s26, 24412160
    v_lshlrev_b32 v106, 4, v1
    v_add_u32 v107, 4096, v106
    v_add_u32 v108, 8192, v106
    v_add_u32 v109, 12288, v106
    buffer_load_dwordx4 v[8:11], v106, s[20:23], s27 offen offset:0 sc1
    buffer_load_dwordx4 v[12:15], v106, s[20:23], s27 offen offset:1024 sc1
    buffer_load_dwordx4 v[16:19], v106, s[20:23], s27 offen offset:2048 sc1
    buffer_load_dwordx4 v[20:23], v106, s[20:23], s27 offen offset:3072 sc1
    buffer_load_dwordx4 v[24:27], v107, s[20:23], s27 offen offset:0 sc1
    buffer_load_dwordx4 v[28:31], v107, s[20:23], s27 offen offset:1024 sc1
    buffer_load_dwordx4 v[32:35], v107, s[20:23], s27 offen offset:2048 sc1
    buffer_load_dwordx4 v[36:39], v107, s[20:23], s27 offen offset:3072 sc1
    buffer_load_dwordx4 v[40:43], v108, s[20:23], s27 offen offset:0 sc1
    buffer_load_dwordx4 v[44:47], v108, s[20:23], s27 offen offset:1024 sc1
    buffer_load_dwordx4 v[48:51], v108, s[20:23], s27 offen offset:2048 sc1
    buffer_load_dwordx4 v[52:55], v108, s[20:23], s27 offen offset:3072 sc1
    buffer_load_dwordx4 v[56:59], v109, s[20:23], s27 offen offset:0 sc1
    buffer_load_dwordx4 v[60:63], v109, s[20:23], s27 offen offset:1024 sc1
    v_mul_u32_u24 v6, 896, v2
    v_lshl_add_u32 v6, v3, 3, v6
    s_mul_i32 s36, s3, 224
    s_add_u32 s37, s26, s36
    s_add_u32 s38, s37, 28082176
    buffer_load_dwordx2 v[92:93], v6, s[20:23], s38 offen offset:0 sc1
    buffer_load_dwordx2 v[94:95], v6, s[20:23], s38 offen offset:32 sc1
    buffer_load_dwordx2 v[96:97], v6, s[20:23], s38 offen offset:64 sc1
    buffer_load_dwordx2 v[98:99], v6, s[20:23], s38 offen offset:96 sc1
    buffer_load_dwordx2 v[100:101], v6, s[20:23], s38 offen offset:128 sc1
    buffer_load_dwordx2 v[102:103], v6, s[20:23], s38 offen offset:160 sc1
    buffer_load_dwordx2 v[104:105], v6, s[20:23], s38 offen offset:192 sc1
    s_waitcnt vmcnt(20)
    v_mfma_f32_16x16x32_bf16 v[64:67], a[0:3], v[8:11], 0
    v_mfma_f32_16x16x32_bf16 v[68:71], a[56:59], v[8:11], 0
    v_mfma_f32_16x16x32_bf16 v[72:75], a[112:115], v[8:11], 0
    v_mfma_f32_16x16x32_bf16 v[76:79], a[168:171], v[8:11], 0
    v_mfma_f32_16x16x32_bf16 v[80:83], a[224:227], v[8:11], 0
    v_mfma_f32_16x16x32_bf16 v[84:87], v[134:137], v[8:11], 0
    v_mfma_f32_16x16x32_bf16 v[88:91], v[190:193], v[8:11], 0
    s_waitcnt vmcnt(19)
    v_mfma_f32_16x16x32_bf16 v[64:67], a[4:7], v[12:15], v[64:67]
    v_mfma_f32_16x16x32_bf16 v[68:71], a[60:63], v[12:15], v[68:71]
    v_mfma_f32_16x16x32_bf16 v[72:75], a[116:119], v[12:15], v[72:75]
    v_mfma_f32_16x16x32_bf16 v[76:79], a[172:175], v[12:15], v[76:79]
    v_mfma_f32_16x16x32_bf16 v[80:83], a[228:231], v[12:15], v[80:83]
    v_mfma_f32_16x16x32_bf16 v[84:87], v[138:141], v[12:15], v[84:87]
    v_mfma_f32_16x16x32_bf16 v[88:91], v[194:197], v[12:15], v[88:91]
    s_waitcnt vmcnt(18)
    v_mfma_f32_16x16x32_bf16 v[64:67], a[8:11], v[16:19], v[64:67]
    v_mfma_f32_16x16x32_bf16 v[68:71], a[64:67], v[16:19], v[68:71]
    v_mfma_f32_16x16x32_bf16 v[72:75], a[120:123], v[16:19], v[72:75]
    v_mfma_f32_16x16x32_bf16 v[76:79], a[176:179], v[16:19], v[76:79]
    v_mfma_f32_16x16x32_bf16 v[80:83], a[232:235], v[16:19], v[80:83]
    v_mfma_f32_16x16x32_bf16 v[84:87], v[142:145], v[16:19], v[84:87]
    v_mfma_f32_16x16x32_bf16 v[88:91], v[198:201], v[16:19], v[88:91]
    s_waitcnt vmcnt(17)
    v_mfma_f32_16x16x32_bf16 v[64:67], a[12:15], v[20:23], v[64:67]
    v_mfma_f32_16x16x32_bf16 v[68:71], a[68:71], v[20:23], v[68:71]
    v_mfma_f32_16x16x32_bf16 v[72:75], a[124:127], v[20:23], v[72:75]
    v_mfma_f32_16x16x32_bf16 v[76:79], a[180:183], v[20:23], v[76:79]
    v_mfma_f32_16x16x32_bf16 v[80:83], a[236:239], v[20:23], v[80:83]
    v_mfma_f32_16x16x32_bf16 v[84:87], v[146:149], v[20:23], v[84:87]
    v_mfma_f32_16x16x32_bf16 v[88:91], v[202:205], v[20:23], v[88:91]
    s_waitcnt vmcnt(16)
    v_mfma_f32_16x16x32_bf16 v[64:67], a[16:19], v[24:27], v[64:67]
    v_mfma_f32_16x16x32_bf16 v[68:71], a[72:75], v[24:27], v[68:71]
    v_mfma_f32_16x16x32_bf16 v[72:75], a[128:131], v[24:27], v[72:75]
    v_mfma_f32_16x16x32_bf16 v[76:79], a[184:187], v[24:27], v[76:79]
    v_mfma_f32_16x16x32_bf16 v[80:83], a[240:243], v[24:27], v[80:83]
    v_mfma_f32_16x16x32_bf16 v[84:87], v[150:153], v[24:27], v[84:87]
    v_mfma_f32_16x16x32_bf16 v[88:91], v[206:209], v[24:27], v[88:91]
    s_waitcnt vmcnt(15)
    v_mfma_f32_16x16x32_bf16 v[64:67], a[20:23], v[28:31], v[64:67]
    v_mfma_f32_16x16x32_bf16 v[68:71], a[76:79], v[28:31], v[68:71]
    v_mfma_f32_16x16x32_bf16 v[72:75], a[132:135], v[28:31], v[72:75]
    v_mfma_f32_16x16x32_bf16 v[76:79], a[188:191], v[28:31], v[76:79]
    v_mfma_f32_16x16x32_bf16 v[80:83], a[244:247], v[28:31], v[80:83]
    v_mfma_f32_16x16x32_bf16 v[84:87], v[154:157], v[28:31], v[84:87]
    v_mfma_f32_16x16x32_bf16 v[88:91], v[210:213], v[28:31], v[88:91]
    s_waitcnt vmcnt(14)
    v_mfma_f32_16x16x32_bf16 v[64:67], a[24:27], v[32:35], v[64:67]
    v_mfma_f32_16x16x32_bf16 v[68:71], a[80:83], v[32:35], v[68:71]
    v_mfma_f32_16x16x32_bf16 v[72:75], a[136:139], v[32:35], v[72:75]
    v_mfma_f32_16x16x32_bf16 v[76:79], a[192:195], v[32:35], v[76:79]
    v_mfma_f32_16x16x32_bf16 v[80:83], a[248:251], v[32:35], v[80:83]
    v_mfma_f32_16x16x32_bf16 v[84:87], v[158:161], v[32:35], v[84:87]
    v_mfma_f32_16x16x32_bf16 v[88:91], v[214:217], v[32:35], v[88:91]
    s_waitcnt vmcnt(13)
    v_mfma_f32_16x16x32_bf16 v[64:67], a[28:31], v[36:39], v[64:67]
    v_mfma_f32_16x16x32_bf16 v[68:71], a[84:87], v[36:39], v[68:71]
    v_mfma_f32_16x16x32_bf16 v[72:75], a[140:143], v[36:39], v[72:75]
    v_mfma_f32_16x16x32_bf16 v[76:79], a[196:199], v[36:39], v[76:79]
    v_mfma_f32_16x16x32_bf16 v[80:83], a[252:255], v[36:39], v[80:83]
    v_mfma_f32_16x16x32_bf16 v[84:87], v[162:165], v[36:39], v[84:87]
    v_mfma_f32_16x16x32_bf16 v[88:91], v[218:221], v[36:39], v[88:91]
    s_waitcnt vmcnt(12)
    v_mfma_f32_16x16x32_bf16 v[64:67], a[32:35], v[40:43], v[64:67]
    v_mfma_f32_16x16x32_bf16 v[68:71], a[88:91], v[40:43], v[68:71]
    v_mfma_f32_16x16x32_bf16 v[72:75], a[144:147], v[40:43], v[72:75]
    v_mfma_f32_16x16x32_bf16 v[76:79], a[200:203], v[40:43], v[76:79]
    v_mfma_f32_16x16x32_bf16 v[80:83], v[110:113], v[40:43], v[80:83]
    v_mfma_f32_16x16x32_bf16 v[84:87], v[166:169], v[40:43], v[84:87]
    v_mfma_f32_16x16x32_bf16 v[88:91], v[222:225], v[40:43], v[88:91]
    s_waitcnt vmcnt(11)
    v_mfma_f32_16x16x32_bf16 v[64:67], a[36:39], v[44:47], v[64:67]
    v_mfma_f32_16x16x32_bf16 v[68:71], a[92:95], v[44:47], v[68:71]
    v_mfma_f32_16x16x32_bf16 v[72:75], a[148:151], v[44:47], v[72:75]
    v_mfma_f32_16x16x32_bf16 v[76:79], a[204:207], v[44:47], v[76:79]
    v_mfma_f32_16x16x32_bf16 v[80:83], v[114:117], v[44:47], v[80:83]
    v_mfma_f32_16x16x32_bf16 v[84:87], v[170:173], v[44:47], v[84:87]
    v_mfma_f32_16x16x32_bf16 v[88:91], v[226:229], v[44:47], v[88:91]
    s_waitcnt vmcnt(10)
    v_mfma_f32_16x16x32_bf16 v[64:67], a[40:43], v[48:51], v[64:67]
    v_mfma_f32_16x16x32_bf16 v[68:71], a[96:99], v[48:51], v[68:71]
    v_mfma_f32_16x16x32_bf16 v[72:75], a[152:155], v[48:51], v[72:75]
    v_mfma_f32_16x16x32_bf16 v[76:79], a[208:211], v[48:51], v[76:79]
    v_mfma_f32_16x16x32_bf16 v[80:83], v[118:121], v[48:51], v[80:83]
    v_mfma_f32_16x16x32_bf16 v[84:87], v[174:177], v[48:51], v[84:87]
    v_mfma_f32_16x16x32_bf16 v[88:91], v[230:233], v[48:51], v[88:91]
    s_waitcnt vmcnt(9)
    v_mfma_f32_16x16x32_bf16 v[64:67], a[44:47], v[52:55], v[64:67]
    v_mfma_f32_16x16x32_bf16 v[68:71], a[100:103], v[52:55], v[68:71]
    v_mfma_f32_16x16x32_bf16 v[72:75], a[156:159], v[52:55], v[72:75]
    v_mfma_f32_16x16x32_bf16 v[76:79], a[212:215], v[52:55], v[76:79]
    v_mfma_f32_16x16x32_bf16 v[80:83], v[122:125], v[52:55], v[80:83]
    v_mfma_f32_16x16x32_bf16 v[84:87], v[178:181], v[52:55], v[84:87]
    v_mfma_f32_16x16x32_bf16 v[88:91], v[234:237], v[52:55], v[88:91]
    s_waitcnt vmcnt(8)
    v_mfma_f32_16x16x32_bf16 v[64:67], a[48:51], v[56:59], v[64:67]
    v_mfma_f32_16x16x32_bf16 v[68:71], a[104:107], v[56:59], v[68:71]
    v_mfma_f32_16x16x32_bf16 v[72:75], a[160:163], v[56:59], v[72:75]
    v_mfma_f32_16x16x32_bf16 v[76:79], a[216:219], v[56:59], v[76:79]
    v_mfma_f32_16x16x32_bf16 v[80:83], v[126:129], v[56:59], v[80:83]
    v_mfma_f32_16x16x32_bf16 v[84:87], v[182:185], v[56:59], v[84:87]
    v_mfma_f32_16x16x32_bf16 v[88:91], v[238:241], v[56:59], v[88:91]
    s_waitcnt vmcnt(7)
    v_mfma_f32_16x16x32_bf16 v[64:67], a[52:55], v[60:63], v[64:67]
    v_mfma_f32_16x16x32_bf16 v[68:71], a[108:111], v[60:63], v[68:71]
    v_mfma_f32_16x16x32_bf16 v[72:75], a[164:167], v[60:63], v[72:75]
    v_mfma_f32_16x16x32_bf16 v[76:79], a[220:223], v[60:63], v[76:79]
    v_mfma_f32_16x16x32_bf16 v[80:83], v[130:133], v[60:63], v[80:83]
    v_mfma_f32_16x16x32_bf16 v[84:87], v[186:189], v[60:63], v[84:87]
    v_mfma_f32_16x16x32_bf16 v[88:91], v[242:245], v[60:63], v[88:91]
    s_waitcnt vmcnt(0)
    s_nop 7
    v_cvt_pk_bf16_f32 v64, v64, v65
    v_cvt_pk_bf16_f32 v65, v66, v67
    v_lshlrev_b32 v50, 16, v64
    v_and_b32 v51, 0xffff0000, v64
    v_lshlrev_b32 v52, 16, v92
    v_and_b32 v53, 0xffff0000, v92
    v_add_f32 v50, v50, v52
    v_add_f32 v51, v51, v53
    v_cvt_pk_bf16_f32 v36, v50, v51
    v_lshlrev_b32 v8, 16, v36
    v_and_b32 v9, 0xffff0000, v36
    v_lshlrev_b32 v50, 16, v65
    v_and_b32 v51, 0xffff0000, v65
    v_lshlrev_b32 v52, 16, v93
    v_and_b32 v53, 0xffff0000, v93
    v_add_f32 v50, v50, v52
    v_add_f32 v51, v51, v53
    v_cvt_pk_bf16_f32 v37, v50, v51
    v_lshlrev_b32 v10, 16, v37
    v_and_b32 v11, 0xffff0000, v37
    v_cvt_pk_bf16_f32 v68, v68, v69
    v_cvt_pk_bf16_f32 v69, v70, v71
    v_lshlrev_b32 v50, 16, v68
    v_and_b32 v51, 0xffff0000, v68
    v_lshlrev_b32 v52, 16, v94
    v_and_b32 v53, 0xffff0000, v94
    v_add_f32 v50, v50, v52
    v_add_f32 v51, v51, v53
    v_cvt_pk_bf16_f32 v38, v50, v51
    v_lshlrev_b32 v12, 16, v38
    v_and_b32 v13, 0xffff0000, v38
    v_lshlrev_b32 v50, 16, v69
    v_and_b32 v51, 0xffff0000, v69
    v_lshlrev_b32 v52, 16, v95
    v_and_b32 v53, 0xffff0000, v95
    v_add_f32 v50, v50, v52
    v_add_f32 v51, v51, v53
    v_cvt_pk_bf16_f32 v39, v50, v51
    v_lshlrev_b32 v14, 16, v39
    v_and_b32 v15, 0xffff0000, v39
    v_cvt_pk_bf16_f32 v72, v72, v73
    v_cvt_pk_bf16_f32 v73, v74, v75
    v_lshlrev_b32 v50, 16, v72
    v_and_b32 v51, 0xffff0000, v72
    v_lshlrev_b32 v52, 16, v96
    v_and_b32 v53, 0xffff0000, v96
    v_add_f32 v50, v50, v52
    v_add_f32 v51, v51, v53
    v_cvt_pk_bf16_f32 v40, v50, v51
    v_lshlrev_b32 v16, 16, v40
    v_and_b32 v17, 0xffff0000, v40
    v_lshlrev_b32 v50, 16, v73
    v_and_b32 v51, 0xffff0000, v73
    v_lshlrev_b32 v52, 16, v97
    v_and_b32 v53, 0xffff0000, v97
    v_add_f32 v50, v50, v52
    v_add_f32 v51, v51, v53
    v_cvt_pk_bf16_f32 v41, v50, v51
    v_lshlrev_b32 v18, 16, v41
    v_and_b32 v19, 0xffff0000, v41
    v_cvt_pk_bf16_f32 v76, v76, v77
    v_cvt_pk_bf16_f32 v77, v78, v79
    v_lshlrev_b32 v50, 16, v76
    v_and_b32 v51, 0xffff0000, v76
    v_lshlrev_b32 v52, 16, v98
    v_and_b32 v53, 0xffff0000, v98
    v_add_f32 v50, v50, v52
    v_add_f32 v51, v51, v53
    v_cvt_pk_bf16_f32 v42, v50, v51
    v_lshlrev_b32 v20, 16, v42
    v_and_b32 v21, 0xffff0000, v42
    v_lshlrev_b32 v50, 16, v77
    v_and_b32 v51, 0xffff0000, v77
    v_lshlrev_b32 v52, 16, v99
    v_and_b32 v53, 0xffff0000, v99
    v_add_f32 v50, v50, v52
    v_add_f32 v51, v51, v53
    v_cvt_pk_bf16_f32 v43, v50, v51
    v_lshlrev_b32 v22, 16, v43
    v_and_b32 v23, 0xffff0000, v43
    v_cvt_pk_bf16_f32 v80, v80, v81
    v_cvt_pk_bf16_f32 v81, v82, v83
    v_lshlrev_b32 v50, 16, v80
    v_and_b32 v51, 0xffff0000, v80
    v_lshlrev_b32 v52, 16, v100
    v_and_b32 v53, 0xffff0000, v100
    v_add_f32 v50, v50, v52
    v_add_f32 v51, v51, v53
    v_cvt_pk_bf16_f32 v44, v50, v51
    v_lshlrev_b32 v24, 16, v44
    v_and_b32 v25, 0xffff0000, v44
    v_lshlrev_b32 v50, 16, v81
    v_and_b32 v51, 0xffff0000, v81
    v_lshlrev_b32 v52, 16, v101
    v_and_b32 v53, 0xffff0000, v101
    v_add_f32 v50, v50, v52
    v_add_f32 v51, v51, v53
    v_cvt_pk_bf16_f32 v45, v50, v51
    v_lshlrev_b32 v26, 16, v45
    v_and_b32 v27, 0xffff0000, v45
    v_cvt_pk_bf16_f32 v84, v84, v85
    v_cvt_pk_bf16_f32 v85, v86, v87
    v_lshlrev_b32 v50, 16, v84
    v_and_b32 v51, 0xffff0000, v84
    v_lshlrev_b32 v52, 16, v102
    v_and_b32 v53, 0xffff0000, v102
    v_add_f32 v50, v50, v52
    v_add_f32 v51, v51, v53
    v_cvt_pk_bf16_f32 v46, v50, v51
    v_lshlrev_b32 v28, 16, v46
    v_and_b32 v29, 0xffff0000, v46
    v_lshlrev_b32 v50, 16, v85
    v_and_b32 v51, 0xffff0000, v85
    v_lshlrev_b32 v52, 16, v103
    v_and_b32 v53, 0xffff0000, v103
    v_add_f32 v50, v50, v52
    v_add_f32 v51, v51, v53
    v_cvt_pk_bf16_f32 v47, v50, v51
    v_lshlrev_b32 v30, 16, v47
    v_and_b32 v31, 0xffff0000, v47
    v_cvt_pk_bf16_f32 v88, v88, v89
    v_cvt_pk_bf16_f32 v89, v90, v91
    v_lshlrev_b32 v50, 16, v88
    v_and_b32 v51, 0xffff0000, v88
    v_lshlrev_b32 v52, 16, v104
    v_and_b32 v53, 0xffff0000, v104
    v_add_f32 v50, v50, v52
    v_add_f32 v51, v51, v53
    v_cvt_pk_bf16_f32 v48, v50, v51
    v_lshlrev_b32 v32, 16, v48
    v_and_b32 v33, 0xffff0000, v48
    v_lshlrev_b32 v50, 16, v89
    v_and_b32 v51, 0xffff0000, v89
    v_lshlrev_b32 v52, 16, v105
    v_and_b32 v53, 0xffff0000, v105
    v_add_f32 v50, v50, v52
    v_add_f32 v51, v51, v53
    v_cvt_pk_bf16_f32 v49, v50, v51
    v_lshlrev_b32 v34, 16, v49
    v_and_b32 v35, 0xffff0000, v49
    s_add_u32 s38, s37, 29917184
    buffer_store_dwordx2 v[36:37], v6, s[20:23], s38 offen offset:0 sc1
    buffer_store_dwordx2 v[38:39], v6, s[20:23], s38 offen offset:32 sc1
    buffer_store_dwordx2 v[40:41], v6, s[20:23], s38 offen offset:64 sc1
    buffer_store_dwordx2 v[42:43], v6, s[20:23], s38 offen offset:96 sc1
    buffer_store_dwordx2 v[44:45], v6, s[20:23], s38 offen offset:128 sc1
    buffer_store_dwordx2 v[46:47], v6, s[20:23], s38 offen offset:160 sc1
    buffer_store_dwordx2 v[48:49], v6, s[20:23], s38 offen offset:192 sc1
    v_lshlrev_b32 v57, 2, v2
    s_lshl_b32 s39, s3, 6
    v_add_u32 v56, s39, v57
    v_add_f32 v54, v8, v9
    v_add_f32 v54, v54, v10
    v_add_f32 v54, v54, v11
    v_add_f32 v54, v54, v12
    v_add_f32 v54, v54, v13
    v_add_f32 v54, v54, v14
    v_add_f32 v54, v54, v15
    v_add_f32 v54, v54, v16
    v_add_f32 v54, v54, v17
    v_add_f32 v54, v54, v18
    v_add_f32 v54, v54, v19
    v_add_f32 v54, v54, v20
    v_add_f32 v54, v54, v21
    v_add_f32 v54, v54, v22
    v_add_f32 v54, v54, v23
    v_add_f32 v54, v54, v24
    v_add_f32 v54, v54, v25
    v_add_f32 v54, v54, v26
    v_add_f32 v54, v54, v27
    v_add_f32 v54, v54, v28
    v_add_f32 v54, v54, v29
    v_add_f32 v54, v54, v30
    v_add_f32 v54, v54, v31
    v_add_f32 v54, v54, v32
    v_add_f32 v54, v54, v33
    v_add_f32 v54, v54, v34
    v_add_f32 v54, v54, v35
    v_mov_b32 v55, v54
    s_nop 1
    v_permlane16_swap_b32 v54, v55
    v_add_f32 v54, v54, v55
    v_mov_b32 v55, v54
    s_nop 1
    v_permlane32_swap_b32 v54, v55
    v_add_f32 v54, v54, v55
    ds_write_b32 v56, v54 offset:0
    s_waitcnt lgkmcnt(0)
    s_barrier
    ds_read_b32 v54, v57 offset:0
    ds_read_b32 v55, v57 offset:64
    ds_read_b32 v58, v57 offset:128
    ds_read_b32 v59, v57 offset:192
    s_waitcnt lgkmcnt(0)
    v_add_f32 v54, v54, v55
    v_add_f32 v58, v58, v59
    v_add_f32 v54, v54, v58
    v_mul_f32 v54, 0x3b124925, v54
    v_mov_b32 v60, 0
    v_sub_f32 v61, v8, v54
    v_fmac_f32 v60, v61, v61
    v_sub_f32 v61, v9, v54
    v_fmac_f32 v60, v61, v61
    v_sub_f32 v61, v10, v54
    v_fmac_f32 v60, v61, v61
    v_sub_f32 v61, v11, v54
    v_fmac_f32 v60, v61, v61
    v_sub_f32 v61, v12, v54
    v_fmac_f32 v60, v61, v61
    v_sub_f32 v61, v13, v54
    v_fmac_f32 v60, v61, v61
    v_sub_f32 v61, v14, v54
    v_fmac_f32 v60, v61, v61
    v_sub_f32 v61, v15, v54
    v_fmac_f32 v60, v61, v61
    v_sub_f32 v61, v16, v54
    v_fmac_f32 v60, v61, v61
    v_sub_f32 v61, v17, v54
    v_fmac_f32 v60, v61, v61
    v_sub_f32 v61, v18, v54
    v_fmac_f32 v60, v61, v61
    v_sub_f32 v61, v19, v54
    v_fmac_f32 v60, v61, v61
    v_sub_f32 v61, v20, v54
    v_fmac_f32 v60, v61, v61
    v_sub_f32 v61, v21, v54
    v_fmac_f32 v60, v61, v61
    v_sub_f32 v61, v22, v54
    v_fmac_f32 v60, v61, v61
    v_sub_f32 v61, v23, v54
    v_fmac_f32 v60, v61, v61
    v_sub_f32 v61, v24, v54
    v_fmac_f32 v60, v61, v61
    v_sub_f32 v61, v25, v54
    v_fmac_f32 v60, v61, v61
    v_sub_f32 v61, v26, v54
    v_fmac_f32 v60, v61, v61
    v_sub_f32 v61, v27, v54
    v_fmac_f32 v60, v61, v61
    v_sub_f32 v61, v28, v54
    v_fmac_f32 v60, v61, v61
    v_sub_f32 v61, v29, v54
    v_fmac_f32 v60, v61, v61
    v_sub_f32 v61, v30, v54
    v_fmac_f32 v60, v61, v61
    v_sub_f32 v61, v31, v54
    v_fmac_f32 v60, v61, v61
    v_sub_f32 v61, v32, v54
    v_fmac_f32 v60, v61, v61
    v_sub_f32 v61, v33, v54
    v_fmac_f32 v60, v61, v61
    v_sub_f32 v61, v34, v54
    v_fmac_f32 v60, v61, v61
    v_sub_f32 v61, v35, v54
    v_fmac_f32 v60, v61, v61
    v_mov_b32 v55, v60
    s_nop 1
    v_permlane16_swap_b32 v60, v55
    v_add_f32 v60, v60, v55
    v_mov_b32 v55, v60
    s_nop 1
    v_permlane32_swap_b32 v60, v55
    v_add_f32 v60, v60, v55
    ds_write_b32 v56, v60 offset:256
    s_waitcnt lgkmcnt(0)
    s_barrier
    ds_read_b32 v60, v57 offset:256
    ds_read_b32 v55, v57 offset:320
    ds_read_b32 v58, v57 offset:384
    ds_read_b32 v59, v57 offset:448
    s_waitcnt lgkmcnt(0)
    v_add_f32 v60, v60, v55
    v_add_f32 v58, v58, v59
    v_add_f32 v60, v60, v58
    v_mul_f32 v60, 0x3b124925, v60
    v_cvt_pk_bf16_f32 v54, v54, v54
    v_and_b32 v54, 0xffff0000, v54
    v_cvt_pk_bf16_f32 v60, v60, v60
    v_and_b32 v60, 0xffff0000, v60
    v_add_f32 v60, 0x3727c5ac, v60
    v_cvt_pk_bf16_f32 v60, v60, v60
    v_and_b32 v60, 0xffff0000, v60
    v_sqrt_f32 v60, v60
    s_nop 0
    v_cvt_pk_bf16_f32 v60, v60, v60
    v_and_b32 v60, 0xffff0000, v60
    v_rcp_f32 v60, v60
    s_nop 0
    v_sub_f32 v8, v8, v54
    v_sub_f32 v9, v9, v54
    v_sub_f32 v10, v10, v54
    v_sub_f32 v11, v11, v54
    v_sub_f32 v12, v12, v54
    v_sub_f32 v13, v13, v54
    v_sub_f32 v14, v14, v54
    v_sub_f32 v15, v15, v54
    v_sub_f32 v16, v16, v54
    v_sub_f32 v17, v17, v54
    v_sub_f32 v18, v18, v54
    v_sub_f32 v19, v19, v54
    v_sub_f32 v20, v20, v54
    v_sub_f32 v21, v21, v54
    v_sub_f32 v22, v22, v54
    v_sub_f32 v23, v23, v54
    v_sub_f32 v24, v24, v54
    v_sub_f32 v25, v25, v54
    v_sub_f32 v26, v26, v54
    v_sub_f32 v27, v27, v54
    v_sub_f32 v28, v28, v54
    v_sub_f32 v29, v29, v54
    v_sub_f32 v30, v30, v54
    v_sub_f32 v31, v31, v54
    v_sub_f32 v32, v32, v54
    v_sub_f32 v33, v33, v54
    v_sub_f32 v34, v34, v54
    v_sub_f32 v35, v35, v54
    v_cvt_pk_bf16_f32 v36, v8, v9
    v_lshlrev_b32 v8, 16, v36
    v_and_b32 v9, 0xffff0000, v36
    v_cvt_pk_bf16_f32 v37, v10, v11
    v_lshlrev_b32 v10, 16, v37
    v_and_b32 v11, 0xffff0000, v37
    v_cvt_pk_bf16_f32 v38, v12, v13
    v_lshlrev_b32 v12, 16, v38
    v_and_b32 v13, 0xffff0000, v38
    v_cvt_pk_bf16_f32 v39, v14, v15
    v_lshlrev_b32 v14, 16, v39
    v_and_b32 v15, 0xffff0000, v39
    v_cvt_pk_bf16_f32 v40, v16, v17
    v_lshlrev_b32 v16, 16, v40
    v_and_b32 v17, 0xffff0000, v40
    v_cvt_pk_bf16_f32 v41, v18, v19
    v_lshlrev_b32 v18, 16, v41
    v_and_b32 v19, 0xffff0000, v41
    v_cvt_pk_bf16_f32 v42, v20, v21
    v_lshlrev_b32 v20, 16, v42
    v_and_b32 v21, 0xffff0000, v42
    v_cvt_pk_bf16_f32 v43, v22, v23
    v_lshlrev_b32 v22, 16, v43
    v_and_b32 v23, 0xffff0000, v43
    v_cvt_pk_bf16_f32 v44, v24, v25
    v_lshlrev_b32 v24, 16, v44
    v_and_b32 v25, 0xffff0000, v44
    v_cvt_pk_bf16_f32 v45, v26, v27
    v_lshlrev_b32 v26, 16, v45
    v_and_b32 v27, 0xffff0000, v45
    v_cvt_pk_bf16_f32 v46, v28, v29
    v_lshlrev_b32 v28, 16, v46
    v_and_b32 v29, 0xffff0000, v46
    v_cvt_pk_bf16_f32 v47, v30, v31
    v_lshlrev_b32 v30, 16, v47
    v_and_b32 v31, 0xffff0000, v47
    v_cvt_pk_bf16_f32 v48, v32, v33
    v_lshlrev_b32 v32, 16, v48
    v_and_b32 v33, 0xffff0000, v48
    v_cvt_pk_bf16_f32 v49, v34, v35
    v_lshlrev_b32 v34, 16, v49
    v_and_b32 v35, 0xffff0000, v49
    v_mul_f32 v8, v8, v60
    v_mul_f32 v9, v9, v60
    v_mul_f32 v10, v10, v60
    v_mul_f32 v11, v11, v60
    v_mul_f32 v12, v12, v60
    v_mul_f32 v13, v13, v60
    v_mul_f32 v14, v14, v60
    v_mul_f32 v15, v15, v60
    v_mul_f32 v16, v16, v60
    v_mul_f32 v17, v17, v60
    v_mul_f32 v18, v18, v60
    v_mul_f32 v19, v19, v60
    v_mul_f32 v20, v20, v60
    v_mul_f32 v21, v21, v60
    v_mul_f32 v22, v22, v60
    v_mul_f32 v23, v23, v60
    v_mul_f32 v24, v24, v60
    v_mul_f32 v25, v25, v60
    v_mul_f32 v26, v26, v60
    v_mul_f32 v27, v27, v60
    v_mul_f32 v28, v28, v60
    v_mul_f32 v29, v29, v60
    v_mul_f32 v30, v30, v60
    v_mul_f32 v31, v31, v60
    v_mul_f32 v32, v32, v60
    v_mul_f32 v33, v33, v60
    v_mul_f32 v34, v34, v60
    v_mul_f32 v35, v35, v60
    v_cvt_pk_bf16_f32 v36, v8, v9
    v_cvt_pk_bf16_f32 v37, v10, v11
    v_cvt_pk_bf16_f32 v38, v12, v13
    v_cvt_pk_bf16_f32 v39, v14, v15
    v_cvt_pk_bf16_f32 v40, v16, v17
    v_cvt_pk_bf16_f32 v41, v18, v19
    v_cvt_pk_bf16_f32 v42, v20, v21
    v_cvt_pk_bf16_f32 v43, v22, v23
    v_cvt_pk_bf16_f32 v44, v24, v25
    v_cvt_pk_bf16_f32 v45, v26, v27
    v_cvt_pk_bf16_f32 v46, v28, v29
    v_cvt_pk_bf16_f32 v47, v30, v31
    v_cvt_pk_bf16_f32 v48, v32, v33
    v_cvt_pk_bf16_f32 v49, v34, v35
    s_add_u32 s38, s37, 33587200
    buffer_store_dwordx2 v[36:37], v6, s[20:23], s38 offen offset:0 sc1
    buffer_store_dwordx2 v[38:39], v6, s[20:23], s38 offen offset:32 sc1
    buffer_store_dwordx2 v[40:41], v6, s[20:23], s38 offen offset:64 sc1
    buffer_store_dwordx2 v[42:43], v6, s[20:23], s38 offen offset:96 sc1
    buffer_store_dwordx2 v[44:45], v6, s[20:23], s38 offen offset:128 sc1
    buffer_store_dwordx2 v[46:47], v6, s[20:23], s38 offen offset:160 sc1
    buffer_store_dwordx2 v[48:49], v6, s[20:23], s38 offen offset:192 sc1
    s_waitcnt vmcnt(0)
    s_barrier
    s_cmp_lg_u32 s3, 0
    s_cbranch_scc1 mega_kernel_sg140
    s_lshl_b32 s70, s24, 7
    s_add_u32 s70, s70, 167567360
    v_mov_b32 v6, 1
    v_mov_b32 v7, 0
    s_mov_b64 exec, 1
    buffer_atomic_add v6, v7, s[20:23], s70 offen sc1
    s_mov_b64 exec, -1
mega_kernel_sg140:
    s_add_u32 s2, s2, 8
    s_cmp_lt_u32 s2, 128
    s_cbranch_scc1 a3_loop
    s_endpgm
    s_endpgm
.section .rodata,"a"
.p2align 6
.amdhsa_kernel k1_kernel
  .amdhsa_next_free_vgpr 144
  .amdhsa_next_free_sgpr 60
  .amdhsa_accum_offset 144
  .amdhsa_group_segment_fixed_size 0
  .amdhsa_kernarg_size 104
  .amdhsa_user_sgpr_count 2
  .amdhsa_user_sgpr_kernarg_segment_ptr 1
  .amdhsa_system_sgpr_workgroup_id_x 1
.end_amdhsa_kernel
.p2align 6
.amdhsa_kernel k2_kernel
  .amdhsa_next_free_vgpr 256
  .amdhsa_next_free_sgpr 60
  .amdhsa_accum_offset 256
  .amdhsa_group_segment_fixed_size 0
  .amdhsa_kernarg_size 104
  .amdhsa_user_sgpr_count 2
  .amdhsa_user_sgpr_kernarg_segment_ptr 1
  .amdhsa_system_sgpr_workgroup_id_x 1
.end_amdhsa_kernel
.p2align 6
.amdhsa_kernel k3_kernel
  .amdhsa_next_free_vgpr 248
  .amdhsa_next_free_sgpr 80
  .amdhsa_accum_offset 248
  .amdhsa_group_segment_fixed_size 0
  .amdhsa_kernarg_size 104
  .amdhsa_user_sgpr_count 2
  .amdhsa_user_sgpr_kernarg_segment_ptr 1
  .amdhsa_system_sgpr_workgroup_id_x 1
.end_amdhsa_kernel
.p2align 6
.amdhsa_kernel k4_kernel
  .amdhsa_next_free_vgpr 512
  .amdhsa_next_free_sgpr 60
  .amdhsa_accum_offset 256
  .amdhsa_group_segment_fixed_size 0
  .amdhsa_kernarg_size 104
  .amdhsa_user_sgpr_count 2
  .amdhsa_user_sgpr_kernarg_segment_ptr 1
  .amdhsa_system_sgpr_workgroup_id_x 1
.end_amdhsa_kernel
.p2align 6
.amdhsa_kernel mega_kernel
  .amdhsa_next_free_vgpr 512
  .amdhsa_next_free_sgpr 100
  .amdhsa_accum_offset 256
  .amdhsa_group_segment_fixed_size 0
  .amdhsa_kernarg_size 104
  .amdhsa_user_sgpr_count 2
  .amdhsa_user_sgpr_kernarg_segment_ptr 1
  .amdhsa_system_sgpr_workgroup_id_x 1
.end_amdhsa_kernel
```
